```python
import torch

def _softmax(x, axis=-1):
    return torch.softmax(x, dim=axis)
def _gelu(x):
    return torch.nn.functional.gelu(x, approximate="tanh")
def _silu(x):
    return torch.nn.functional.silu(x)
def _sigmoid(x):
    return torch.sigmoid(x)
def _layernorm(x, axis=-1, eps=1e-5):
    m = x.mean(dim=axis, keepdim=True)
    v = x.var(dim=axis, keepdim=True, unbiased=False)
    return (x - m) / torch.sqrt(v + eps)
def _scatter_add(tgt, idx, src, axis=0):
    return tgt.clone().index_add_(axis, idx, src)
def _segment_sum(src, seg, n):
    out = torch.zeros((n,) + src.shape[1:], dtype=src.dtype)
    return out.index_add_(0, seg, src)
def _pad(x, pw):
    flat = tuple(v for pair in reversed(pw) for v in pair)
    return torch.nn.functional.pad(x, flat)

kernel_name = 'concat_heads__linear_kernel_hedgehog__compressed_kv_cla__prompt'

def setup_inputs():

    _w = (lambda a: (lambda t: t.to(torch.bfloat16) if t.is_floating_point() else t)(torch.as_tensor(a)))
    def _A_setup():
        B, S, D, H = 1, 2048, 640, 32
        Dh = D // H
        return {
            "x": _w((lambda *s: torch.randn(*s, dtype=torch.bfloat16) * 0.4)(B, S, D)),
            "wqkv": _w((lambda *s: torch.randn(*s, dtype=torch.bfloat16) * 0.4)(D, 3 * D)),
            "w_phi": _w((lambda *s: torch.randn(*s, dtype=torch.bfloat16) * 0.4)(H, Dh, Dh) * (Dh ** -0.5)),
            "wo": _w((lambda *s: torch.randn(*s, dtype=torch.bfloat16) * 0.05)(D, D)),
        }
    _A_in = _A_setup()

    def _B_setup():
        B, H, Sq, Sk, D, M = 1, 32, 2048, 2048, 128, 640
        Dc = 4 * D
        return {
            "x": _w((lambda *s: torch.randn(*s, dtype=torch.bfloat16) * 0.8)(B, Sq, M)),
            "c_kv": _w((lambda *s: torch.randn(*s, dtype=torch.bfloat16) * 0.4)(B, Sk, Dc)),
            "w_q": _w((lambda *s: torch.randn(*s, dtype=torch.bfloat16) * 6.4)(M, H, D) * (M ** -0.5)),
            "w_uk": _w((lambda *s: torch.randn(*s, dtype=torch.bfloat16) * 6.4)(Dc, H, D) * (Dc ** -0.5)),
            "w_uv": _w((lambda *s: torch.randn(*s, dtype=torch.bfloat16) * 0.4)(Dc, H, D) * (Dc ** -0.5)),
            "w_o": _w((lambda *s: torch.randn(*s, dtype=torch.bfloat16) * 0.4)(H, D, M) * ((H * D) ** -0.5)),
        }
    _B_in = _B_setup()

    return {
        "A_x": _A_in["x"],
        "A_wqkv": _A_in["wqkv"],
        "A_w_phi": _A_in["w_phi"],
        "A_wo": _A_in["wo"],
        "B_x": _B_in["x"],
        "B_c_kv": _B_in["c_kv"],
        "B_w_q": _B_in["w_q"],
        "B_w_uk": _B_in["w_uk"],
        "B_w_uv": _B_in["w_uv"],
        "B_w_o": _B_in["w_o"],
    }

def reference(A_x, A_wqkv, A_w_phi, A_wo, B_x, B_c_kv, B_w_q, B_w_uk, B_w_uv, B_w_o):
    def _A_ref(x, wqkv, w_phi, wo):
        B, S, D = x.shape
        H = 32; Dh = D // H
        qkv = (lambda x, *d: x.permute(*d))((x @ wqkv).reshape(B, S, 3, H, Dh), 2, 0, 3, 1, 4)
        q, k, v = qkv[0], qkv[1], qkv[2]
        pq = torch.einsum("bhsd,hdf->bhsf", q, w_phi)
        pk = torch.einsum("bhsd,hdf->bhsf", k, w_phi)
        phi_q = torch.concatenate([_softmax(pq, axis=-1), _softmax(-pq, axis=-1)], axis=-1)
        phi_k = torch.concatenate([_softmax(pk, axis=-1), _softmax(-pk, axis=-1)], axis=-1)
        kv = torch.einsum("bhsf,bhsd->bhfd", phi_k, v)
        z  = torch.einsum("bhsf->bhf", phi_k)
        num = torch.einsum("bhqf,bhfd->bhqd", phi_q, kv)
        den = torch.einsum("bhqf,bhf->bhq", phi_q, z)[..., None] + 1e-6
        o = num / den
        return (lambda x, *d: x.permute(*d))(o, 0, 2, 1, 3).reshape(B, S, D) @ wo

    def _B_ref(x, c_kv, w_q, w_uk, w_uv, w_o):
        B, Sq, M = x.shape[0], x.shape[1], x.shape[2]
        Sk = c_kv.shape[1]
        H, D = w_q.shape[1], w_q.shape[2]
        q = torch.einsum("bqm,mhd->bhqd", x, w_q)
        k = torch.einsum("bkc,chd->bhkd", c_kv, w_uk)
        v = torch.einsum("bkc,chd->bhkd", c_kv, w_uv)
        scores = torch.einsum("bhqd,bhkd->bhqk", q, k) * (D ** -0.5)
        off = Sk - Sq
        qi = torch.arange(Sq)[:, None]
        kj = torch.arange(Sk)[None, :]
        cmask = kj <= (qi + off)
        scores = torch.where(cmask[None, None], scores, -1e9)
        p = _softmax(scores, axis=-1)
        ctx = torch.einsum("bhqk,bhkd->bhqd", p, v)
        return torch.einsum("bhqd,hdm->bqm", ctx, w_o)

    a = _A_ref(A_x, A_wqkv, A_w_phi, A_wo)
    b = _B_ref(B_x, B_c_kv, B_w_q, B_w_uk, B_w_uv, B_w_o)
    return torch.concatenate([a, b], axis=-1)
```

```asm
; @launch kernel=mega_kernel grid=(256,1,1) block=(512,1,1) lds=163840
.amdgcn_target "amdgcn-amd-amdhsa--gfx950"
.text
.globl mega_kernel
.p2align 8
.type mega_kernel,@function
mega_kernel:
    s_cmp_ge_u32 s2, 256
    s_cbranch_scc1 mg_end
    s_load_dwordx2 s[4:5], s[0:1], 40
    s_load_dwordx4 s[8:11], s[0:1], 56
    s_load_dwordx2 s[6:7], s[0:1], 96
    s_load_dwordx4 s[72:75], s[0:1], 0
    s_load_dwordx2 s[70:71], s[0:1], 72
    s_load_dwordx2 s[76:77], s[0:1], 88
    s_getpc_b64 s[56:57]
mg_pc:
    v_lshrrev_b32 v8, 6, v0
    s_lshr_b32 s13, s2, 3
    s_lshl_b32 s13, s13, 13
    v_lshl_add_u32 v2, v0, 4, s13
    v_readfirstlane_b32 s12, v8
    v_and_b32 v0, 63, v0
    s_mov_b32 s40, s56
    s_and_b32 s41, s57, 0xffff
    s_mov_b32 s42, mg_codeend-mg_pc
    s_mov_b32 s43, 0x20000
    buffer_load_dword v166, v2, s[40:43], 0 offen
    s_bfe_u32 s51, s2, 0x30003
    s_and_b32 s13, s2, 7
    s_lshl_b32 s52, s13, 1
    s_lshr_b32 s13, s2, 6
    s_lshr_b32 s13, 9, s13
    s_and_b32 s13, s13, 1
    s_add_u32 s52, s52, s13
    s_lshr_b32 s3, s2, 7
    s_lshl_b32 s13, s51, 17
    s_bfe_u32 s14, s12, 0x10001
    s_lshl_b32 s14, s14, 20
    s_add_u32 s13, s13, s14
    s_lshr_b32 s14, s12, 2
    s_lshl_b32 s14, s14, 16
    s_add_u32 s13, s13, s14
    s_and_b32 s14, s12, 1
    s_lshl_b32 s14, s14, 15
    s_add_u32 s13, s13, s14
    v_lshrrev_b32 v10, 5, v0
    v_lshrrev_b32 v8, 3, v0
    v_lshlrev_b32 v8, 10, v8
    v_add_u32 v8, s13, v8
    v_and_b32 v9, 7, v0
    v_lshrrev_b32 v11, 4, v0
    v_xor_b32 v9, v9, v11
    v_lshlrev_b32 v9, 4, v9
    v_xor_b32 v11, 64, v9
    v_add_u32 v176, v8, v9
    v_add_u32 v177, v8, v11
    v_add_u32 v177, 7168, v177
    v_add_u32 v178, v8, v9
    v_add_u32 v178, 14336, v178
    v_add_u32 v179, v8, v11
    v_add_u32 v179, 21504, v179
    s_lshl_b32 s13, s12, 16
    s_lshl_b32 s14, s52, 9
    s_add_u32 s13, s13, s14
    v_lshlrev_b32 v11, 2, v10
    v_lshlrev_b32 v8, 13, v10
    v_add_u32 v8, s13, v8
    s_and_b32 s14, s12, 1
    s_lshl_b32 s14, s14, 1
    v_and_b32 v9, 31, v0
    v_xor_b32 v9, s14, v9
    v_xor_b32 v9, v9, v11
    v_lshlrev_b32 v9, 4, v9
    v_xor_b32 v11, 128, v9
    v_add_u32 v180, v8, v9
    v_add_u32 v181, v8, v11
    v_add_u32 v181, 15360, v181
    v_add_u32 v182, v8, v9
    v_add_u32 v182, 30720, v182
    v_add_u32 v183, v8, v11
    v_add_u32 v183, 46080, v183
    s_lshl_b32 s44, s12, 12
    s_lshr_b32 s13, s2, 6
    s_add_u32 s13, s13, s51
    s_lshl_b32 s13, s13, 2
    s_add_u32 s13, s13, s2
    s_and_b32 s13, s13, 7
    s_lshl_b32 s45, s13, 7
    s_lshl_b32 s46, s13, 19
    s_cmp_eq_u32 s3, 0
    s_waitcnt lgkmcnt(0)
    s_cselect_b32 s56, s8, s10
    s_cselect_b32 s57, s9, s11
    s_mov_b32 s24, s4
    s_and_b32 s25, s5, 0xffff
    s_mov_b32 s26, 2097152
    s_mov_b32 s27, 0x20000
    s_mov_b32 s28, s56
    s_and_b32 s29, s57, 0xffff
    s_mov_b32 s30, 4194304
    s_mov_b32 s31, 0x20000
    s_add_u32 m0, s44, 0
    s_nop 0
    buffer_load_dwordx4 v176, s[24:27], s45 offen offset:0 lds
    buffer_load_dwordx4 v177, s[24:27], s45 offen offset:1024 lds
    buffer_load_dwordx4 v178, s[24:27], s45 offen offset:2048 lds
    buffer_load_dwordx4 v179, s[24:27], s45 offen offset:3072 lds
    s_add_u32 s45, s45, 128
    s_and_b32 s45, s45, 1023
    s_add_u32 m0, s44, 32768
    s_nop 0
    buffer_load_dwordx4 v180, s[28:31], s46 offen offset:0 lds
    buffer_load_dwordx4 v181, s[28:31], s46 offen offset:1024 lds
    buffer_load_dwordx4 v182, s[28:31], s46 offen offset:2048 lds
    buffer_load_dwordx4 v183, s[28:31], s46 offen offset:3072 lds
    s_add_u32 s46, s46, 524288
    s_and_b32 s46, s46, 0x3fffff
    s_mov_b32 s16, s6
    s_and_b32 s17, s7, 0xffff
    s_mov_b32 s18, 268435456
    s_mov_b32 s19, 0x20000
    s_mov_b32 s20, s76
    s_and_b32 s21, s77, 0xffff
    s_mov_b32 s22, 256
    s_mov_b32 s23, 0x20000
    s_mov_b32 s32, s72
    s_and_b32 s33, s73, 0xffff
    s_mov_b32 s34, 2621440
    s_mov_b32 s35, 0x20000
    s_mov_b32 s36, s74
    s_and_b32 s37, s75, 0xffff
    s_mov_b32 s38, 2457600
    s_mov_b32 s39, 0x20000
    s_load_dwordx4 s[8:11], s[0:1], 16
    s_load_dwordx2 s[4:5], s[0:1], 32
    s_load_dwordx2 s[72:73], s[0:1], 48
    s_and_b32 s60, s12, 1
    s_lshr_b32 s61, s12, 1
    s_lshr_b32 s15, s12, 2
    v_lshlrev_b32 v1, 4, v0
    v_add_u32 v3, 262144, v1
    s_lshl_b32 s13, s60, 14
    v_and_b32 v8, 15, v0
    v_lshlrev_b32 v8, 7, v8
    v_add_u32 v8, s13, v8
    v_bfe_u32 v9, v0, 1, 3
    v_lshrrev_b32 v13, 4, v0
    v_xor_b32 v9, v9, v13
    v_lshl_add_u32 v184, v9, 4, v8
    v_xor_b32 v185, 64, v184
    v_bfe_u32 v8, v0, 2, 2
    v_lshl_add_u32 v9, v13, 3, v8
    v_lshlrev_b32 v9, 9, v9
    v_and_b32 v11, 1, v0
    v_lshl_add_u32 v9, v11, 3, v9
    v_add_u32 v9, 32768, v9
    v_bfe_u32 v11, v0, 4, 1
    v_bfe_u32 v12, v0, 1, 1
    v_lshl_add_u32 v11, v11, 1, v12
    s_lshl_b32 s13, s61, 3
    v_add_u32 v11, s13, v11
    v_lshlrev_b32 v8, 2, v8
    v_xor_b32 v11, v11, v8
    v_lshl_add_u32 v186, v11, 4, v9
    v_xor_b32 v187, 32, v186
    v_xor_b32 v188, 64, v186
    v_xor_b32 v189, 96, v186
    s_lshr_b32 s13, s61, 1
    s_lshl_b32 s74, s52, 1
    s_add_u32 s74, s74, s13
    s_lshl_b32 s74, s74, 19
    s_lshl_b32 s13, s51, 1
    s_add_u32 s13, s13, s60
    s_lshl_b32 s13, s13, 14
    s_add_u32 s74, s74, s13
    s_lshl_b32 s13, s3, 24
    s_add_u32 s74, s74, s13
    s_and_b32 s13, s61, 1
    s_add_u32 s14, s3, 11
    s_lshl_b32 s13, s13, s14
    s_add_u32 s74, s74, s13
    s_lshr_b32 s14, 4096, s3
    s_add_u32 s75, s74, s14
    s_add_u32 s76, s74, 8192
    s_add_u32 s77, s75, 8192
    s_and_b32 s13, s2, 3
    s_lshl_b32 s13, s13, 2
    s_bfe_u32 s14, s2, 0x20003
    s_add_u32 s62, s13, s14
    s_bfe_u32 s13, s2, 0x10002
    s_lshl_b32 s13, s13, 3
    s_lshr_b32 s14, s2, 5
    s_add_u32 s63, s13, s14
    v_mul_u32_u24 v167, 20, v0
    s_add_u32 m0, s44, 65536
    s_nop 0
    buffer_load_dwordx4 v176, s[24:27], s45 offen offset:0 lds
    buffer_load_dwordx4 v177, s[24:27], s45 offen offset:1024 lds
    buffer_load_dwordx4 v178, s[24:27], s45 offen offset:2048 lds
    buffer_load_dwordx4 v179, s[24:27], s45 offen offset:3072 lds
    s_add_u32 s45, s45, 128
    s_and_b32 s45, s45, 1023
    s_add_u32 m0, s44, 98304
    s_nop 0
    buffer_load_dwordx4 v180, s[28:31], s46 offen offset:0 lds
    buffer_load_dwordx4 v181, s[28:31], s46 offen offset:1024 lds
    buffer_load_dwordx4 v182, s[28:31], s46 offen offset:2048 lds
    buffer_load_dwordx4 v183, s[28:31], s46 offen offset:3072 lds
    s_add_u32 s46, s46, 524288
    s_and_b32 s46, s46, 0x3fffff
    s_mov_b32 s56, 0x11001100
    s_mov_b32 s57, 0x22222120
    s_mov_b32 s58, 0x32321010
    s_mov_b32 s59, 0x43204414
    v_lshrrev_b32 v11, 4, v0
    v_lshlrev_b32 v8, 2, v11
    v_sub_u32 v8, v0, v8
    v_and_b32 v8, 15, v8
    v_lshlrev_b32 v9, 2, v8
    v_lshrrev_b64 v[12:13], v9, s[56:57]
    v_lshrrev_b64 v[14:15], v9, s[58:59]
    v_and_b32 v12, 15, v12
    v_and_b32 v14, 15, v14
    v_mul_u32_u24 v12, 1280, v12
    v_lshl_add_u32 v12, v14, 4, v12
    v_mul_u32_u24 v8, 3840, v11
    s_mul_i32 s64, s62, 10
    s_add_u32 s64, s64, s12
    s_mul_i32 s13, s64, 15360
    s_mul_i32 s14, s63, 80
    s_add_u32 s13, s13, s14
    v_add3_u32 v242, v8, v12, s13
    s_mov_b32 s14, 2147418112
    s_cmp_lt_u32 s12, 2
    s_cselect_b32 s13, 122880, s14
    buffer_load_dwordx4 v[144:147], v242, s[36:39], 0 offen nt
    buffer_load_dwordx4 v[148:151], v242, s[36:39], s13 offen nt
    s_waitcnt vmcnt(10)
    s_barrier
    ds_read_b64_tr_b16 v[204:205], v189 offset:0
    ds_read_b64_tr_b16 v[206:207], v189 offset:2048
    ds_read_b128 v[216:219], v184 offset:0
    ds_read_b64_tr_b16 v[200:201], v188 offset:0
    ds_read_b64_tr_b16 v[202:203], v188 offset:2048
    ds_read_b64_tr_b16 v[196:197], v187 offset:0
    ds_read_b64_tr_b16 v[198:199], v187 offset:2048
    ds_read_b64_tr_b16 v[192:193], v186 offset:0
    ds_read_b64_tr_b16 v[194:195], v186 offset:2048
    ds_read_b128 v[220:223], v184 offset:2048
    ds_read_b128 v[252:255], v184 offset:4096
    ds_read_b128 v[208:211], v184 offset:6144
    ds_read_b128 v[212:215], v184 offset:8192
    s_lshl_b32 s13, s3, 1
    s_or_b32 s13, s13, s15
    s_cbranch_scc0 mg_gk_r0
    s_cmp_eq_u32 s13, 2
    s_cbranch_scc1 mg_gv_r0
    s_and_b32 s44, s44, 16383
    s_cmp_eq_u32 s13, 3
    s_cbranch_scc1 mg_gv_r1
mg_gk_r1:
    s_waitcnt lgkmcnt(4)
    v_mfma_f32_16x16x32_bf16 v[28:31], v[204:207], v[216:219], 0
    ds_read_b64_tr_b16 v[236:237], v189 offset:16384
    v_mfma_f32_16x16x32_bf16 v[24:27], v[200:203], v[216:219], 0
    ds_read_b64_tr_b16 v[238:239], v189 offset:18432
    v_mfma_f32_16x16x32_bf16 v[20:23], v[196:199], v[216:219], 0
    ds_read_b64_tr_b16 v[232:233], v188 offset:16384
    v_mfma_f32_16x16x32_bf16 v[16:19], v[192:195], v[216:219], 0
    ds_read_b128 v[216:219], v184 offset:10240
    s_waitcnt lgkmcnt(7)
    v_mfma_f32_16x16x32_bf16 v[32:35], v[192:195], v[220:223], 0
    ds_read_b64_tr_b16 v[234:235], v188 offset:18432
    v_mfma_f32_16x16x32_bf16 v[36:39], v[196:199], v[220:223], 0
    ds_read_b64_tr_b16 v[228:229], v187 offset:16384
    v_mfma_f32_16x16x32_bf16 v[40:43], v[200:203], v[220:223], 0
    ds_read_b64_tr_b16 v[230:231], v187 offset:18432
    v_mfma_f32_16x16x32_bf16 v[44:47], v[204:207], v[220:223], 0
    ds_read_b128 v[220:223], v184 offset:12288
    s_waitcnt lgkmcnt(10)
    v_mfma_f32_16x16x32_bf16 v[60:63], v[204:207], v[252:255], 0
    ds_read_b64_tr_b16 v[224:225], v186 offset:16384
    v_mfma_f32_16x16x32_bf16 v[56:59], v[200:203], v[252:255], 0
    ds_read_b64_tr_b16 v[226:227], v186 offset:18432
    v_mfma_f32_16x16x32_bf16 v[52:55], v[196:199], v[252:255], 0
    v_mfma_f32_16x16x32_bf16 v[48:51], v[192:195], v[252:255], 0
    ds_read_b128 v[252:255], v184 offset:14336
    s_waitcnt lgkmcnt(12)
    v_mfma_f32_16x16x32_bf16 v[64:67], v[192:195], v[208:211], 0
    v_mfma_f32_16x16x32_bf16 v[68:71], v[196:199], v[208:211], 0
    v_mfma_f32_16x16x32_bf16 v[72:75], v[200:203], v[208:211], 0
    v_mfma_f32_16x16x32_bf16 v[76:79], v[204:207], v[208:211], 0
    ds_read_b128 v[208:211], v185 offset:0
    s_waitcnt lgkmcnt(12)
    v_mfma_f32_16x16x32_bf16 v[92:95], v[204:207], v[212:215], 0
    v_mfma_f32_16x16x32_bf16 v[88:91], v[200:203], v[212:215], 0
    v_mfma_f32_16x16x32_bf16 v[84:87], v[196:199], v[212:215], 0
    v_mfma_f32_16x16x32_bf16 v[80:83], v[192:195], v[212:215], 0
    ds_read_b128 v[212:215], v185 offset:2048
    s_waitcnt lgkmcnt(9)
    v_mfma_f32_16x16x32_bf16 v[96:99], v[192:195], v[216:219], 0
    v_mfma_f32_16x16x32_bf16 v[100:103], v[196:199], v[216:219], 0
    v_mfma_f32_16x16x32_bf16 v[104:107], v[200:203], v[216:219], 0
    v_mfma_f32_16x16x32_bf16 v[108:111], v[204:207], v[216:219], 0
    ds_read_b128 v[216:219], v185 offset:4096
    s_waitcnt lgkmcnt(6)
    v_mfma_f32_16x16x32_bf16 v[124:127], v[204:207], v[220:223], 0
    s_mul_i32 s13, s63, 1600
    s_add_u32 s40, s8, s13
    s_addc_u32 s41, s9, 0
    s_and_b32 s41, s41, 0xffff
    s_mov_b32 s42, 1600
    s_mov_b32 s43, 0x20000
    v_mfma_f32_16x16x32_bf16 v[120:123], v[200:203], v[220:223], 0
    s_lshl_b32 s13, s12, 10
    s_min_u32 s14, s13, 2048
    v_mfma_f32_16x16x32_bf16 v[116:119], v[196:199], v[220:223], 0
    s_add_u32 m0, s14, 159744
    s_nop 0
    v_mfma_f32_16x16x32_bf16 v[112:115], v[192:195], v[220:223], 0
    ds_read_b128 v[220:223], v185 offset:6144
    s_waitcnt lgkmcnt(4)
    v_mfma_f32_16x16x32_bf16 v[128:131], v[192:195], v[252:255], 0
    buffer_load_dwordx4 v1, s[40:43], s13 offen lds
    v_mfma_f32_16x16x32_bf16 v[132:135], v[196:199], v[252:255], 0
    v_mfma_f32_16x16x32_bf16 v[136:139], v[200:203], v[252:255], 0
    v_mfma_f32_16x16x32_bf16 v[140:143], v[204:207], v[252:255], 0
    ds_read_b128 v[252:255], v185 offset:8192
    s_waitcnt lgkmcnt(4)
    v_mfma_f32_16x16x32_bf16 v[28:31], v[236:239], v[208:211], v[28:31]
    v_mfma_f32_16x16x32_bf16 v[24:27], v[232:235], v[208:211], v[24:27]
    v_mfma_f32_16x16x32_bf16 v[20:23], v[228:231], v[208:211], v[20:23]
    v_mfma_f32_16x16x32_bf16 v[16:19], v[224:227], v[208:211], v[16:19]
    ds_read_b128 v[208:211], v185 offset:10240
    s_waitcnt lgkmcnt(4)
    v_mfma_f32_16x16x32_bf16 v[32:35], v[224:227], v[212:215], v[32:35]
    v_mfma_f32_16x16x32_bf16 v[36:39], v[228:231], v[212:215], v[36:39]
    v_mfma_f32_16x16x32_bf16 v[40:43], v[232:235], v[212:215], v[40:43]
    v_mfma_f32_16x16x32_bf16 v[44:47], v[236:239], v[212:215], v[44:47]
    ds_read_b128 v[212:215], v185 offset:12288
    s_waitcnt lgkmcnt(4)
    v_mfma_f32_16x16x32_bf16 v[60:63], v[236:239], v[216:219], v[60:63]
    s_lshl_b32 s13, s62, 3
    s_and_b32 s14, s12, 3
    s_add_u32 s13, s13, s14
    s_mul_i32 s13, s13, 20480
    v_lshrrev_b32 v8, 3, v0
    v_mul_u32_u24 v8, 1280, v8
    v_and_b32 v9, 7, v0
    v_lshrrev_b32 v11, 4, v0
    v_mfma_f32_16x16x32_bf16 v[56:59], v[232:235], v[216:219], v[56:59]
    v_xor_b32 v9, v9, v11
    v_lshlrev_b32 v9, 4, v9
    v_add3_u32 v240, v8, v9, s13
    v_xor_b32 v9, 64, v9
    s_add_u32 s13, s13, 9216
    v_add3_u32 v241, v8, v9, s13
    s_mul_i32 s55, s63, 163840
    s_lshl_b32 s13, s14, 11
    v_mfma_f32_16x16x32_bf16 v[52:55], v[228:231], v[216:219], v[52:55]
    s_add_u32 s55, s55, s13
    s_add_u32 s55, s55, 79691776
    v_add_u32 v243, s55, v1
    s_bfe_u32 s13, s2, 0x20003
    s_mul_i32 s13, s13, 5
    s_lshr_b32 s13, s13, 1
    s_lshr_b32 s54, s2, 5
    s_add_u32 s54, s54, s13
    v_mfma_f32_16x16x32_bf16 v[48:51], v[224:227], v[216:219], v[48:51]
    ds_read_b128 v[216:219], v185 offset:14336
    s_waitcnt lgkmcnt(4)
    v_mfma_f32_16x16x32_bf16 v[64:67], v[224:227], v[220:223], v[64:67]
    s_sub_u32 s13, s54, 10
    s_cselect_b32 s54, s54, s13
    s_lshl_b32 s54, s54, 7
    s_lshl_b32 s55, s54, 7
    s_lshl_b32 s64, s64, 10
    s_mul_i32 s13, s63, 163840
    s_add_u32 s64, s64, s13
    s_add_u32 s64, s64, 79691776
    s_add_u32 s65, s64, 8192
    v_mfma_f32_16x16x32_bf16 v[68:71], v[228:231], v[220:223], v[68:71]
    s_cmp_lt_u32 s12, 2
    s_cselect_b32 s65, s65, 2147418112
    s_lshl_b32 s13, s63, 4
    s_add_u32 s13, s13, s62
    s_lshl_b32 s13, s13, 2
    s_add_u32 s13, s13, s12
    s_lshl_b32 s13, s13, 10
    s_add_u32 s13, s13, 58716160
    s_sub_u32 s66, 0, s15
    v_mfma_f32_16x16x32_bf16 v[72:75], v[232:235], v[220:223], v[72:75]
    s_cmp_eq_u32 s15, 0
    s_cselect_b32 s65, s65, s13
    s_lshl_b32 s67, s63, 2
    v_mov_b32 v5, 0x10000
    v_mfma_f32_16x16x32_bf16 v[76:79], v[236:239], v[220:223], v[76:79]
    s_waitcnt vmcnt(3)
    s_waitcnt lgkmcnt(0)
    v_xor_b32 v184, 65536, v184
    v_xor_b32 v185, 65536, v185
    v_xor_b32 v186, 0x10000, v186
    v_xor_b32 v187, 0x10000, v187
    v_xor_b32 v188, 0x10000, v188
    v_xor_b32 v189, 0x10000, v189
    s_barrier
    v_mfma_f32_16x16x32_bf16 v[92:95], v[236:239], v[252:255], v[92:95]
    ds_read_b64_tr_b16 v[204:205], v189 offset:0
    ds_read_b64_tr_b16 v[206:207], v189 offset:2048
    v_mfma_f32_16x16x32_bf16 v[88:91], v[232:235], v[252:255], v[88:91]
    ds_read_b128 v[220:223], v184 offset:0
    ds_read_b64_tr_b16 v[200:201], v188 offset:0
    v_mfma_f32_16x16x32_bf16 v[84:87], v[228:231], v[252:255], v[84:87]
    ds_read_b64_tr_b16 v[202:203], v188 offset:2048
    ds_read_b64_tr_b16 v[196:197], v187 offset:0
    v_mfma_f32_16x16x32_bf16 v[80:83], v[224:227], v[252:255], v[80:83]
    ds_read_b64_tr_b16 v[198:199], v187 offset:2048
    ds_read_b128 v[252:255], v184 offset:2048
    v_mfma_f32_16x16x32_bf16 v[96:99], v[224:227], v[208:211], v[96:99]
    ds_read_b64_tr_b16 v[192:193], v186 offset:0
    ds_read_b64_tr_b16 v[194:195], v186 offset:2048
    v_mfma_f32_16x16x32_bf16 v[100:103], v[228:231], v[208:211], v[100:103]
    v_mfma_f32_16x16x32_bf16 v[104:107], v[232:235], v[208:211], v[104:107]
    v_mfma_f32_16x16x32_bf16 v[108:111], v[236:239], v[208:211], v[108:111]
    ds_read_b128 v[208:211], v184 offset:4096
    v_mfma_f32_16x16x32_bf16 v[124:127], v[236:239], v[212:215], v[124:127]
    v_mfma_f32_16x16x32_bf16 v[120:123], v[232:235], v[212:215], v[120:123]
    v_mfma_f32_16x16x32_bf16 v[116:119], v[228:231], v[212:215], v[116:119]
    v_mfma_f32_16x16x32_bf16 v[112:115], v[224:227], v[212:215], v[112:115]
    ds_read_b128 v[212:215], v184 offset:6144
    v_mfma_f32_16x16x32_bf16 v[128:131], v[224:227], v[216:219], v[128:131]
    v_mfma_f32_16x16x32_bf16 v[132:135], v[228:231], v[216:219], v[132:135]
    v_mfma_f32_16x16x32_bf16 v[136:139], v[232:235], v[216:219], v[136:139]
    v_mfma_f32_16x16x32_bf16 v[140:143], v[236:239], v[216:219], v[140:143]
    ds_read_b128 v[216:219], v184 offset:8192
    s_waitcnt lgkmcnt(3)
    v_mfma_f32_16x16x32_bf16 v[28:31], v[204:207], v[220:223], v[28:31]
    ds_read_b64_tr_b16 v[236:237], v189 offset:16384
    v_mfma_f32_16x16x32_bf16 v[24:27], v[200:203], v[220:223], v[24:27]
    ds_read_b64_tr_b16 v[238:239], v189 offset:18432
    v_mfma_f32_16x16x32_bf16 v[20:23], v[196:199], v[220:223], v[20:23]
    ds_read_b64_tr_b16 v[232:233], v188 offset:16384
    v_mfma_f32_16x16x32_bf16 v[16:19], v[192:195], v[220:223], v[16:19]
    ds_read_b128 v[220:223], v184 offset:10240
    v_mfma_f32_16x16x32_bf16 v[32:35], v[192:195], v[252:255], v[32:35]
    ds_read_b64_tr_b16 v[234:235], v188 offset:18432
    v_mfma_f32_16x16x32_bf16 v[36:39], v[196:199], v[252:255], v[36:39]
    ds_read_b64_tr_b16 v[228:229], v187 offset:16384
    v_mfma_f32_16x16x32_bf16 v[40:43], v[200:203], v[252:255], v[40:43]
    ds_read_b64_tr_b16 v[230:231], v187 offset:18432
    v_mfma_f32_16x16x32_bf16 v[44:47], v[204:207], v[252:255], v[44:47]
    ds_read_b128 v[252:255], v184 offset:12288
    s_waitcnt lgkmcnt(10)
    v_mfma_f32_16x16x32_bf16 v[60:63], v[204:207], v[208:211], v[60:63]
    ds_read_b64_tr_b16 v[224:225], v186 offset:16384
    s_waitcnt vmcnt(1)
    v_mfma_f32_16x16x32_bf16 v[56:59], v[200:203], v[208:211], v[56:59]
    ds_read_b64_tr_b16 v[226:227], v186 offset:18432
    buffer_store_dwordx4 v[144:147], v1, s[16:19], s64 offen sc1
    v_mfma_f32_16x16x32_bf16 v[52:55], v[196:199], v[208:211], v[52:55]
    v_or_b32 v148, s66, v148
    v_mfma_f32_16x16x32_bf16 v[48:51], v[192:195], v[208:211], v[48:51]
    ds_read_b128 v[208:211], v184 offset:14336
    s_waitcnt lgkmcnt(12)
    v_mfma_f32_16x16x32_bf16 v[64:67], v[192:195], v[212:215], v[64:67]
    v_or_b32 v149, s66, v149
    v_mfma_f32_16x16x32_bf16 v[68:71], v[196:199], v[212:215], v[68:71]
    v_or_b32 v150, s66, v150
    v_mfma_f32_16x16x32_bf16 v[72:75], v[200:203], v[212:215], v[72:75]
    v_or_b32 v151, s66, v151
    v_mfma_f32_16x16x32_bf16 v[76:79], v[204:207], v[212:215], v[76:79]
    ds_read_b128 v[212:215], v185 offset:0
    s_waitcnt lgkmcnt(12)
    v_mfma_f32_16x16x32_bf16 v[92:95], v[204:207], v[216:219], v[92:95]
    v_mfma_f32_16x16x32_bf16 v[88:91], v[200:203], v[216:219], v[88:91]
    v_mfma_f32_16x16x32_bf16 v[84:87], v[196:199], v[216:219], v[84:87]
    v_mfma_f32_16x16x32_bf16 v[80:83], v[192:195], v[216:219], v[80:83]
    ds_read_b128 v[216:219], v185 offset:2048
    s_waitcnt lgkmcnt(9)
    v_mfma_f32_16x16x32_bf16 v[96:99], v[192:195], v[220:223], v[96:99]
    v_mfma_f32_16x16x32_bf16 v[100:103], v[196:199], v[220:223], v[100:103]
    v_mfma_f32_16x16x32_bf16 v[104:107], v[200:203], v[220:223], v[104:107]
    v_mfma_f32_16x16x32_bf16 v[108:111], v[204:207], v[220:223], v[108:111]
    ds_read_b128 v[220:223], v185 offset:4096
    s_waitcnt lgkmcnt(6)
    v_mfma_f32_16x16x32_bf16 v[124:127], v[204:207], v[252:255], v[124:127]
    buffer_store_dwordx4 v[148:151], v1, s[16:19], s65 offen sc1
    v_mfma_f32_16x16x32_bf16 v[120:123], v[200:203], v[252:255], v[120:123]
    v_mfma_f32_16x16x32_bf16 v[116:119], v[196:199], v[252:255], v[116:119]
    v_mfma_f32_16x16x32_bf16 v[112:115], v[192:195], v[252:255], v[112:115]
    ds_read_b128 v[252:255], v185 offset:6144
    s_waitcnt lgkmcnt(4)
    v_mfma_f32_16x16x32_bf16 v[128:131], v[192:195], v[208:211], v[128:131]
    v_mfma_f32_16x16x32_bf16 v[132:135], v[196:199], v[208:211], v[132:135]
    v_mfma_f32_16x16x32_bf16 v[136:139], v[200:203], v[208:211], v[136:139]
    v_mfma_f32_16x16x32_bf16 v[140:143], v[204:207], v[208:211], v[140:143]
    ds_read_b128 v[208:211], v185 offset:8192
    s_waitcnt lgkmcnt(4)
    v_mfma_f32_16x16x32_bf16 v[28:31], v[236:239], v[212:215], v[28:31]
    v_mfma_f32_16x16x32_bf16 v[24:27], v[232:235], v[212:215], v[24:27]
    v_mfma_f32_16x16x32_bf16 v[20:23], v[228:231], v[212:215], v[20:23]
    v_mfma_f32_16x16x32_bf16 v[16:19], v[224:227], v[212:215], v[16:19]
    ds_read_b128 v[212:215], v185 offset:10240
    s_waitcnt lgkmcnt(4)
    v_mfma_f32_16x16x32_bf16 v[32:35], v[224:227], v[216:219], v[32:35]
    v_mfma_f32_16x16x32_bf16 v[36:39], v[228:231], v[216:219], v[36:39]
    v_mfma_f32_16x16x32_bf16 v[40:43], v[232:235], v[216:219], v[40:43]
    v_mfma_f32_16x16x32_bf16 v[44:47], v[236:239], v[216:219], v[44:47]
    ds_read_b128 v[216:219], v185 offset:12288
    s_waitcnt lgkmcnt(4)
    v_mfma_f32_16x16x32_bf16 v[60:63], v[236:239], v[220:223], v[60:63]
    v_mfma_f32_16x16x32_bf16 v[56:59], v[232:235], v[220:223], v[56:59]
    v_mfma_f32_16x16x32_bf16 v[52:55], v[228:231], v[220:223], v[52:55]
    v_mfma_f32_16x16x32_bf16 v[48:51], v[224:227], v[220:223], v[48:51]
    ds_read_b128 v[220:223], v185 offset:14336
    s_waitcnt lgkmcnt(4)
    v_mfma_f32_16x16x32_bf16 v[64:67], v[224:227], v[252:255], v[64:67]
    v_mfma_f32_16x16x32_bf16 v[68:71], v[228:231], v[252:255], v[68:71]
    v_mfma_f32_16x16x32_bf16 v[72:75], v[232:235], v[252:255], v[72:75]
    v_mfma_f32_16x16x32_bf16 v[76:79], v[236:239], v[252:255], v[76:79]
    s_waitcnt lgkmcnt(0)
    v_xor_b32 v184, 65536, v184
    v_xor_b32 v185, 65536, v185
    v_xor_b32 v186, 0x10000, v186
    v_xor_b32 v187, 0x10000, v187
    v_xor_b32 v188, 0x10000, v188
    v_xor_b32 v189, 0x10000, v189
    s_barrier
    v_mfma_f32_16x16x32_bf16 v[92:95], v[236:239], v[208:211], v[92:95]
    ds_read_b64_tr_b16 v[204:205], v189 offset:0
    ds_read_b64_tr_b16 v[206:207], v189 offset:2048
    v_mfma_f32_16x16x32_bf16 v[88:91], v[232:235], v[208:211], v[88:91]
    ds_read_b128 v[252:255], v184 offset:0
    ds_read_b64_tr_b16 v[200:201], v188 offset:0
    v_mfma_f32_16x16x32_bf16 v[84:87], v[228:231], v[208:211], v[84:87]
    ds_read_b64_tr_b16 v[202:203], v188 offset:2048
    ds_read_b64_tr_b16 v[196:197], v187 offset:0
    v_mfma_f32_16x16x32_bf16 v[80:83], v[224:227], v[208:211], v[80:83]
    ds_read_b64_tr_b16 v[198:199], v187 offset:2048
    ds_read_b128 v[208:211], v184 offset:2048
    v_mfma_f32_16x16x32_bf16 v[96:99], v[224:227], v[212:215], v[96:99]
    ds_read_b64_tr_b16 v[192:193], v186 offset:0
    ds_read_b64_tr_b16 v[194:195], v186 offset:2048
    v_mfma_f32_16x16x32_bf16 v[100:103], v[228:231], v[212:215], v[100:103]
    v_mfma_f32_16x16x32_bf16 v[104:107], v[232:235], v[212:215], v[104:107]
    v_mfma_f32_16x16x32_bf16 v[108:111], v[236:239], v[212:215], v[108:111]
    ds_read_b128 v[212:215], v184 offset:4096
    v_mfma_f32_16x16x32_bf16 v[124:127], v[236:239], v[216:219], v[124:127]
    v_mfma_f32_16x16x32_bf16 v[120:123], v[232:235], v[216:219], v[120:123]
    v_mfma_f32_16x16x32_bf16 v[116:119], v[228:231], v[216:219], v[116:119]
    v_mfma_f32_16x16x32_bf16 v[112:115], v[224:227], v[216:219], v[112:115]
    ds_read_b128 v[216:219], v184 offset:6144
    v_mfma_f32_16x16x32_bf16 v[128:131], v[224:227], v[220:223], v[128:131]
    v_mfma_f32_16x16x32_bf16 v[132:135], v[228:231], v[220:223], v[132:135]
    v_mfma_f32_16x16x32_bf16 v[136:139], v[232:235], v[220:223], v[136:139]
    v_mfma_f32_16x16x32_bf16 v[140:143], v[236:239], v[220:223], v[140:143]
    ds_read_b128 v[220:223], v184 offset:8192
    s_waitcnt lgkmcnt(3)
    v_mfma_f32_16x16x32_bf16 v[28:31], v[204:207], v[252:255], v[28:31]
    ds_read_b64_tr_b16 v[236:237], v189 offset:16384
    v_mfma_f32_16x16x32_bf16 v[24:27], v[200:203], v[252:255], v[24:27]
    ds_read_b64_tr_b16 v[238:239], v189 offset:18432
    v_mfma_f32_16x16x32_bf16 v[20:23], v[196:199], v[252:255], v[20:23]
    ds_read_b64_tr_b16 v[232:233], v188 offset:16384
    v_mfma_f32_16x16x32_bf16 v[16:19], v[192:195], v[252:255], v[16:19]
    ds_read_b128 v[252:255], v184 offset:10240
    v_mfma_f32_16x16x32_bf16 v[32:35], v[192:195], v[208:211], v[32:35]
    ds_read_b64_tr_b16 v[234:235], v188 offset:18432
    v_mfma_f32_16x16x32_bf16 v[36:39], v[196:199], v[208:211], v[36:39]
    ds_read_b64_tr_b16 v[228:229], v187 offset:16384
    v_mfma_f32_16x16x32_bf16 v[40:43], v[200:203], v[208:211], v[40:43]
    ds_read_b64_tr_b16 v[230:231], v187 offset:18432
    v_mfma_f32_16x16x32_bf16 v[44:47], v[204:207], v[208:211], v[44:47]
    ds_read_b128 v[208:211], v184 offset:12288
    s_waitcnt lgkmcnt(10)
    v_mfma_f32_16x16x32_bf16 v[60:63], v[204:207], v[212:215], v[60:63]
    ds_read_b64_tr_b16 v[224:225], v186 offset:16384
    s_and_b32 s13, s2, 3
    s_lshl_b32 s13, s13, 8
    v_mfma_f32_16x16x32_bf16 v[56:59], v[200:203], v[212:215], v[56:59]
    ds_read_b64_tr_b16 v[226:227], v186 offset:18432
    s_andn2_b32 s14, s2, 3
    s_add_u32 s13, s13, s14
    v_mfma_f32_16x16x32_bf16 v[52:55], v[196:199], v[212:215], v[52:55]
    s_lshl_b32 s13, s13, 1
    s_add_u32 s13, s13, s12
    v_mfma_f32_16x16x32_bf16 v[48:51], v[192:195], v[212:215], v[48:51]
    ds_read_b128 v[212:215], v184 offset:14336
    s_waitcnt lgkmcnt(12)
    v_mfma_f32_16x16x32_bf16 v[64:67], v[192:195], v[216:219], v[64:67]
    s_mul_i32 s13, s13, 1280
    buffer_load_dword v166, v167, s[32:35], s13 offen
    v_mfma_f32_16x16x32_bf16 v[68:71], v[196:199], v[216:219], v[68:71]
    v_mfma_f32_16x16x32_bf16 v[72:75], v[200:203], v[216:219], v[72:75]
    v_mfma_f32_16x16x32_bf16 v[76:79], v[204:207], v[216:219], v[76:79]
    ds_read_b128 v[216:219], v185 offset:0
    s_waitcnt lgkmcnt(12)
    v_mfma_f32_16x16x32_bf16 v[92:95], v[204:207], v[220:223], v[92:95]
    v_mfma_f32_16x16x32_bf16 v[88:91], v[200:203], v[220:223], v[88:91]
    v_mfma_f32_16x16x32_bf16 v[84:87], v[196:199], v[220:223], v[84:87]
    v_mfma_f32_16x16x32_bf16 v[80:83], v[192:195], v[220:223], v[80:83]
    ds_read_b128 v[220:223], v185 offset:2048
    s_waitcnt lgkmcnt(9)
    v_mfma_f32_16x16x32_bf16 v[96:99], v[192:195], v[252:255], v[96:99]
    v_mfma_f32_16x16x32_bf16 v[100:103], v[196:199], v[252:255], v[100:103]
    v_mfma_f32_16x16x32_bf16 v[104:107], v[200:203], v[252:255], v[104:107]
    v_mfma_f32_16x16x32_bf16 v[108:111], v[204:207], v[252:255], v[108:111]
    ds_read_b128 v[252:255], v185 offset:4096
    s_waitcnt lgkmcnt(6)
    v_mfma_f32_16x16x32_bf16 v[124:127], v[204:207], v[208:211], v[124:127]
    v_mfma_f32_16x16x32_bf16 v[120:123], v[200:203], v[208:211], v[120:123]
    v_mfma_f32_16x16x32_bf16 v[116:119], v[196:199], v[208:211], v[116:119]
    v_mfma_f32_16x16x32_bf16 v[112:115], v[192:195], v[208:211], v[112:115]
    ds_read_b128 v[208:211], v185 offset:6144
    s_waitcnt lgkmcnt(4)
    v_mfma_f32_16x16x32_bf16 v[128:131], v[192:195], v[212:215], v[128:131]
    v_mfma_f32_16x16x32_bf16 v[132:135], v[196:199], v[212:215], v[132:135]
    v_mfma_f32_16x16x32_bf16 v[136:139], v[200:203], v[212:215], v[136:139]
    v_mfma_f32_16x16x32_bf16 v[140:143], v[204:207], v[212:215], v[140:143]
    ds_read_b128 v[212:215], v185 offset:8192
    s_waitcnt lgkmcnt(4)
    v_mfma_f32_16x16x32_bf16 v[28:31], v[236:239], v[216:219], v[28:31]
    v_mfma_f32_16x16x32_bf16 v[24:27], v[232:235], v[216:219], v[24:27]
    v_mfma_f32_16x16x32_bf16 v[20:23], v[228:231], v[216:219], v[20:23]
    v_mfma_f32_16x16x32_bf16 v[16:19], v[224:227], v[216:219], v[16:19]
    ds_read_b128 v[216:219], v185 offset:10240
    s_waitcnt lgkmcnt(4)
    v_mfma_f32_16x16x32_bf16 v[32:35], v[224:227], v[220:223], v[32:35]
    v_mfma_f32_16x16x32_bf16 v[36:39], v[228:231], v[220:223], v[36:39]
    v_mfma_f32_16x16x32_bf16 v[40:43], v[232:235], v[220:223], v[40:43]
    v_mfma_f32_16x16x32_bf16 v[44:47], v[236:239], v[220:223], v[44:47]
    ds_read_b128 v[220:223], v185 offset:12288
    s_waitcnt lgkmcnt(4)
    v_mfma_f32_16x16x32_bf16 v[60:63], v[236:239], v[252:255], v[60:63]
    s_and_b32 s13, s12, 3
    s_lshl_b32 s13, s13, 13
    s_add_u32 s13, s13, 2048
    v_mfma_f32_16x16x32_bf16 v[56:59], v[232:235], v[252:255], v[56:59]
    v_bfe_u32 v8, v0, 4, 1
    v_lshlrev_b32 v8, 12, v8
    v_and_b32 v9, 15, v0
    v_mfma_f32_16x16x32_bf16 v[52:55], v[228:231], v[252:255], v[52:55]
    v_lshl_add_u32 v8, v9, 7, v8
    v_add_u32 v8, s13, v8
    v_bfe_u32 v9, v0, 1, 3
    v_mfma_f32_16x16x32_bf16 v[48:51], v[224:227], v[252:255], v[48:51]
    ds_read_b128 v[252:255], v185 offset:14336
    s_waitcnt lgkmcnt(4)
    v_mfma_f32_16x16x32_bf16 v[64:67], v[224:227], v[208:211], v[64:67]
    v_xor_b32 v9, v9, v10
    v_xor_b32 v11, 0, v9
    v_lshl_add_u32 v244, v11, 4, v8
    v_mfma_f32_16x16x32_bf16 v[68:71], v[228:231], v[208:211], v[68:71]
    v_xor_b32 v11, 2, v9
    v_lshl_add_u32 v245, v11, 4, v8
    v_xor_b32 v11, 4, v9
    v_mfma_f32_16x16x32_bf16 v[72:75], v[232:235], v[208:211], v[72:75]
    v_lshl_add_u32 v246, v11, 4, v8
    v_xor_b32 v11, 6, v9
    v_lshl_add_u32 v247, v11, 4, v8
    v_mfma_f32_16x16x32_bf16 v[76:79], v[236:239], v[208:211], v[76:79]
    s_waitcnt vmcnt(1)
    s_waitcnt lgkmcnt(0)
    v_xor_b32 v184, 65536, v184
    v_xor_b32 v185, 65536, v185
    v_xor_b32 v186, 0x10000, v186
    v_xor_b32 v187, 0x10000, v187
    v_xor_b32 v188, 0x10000, v188
    v_xor_b32 v189, 0x10000, v189
    s_barrier
    v_mfma_f32_16x16x32_bf16 v[92:95], v[236:239], v[212:215], v[92:95]
    ds_read_b64_tr_b16 v[204:205], v189 offset:0
    ds_read_b64_tr_b16 v[206:207], v189 offset:2048
    v_mfma_f32_16x16x32_bf16 v[88:91], v[232:235], v[212:215], v[88:91]
    ds_read_b128 v[208:211], v184 offset:0
    ds_read_b64_tr_b16 v[200:201], v188 offset:0
    v_mfma_f32_16x16x32_bf16 v[84:87], v[228:231], v[212:215], v[84:87]
    ds_read_b64_tr_b16 v[202:203], v188 offset:2048
    ds_read_b64_tr_b16 v[196:197], v187 offset:0
    v_mfma_f32_16x16x32_bf16 v[80:83], v[224:227], v[212:215], v[80:83]
    ds_read_b64_tr_b16 v[198:199], v187 offset:2048
    ds_read_b128 v[212:215], v184 offset:2048
    v_mfma_f32_16x16x32_bf16 v[96:99], v[224:227], v[216:219], v[96:99]
    ds_read_b64_tr_b16 v[192:193], v186 offset:0
    ds_read_b64_tr_b16 v[194:195], v186 offset:2048
    v_mfma_f32_16x16x32_bf16 v[100:103], v[228:231], v[216:219], v[100:103]
    v_mfma_f32_16x16x32_bf16 v[104:107], v[232:235], v[216:219], v[104:107]
    v_mfma_f32_16x16x32_bf16 v[108:111], v[236:239], v[216:219], v[108:111]
    ds_read_b128 v[216:219], v184 offset:4096
    v_mfma_f32_16x16x32_bf16 v[124:127], v[236:239], v[220:223], v[124:127]
    v_mfma_f32_16x16x32_bf16 v[120:123], v[232:235], v[220:223], v[120:123]
    v_mfma_f32_16x16x32_bf16 v[116:119], v[228:231], v[220:223], v[116:119]
    v_mfma_f32_16x16x32_bf16 v[112:115], v[224:227], v[220:223], v[112:115]
    ds_read_b128 v[220:223], v184 offset:6144
    v_mfma_f32_16x16x32_bf16 v[128:131], v[224:227], v[252:255], v[128:131]
    v_mfma_f32_16x16x32_bf16 v[132:135], v[228:231], v[252:255], v[132:135]
    v_mfma_f32_16x16x32_bf16 v[136:139], v[232:235], v[252:255], v[136:139]
    v_mfma_f32_16x16x32_bf16 v[140:143], v[236:239], v[252:255], v[140:143]
    ds_read_b128 v[252:255], v184 offset:8192
    s_waitcnt lgkmcnt(3)
    v_mfma_f32_16x16x32_bf16 v[28:31], v[204:207], v[208:211], v[28:31]
    ds_read_b64_tr_b16 v[236:237], v189 offset:16384
    v_mfma_f32_16x16x32_bf16 v[24:27], v[200:203], v[208:211], v[24:27]
    ds_read_b64_tr_b16 v[238:239], v189 offset:18432
    v_mfma_f32_16x16x32_bf16 v[20:23], v[196:199], v[208:211], v[20:23]
    ds_read_b64_tr_b16 v[232:233], v188 offset:16384
    v_mfma_f32_16x16x32_bf16 v[16:19], v[192:195], v[208:211], v[16:19]
    ds_read_b128 v[208:211], v184 offset:10240
    v_mfma_f32_16x16x32_bf16 v[32:35], v[192:195], v[212:215], v[32:35]
    ds_read_b64_tr_b16 v[234:235], v188 offset:18432
    v_mfma_f32_16x16x32_bf16 v[36:39], v[196:199], v[212:215], v[36:39]
    ds_read_b64_tr_b16 v[228:229], v187 offset:16384
    v_mfma_f32_16x16x32_bf16 v[40:43], v[200:203], v[212:215], v[40:43]
    ds_read_b64_tr_b16 v[230:231], v187 offset:18432
    v_mfma_f32_16x16x32_bf16 v[44:47], v[204:207], v[212:215], v[44:47]
    ds_read_b128 v[212:215], v184 offset:12288
    s_waitcnt lgkmcnt(10)
    v_mfma_f32_16x16x32_bf16 v[60:63], v[204:207], v[216:219], v[60:63]
    ds_read_b64_tr_b16 v[224:225], v186 offset:16384
    v_mfma_f32_16x16x32_bf16 v[56:59], v[200:203], v[216:219], v[56:59]
    ds_read_b64_tr_b16 v[226:227], v186 offset:18432
    v_mfma_f32_16x16x32_bf16 v[52:55], v[196:199], v[216:219], v[52:55]
    v_mfma_f32_16x16x32_bf16 v[48:51], v[192:195], v[216:219], v[48:51]
    ds_read_b128 v[216:219], v184 offset:14336
    s_waitcnt lgkmcnt(12)
    v_mfma_f32_16x16x32_bf16 v[64:67], v[192:195], v[220:223], v[64:67]
    v_mfma_f32_16x16x32_bf16 v[68:71], v[196:199], v[220:223], v[68:71]
    v_mfma_f32_16x16x32_bf16 v[72:75], v[200:203], v[220:223], v[72:75]
    v_mfma_f32_16x16x32_bf16 v[76:79], v[204:207], v[220:223], v[76:79]
    ds_read_b128 v[220:223], v185 offset:0
    s_waitcnt lgkmcnt(12)
    v_mfma_f32_16x16x32_bf16 v[92:95], v[204:207], v[252:255], v[92:95]
    v_mfma_f32_16x16x32_bf16 v[88:91], v[200:203], v[252:255], v[88:91]
    v_mfma_f32_16x16x32_bf16 v[84:87], v[196:199], v[252:255], v[84:87]
    v_mfma_f32_16x16x32_bf16 v[80:83], v[192:195], v[252:255], v[80:83]
    ds_read_b128 v[252:255], v185 offset:2048
    s_waitcnt lgkmcnt(9)
    v_mfma_f32_16x16x32_bf16 v[96:99], v[192:195], v[208:211], v[96:99]
    v_mfma_f32_16x16x32_bf16 v[100:103], v[196:199], v[208:211], v[100:103]
    v_mfma_f32_16x16x32_bf16 v[104:107], v[200:203], v[208:211], v[104:107]
    v_mfma_f32_16x16x32_bf16 v[108:111], v[204:207], v[208:211], v[108:111]
    ds_read_b128 v[208:211], v185 offset:4096
    s_waitcnt lgkmcnt(6)
    v_mfma_f32_16x16x32_bf16 v[124:127], v[204:207], v[212:215], v[124:127]
    v_mfma_f32_16x16x32_bf16 v[120:123], v[200:203], v[212:215], v[120:123]
    v_mfma_f32_16x16x32_bf16 v[116:119], v[196:199], v[212:215], v[116:119]
    v_mfma_f32_16x16x32_bf16 v[112:115], v[192:195], v[212:215], v[112:115]
    ds_read_b128 v[212:215], v185 offset:6144
    s_waitcnt lgkmcnt(4)
    v_mfma_f32_16x16x32_bf16 v[128:131], v[192:195], v[216:219], v[128:131]
    v_mfma_f32_16x16x32_bf16 v[132:135], v[196:199], v[216:219], v[132:135]
    v_mfma_f32_16x16x32_bf16 v[136:139], v[200:203], v[216:219], v[136:139]
    v_mfma_f32_16x16x32_bf16 v[140:143], v[204:207], v[216:219], v[140:143]
    ds_read_b128 v[216:219], v185 offset:8192
    s_waitcnt lgkmcnt(4)
    v_mfma_f32_16x16x32_bf16 v[28:31], v[236:239], v[220:223], v[28:31]
    v_mfma_f32_16x16x32_bf16 v[24:27], v[232:235], v[220:223], v[24:27]
    v_mfma_f32_16x16x32_bf16 v[20:23], v[228:231], v[220:223], v[20:23]
    v_mfma_f32_16x16x32_bf16 v[16:19], v[224:227], v[220:223], v[16:19]
    ds_read_b128 v[220:223], v185 offset:10240
    s_waitcnt lgkmcnt(4)
    v_mfma_f32_16x16x32_bf16 v[32:35], v[224:227], v[252:255], v[32:35]
    v_mfma_f32_16x16x32_bf16 v[36:39], v[228:231], v[252:255], v[36:39]
    v_mfma_f32_16x16x32_bf16 v[40:43], v[232:235], v[252:255], v[40:43]
    v_mfma_f32_16x16x32_bf16 v[44:47], v[236:239], v[252:255], v[44:47]
    ds_read_b128 v[252:255], v185 offset:12288
    s_waitcnt lgkmcnt(4)
    v_mfma_f32_16x16x32_bf16 v[60:63], v[236:239], v[208:211], v[60:63]
    v_bfe_u32 v8, v0, 4, 1
    v_and_b32 v9, 3, v0
    v_lshl_add_u32 v8, v8, 2, v9
    v_lshlrev_b32 v8, 3, v8
    v_mfma_f32_16x16x32_bf16 v[56:59], v[232:235], v[208:211], v[56:59]
    v_bfe_u32 v9, v0, 2, 2
    v_lshlrev_b32 v11, 8, v9
    v_lshl_add_u32 v11, v10, 12, v11
    s_mov_b32 s58, 0x70506848
    v_mfma_f32_16x16x32_bf16 v[52:55], v[228:231], v[208:211], v[52:55]
    s_mov_b32 s59, 0xa0807858
    s_cmp_eq_u32 s15, 0
    s_cselect_b32 s56, 0x28082000, s58
    s_cselect_b32 s57, 0x38183010, s59
    v_lshrrev_b64 v[12:13], v8, s[56:57]
    v_lshl_add_u32 v12, v9, 6, v12
    v_mfma_f32_16x16x32_bf16 v[48:51], v[224:227], v[208:211], v[48:51]
    ds_read_b128 v[208:211], v185 offset:14336
    s_waitcnt lgkmcnt(4)
    v_mfma_f32_16x16x32_bf16 v[64:67], v[224:227], v[212:215], v[64:67]
    v_and_b32 v12, 255, v12
    v_add_u32 v248, v12, v11
    s_mov_b32 s58, 0xb0d8a888
    s_mov_b32 s59, 0xe8e8b8e0
    v_mfma_f32_16x16x32_bf16 v[68:71], v[228:231], v[212:215], v[68:71]
    s_cmp_eq_u32 s15, 0
    s_cselect_b32 s56, 0x98c06040, s58
    s_cselect_b32 s57, 0x9090d0c8, s59
    v_lshrrev_b64 v[12:13], v8, s[56:57]
    v_lshl_add_u32 v12, v9, 6, v12
    v_and_b32 v12, 255, v12
    v_mfma_f32_16x16x32_bf16 v[72:75], v[232:235], v[212:215], v[72:75]
    v_add_u32 v249, v12, v11
    v_mfma_f32_16x16x32_bf16 v[76:79], v[236:239], v[212:215], v[76:79]
    s_waitcnt lgkmcnt(0)
    v_xor_b32 v184, 65536, v184
    v_xor_b32 v185, 65536, v185
    v_xor_b32 v186, 0x10000, v186
    v_xor_b32 v187, 0x10000, v187
    v_xor_b32 v188, 0x10000, v188
    v_xor_b32 v189, 0x10000, v189
    s_barrier
    v_mfma_f32_16x16x32_bf16 v[92:95], v[236:239], v[216:219], v[92:95]
    ds_read_b64_tr_b16 v[204:205], v189 offset:0
    ds_read_b64_tr_b16 v[206:207], v189 offset:2048
    v_mfma_f32_16x16x32_bf16 v[88:91], v[232:235], v[216:219], v[88:91]
    ds_read_b128 v[212:215], v184 offset:0
    ds_read_b64_tr_b16 v[200:201], v188 offset:0
    v_mfma_f32_16x16x32_bf16 v[84:87], v[228:231], v[216:219], v[84:87]
    ds_read_b64_tr_b16 v[202:203], v188 offset:2048
    ds_read_b64_tr_b16 v[196:197], v187 offset:0
    v_mfma_f32_16x16x32_bf16 v[80:83], v[224:227], v[216:219], v[80:83]
    ds_read_b64_tr_b16 v[198:199], v187 offset:2048
    ds_read_b128 v[216:219], v184 offset:2048
    v_mfma_f32_16x16x32_bf16 v[96:99], v[224:227], v[220:223], v[96:99]
    ds_read_b64_tr_b16 v[192:193], v186 offset:0
    ds_read_b64_tr_b16 v[194:195], v186 offset:2048
    v_mfma_f32_16x16x32_bf16 v[100:103], v[228:231], v[220:223], v[100:103]
    v_mfma_f32_16x16x32_bf16 v[104:107], v[232:235], v[220:223], v[104:107]
    v_mfma_f32_16x16x32_bf16 v[108:111], v[236:239], v[220:223], v[108:111]
    ds_read_b128 v[220:223], v184 offset:4096
    v_mfma_f32_16x16x32_bf16 v[124:127], v[236:239], v[252:255], v[124:127]
    v_mfma_f32_16x16x32_bf16 v[120:123], v[232:235], v[252:255], v[120:123]
    v_mfma_f32_16x16x32_bf16 v[116:119], v[228:231], v[252:255], v[116:119]
    v_mfma_f32_16x16x32_bf16 v[112:115], v[224:227], v[252:255], v[112:115]
    ds_read_b128 v[252:255], v184 offset:6144
    v_mfma_f32_16x16x32_bf16 v[128:131], v[224:227], v[208:211], v[128:131]
    v_mfma_f32_16x16x32_bf16 v[132:135], v[228:231], v[208:211], v[132:135]
    v_mfma_f32_16x16x32_bf16 v[136:139], v[232:235], v[208:211], v[136:139]
    v_mfma_f32_16x16x32_bf16 v[140:143], v[236:239], v[208:211], v[140:143]
    ds_read_b128 v[208:211], v184 offset:8192
    s_waitcnt lgkmcnt(3)
    v_mfma_f32_16x16x32_bf16 v[28:31], v[204:207], v[212:215], v[28:31]
    ds_read_b64_tr_b16 v[236:237], v189 offset:16384
    v_mfma_f32_16x16x32_bf16 v[24:27], v[200:203], v[212:215], v[24:27]
    ds_read_b64_tr_b16 v[238:239], v189 offset:18432
    v_mfma_f32_16x16x32_bf16 v[20:23], v[196:199], v[212:215], v[20:23]
    ds_read_b64_tr_b16 v[232:233], v188 offset:16384
    v_mfma_f32_16x16x32_bf16 v[16:19], v[192:195], v[212:215], v[16:19]
    ds_read_b128 v[212:215], v184 offset:10240
    v_mfma_f32_16x16x32_bf16 v[32:35], v[192:195], v[216:219], v[32:35]
    ds_read_b64_tr_b16 v[234:235], v188 offset:18432
    v_mfma_f32_16x16x32_bf16 v[36:39], v[196:199], v[216:219], v[36:39]
    ds_read_b64_tr_b16 v[228:229], v187 offset:16384
    v_mfma_f32_16x16x32_bf16 v[40:43], v[200:203], v[216:219], v[40:43]
    ds_read_b64_tr_b16 v[230:231], v187 offset:18432
    v_mfma_f32_16x16x32_bf16 v[44:47], v[204:207], v[216:219], v[44:47]
    ds_read_b128 v[216:219], v184 offset:12288
    s_waitcnt lgkmcnt(10)
    v_mfma_f32_16x16x32_bf16 v[60:63], v[204:207], v[220:223], v[60:63]
    ds_read_b64_tr_b16 v[224:225], v186 offset:16384
    s_mov_b32 s40, s4
    s_and_b32 s41, s5, 0xffff
    s_mov_b32 s42, 2621440
    s_mov_b32 s43, 0x20000
    v_mfma_f32_16x16x32_bf16 v[56:59], v[200:203], v[220:223], v[56:59]
    ds_read_b64_tr_b16 v[226:227], v186 offset:18432
    s_lshl_b32 s13, s2, 3
    v_mfma_f32_16x16x32_bf16 v[52:55], v[196:199], v[220:223], v[52:55]
    s_add_u32 s13, s13, s12
    v_mfma_f32_16x16x32_bf16 v[48:51], v[192:195], v[220:223], v[48:51]
    ds_read_b128 v[220:223], v184 offset:14336
    s_waitcnt lgkmcnt(12)
    v_mfma_f32_16x16x32_bf16 v[64:67], v[192:195], v[252:255], v[64:67]
    s_mul_i32 s13, s13, 1280
    v_mfma_f32_16x16x32_bf16 v[68:71], v[196:199], v[252:255], v[68:71]
    buffer_load_dword v166, v167, s[40:43], s13 offen
    v_mfma_f32_16x16x32_bf16 v[72:75], v[200:203], v[252:255], v[72:75]
    v_mfma_f32_16x16x32_bf16 v[76:79], v[204:207], v[252:255], v[76:79]
    ds_read_b128 v[252:255], v185 offset:0
    s_waitcnt lgkmcnt(12)
    v_mfma_f32_16x16x32_bf16 v[92:95], v[204:207], v[208:211], v[92:95]
    v_mfma_f32_16x16x32_bf16 v[88:91], v[200:203], v[208:211], v[88:91]
    v_mfma_f32_16x16x32_bf16 v[84:87], v[196:199], v[208:211], v[84:87]
    v_mfma_f32_16x16x32_bf16 v[80:83], v[192:195], v[208:211], v[80:83]
    ds_read_b128 v[208:211], v185 offset:2048
    s_waitcnt lgkmcnt(9)
    v_mfma_f32_16x16x32_bf16 v[96:99], v[192:195], v[212:215], v[96:99]
    v_mfma_f32_16x16x32_bf16 v[100:103], v[196:199], v[212:215], v[100:103]
    v_mfma_f32_16x16x32_bf16 v[104:107], v[200:203], v[212:215], v[104:107]
    v_mfma_f32_16x16x32_bf16 v[108:111], v[204:207], v[212:215], v[108:111]
    ds_read_b128 v[212:215], v185 offset:4096
    s_waitcnt lgkmcnt(6)
    v_mfma_f32_16x16x32_bf16 v[124:127], v[204:207], v[216:219], v[124:127]
    s_mov_b32 s40, s72
    s_and_b32 s41, s73, 0xffff
    s_mov_b32 s42, 5242880
    s_mov_b32 s43, 0x20000
    s_and_b32 s13, s2, 248
    v_mfma_f32_16x16x32_bf16 v[120:123], v[200:203], v[216:219], v[120:123]
    s_add_u32 s13, s13, s12
    s_lshl_b32 s13, s13, 13
    v_mfma_f32_16x16x32_bf16 v[116:119], v[196:199], v[216:219], v[116:119]
    s_and_b32 s14, s2, 7
    s_lshl_b32 s14, s14, 10
    v_mfma_f32_16x16x32_bf16 v[112:115], v[192:195], v[216:219], v[112:115]
    ds_read_b128 v[216:219], v185 offset:6144
    s_waitcnt lgkmcnt(4)
    v_mfma_f32_16x16x32_bf16 v[128:131], v[192:195], v[220:223], v[128:131]
    s_add_u32 s13, s13, s14
    buffer_load_dword v166, v1, s[40:43], s13 offen
    v_mfma_f32_16x16x32_bf16 v[132:135], v[196:199], v[220:223], v[132:135]
    v_mfma_f32_16x16x32_bf16 v[136:139], v[200:203], v[220:223], v[136:139]
    v_mfma_f32_16x16x32_bf16 v[140:143], v[204:207], v[220:223], v[140:143]
    ds_read_b128 v[220:223], v185 offset:8192
    s_waitcnt lgkmcnt(4)
    v_mfma_f32_16x16x32_bf16 v[28:31], v[236:239], v[252:255], v[28:31]
    v_mfma_f32_16x16x32_bf16 v[24:27], v[232:235], v[252:255], v[24:27]
    v_mfma_f32_16x16x32_bf16 v[20:23], v[228:231], v[252:255], v[20:23]
    v_mfma_f32_16x16x32_bf16 v[16:19], v[224:227], v[252:255], v[16:19]
    ds_read_b128 v[252:255], v185 offset:10240
    s_waitcnt lgkmcnt(4)
    v_mfma_f32_16x16x32_bf16 v[32:35], v[224:227], v[208:211], v[32:35]
    v_mfma_f32_16x16x32_bf16 v[36:39], v[228:231], v[208:211], v[36:39]
    v_mfma_f32_16x16x32_bf16 v[40:43], v[232:235], v[208:211], v[40:43]
    v_mfma_f32_16x16x32_bf16 v[44:47], v[236:239], v[208:211], v[44:47]
    ds_read_b128 v[208:211], v185 offset:12288
    s_waitcnt lgkmcnt(4)
    v_mfma_f32_16x16x32_bf16 v[60:63], v[236:239], v[212:215], v[60:63]
    v_mfma_f32_16x16x32_bf16 v[56:59], v[232:235], v[212:215], v[56:59]
    v_mfma_f32_16x16x32_bf16 v[52:55], v[228:231], v[212:215], v[52:55]
    v_mfma_f32_16x16x32_bf16 v[48:51], v[224:227], v[212:215], v[48:51]
    ds_read_b128 v[212:215], v185 offset:14336
    s_waitcnt lgkmcnt(4)
    v_mfma_f32_16x16x32_bf16 v[64:67], v[224:227], v[216:219], v[64:67]
    v_mfma_f32_16x16x32_bf16 v[68:71], v[228:231], v[216:219], v[68:71]
    v_mfma_f32_16x16x32_bf16 v[72:75], v[232:235], v[216:219], v[72:75]
    v_mfma_f32_16x16x32_bf16 v[76:79], v[236:239], v[216:219], v[76:79]
    s_waitcnt lgkmcnt(0)
    v_xor_b32 v184, 65536, v184
    v_xor_b32 v185, 65536, v185
    v_xor_b32 v186, 0x10000, v186
    v_xor_b32 v187, 0x10000, v187
    v_xor_b32 v188, 0x10000, v188
    v_xor_b32 v189, 0x10000, v189
    s_barrier
    v_mfma_f32_16x16x32_bf16 v[92:95], v[236:239], v[220:223], v[92:95]
    ds_read_b64_tr_b16 v[204:205], v189 offset:0
    ds_read_b64_tr_b16 v[206:207], v189 offset:2048
    v_mfma_f32_16x16x32_bf16 v[88:91], v[232:235], v[220:223], v[88:91]
    ds_read_b128 v[216:219], v184 offset:0
    ds_read_b64_tr_b16 v[200:201], v188 offset:0
    v_mfma_f32_16x16x32_bf16 v[84:87], v[228:231], v[220:223], v[84:87]
    ds_read_b64_tr_b16 v[202:203], v188 offset:2048
    ds_read_b64_tr_b16 v[196:197], v187 offset:0
    v_mfma_f32_16x16x32_bf16 v[80:83], v[224:227], v[220:223], v[80:83]
    ds_read_b64_tr_b16 v[198:199], v187 offset:2048
    ds_read_b128 v[220:223], v184 offset:2048
    v_mfma_f32_16x16x32_bf16 v[96:99], v[224:227], v[252:255], v[96:99]
    ds_read_b64_tr_b16 v[192:193], v186 offset:0
    ds_read_b64_tr_b16 v[194:195], v186 offset:2048
    v_mfma_f32_16x16x32_bf16 v[100:103], v[228:231], v[252:255], v[100:103]
    v_mfma_f32_16x16x32_bf16 v[104:107], v[232:235], v[252:255], v[104:107]
    v_mfma_f32_16x16x32_bf16 v[108:111], v[236:239], v[252:255], v[108:111]
    ds_read_b128 v[252:255], v184 offset:4096
    v_mfma_f32_16x16x32_bf16 v[124:127], v[236:239], v[208:211], v[124:127]
    v_mfma_f32_16x16x32_bf16 v[120:123], v[232:235], v[208:211], v[120:123]
    v_mfma_f32_16x16x32_bf16 v[116:119], v[228:231], v[208:211], v[116:119]
    v_mfma_f32_16x16x32_bf16 v[112:115], v[224:227], v[208:211], v[112:115]
    ds_read_b128 v[208:211], v184 offset:6144
    v_mfma_f32_16x16x32_bf16 v[128:131], v[224:227], v[212:215], v[128:131]
    v_mfma_f32_16x16x32_bf16 v[132:135], v[228:231], v[212:215], v[132:135]
    v_mfma_f32_16x16x32_bf16 v[136:139], v[232:235], v[212:215], v[136:139]
    v_mfma_f32_16x16x32_bf16 v[140:143], v[236:239], v[212:215], v[140:143]
    ds_read_b128 v[212:215], v184 offset:8192
    s_waitcnt lgkmcnt(3)
    v_mfma_f32_16x16x32_bf16 v[28:31], v[204:207], v[216:219], v[28:31]
    ds_read_b64_tr_b16 v[236:237], v189 offset:16384
    v_mfma_f32_16x16x32_bf16 v[24:27], v[200:203], v[216:219], v[24:27]
    ds_read_b64_tr_b16 v[238:239], v189 offset:18432
    v_mfma_f32_16x16x32_bf16 v[20:23], v[196:199], v[216:219], v[20:23]
    ds_read_b64_tr_b16 v[232:233], v188 offset:16384
    v_mfma_f32_16x16x32_bf16 v[16:19], v[192:195], v[216:219], v[16:19]
    ds_read_b128 v[216:219], v184 offset:10240
    v_mfma_f32_16x16x32_bf16 v[32:35], v[192:195], v[220:223], v[32:35]
    ds_read_b64_tr_b16 v[234:235], v188 offset:18432
    v_mfma_f32_16x16x32_bf16 v[36:39], v[196:199], v[220:223], v[36:39]
    ds_read_b64_tr_b16 v[228:229], v187 offset:16384
    v_mfma_f32_16x16x32_bf16 v[40:43], v[200:203], v[220:223], v[40:43]
    ds_read_b64_tr_b16 v[230:231], v187 offset:18432
    v_mfma_f32_16x16x32_bf16 v[44:47], v[204:207], v[220:223], v[44:47]
    ds_read_b128 v[220:223], v184 offset:12288
    s_waitcnt lgkmcnt(10)
    v_mfma_f32_16x16x32_bf16 v[60:63], v[204:207], v[252:255], v[60:63]
    ds_read_b64_tr_b16 v[224:225], v186 offset:16384
    s_mov_b32 s40, s72
    s_and_b32 s41, s73, 0xffff
    s_mov_b32 s42, 5242880
    s_mov_b32 s43, 0x20000
    s_and_b32 s13, s2, 248
    v_mfma_f32_16x16x32_bf16 v[56:59], v[200:203], v[252:255], v[56:59]
    ds_read_b64_tr_b16 v[226:227], v186 offset:18432
    s_add_u32 s13, s13, s12
    s_lshl_b32 s13, s13, 13
    v_mfma_f32_16x16x32_bf16 v[52:55], v[196:199], v[252:255], v[52:55]
    s_and_b32 s14, s2, 7
    s_lshl_b32 s14, s14, 10
    v_mfma_f32_16x16x32_bf16 v[48:51], v[192:195], v[252:255], v[48:51]
    ds_read_b128 v[252:255], v184 offset:14336
    s_waitcnt lgkmcnt(12)
    v_mfma_f32_16x16x32_bf16 v[64:67], v[192:195], v[208:211], v[64:67]
    s_add_u32 s13, s13, s14
    s_add_u32 s13, s13, 2097152
    v_mfma_f32_16x16x32_bf16 v[68:71], v[196:199], v[208:211], v[68:71]
    buffer_load_dword v166, v1, s[40:43], s13 offen
    v_mfma_f32_16x16x32_bf16 v[72:75], v[200:203], v[208:211], v[72:75]
    v_mfma_f32_16x16x32_bf16 v[76:79], v[204:207], v[208:211], v[76:79]
    ds_read_b128 v[208:211], v185 offset:0
    s_waitcnt lgkmcnt(12)
    v_mfma_f32_16x16x32_bf16 v[92:95], v[204:207], v[212:215], v[92:95]
    v_mfma_f32_16x16x32_bf16 v[88:91], v[200:203], v[212:215], v[88:91]
    v_mfma_f32_16x16x32_bf16 v[84:87], v[196:199], v[212:215], v[84:87]
    v_mfma_f32_16x16x32_bf16 v[80:83], v[192:195], v[212:215], v[80:83]
    ds_read_b128 v[212:215], v185 offset:2048
    s_waitcnt lgkmcnt(9)
    v_mfma_f32_16x16x32_bf16 v[96:99], v[192:195], v[216:219], v[96:99]
    v_mfma_f32_16x16x32_bf16 v[100:103], v[196:199], v[216:219], v[100:103]
    v_mfma_f32_16x16x32_bf16 v[104:107], v[200:203], v[216:219], v[104:107]
    v_mfma_f32_16x16x32_bf16 v[108:111], v[204:207], v[216:219], v[108:111]
    ds_read_b128 v[216:219], v185 offset:4096
    s_waitcnt lgkmcnt(6)
    v_mfma_f32_16x16x32_bf16 v[124:127], v[204:207], v[220:223], v[124:127]
    s_mov_b32 s40, s72
    s_and_b32 s41, s73, 0xffff
    s_mov_b32 s42, 5242880
    s_mov_b32 s43, 0x20000
    s_and_b32 s13, s2, 248
    v_mfma_f32_16x16x32_bf16 v[120:123], v[200:203], v[220:223], v[120:123]
    s_add_u32 s13, s13, s12
    s_lshl_b32 s13, s13, 13
    v_mfma_f32_16x16x32_bf16 v[116:119], v[196:199], v[220:223], v[116:119]
    s_and_b32 s14, s2, 7
    s_lshl_b32 s14, s14, 10
    v_mfma_f32_16x16x32_bf16 v[112:115], v[192:195], v[220:223], v[112:115]
    ds_read_b128 v[220:223], v185 offset:6144
    s_waitcnt lgkmcnt(4)
    v_mfma_f32_16x16x32_bf16 v[128:131], v[192:195], v[252:255], v[128:131]
    s_add_u32 s13, s13, s14
    s_add_u32 s13, s13, 4194304
    v_mfma_f32_16x16x32_bf16 v[132:135], v[196:199], v[252:255], v[132:135]
    buffer_load_dword v166, v1, s[40:43], s13 offen
    v_mfma_f32_16x16x32_bf16 v[136:139], v[200:203], v[252:255], v[136:139]
    v_mfma_f32_16x16x32_bf16 v[140:143], v[204:207], v[252:255], v[140:143]
    ds_read_b128 v[252:255], v185 offset:8192
    s_waitcnt lgkmcnt(4)
    v_mfma_f32_16x16x32_bf16 v[28:31], v[236:239], v[208:211], v[28:31]
    v_mfma_f32_16x16x32_bf16 v[24:27], v[232:235], v[208:211], v[24:27]
    v_mfma_f32_16x16x32_bf16 v[20:23], v[228:231], v[208:211], v[20:23]
    v_mfma_f32_16x16x32_bf16 v[16:19], v[224:227], v[208:211], v[16:19]
    ds_read_b128 v[208:211], v185 offset:10240
    s_waitcnt lgkmcnt(4)
    v_mfma_f32_16x16x32_bf16 v[32:35], v[224:227], v[212:215], v[32:35]
    v_mfma_f32_16x16x32_bf16 v[36:39], v[228:231], v[212:215], v[36:39]
    v_mfma_f32_16x16x32_bf16 v[40:43], v[232:235], v[212:215], v[40:43]
    v_mfma_f32_16x16x32_bf16 v[44:47], v[236:239], v[212:215], v[44:47]
    ds_read_b128 v[212:215], v185 offset:12288
    s_waitcnt lgkmcnt(4)
    v_mfma_f32_16x16x32_bf16 v[60:63], v[236:239], v[216:219], v[60:63]
    v_mfma_f32_16x16x32_bf16 v[56:59], v[232:235], v[216:219], v[56:59]
    v_mfma_f32_16x16x32_bf16 v[52:55], v[228:231], v[216:219], v[52:55]
    v_mfma_f32_16x16x32_bf16 v[48:51], v[224:227], v[216:219], v[48:51]
    ds_read_b128 v[216:219], v185 offset:14336
    s_waitcnt lgkmcnt(4)
    v_mfma_f32_16x16x32_bf16 v[64:67], v[224:227], v[220:223], v[64:67]
    v_mfma_f32_16x16x32_bf16 v[68:71], v[228:231], v[220:223], v[68:71]
    v_mfma_f32_16x16x32_bf16 v[72:75], v[232:235], v[220:223], v[72:75]
    v_mfma_f32_16x16x32_bf16 v[76:79], v[236:239], v[220:223], v[76:79]
    s_waitcnt lgkmcnt(0)
    v_xor_b32 v184, 65536, v184
    v_xor_b32 v185, 65536, v185
    v_xor_b32 v186, 0x10000, v186
    v_xor_b32 v187, 0x10000, v187
    v_xor_b32 v188, 0x10000, v188
    v_xor_b32 v189, 0x10000, v189
    s_barrier
    v_mfma_f32_16x16x32_bf16 v[92:95], v[236:239], v[252:255], v[92:95]
    ds_read_b64_tr_b16 v[204:205], v189 offset:0
    ds_read_b64_tr_b16 v[206:207], v189 offset:2048
    v_mfma_f32_16x16x32_bf16 v[88:91], v[232:235], v[252:255], v[88:91]
    ds_read_b128 v[220:223], v184 offset:0
    ds_read_b64_tr_b16 v[200:201], v188 offset:0
    v_mfma_f32_16x16x32_bf16 v[84:87], v[228:231], v[252:255], v[84:87]
    ds_read_b64_tr_b16 v[202:203], v188 offset:2048
    ds_read_b64_tr_b16 v[196:197], v187 offset:0
    v_mfma_f32_16x16x32_bf16 v[80:83], v[224:227], v[252:255], v[80:83]
    ds_read_b64_tr_b16 v[198:199], v187 offset:2048
    ds_read_b128 v[252:255], v184 offset:2048
    v_mfma_f32_16x16x32_bf16 v[96:99], v[224:227], v[208:211], v[96:99]
    ds_read_b64_tr_b16 v[192:193], v186 offset:0
    ds_read_b64_tr_b16 v[194:195], v186 offset:2048
    v_mfma_f32_16x16x32_bf16 v[100:103], v[228:231], v[208:211], v[100:103]
    v_mfma_f32_16x16x32_bf16 v[104:107], v[232:235], v[208:211], v[104:107]
    v_mfma_f32_16x16x32_bf16 v[108:111], v[236:239], v[208:211], v[108:111]
    ds_read_b128 v[208:211], v184 offset:4096
    v_mfma_f32_16x16x32_bf16 v[124:127], v[236:239], v[212:215], v[124:127]
    v_mfma_f32_16x16x32_bf16 v[120:123], v[232:235], v[212:215], v[120:123]
    v_mfma_f32_16x16x32_bf16 v[116:119], v[228:231], v[212:215], v[116:119]
    v_mfma_f32_16x16x32_bf16 v[112:115], v[224:227], v[212:215], v[112:115]
    ds_read_b128 v[212:215], v184 offset:6144
    v_mfma_f32_16x16x32_bf16 v[128:131], v[224:227], v[216:219], v[128:131]
    v_mfma_f32_16x16x32_bf16 v[132:135], v[228:231], v[216:219], v[132:135]
    v_mfma_f32_16x16x32_bf16 v[136:139], v[232:235], v[216:219], v[136:139]
    v_mfma_f32_16x16x32_bf16 v[140:143], v[236:239], v[216:219], v[140:143]
    ds_read_b128 v[216:219], v184 offset:8192
    s_waitcnt lgkmcnt(3)
    v_mfma_f32_16x16x32_bf16 v[28:31], v[204:207], v[220:223], v[28:31]
    ds_read_b64_tr_b16 v[236:237], v189 offset:16384
    v_mfma_f32_16x16x32_bf16 v[24:27], v[200:203], v[220:223], v[24:27]
    ds_read_b64_tr_b16 v[238:239], v189 offset:18432
    v_mfma_f32_16x16x32_bf16 v[20:23], v[196:199], v[220:223], v[20:23]
    ds_read_b64_tr_b16 v[232:233], v188 offset:16384
    v_mfma_f32_16x16x32_bf16 v[16:19], v[192:195], v[220:223], v[16:19]
    ds_read_b128 v[220:223], v184 offset:10240
    v_mfma_f32_16x16x32_bf16 v[32:35], v[192:195], v[252:255], v[32:35]
    ds_read_b64_tr_b16 v[234:235], v188 offset:18432
    v_mfma_f32_16x16x32_bf16 v[36:39], v[196:199], v[252:255], v[36:39]
    ds_read_b64_tr_b16 v[228:229], v187 offset:16384
    v_mfma_f32_16x16x32_bf16 v[40:43], v[200:203], v[252:255], v[40:43]
    ds_read_b64_tr_b16 v[230:231], v187 offset:18432
    v_mfma_f32_16x16x32_bf16 v[44:47], v[204:207], v[252:255], v[44:47]
    ds_read_b128 v[252:255], v184 offset:12288
    s_waitcnt lgkmcnt(10)
    v_mfma_f32_16x16x32_bf16 v[60:63], v[204:207], v[208:211], v[60:63]
    ds_read_b64_tr_b16 v[224:225], v186 offset:16384
    v_mfma_f32_16x16x32_bf16 v[56:59], v[200:203], v[208:211], v[56:59]
    ds_read_b64_tr_b16 v[226:227], v186 offset:18432
    v_mfma_f32_16x16x32_bf16 v[52:55], v[196:199], v[208:211], v[52:55]
    v_mfma_f32_16x16x32_bf16 v[48:51], v[192:195], v[208:211], v[48:51]
    ds_read_b128 v[208:211], v184 offset:14336
    s_waitcnt lgkmcnt(12)
    v_mfma_f32_16x16x32_bf16 v[64:67], v[192:195], v[212:215], v[64:67]
    v_mfma_f32_16x16x32_bf16 v[68:71], v[196:199], v[212:215], v[68:71]
    v_mfma_f32_16x16x32_bf16 v[72:75], v[200:203], v[212:215], v[72:75]
    v_mfma_f32_16x16x32_bf16 v[76:79], v[204:207], v[212:215], v[76:79]
    ds_read_b128 v[212:215], v185 offset:0
    s_waitcnt lgkmcnt(12)
    v_mfma_f32_16x16x32_bf16 v[92:95], v[204:207], v[216:219], v[92:95]
    v_mfma_f32_16x16x32_bf16 v[88:91], v[200:203], v[216:219], v[88:91]
    v_mfma_f32_16x16x32_bf16 v[84:87], v[196:199], v[216:219], v[84:87]
    v_mfma_f32_16x16x32_bf16 v[80:83], v[192:195], v[216:219], v[80:83]
    ds_read_b128 v[216:219], v185 offset:2048
    s_waitcnt lgkmcnt(9)
    v_mfma_f32_16x16x32_bf16 v[96:99], v[192:195], v[220:223], v[96:99]
    v_mfma_f32_16x16x32_bf16 v[100:103], v[196:199], v[220:223], v[100:103]
    v_mfma_f32_16x16x32_bf16 v[104:107], v[200:203], v[220:223], v[104:107]
    v_mfma_f32_16x16x32_bf16 v[108:111], v[204:207], v[220:223], v[108:111]
    ds_read_b128 v[220:223], v185 offset:4096
    s_waitcnt lgkmcnt(6)
    v_mfma_f32_16x16x32_bf16 v[124:127], v[204:207], v[252:255], v[124:127]
    v_mfma_f32_16x16x32_bf16 v[120:123], v[200:203], v[252:255], v[120:123]
    v_mfma_f32_16x16x32_bf16 v[116:119], v[196:199], v[252:255], v[116:119]
    v_mfma_f32_16x16x32_bf16 v[112:115], v[192:195], v[252:255], v[112:115]
    ds_read_b128 v[252:255], v185 offset:6144
    s_waitcnt lgkmcnt(4)
    v_mfma_f32_16x16x32_bf16 v[128:131], v[192:195], v[208:211], v[128:131]
    v_mfma_f32_16x16x32_bf16 v[132:135], v[196:199], v[208:211], v[132:135]
    v_mfma_f32_16x16x32_bf16 v[136:139], v[200:203], v[208:211], v[136:139]
    v_mfma_f32_16x16x32_bf16 v[140:143], v[204:207], v[208:211], v[140:143]
    ds_read_b128 v[208:211], v185 offset:8192
    s_waitcnt lgkmcnt(4)
    v_mfma_f32_16x16x32_bf16 v[28:31], v[236:239], v[212:215], v[28:31]
    v_mfma_f32_16x16x32_bf16 v[24:27], v[232:235], v[212:215], v[24:27]
    v_mfma_f32_16x16x32_bf16 v[20:23], v[228:231], v[212:215], v[20:23]
    v_mfma_f32_16x16x32_bf16 v[16:19], v[224:227], v[212:215], v[16:19]
    ds_read_b128 v[212:215], v185 offset:10240
    s_waitcnt lgkmcnt(4)
    v_mfma_f32_16x16x32_bf16 v[32:35], v[224:227], v[216:219], v[32:35]
    v_mfma_f32_16x16x32_bf16 v[36:39], v[228:231], v[216:219], v[36:39]
    v_mfma_f32_16x16x32_bf16 v[40:43], v[232:235], v[216:219], v[40:43]
    v_mfma_f32_16x16x32_bf16 v[44:47], v[236:239], v[216:219], v[44:47]
    ds_read_b128 v[216:219], v185 offset:12288
    s_waitcnt lgkmcnt(4)
    v_mfma_f32_16x16x32_bf16 v[60:63], v[236:239], v[220:223], v[60:63]
    v_mfma_f32_16x16x32_bf16 v[56:59], v[232:235], v[220:223], v[56:59]
    v_mfma_f32_16x16x32_bf16 v[52:55], v[228:231], v[220:223], v[52:55]
    v_mfma_f32_16x16x32_bf16 v[48:51], v[224:227], v[220:223], v[48:51]
    ds_read_b128 v[220:223], v185 offset:14336
    s_waitcnt lgkmcnt(4)
    v_mfma_f32_16x16x32_bf16 v[64:67], v[224:227], v[252:255], v[64:67]
    v_mfma_f32_16x16x32_bf16 v[68:71], v[228:231], v[252:255], v[68:71]
    v_mfma_f32_16x16x32_bf16 v[72:75], v[232:235], v[252:255], v[72:75]
    v_mfma_f32_16x16x32_bf16 v[76:79], v[236:239], v[252:255], v[76:79]
    s_waitcnt lgkmcnt(0)
    v_xor_b32 v184, 65536, v184
    v_xor_b32 v185, 65536, v185
    v_xor_b32 v186, 0x10000, v186
    v_xor_b32 v187, 0x10000, v187
    v_xor_b32 v188, 0x10000, v188
    v_xor_b32 v189, 0x10000, v189
    s_barrier
    v_mfma_f32_16x16x32_bf16 v[92:95], v[236:239], v[208:211], v[92:95]
    ds_read_b64_tr_b16 v[204:205], v189 offset:0
    ds_read_b64_tr_b16 v[206:207], v189 offset:2048
    v_mfma_f32_16x16x32_bf16 v[88:91], v[232:235], v[208:211], v[88:91]
    ds_read_b128 v[252:255], v184 offset:0
    ds_read_b64_tr_b16 v[200:201], v188 offset:0
    v_mfma_f32_16x16x32_bf16 v[84:87], v[228:231], v[208:211], v[84:87]
    ds_read_b64_tr_b16 v[202:203], v188 offset:2048
    ds_read_b64_tr_b16 v[196:197], v187 offset:0
    v_mfma_f32_16x16x32_bf16 v[80:83], v[224:227], v[208:211], v[80:83]
    ds_read_b64_tr_b16 v[198:199], v187 offset:2048
    ds_read_b128 v[208:211], v184 offset:2048
    v_mfma_f32_16x16x32_bf16 v[96:99], v[224:227], v[212:215], v[96:99]
    ds_read_b64_tr_b16 v[192:193], v186 offset:0
    ds_read_b64_tr_b16 v[194:195], v186 offset:2048
    v_mfma_f32_16x16x32_bf16 v[100:103], v[228:231], v[212:215], v[100:103]
    v_mfma_f32_16x16x32_bf16 v[104:107], v[232:235], v[212:215], v[104:107]
    v_mfma_f32_16x16x32_bf16 v[108:111], v[236:239], v[212:215], v[108:111]
    ds_read_b128 v[212:215], v184 offset:4096
    v_mfma_f32_16x16x32_bf16 v[124:127], v[236:239], v[216:219], v[124:127]
    v_mfma_f32_16x16x32_bf16 v[120:123], v[232:235], v[216:219], v[120:123]
    v_mfma_f32_16x16x32_bf16 v[116:119], v[228:231], v[216:219], v[116:119]
    v_mfma_f32_16x16x32_bf16 v[112:115], v[224:227], v[216:219], v[112:115]
    ds_read_b128 v[216:219], v184 offset:6144
    v_mfma_f32_16x16x32_bf16 v[128:131], v[224:227], v[220:223], v[128:131]
    v_mfma_f32_16x16x32_bf16 v[132:135], v[228:231], v[220:223], v[132:135]
    v_mfma_f32_16x16x32_bf16 v[136:139], v[232:235], v[220:223], v[136:139]
    v_mfma_f32_16x16x32_bf16 v[140:143], v[236:239], v[220:223], v[140:143]
    ds_read_b128 v[220:223], v184 offset:8192
    s_waitcnt lgkmcnt(3)
    v_mfma_f32_16x16x32_bf16 v[28:31], v[204:207], v[252:255], v[28:31]
    ds_read_b64_tr_b16 v[236:237], v189 offset:16384
    v_mfma_f32_16x16x32_bf16 v[24:27], v[200:203], v[252:255], v[24:27]
    ds_read_b64_tr_b16 v[238:239], v189 offset:18432
    v_mfma_f32_16x16x32_bf16 v[20:23], v[196:199], v[252:255], v[20:23]
    ds_read_b64_tr_b16 v[232:233], v188 offset:16384
    v_mfma_f32_16x16x32_bf16 v[16:19], v[192:195], v[252:255], v[16:19]
    ds_read_b128 v[252:255], v184 offset:10240
    v_mfma_f32_16x16x32_bf16 v[32:35], v[192:195], v[208:211], v[32:35]
    ds_read_b64_tr_b16 v[234:235], v188 offset:18432
    v_mfma_f32_16x16x32_bf16 v[36:39], v[196:199], v[208:211], v[36:39]
    ds_read_b64_tr_b16 v[228:229], v187 offset:16384
    v_mfma_f32_16x16x32_bf16 v[40:43], v[200:203], v[208:211], v[40:43]
    ds_read_b64_tr_b16 v[230:231], v187 offset:18432
    v_mfma_f32_16x16x32_bf16 v[44:47], v[204:207], v[208:211], v[44:47]
    ds_read_b128 v[208:211], v184 offset:12288
    s_waitcnt lgkmcnt(10)
    v_mfma_f32_16x16x32_bf16 v[60:63], v[204:207], v[212:215], v[60:63]
    ds_read_b64_tr_b16 v[224:225], v186 offset:16384
    v_mfma_f32_16x16x32_bf16 v[56:59], v[200:203], v[212:215], v[56:59]
    ds_read_b64_tr_b16 v[226:227], v186 offset:18432
    v_mfma_f32_16x16x32_bf16 v[52:55], v[196:199], v[212:215], v[52:55]
    v_mfma_f32_16x16x32_bf16 v[48:51], v[192:195], v[212:215], v[48:51]
    ds_read_b128 v[212:215], v184 offset:14336
    s_waitcnt lgkmcnt(12)
    v_mfma_f32_16x16x32_bf16 v[64:67], v[192:195], v[216:219], v[64:67]
    v_mfma_f32_16x16x32_bf16 v[68:71], v[196:199], v[216:219], v[68:71]
    v_mfma_f32_16x16x32_bf16 v[72:75], v[200:203], v[216:219], v[72:75]
    v_mfma_f32_16x16x32_bf16 v[76:79], v[204:207], v[216:219], v[76:79]
    ds_read_b128 v[216:219], v185 offset:0
    s_waitcnt lgkmcnt(12)
    v_mfma_f32_16x16x32_bf16 v[92:95], v[204:207], v[220:223], v[92:95]
    v_mfma_f32_16x16x32_bf16 v[88:91], v[200:203], v[220:223], v[88:91]
    v_mfma_f32_16x16x32_bf16 v[84:87], v[196:199], v[220:223], v[84:87]
    v_mfma_f32_16x16x32_bf16 v[80:83], v[192:195], v[220:223], v[80:83]
    ds_read_b128 v[220:223], v185 offset:2048
    s_waitcnt lgkmcnt(9)
    v_mfma_f32_16x16x32_bf16 v[96:99], v[192:195], v[252:255], v[96:99]
    v_mfma_f32_16x16x32_bf16 v[100:103], v[196:199], v[252:255], v[100:103]
    v_mfma_f32_16x16x32_bf16 v[104:107], v[200:203], v[252:255], v[104:107]
    v_mfma_f32_16x16x32_bf16 v[108:111], v[204:207], v[252:255], v[108:111]
    ds_read_b128 v[252:255], v185 offset:4096
    s_waitcnt lgkmcnt(6)
    v_mfma_f32_16x16x32_bf16 v[124:127], v[204:207], v[208:211], v[124:127]
    v_mfma_f32_16x16x32_bf16 v[120:123], v[200:203], v[208:211], v[120:123]
    v_mfma_f32_16x16x32_bf16 v[116:119], v[196:199], v[208:211], v[116:119]
    v_mfma_f32_16x16x32_bf16 v[112:115], v[192:195], v[208:211], v[112:115]
    ds_read_b128 v[208:211], v185 offset:6144
    s_waitcnt lgkmcnt(4)
    v_mfma_f32_16x16x32_bf16 v[128:131], v[192:195], v[212:215], v[128:131]
    v_mfma_f32_16x16x32_bf16 v[132:135], v[196:199], v[212:215], v[132:135]
    v_mfma_f32_16x16x32_bf16 v[136:139], v[200:203], v[212:215], v[136:139]
    v_mfma_f32_16x16x32_bf16 v[140:143], v[204:207], v[212:215], v[140:143]
    ds_read_b128 v[212:215], v185 offset:8192
    s_waitcnt lgkmcnt(4)
    v_mfma_f32_16x16x32_bf16 v[28:31], v[236:239], v[216:219], v[28:31]
    v_mfma_f32_16x16x32_bf16 v[24:27], v[232:235], v[216:219], v[24:27]
    v_mfma_f32_16x16x32_bf16 v[20:23], v[228:231], v[216:219], v[20:23]
    v_mfma_f32_16x16x32_bf16 v[16:19], v[224:227], v[216:219], v[16:19]
    ds_read_b128 v[216:219], v185 offset:10240
    s_waitcnt lgkmcnt(4)
    v_mfma_f32_16x16x32_bf16 v[32:35], v[224:227], v[220:223], v[32:35]
    v_mfma_f32_16x16x32_bf16 v[36:39], v[228:231], v[220:223], v[36:39]
    s_nop 1
    v_cvt_pk_bf16_f32 v16, v16, v17
    v_cvt_pk_bf16_f32 v17, v18, v19
    v_cvt_pk_bf16_f32 v18, v20, v21
    v_cvt_pk_bf16_f32 v19, v22, v23
    v_mfma_f32_16x16x32_bf16 v[40:43], v[232:235], v[220:223], v[40:43]
    v_cvt_pk_bf16_f32 v20, v24, v25
    v_cvt_pk_bf16_f32 v21, v26, v27
    v_cvt_pk_bf16_f32 v22, v28, v29
    v_cvt_pk_bf16_f32 v23, v30, v31
    v_mfma_f32_16x16x32_bf16 v[44:47], v[236:239], v[220:223], v[44:47]
    ds_read_b128 v[220:223], v185 offset:12288
    s_waitcnt lgkmcnt(4)
    v_mfma_f32_16x16x32_bf16 v[60:63], v[236:239], v[252:255], v[60:63]
    v_mfma_f32_16x16x32_bf16 v[56:59], v[232:235], v[252:255], v[56:59]
    v_cvt_pk_bf16_f32 v24, v32, v33
    v_cvt_pk_bf16_f32 v25, v34, v35
    v_cvt_pk_bf16_f32 v26, v36, v37
    v_cvt_pk_bf16_f32 v27, v38, v39
    v_mfma_f32_16x16x32_bf16 v[52:55], v[228:231], v[252:255], v[52:55]
    v_cvt_pk_bf16_f32 v28, v40, v41
    v_cvt_pk_bf16_f32 v29, v42, v43
    v_cvt_pk_bf16_f32 v30, v44, v45
    v_cvt_pk_bf16_f32 v31, v46, v47
    v_mfma_f32_16x16x32_bf16 v[48:51], v[224:227], v[252:255], v[48:51]
    ds_read_b128 v[252:255], v185 offset:14336
    s_waitcnt lgkmcnt(4)
    v_mfma_f32_16x16x32_bf16 v[64:67], v[224:227], v[208:211], v[64:67]
    v_mfma_f32_16x16x32_bf16 v[68:71], v[228:231], v[208:211], v[68:71]
    s_nop 1
    v_cvt_pk_bf16_f32 v32, v48, v49
    v_cvt_pk_bf16_f32 v33, v50, v51
    v_cvt_pk_bf16_f32 v34, v52, v53
    v_cvt_pk_bf16_f32 v35, v54, v55
    v_mfma_f32_16x16x32_bf16 v[72:75], v[232:235], v[208:211], v[72:75]
    v_cvt_pk_bf16_f32 v36, v56, v57
    v_cvt_pk_bf16_f32 v37, v58, v59
    v_cvt_pk_bf16_f32 v38, v60, v61
    v_cvt_pk_bf16_f32 v39, v62, v63
    v_mfma_f32_16x16x32_bf16 v[76:79], v[236:239], v[208:211], v[76:79]
    s_waitcnt lgkmcnt(0)
    s_barrier
    v_mfma_f32_16x16x32_bf16 v[92:95], v[236:239], v[212:215], v[92:95]
    ds_read_b128 v[192:195], v244 offset:0
    ds_read_b64_tr_b16 v[196:197], v248 offset:0
    ds_read_b64_tr_b16 v[198:199], v248 offset:1024
    v_mfma_f32_16x16x32_bf16 v[88:91], v[232:235], v[212:215], v[88:91]
    ds_read_b64_tr_b16 v[200:201], v249 offset:0
    ds_read_b64_tr_b16 v[202:203], v249 offset:1024
    v_cvt_pk_bf16_f32 v40, v64, v65
    v_cvt_pk_bf16_f32 v41, v66, v67
    v_cvt_pk_bf16_f32 v42, v68, v69
    v_cvt_pk_bf16_f32 v43, v70, v71
    v_mfma_f32_16x16x32_bf16 v[84:87], v[228:231], v[212:215], v[84:87]
    v_cvt_pk_bf16_f32 v44, v72, v73
    v_cvt_pk_bf16_f32 v45, v74, v75
    v_cvt_pk_bf16_f32 v46, v76, v77
    v_cvt_pk_bf16_f32 v47, v78, v79
    v_mfma_f32_16x16x32_bf16 v[80:83], v[224:227], v[212:215], v[80:83]
    v_mfma_f32_16x16x32_bf16 v[96:99], v[224:227], v[216:219], v[96:99]
    ds_read_b128 v[204:207], v245 offset:0
    ds_read_b64_tr_b16 v[208:209], v248 offset:8192
    ds_read_b64_tr_b16 v[210:211], v248 offset:9216
    v_mfma_f32_16x16x32_bf16 v[100:103], v[228:231], v[216:219], v[100:103]
    ds_read_b64_tr_b16 v[212:213], v249 offset:8192
    ds_read_b64_tr_b16 v[214:215], v249 offset:9216
    v_cvt_pk_bf16_f32 v48, v80, v81
    v_cvt_pk_bf16_f32 v49, v82, v83
    v_cvt_pk_bf16_f32 v50, v84, v85
    v_cvt_pk_bf16_f32 v51, v86, v87
    v_mfma_f32_16x16x32_bf16 v[104:107], v[232:235], v[216:219], v[104:107]
    v_cvt_pk_bf16_f32 v52, v88, v89
    v_cvt_pk_bf16_f32 v53, v90, v91
    v_cvt_pk_bf16_f32 v54, v92, v93
    v_cvt_pk_bf16_f32 v55, v94, v95
    v_mfma_f32_16x16x32_bf16 v[108:111], v[236:239], v[216:219], v[108:111]
    v_mfma_f32_16x16x32_bf16 v[124:127], v[236:239], v[220:223], v[124:127]
    ds_read_b128 v[216:219], v246 offset:0
    v_mfma_f32_16x16x32_bf16 v[120:123], v[232:235], v[220:223], v[120:123]
    v_cvt_pk_bf16_f32 v56, v96, v97
    v_cvt_pk_bf16_f32 v57, v98, v99
    v_cvt_pk_bf16_f32 v58, v100, v101
    v_cvt_pk_bf16_f32 v59, v102, v103
    v_mfma_f32_16x16x32_bf16 v[116:119], v[228:231], v[220:223], v[116:119]
    v_cvt_pk_bf16_f32 v60, v104, v105
    v_cvt_pk_bf16_f32 v61, v106, v107
    v_cvt_pk_bf16_f32 v62, v108, v109
    v_cvt_pk_bf16_f32 v63, v110, v111
    v_mfma_f32_16x16x32_bf16 v[112:115], v[224:227], v[220:223], v[112:115]
    v_mfma_f32_16x16x32_bf16 v[128:131], v[224:227], v[252:255], v[128:131]
    ds_read_b64_tr_b16 v[220:221], v248 offset:16384
    ds_read_b64_tr_b16 v[222:223], v248 offset:17408
    v_mfma_f32_16x16x32_bf16 v[132:135], v[228:231], v[252:255], v[132:135]
    s_nop 1
    v_cvt_pk_bf16_f32 v64, v112, v113
    v_cvt_pk_bf16_f32 v65, v114, v115
    v_cvt_pk_bf16_f32 v66, v116, v117
    v_cvt_pk_bf16_f32 v67, v118, v119
    v_mfma_f32_16x16x32_bf16 v[136:139], v[232:235], v[252:255], v[136:139]
    v_cvt_pk_bf16_f32 v68, v120, v121
    v_cvt_pk_bf16_f32 v69, v122, v123
    v_cvt_pk_bf16_f32 v70, v124, v125
    v_cvt_pk_bf16_f32 v71, v126, v127
    v_mfma_f32_16x16x32_bf16 v[140:143], v[236:239], v[252:255], v[140:143]
    ds_read_b64_tr_b16 v[224:225], v249 offset:16384
    ds_read_b64_tr_b16 v[226:227], v249 offset:17408
    ds_read_b128 v[228:231], v247 offset:0
    ds_read_b64_tr_b16 v[232:233], v248 offset:24576
    ds_read_b64_tr_b16 v[234:235], v248 offset:25600
    ds_read_b64_tr_b16 v[236:237], v249 offset:24576
    ds_read_b64_tr_b16 v[238:239], v249 offset:25600
    v_cvt_pk_bf16_f32 v72, v128, v129
    v_cvt_pk_bf16_f32 v73, v130, v131
    v_cvt_pk_bf16_f32 v74, v132, v133
    v_cvt_pk_bf16_f32 v75, v134, v135
    v_cvt_pk_bf16_f32 v76, v136, v137
    v_cvt_pk_bf16_f32 v77, v138, v139
    v_cvt_pk_bf16_f32 v78, v140, v141
    v_cvt_pk_bf16_f32 v79, v142, v143
    s_branch mg_a1_r1
mg_gv_r1:
    s_waitcnt lgkmcnt(4)
    v_mfma_f32_16x16x32_bf16 v[40:43], v[216:219], v[204:207], 0
    ds_read_b64_tr_b16 v[236:237], v189 offset:16384
    v_mfma_f32_16x16x32_bf16 v[32:35], v[216:219], v[200:203], 0
    ds_read_b64_tr_b16 v[238:239], v189 offset:18432
    v_mfma_f32_16x16x32_bf16 v[24:27], v[216:219], v[196:199], 0
    ds_read_b64_tr_b16 v[232:233], v188 offset:16384
    v_mfma_f32_16x16x32_bf16 v[16:19], v[216:219], v[192:195], 0
    ds_read_b128 v[216:219], v184 offset:10240
    s_waitcnt lgkmcnt(7)
    v_mfma_f32_16x16x32_bf16 v[20:23], v[220:223], v[192:195], 0
    ds_read_b64_tr_b16 v[234:235], v188 offset:18432
    v_mfma_f32_16x16x32_bf16 v[28:31], v[220:223], v[196:199], 0
    ds_read_b64_tr_b16 v[228:229], v187 offset:16384
    v_mfma_f32_16x16x32_bf16 v[36:39], v[220:223], v[200:203], 0
    ds_read_b64_tr_b16 v[230:231], v187 offset:18432
    v_mfma_f32_16x16x32_bf16 v[44:47], v[220:223], v[204:207], 0
    ds_read_b128 v[220:223], v184 offset:12288
    s_waitcnt lgkmcnt(10)
    v_mfma_f32_16x16x32_bf16 v[72:75], v[252:255], v[204:207], 0
    ds_read_b64_tr_b16 v[224:225], v186 offset:16384
    v_mfma_f32_16x16x32_bf16 v[64:67], v[252:255], v[200:203], 0
    ds_read_b64_tr_b16 v[226:227], v186 offset:18432
    v_mfma_f32_16x16x32_bf16 v[56:59], v[252:255], v[196:199], 0
    v_mfma_f32_16x16x32_bf16 v[48:51], v[252:255], v[192:195], 0
    ds_read_b128 v[252:255], v184 offset:14336
    s_waitcnt lgkmcnt(12)
    v_mfma_f32_16x16x32_bf16 v[52:55], v[208:211], v[192:195], 0
    v_mfma_f32_16x16x32_bf16 v[60:63], v[208:211], v[196:199], 0
    v_mfma_f32_16x16x32_bf16 v[68:71], v[208:211], v[200:203], 0
    v_mfma_f32_16x16x32_bf16 v[76:79], v[208:211], v[204:207], 0
    ds_read_b128 v[208:211], v185 offset:0
    s_waitcnt lgkmcnt(12)
    v_mfma_f32_16x16x32_bf16 v[104:107], v[212:215], v[204:207], 0
    v_mfma_f32_16x16x32_bf16 v[96:99], v[212:215], v[200:203], 0
    v_mfma_f32_16x16x32_bf16 v[88:91], v[212:215], v[196:199], 0
    v_mfma_f32_16x16x32_bf16 v[80:83], v[212:215], v[192:195], 0
    ds_read_b128 v[212:215], v185 offset:2048
    s_waitcnt lgkmcnt(9)
    v_mfma_f32_16x16x32_bf16 v[84:87], v[216:219], v[192:195], 0
    v_mfma_f32_16x16x32_bf16 v[92:95], v[216:219], v[196:199], 0
    v_mfma_f32_16x16x32_bf16 v[100:103], v[216:219], v[200:203], 0
    v_mfma_f32_16x16x32_bf16 v[108:111], v[216:219], v[204:207], 0
    ds_read_b128 v[216:219], v185 offset:4096
    s_waitcnt lgkmcnt(6)
    v_mfma_f32_16x16x32_bf16 v[136:139], v[220:223], v[204:207], 0
    s_mul_i32 s13, s63, 1600
    s_add_u32 s40, s8, s13
    s_addc_u32 s41, s9, 0
    s_and_b32 s41, s41, 0xffff
    s_mov_b32 s42, 1600
    s_mov_b32 s43, 0x20000
    v_mfma_f32_16x16x32_bf16 v[128:131], v[220:223], v[200:203], 0
    s_lshl_b32 s13, s12, 10
    s_min_u32 s14, s13, 2048
    v_mfma_f32_16x16x32_bf16 v[120:123], v[220:223], v[196:199], 0
    s_add_u32 m0, s14, 159744
    s_nop 0
    v_mfma_f32_16x16x32_bf16 v[112:115], v[220:223], v[192:195], 0
    ds_read_b128 v[220:223], v185 offset:6144
    s_waitcnt lgkmcnt(4)
    v_mfma_f32_16x16x32_bf16 v[116:119], v[252:255], v[192:195], 0
    buffer_load_dwordx4 v1, s[40:43], s13 offen lds
    v_mfma_f32_16x16x32_bf16 v[124:127], v[252:255], v[196:199], 0
    v_mfma_f32_16x16x32_bf16 v[132:135], v[252:255], v[200:203], 0
    v_mfma_f32_16x16x32_bf16 v[140:143], v[252:255], v[204:207], 0
    ds_read_b128 v[252:255], v185 offset:8192
    s_waitcnt lgkmcnt(4)
    v_mfma_f32_16x16x32_bf16 v[40:43], v[208:211], v[236:239], v[40:43]
    v_mfma_f32_16x16x32_bf16 v[32:35], v[208:211], v[232:235], v[32:35]
    v_mfma_f32_16x16x32_bf16 v[24:27], v[208:211], v[228:231], v[24:27]
    v_mfma_f32_16x16x32_bf16 v[16:19], v[208:211], v[224:227], v[16:19]
    ds_read_b128 v[208:211], v185 offset:10240
    s_waitcnt lgkmcnt(4)
    v_mfma_f32_16x16x32_bf16 v[20:23], v[212:215], v[224:227], v[20:23]
    v_mfma_f32_16x16x32_bf16 v[28:31], v[212:215], v[228:231], v[28:31]
    v_mfma_f32_16x16x32_bf16 v[36:39], v[212:215], v[232:235], v[36:39]
    v_mfma_f32_16x16x32_bf16 v[44:47], v[212:215], v[236:239], v[44:47]
    ds_read_b128 v[212:215], v185 offset:12288
    s_waitcnt lgkmcnt(4)
    v_mfma_f32_16x16x32_bf16 v[72:75], v[216:219], v[236:239], v[72:75]
    s_lshl_b32 s13, s62, 3
    s_and_b32 s14, s12, 3
    s_add_u32 s13, s13, s14
    s_mul_i32 s13, s13, 20480
    v_lshrrev_b32 v8, 3, v0
    v_mul_u32_u24 v8, 1280, v8
    v_and_b32 v9, 7, v0
    v_lshrrev_b32 v11, 4, v0
    v_mfma_f32_16x16x32_bf16 v[64:67], v[216:219], v[232:235], v[64:67]
    v_xor_b32 v9, v9, v11
    v_lshlrev_b32 v9, 4, v9
    v_add3_u32 v240, v8, v9, s13
    v_xor_b32 v9, 64, v9
    s_add_u32 s13, s13, 9216
    v_add3_u32 v241, v8, v9, s13
    s_mul_i32 s55, s63, 163840
    s_lshl_b32 s13, s14, 11
    v_mfma_f32_16x16x32_bf16 v[56:59], v[216:219], v[228:231], v[56:59]
    s_add_u32 s55, s55, s13
    s_add_u32 s55, s55, 79691776
    v_add_u32 v243, s55, v1
    s_bfe_u32 s13, s2, 0x20003
    s_mul_i32 s13, s13, 5
    s_lshr_b32 s13, s13, 1
    s_lshr_b32 s54, s2, 5
    s_add_u32 s54, s54, s13
    v_mfma_f32_16x16x32_bf16 v[48:51], v[216:219], v[224:227], v[48:51]
    ds_read_b128 v[216:219], v185 offset:14336
    s_waitcnt lgkmcnt(4)
    v_mfma_f32_16x16x32_bf16 v[52:55], v[220:223], v[224:227], v[52:55]
    s_sub_u32 s13, s54, 10
    s_cselect_b32 s54, s54, s13
    s_lshl_b32 s54, s54, 7
    s_lshl_b32 s55, s54, 7
    s_lshl_b32 s64, s64, 10
    s_mul_i32 s13, s63, 163840
    s_add_u32 s64, s64, s13
    s_add_u32 s64, s64, 79691776
    s_add_u32 s65, s64, 8192
    v_mfma_f32_16x16x32_bf16 v[60:63], v[220:223], v[228:231], v[60:63]
    s_cmp_lt_u32 s12, 2
    s_cselect_b32 s65, s65, 2147418112
    s_lshl_b32 s13, s63, 4
    s_add_u32 s13, s13, s62
    s_lshl_b32 s13, s13, 2
    s_add_u32 s13, s13, s12
    s_lshl_b32 s13, s13, 10
    s_add_u32 s13, s13, 58716160
    s_sub_u32 s66, 0, s15
    v_mfma_f32_16x16x32_bf16 v[68:71], v[220:223], v[232:235], v[68:71]
    s_cmp_eq_u32 s15, 0
    s_cselect_b32 s65, s65, s13
    s_lshl_b32 s67, s63, 2
    v_mov_b32 v5, 0x10000
    v_mfma_f32_16x16x32_bf16 v[76:79], v[220:223], v[236:239], v[76:79]
    s_waitcnt vmcnt(3)
    s_waitcnt lgkmcnt(0)
    v_xor_b32 v184, 65536, v184
    v_xor_b32 v185, 65536, v185
    v_xor_b32 v186, 0x10000, v186
    v_xor_b32 v187, 0x10000, v187
    v_xor_b32 v188, 0x10000, v188
    v_xor_b32 v189, 0x10000, v189
    s_barrier
    v_mfma_f32_16x16x32_bf16 v[104:107], v[252:255], v[236:239], v[104:107]
    ds_read_b64_tr_b16 v[204:205], v189 offset:0
    ds_read_b64_tr_b16 v[206:207], v189 offset:2048
    v_mfma_f32_16x16x32_bf16 v[96:99], v[252:255], v[232:235], v[96:99]
    ds_read_b128 v[220:223], v184 offset:0
    ds_read_b64_tr_b16 v[200:201], v188 offset:0
    v_mfma_f32_16x16x32_bf16 v[88:91], v[252:255], v[228:231], v[88:91]
    ds_read_b64_tr_b16 v[202:203], v188 offset:2048
    ds_read_b64_tr_b16 v[196:197], v187 offset:0
    v_mfma_f32_16x16x32_bf16 v[80:83], v[252:255], v[224:227], v[80:83]
    ds_read_b64_tr_b16 v[198:199], v187 offset:2048
    ds_read_b128 v[252:255], v184 offset:2048
    v_mfma_f32_16x16x32_bf16 v[84:87], v[208:211], v[224:227], v[84:87]
    ds_read_b64_tr_b16 v[192:193], v186 offset:0
    ds_read_b64_tr_b16 v[194:195], v186 offset:2048
    v_mfma_f32_16x16x32_bf16 v[92:95], v[208:211], v[228:231], v[92:95]
    v_mfma_f32_16x16x32_bf16 v[100:103], v[208:211], v[232:235], v[100:103]
    v_mfma_f32_16x16x32_bf16 v[108:111], v[208:211], v[236:239], v[108:111]
    ds_read_b128 v[208:211], v184 offset:4096
    v_mfma_f32_16x16x32_bf16 v[136:139], v[212:215], v[236:239], v[136:139]
    v_mfma_f32_16x16x32_bf16 v[128:131], v[212:215], v[232:235], v[128:131]
    v_mfma_f32_16x16x32_bf16 v[120:123], v[212:215], v[228:231], v[120:123]
    v_mfma_f32_16x16x32_bf16 v[112:115], v[212:215], v[224:227], v[112:115]
    ds_read_b128 v[212:215], v184 offset:6144
    v_mfma_f32_16x16x32_bf16 v[116:119], v[216:219], v[224:227], v[116:119]
    v_mfma_f32_16x16x32_bf16 v[124:127], v[216:219], v[228:231], v[124:127]
    v_mfma_f32_16x16x32_bf16 v[132:135], v[216:219], v[232:235], v[132:135]
    v_mfma_f32_16x16x32_bf16 v[140:143], v[216:219], v[236:239], v[140:143]
    ds_read_b128 v[216:219], v184 offset:8192
    s_waitcnt lgkmcnt(3)
    v_mfma_f32_16x16x32_bf16 v[40:43], v[220:223], v[204:207], v[40:43]
    ds_read_b64_tr_b16 v[236:237], v189 offset:16384
    v_mfma_f32_16x16x32_bf16 v[32:35], v[220:223], v[200:203], v[32:35]
    ds_read_b64_tr_b16 v[238:239], v189 offset:18432
    v_mfma_f32_16x16x32_bf16 v[24:27], v[220:223], v[196:199], v[24:27]
    ds_read_b64_tr_b16 v[232:233], v188 offset:16384
    v_mfma_f32_16x16x32_bf16 v[16:19], v[220:223], v[192:195], v[16:19]
    ds_read_b128 v[220:223], v184 offset:10240
    v_mfma_f32_16x16x32_bf16 v[20:23], v[252:255], v[192:195], v[20:23]
    ds_read_b64_tr_b16 v[234:235], v188 offset:18432
    v_mfma_f32_16x16x32_bf16 v[28:31], v[252:255], v[196:199], v[28:31]
    ds_read_b64_tr_b16 v[228:229], v187 offset:16384
    v_mfma_f32_16x16x32_bf16 v[36:39], v[252:255], v[200:203], v[36:39]
    ds_read_b64_tr_b16 v[230:231], v187 offset:18432
    v_mfma_f32_16x16x32_bf16 v[44:47], v[252:255], v[204:207], v[44:47]
    ds_read_b128 v[252:255], v184 offset:12288
    s_waitcnt lgkmcnt(10)
    v_mfma_f32_16x16x32_bf16 v[72:75], v[208:211], v[204:207], v[72:75]
    ds_read_b64_tr_b16 v[224:225], v186 offset:16384
    s_waitcnt vmcnt(1)
    v_mfma_f32_16x16x32_bf16 v[64:67], v[208:211], v[200:203], v[64:67]
    ds_read_b64_tr_b16 v[226:227], v186 offset:18432
    buffer_store_dwordx4 v[144:147], v1, s[16:19], s64 offen sc1
    v_mfma_f32_16x16x32_bf16 v[56:59], v[208:211], v[196:199], v[56:59]
    v_or_b32 v148, s66, v148
    v_mfma_f32_16x16x32_bf16 v[48:51], v[208:211], v[192:195], v[48:51]
    ds_read_b128 v[208:211], v184 offset:14336
    s_waitcnt lgkmcnt(12)
    v_mfma_f32_16x16x32_bf16 v[52:55], v[212:215], v[192:195], v[52:55]
    v_or_b32 v149, s66, v149
    v_mfma_f32_16x16x32_bf16 v[60:63], v[212:215], v[196:199], v[60:63]
    v_or_b32 v150, s66, v150
    v_mfma_f32_16x16x32_bf16 v[68:71], v[212:215], v[200:203], v[68:71]
    v_or_b32 v151, s66, v151
    v_mfma_f32_16x16x32_bf16 v[76:79], v[212:215], v[204:207], v[76:79]
    ds_read_b128 v[212:215], v185 offset:0
    s_waitcnt lgkmcnt(12)
    v_mfma_f32_16x16x32_bf16 v[104:107], v[216:219], v[204:207], v[104:107]
    v_mfma_f32_16x16x32_bf16 v[96:99], v[216:219], v[200:203], v[96:99]
    v_mfma_f32_16x16x32_bf16 v[88:91], v[216:219], v[196:199], v[88:91]
    v_mfma_f32_16x16x32_bf16 v[80:83], v[216:219], v[192:195], v[80:83]
    ds_read_b128 v[216:219], v185 offset:2048
    s_waitcnt lgkmcnt(9)
    v_mfma_f32_16x16x32_bf16 v[84:87], v[220:223], v[192:195], v[84:87]
    v_mfma_f32_16x16x32_bf16 v[92:95], v[220:223], v[196:199], v[92:95]
    v_mfma_f32_16x16x32_bf16 v[100:103], v[220:223], v[200:203], v[100:103]
    v_mfma_f32_16x16x32_bf16 v[108:111], v[220:223], v[204:207], v[108:111]
    ds_read_b128 v[220:223], v185 offset:4096
    s_waitcnt lgkmcnt(6)
    v_mfma_f32_16x16x32_bf16 v[136:139], v[252:255], v[204:207], v[136:139]
    buffer_store_dwordx4 v[148:151], v1, s[16:19], s65 offen sc1
    v_mfma_f32_16x16x32_bf16 v[128:131], v[252:255], v[200:203], v[128:131]
    v_mfma_f32_16x16x32_bf16 v[120:123], v[252:255], v[196:199], v[120:123]
    v_mfma_f32_16x16x32_bf16 v[112:115], v[252:255], v[192:195], v[112:115]
    ds_read_b128 v[252:255], v185 offset:6144
    s_waitcnt lgkmcnt(4)
    v_mfma_f32_16x16x32_bf16 v[116:119], v[208:211], v[192:195], v[116:119]
    v_mfma_f32_16x16x32_bf16 v[124:127], v[208:211], v[196:199], v[124:127]
    v_mfma_f32_16x16x32_bf16 v[132:135], v[208:211], v[200:203], v[132:135]
    v_mfma_f32_16x16x32_bf16 v[140:143], v[208:211], v[204:207], v[140:143]
    ds_read_b128 v[208:211], v185 offset:8192
    s_waitcnt lgkmcnt(4)
    v_mfma_f32_16x16x32_bf16 v[40:43], v[212:215], v[236:239], v[40:43]
    v_mfma_f32_16x16x32_bf16 v[32:35], v[212:215], v[232:235], v[32:35]
    v_mfma_f32_16x16x32_bf16 v[24:27], v[212:215], v[228:231], v[24:27]
    v_mfma_f32_16x16x32_bf16 v[16:19], v[212:215], v[224:227], v[16:19]
    ds_read_b128 v[212:215], v185 offset:10240
    s_waitcnt lgkmcnt(4)
    v_mfma_f32_16x16x32_bf16 v[20:23], v[216:219], v[224:227], v[20:23]
    v_mfma_f32_16x16x32_bf16 v[28:31], v[216:219], v[228:231], v[28:31]
    v_mfma_f32_16x16x32_bf16 v[36:39], v[216:219], v[232:235], v[36:39]
    v_mfma_f32_16x16x32_bf16 v[44:47], v[216:219], v[236:239], v[44:47]
    ds_read_b128 v[216:219], v185 offset:12288
    s_waitcnt lgkmcnt(4)
    v_mfma_f32_16x16x32_bf16 v[72:75], v[220:223], v[236:239], v[72:75]
    v_mfma_f32_16x16x32_bf16 v[64:67], v[220:223], v[232:235], v[64:67]
    v_mfma_f32_16x16x32_bf16 v[56:59], v[220:223], v[228:231], v[56:59]
    v_mfma_f32_16x16x32_bf16 v[48:51], v[220:223], v[224:227], v[48:51]
    ds_read_b128 v[220:223], v185 offset:14336
    s_waitcnt lgkmcnt(4)
    v_mfma_f32_16x16x32_bf16 v[52:55], v[252:255], v[224:227], v[52:55]
    v_mfma_f32_16x16x32_bf16 v[60:63], v[252:255], v[228:231], v[60:63]
    v_mfma_f32_16x16x32_bf16 v[68:71], v[252:255], v[232:235], v[68:71]
    v_mfma_f32_16x16x32_bf16 v[76:79], v[252:255], v[236:239], v[76:79]
    s_waitcnt lgkmcnt(0)
    v_xor_b32 v184, 65536, v184
    v_xor_b32 v185, 65536, v185
    v_xor_b32 v186, 0x10000, v186
    v_xor_b32 v187, 0x10000, v187
    v_xor_b32 v188, 0x10000, v188
    v_xor_b32 v189, 0x10000, v189
    s_barrier
    v_mfma_f32_16x16x32_bf16 v[104:107], v[208:211], v[236:239], v[104:107]
    ds_read_b64_tr_b16 v[204:205], v189 offset:0
    ds_read_b64_tr_b16 v[206:207], v189 offset:2048
    v_mfma_f32_16x16x32_bf16 v[96:99], v[208:211], v[232:235], v[96:99]
    ds_read_b128 v[252:255], v184 offset:0
    ds_read_b64_tr_b16 v[200:201], v188 offset:0
    v_mfma_f32_16x16x32_bf16 v[88:91], v[208:211], v[228:231], v[88:91]
    ds_read_b64_tr_b16 v[202:203], v188 offset:2048
    ds_read_b64_tr_b16 v[196:197], v187 offset:0
    v_mfma_f32_16x16x32_bf16 v[80:83], v[208:211], v[224:227], v[80:83]
    ds_read_b64_tr_b16 v[198:199], v187 offset:2048
    ds_read_b128 v[208:211], v184 offset:2048
    v_mfma_f32_16x16x32_bf16 v[84:87], v[212:215], v[224:227], v[84:87]
    ds_read_b64_tr_b16 v[192:193], v186 offset:0
    ds_read_b64_tr_b16 v[194:195], v186 offset:2048
    v_mfma_f32_16x16x32_bf16 v[92:95], v[212:215], v[228:231], v[92:95]
    v_mfma_f32_16x16x32_bf16 v[100:103], v[212:215], v[232:235], v[100:103]
    v_mfma_f32_16x16x32_bf16 v[108:111], v[212:215], v[236:239], v[108:111]
    ds_read_b128 v[212:215], v184 offset:4096
    v_mfma_f32_16x16x32_bf16 v[136:139], v[216:219], v[236:239], v[136:139]
    v_mfma_f32_16x16x32_bf16 v[128:131], v[216:219], v[232:235], v[128:131]
    v_mfma_f32_16x16x32_bf16 v[120:123], v[216:219], v[228:231], v[120:123]
    v_mfma_f32_16x16x32_bf16 v[112:115], v[216:219], v[224:227], v[112:115]
    ds_read_b128 v[216:219], v184 offset:6144
    v_mfma_f32_16x16x32_bf16 v[116:119], v[220:223], v[224:227], v[116:119]
    v_mfma_f32_16x16x32_bf16 v[124:127], v[220:223], v[228:231], v[124:127]
    v_mfma_f32_16x16x32_bf16 v[132:135], v[220:223], v[232:235], v[132:135]
    v_mfma_f32_16x16x32_bf16 v[140:143], v[220:223], v[236:239], v[140:143]
    ds_read_b128 v[220:223], v184 offset:8192
    s_waitcnt lgkmcnt(3)
    v_mfma_f32_16x16x32_bf16 v[40:43], v[252:255], v[204:207], v[40:43]
    ds_read_b64_tr_b16 v[236:237], v189 offset:16384
    v_mfma_f32_16x16x32_bf16 v[32:35], v[252:255], v[200:203], v[32:35]
    ds_read_b64_tr_b16 v[238:239], v189 offset:18432
    v_mfma_f32_16x16x32_bf16 v[24:27], v[252:255], v[196:199], v[24:27]
    ds_read_b64_tr_b16 v[232:233], v188 offset:16384
    v_mfma_f32_16x16x32_bf16 v[16:19], v[252:255], v[192:195], v[16:19]
    ds_read_b128 v[252:255], v184 offset:10240
    v_mfma_f32_16x16x32_bf16 v[20:23], v[208:211], v[192:195], v[20:23]
    ds_read_b64_tr_b16 v[234:235], v188 offset:18432
    v_mfma_f32_16x16x32_bf16 v[28:31], v[208:211], v[196:199], v[28:31]
    ds_read_b64_tr_b16 v[228:229], v187 offset:16384
    v_mfma_f32_16x16x32_bf16 v[36:39], v[208:211], v[200:203], v[36:39]
    ds_read_b64_tr_b16 v[230:231], v187 offset:18432
    v_mfma_f32_16x16x32_bf16 v[44:47], v[208:211], v[204:207], v[44:47]
    ds_read_b128 v[208:211], v184 offset:12288
    s_waitcnt lgkmcnt(10)
    v_mfma_f32_16x16x32_bf16 v[72:75], v[212:215], v[204:207], v[72:75]
    ds_read_b64_tr_b16 v[224:225], v186 offset:16384
    s_and_b32 s13, s2, 3
    s_lshl_b32 s13, s13, 8
    v_mfma_f32_16x16x32_bf16 v[64:67], v[212:215], v[200:203], v[64:67]
    ds_read_b64_tr_b16 v[226:227], v186 offset:18432
    s_andn2_b32 s14, s2, 3
    s_add_u32 s13, s13, s14
    v_mfma_f32_16x16x32_bf16 v[56:59], v[212:215], v[196:199], v[56:59]
    s_lshl_b32 s13, s13, 1
    s_add_u32 s13, s13, s12
    v_mfma_f32_16x16x32_bf16 v[48:51], v[212:215], v[192:195], v[48:51]
    ds_read_b128 v[212:215], v184 offset:14336
    s_waitcnt lgkmcnt(12)
    v_mfma_f32_16x16x32_bf16 v[52:55], v[216:219], v[192:195], v[52:55]
    s_mul_i32 s13, s13, 1280
    buffer_load_dword v166, v167, s[32:35], s13 offen
    v_mfma_f32_16x16x32_bf16 v[60:63], v[216:219], v[196:199], v[60:63]
    v_mfma_f32_16x16x32_bf16 v[68:71], v[216:219], v[200:203], v[68:71]
    v_mfma_f32_16x16x32_bf16 v[76:79], v[216:219], v[204:207], v[76:79]
    ds_read_b128 v[216:219], v185 offset:0
    s_waitcnt lgkmcnt(12)
    v_mfma_f32_16x16x32_bf16 v[104:107], v[220:223], v[204:207], v[104:107]
    v_mfma_f32_16x16x32_bf16 v[96:99], v[220:223], v[200:203], v[96:99]
    v_mfma_f32_16x16x32_bf16 v[88:91], v[220:223], v[196:199], v[88:91]
    v_mfma_f32_16x16x32_bf16 v[80:83], v[220:223], v[192:195], v[80:83]
    ds_read_b128 v[220:223], v185 offset:2048
    s_waitcnt lgkmcnt(9)
    v_mfma_f32_16x16x32_bf16 v[84:87], v[252:255], v[192:195], v[84:87]
    v_mfma_f32_16x16x32_bf16 v[92:95], v[252:255], v[196:199], v[92:95]
    v_mfma_f32_16x16x32_bf16 v[100:103], v[252:255], v[200:203], v[100:103]
    v_mfma_f32_16x16x32_bf16 v[108:111], v[252:255], v[204:207], v[108:111]
    ds_read_b128 v[252:255], v185 offset:4096
    s_waitcnt lgkmcnt(6)
    v_mfma_f32_16x16x32_bf16 v[136:139], v[208:211], v[204:207], v[136:139]
    v_mfma_f32_16x16x32_bf16 v[128:131], v[208:211], v[200:203], v[128:131]
    v_mfma_f32_16x16x32_bf16 v[120:123], v[208:211], v[196:199], v[120:123]
    v_mfma_f32_16x16x32_bf16 v[112:115], v[208:211], v[192:195], v[112:115]
    ds_read_b128 v[208:211], v185 offset:6144
    s_waitcnt lgkmcnt(4)
    v_mfma_f32_16x16x32_bf16 v[116:119], v[212:215], v[192:195], v[116:119]
    v_mfma_f32_16x16x32_bf16 v[124:127], v[212:215], v[196:199], v[124:127]
    v_mfma_f32_16x16x32_bf16 v[132:135], v[212:215], v[200:203], v[132:135]
    v_mfma_f32_16x16x32_bf16 v[140:143], v[212:215], v[204:207], v[140:143]
    ds_read_b128 v[212:215], v185 offset:8192
    s_waitcnt lgkmcnt(4)
    v_mfma_f32_16x16x32_bf16 v[40:43], v[216:219], v[236:239], v[40:43]
    v_mfma_f32_16x16x32_bf16 v[32:35], v[216:219], v[232:235], v[32:35]
    v_mfma_f32_16x16x32_bf16 v[24:27], v[216:219], v[228:231], v[24:27]
    v_mfma_f32_16x16x32_bf16 v[16:19], v[216:219], v[224:227], v[16:19]
    ds_read_b128 v[216:219], v185 offset:10240
    s_waitcnt lgkmcnt(4)
    v_mfma_f32_16x16x32_bf16 v[20:23], v[220:223], v[224:227], v[20:23]
    v_mfma_f32_16x16x32_bf16 v[28:31], v[220:223], v[228:231], v[28:31]
    v_mfma_f32_16x16x32_bf16 v[36:39], v[220:223], v[232:235], v[36:39]
    v_mfma_f32_16x16x32_bf16 v[44:47], v[220:223], v[236:239], v[44:47]
    ds_read_b128 v[220:223], v185 offset:12288
    s_waitcnt lgkmcnt(4)
    v_mfma_f32_16x16x32_bf16 v[72:75], v[252:255], v[236:239], v[72:75]
    s_and_b32 s13, s12, 3
    s_lshl_b32 s13, s13, 13
    s_add_u32 s13, s13, 2048
    v_mfma_f32_16x16x32_bf16 v[64:67], v[252:255], v[232:235], v[64:67]
    v_bfe_u32 v8, v0, 4, 1
    v_lshlrev_b32 v8, 12, v8
    v_and_b32 v9, 15, v0
    v_mfma_f32_16x16x32_bf16 v[56:59], v[252:255], v[228:231], v[56:59]
    v_lshl_add_u32 v8, v9, 7, v8
    v_add_u32 v8, s13, v8
    v_bfe_u32 v9, v0, 1, 3
    v_mfma_f32_16x16x32_bf16 v[48:51], v[252:255], v[224:227], v[48:51]
    ds_read_b128 v[252:255], v185 offset:14336
    s_waitcnt lgkmcnt(4)
    v_mfma_f32_16x16x32_bf16 v[52:55], v[208:211], v[224:227], v[52:55]
    v_xor_b32 v9, v9, v10
    v_xor_b32 v11, 0, v9
    v_lshl_add_u32 v244, v11, 4, v8
    v_mfma_f32_16x16x32_bf16 v[60:63], v[208:211], v[228:231], v[60:63]
    v_xor_b32 v11, 2, v9
    v_lshl_add_u32 v245, v11, 4, v8
    v_xor_b32 v11, 4, v9
    v_mfma_f32_16x16x32_bf16 v[68:71], v[208:211], v[232:235], v[68:71]
    v_lshl_add_u32 v246, v11, 4, v8
    v_xor_b32 v11, 6, v9
    v_lshl_add_u32 v247, v11, 4, v8
    v_mfma_f32_16x16x32_bf16 v[76:79], v[208:211], v[236:239], v[76:79]
    s_waitcnt vmcnt(1)
    s_waitcnt lgkmcnt(0)
    v_xor_b32 v184, 65536, v184
    v_xor_b32 v185, 65536, v185
    v_xor_b32 v186, 0x10000, v186
    v_xor_b32 v187, 0x10000, v187
    v_xor_b32 v188, 0x10000, v188
    v_xor_b32 v189, 0x10000, v189
    s_barrier
    v_mfma_f32_16x16x32_bf16 v[104:107], v[212:215], v[236:239], v[104:107]
    ds_read_b64_tr_b16 v[204:205], v189 offset:0
    ds_read_b64_tr_b16 v[206:207], v189 offset:2048
    v_mfma_f32_16x16x32_bf16 v[96:99], v[212:215], v[232:235], v[96:99]
    ds_read_b128 v[208:211], v184 offset:0
    ds_read_b64_tr_b16 v[200:201], v188 offset:0
    v_mfma_f32_16x16x32_bf16 v[88:91], v[212:215], v[228:231], v[88:91]
    ds_read_b64_tr_b16 v[202:203], v188 offset:2048
    ds_read_b64_tr_b16 v[196:197], v187 offset:0
    v_mfma_f32_16x16x32_bf16 v[80:83], v[212:215], v[224:227], v[80:83]
    ds_read_b64_tr_b16 v[198:199], v187 offset:2048
    ds_read_b128 v[212:215], v184 offset:2048
    v_mfma_f32_16x16x32_bf16 v[84:87], v[216:219], v[224:227], v[84:87]
    ds_read_b64_tr_b16 v[192:193], v186 offset:0
    ds_read_b64_tr_b16 v[194:195], v186 offset:2048
    v_mfma_f32_16x16x32_bf16 v[92:95], v[216:219], v[228:231], v[92:95]
    v_mfma_f32_16x16x32_bf16 v[100:103], v[216:219], v[232:235], v[100:103]
    v_mfma_f32_16x16x32_bf16 v[108:111], v[216:219], v[236:239], v[108:111]
    ds_read_b128 v[216:219], v184 offset:4096
    v_mfma_f32_16x16x32_bf16 v[136:139], v[220:223], v[236:239], v[136:139]
    v_mfma_f32_16x16x32_bf16 v[128:131], v[220:223], v[232:235], v[128:131]
    v_mfma_f32_16x16x32_bf16 v[120:123], v[220:223], v[228:231], v[120:123]
    v_mfma_f32_16x16x32_bf16 v[112:115], v[220:223], v[224:227], v[112:115]
    ds_read_b128 v[220:223], v184 offset:6144
    v_mfma_f32_16x16x32_bf16 v[116:119], v[252:255], v[224:227], v[116:119]
    v_mfma_f32_16x16x32_bf16 v[124:127], v[252:255], v[228:231], v[124:127]
    v_mfma_f32_16x16x32_bf16 v[132:135], v[252:255], v[232:235], v[132:135]
    v_mfma_f32_16x16x32_bf16 v[140:143], v[252:255], v[236:239], v[140:143]
    ds_read_b128 v[252:255], v184 offset:8192
    s_waitcnt lgkmcnt(3)
    v_mfma_f32_16x16x32_bf16 v[40:43], v[208:211], v[204:207], v[40:43]
    ds_read_b64_tr_b16 v[236:237], v189 offset:16384
    v_mfma_f32_16x16x32_bf16 v[32:35], v[208:211], v[200:203], v[32:35]
    ds_read_b64_tr_b16 v[238:239], v189 offset:18432
    v_mfma_f32_16x16x32_bf16 v[24:27], v[208:211], v[196:199], v[24:27]
    ds_read_b64_tr_b16 v[232:233], v188 offset:16384
    v_mfma_f32_16x16x32_bf16 v[16:19], v[208:211], v[192:195], v[16:19]
    ds_read_b128 v[208:211], v184 offset:10240
    v_mfma_f32_16x16x32_bf16 v[20:23], v[212:215], v[192:195], v[20:23]
    ds_read_b64_tr_b16 v[234:235], v188 offset:18432
    v_mfma_f32_16x16x32_bf16 v[28:31], v[212:215], v[196:199], v[28:31]
    ds_read_b64_tr_b16 v[228:229], v187 offset:16384
    v_mfma_f32_16x16x32_bf16 v[36:39], v[212:215], v[200:203], v[36:39]
    ds_read_b64_tr_b16 v[230:231], v187 offset:18432
    v_mfma_f32_16x16x32_bf16 v[44:47], v[212:215], v[204:207], v[44:47]
    ds_read_b128 v[212:215], v184 offset:12288
    s_waitcnt lgkmcnt(10)
    v_mfma_f32_16x16x32_bf16 v[72:75], v[216:219], v[204:207], v[72:75]
    ds_read_b64_tr_b16 v[224:225], v186 offset:16384
    v_mfma_f32_16x16x32_bf16 v[64:67], v[216:219], v[200:203], v[64:67]
    ds_read_b64_tr_b16 v[226:227], v186 offset:18432
    v_mfma_f32_16x16x32_bf16 v[56:59], v[216:219], v[196:199], v[56:59]
    v_mfma_f32_16x16x32_bf16 v[48:51], v[216:219], v[192:195], v[48:51]
    ds_read_b128 v[216:219], v184 offset:14336
    s_waitcnt lgkmcnt(12)
    v_mfma_f32_16x16x32_bf16 v[52:55], v[220:223], v[192:195], v[52:55]
    v_mfma_f32_16x16x32_bf16 v[60:63], v[220:223], v[196:199], v[60:63]
    v_mfma_f32_16x16x32_bf16 v[68:71], v[220:223], v[200:203], v[68:71]
    v_mfma_f32_16x16x32_bf16 v[76:79], v[220:223], v[204:207], v[76:79]
    ds_read_b128 v[220:223], v185 offset:0
    s_waitcnt lgkmcnt(12)
    v_mfma_f32_16x16x32_bf16 v[104:107], v[252:255], v[204:207], v[104:107]
    v_mfma_f32_16x16x32_bf16 v[96:99], v[252:255], v[200:203], v[96:99]
    v_mfma_f32_16x16x32_bf16 v[88:91], v[252:255], v[196:199], v[88:91]
    v_mfma_f32_16x16x32_bf16 v[80:83], v[252:255], v[192:195], v[80:83]
    ds_read_b128 v[252:255], v185 offset:2048
    s_waitcnt lgkmcnt(9)
    v_mfma_f32_16x16x32_bf16 v[84:87], v[208:211], v[192:195], v[84:87]
    v_mfma_f32_16x16x32_bf16 v[92:95], v[208:211], v[196:199], v[92:95]
    v_mfma_f32_16x16x32_bf16 v[100:103], v[208:211], v[200:203], v[100:103]
    v_mfma_f32_16x16x32_bf16 v[108:111], v[208:211], v[204:207], v[108:111]
    ds_read_b128 v[208:211], v185 offset:4096
    s_waitcnt lgkmcnt(6)
    v_mfma_f32_16x16x32_bf16 v[136:139], v[212:215], v[204:207], v[136:139]
    v_mfma_f32_16x16x32_bf16 v[128:131], v[212:215], v[200:203], v[128:131]
    v_mfma_f32_16x16x32_bf16 v[120:123], v[212:215], v[196:199], v[120:123]
    v_mfma_f32_16x16x32_bf16 v[112:115], v[212:215], v[192:195], v[112:115]
    ds_read_b128 v[212:215], v185 offset:6144
    s_waitcnt lgkmcnt(4)
    v_mfma_f32_16x16x32_bf16 v[116:119], v[216:219], v[192:195], v[116:119]
    v_mfma_f32_16x16x32_bf16 v[124:127], v[216:219], v[196:199], v[124:127]
    v_mfma_f32_16x16x32_bf16 v[132:135], v[216:219], v[200:203], v[132:135]
    v_mfma_f32_16x16x32_bf16 v[140:143], v[216:219], v[204:207], v[140:143]
    ds_read_b128 v[216:219], v185 offset:8192
    s_waitcnt lgkmcnt(4)
    v_mfma_f32_16x16x32_bf16 v[40:43], v[220:223], v[236:239], v[40:43]
    v_mfma_f32_16x16x32_bf16 v[32:35], v[220:223], v[232:235], v[32:35]
    v_mfma_f32_16x16x32_bf16 v[24:27], v[220:223], v[228:231], v[24:27]
    v_mfma_f32_16x16x32_bf16 v[16:19], v[220:223], v[224:227], v[16:19]
    ds_read_b128 v[220:223], v185 offset:10240
    s_waitcnt lgkmcnt(4)
    v_mfma_f32_16x16x32_bf16 v[20:23], v[252:255], v[224:227], v[20:23]
    v_mfma_f32_16x16x32_bf16 v[28:31], v[252:255], v[228:231], v[28:31]
    v_mfma_f32_16x16x32_bf16 v[36:39], v[252:255], v[232:235], v[36:39]
    v_mfma_f32_16x16x32_bf16 v[44:47], v[252:255], v[236:239], v[44:47]
    ds_read_b128 v[252:255], v185 offset:12288
    s_waitcnt lgkmcnt(4)
    v_mfma_f32_16x16x32_bf16 v[72:75], v[208:211], v[236:239], v[72:75]
    v_bfe_u32 v8, v0, 4, 1
    v_and_b32 v9, 3, v0
    v_lshl_add_u32 v8, v8, 2, v9
    v_lshlrev_b32 v8, 3, v8
    v_mfma_f32_16x16x32_bf16 v[64:67], v[208:211], v[232:235], v[64:67]
    v_bfe_u32 v9, v0, 2, 2
    v_lshlrev_b32 v11, 8, v9
    v_lshl_add_u32 v11, v10, 12, v11
    s_mov_b32 s58, 0x70506848
    v_mfma_f32_16x16x32_bf16 v[56:59], v[208:211], v[228:231], v[56:59]
    s_mov_b32 s59, 0xa0807858
    s_cmp_eq_u32 s15, 0
    s_cselect_b32 s56, 0x28082000, s58
    s_cselect_b32 s57, 0x38183010, s59
    v_lshrrev_b64 v[12:13], v8, s[56:57]
    v_lshl_add_u32 v12, v9, 6, v12
    v_mfma_f32_16x16x32_bf16 v[48:51], v[208:211], v[224:227], v[48:51]
    ds_read_b128 v[208:211], v185 offset:14336
    s_waitcnt lgkmcnt(4)
    v_mfma_f32_16x16x32_bf16 v[52:55], v[212:215], v[224:227], v[52:55]
    v_and_b32 v12, 255, v12
    v_add_u32 v248, v12, v11
    s_mov_b32 s58, 0xb0d8a888
    s_mov_b32 s59, 0xe8e8b8e0
    v_mfma_f32_16x16x32_bf16 v[60:63], v[212:215], v[228:231], v[60:63]
    s_cmp_eq_u32 s15, 0
    s_cselect_b32 s56, 0x98c06040, s58
    s_cselect_b32 s57, 0x9090d0c8, s59
    v_lshrrev_b64 v[12:13], v8, s[56:57]
    v_lshl_add_u32 v12, v9, 6, v12
    v_and_b32 v12, 255, v12
    v_mfma_f32_16x16x32_bf16 v[68:71], v[212:215], v[232:235], v[68:71]
    v_add_u32 v249, v12, v11
    v_mfma_f32_16x16x32_bf16 v[76:79], v[212:215], v[236:239], v[76:79]
    s_waitcnt lgkmcnt(0)
    v_xor_b32 v184, 65536, v184
    v_xor_b32 v185, 65536, v185
    v_xor_b32 v186, 0x10000, v186
    v_xor_b32 v187, 0x10000, v187
    v_xor_b32 v188, 0x10000, v188
    v_xor_b32 v189, 0x10000, v189
    s_barrier
    v_mfma_f32_16x16x32_bf16 v[104:107], v[216:219], v[236:239], v[104:107]
    ds_read_b64_tr_b16 v[204:205], v189 offset:0
    ds_read_b64_tr_b16 v[206:207], v189 offset:2048
    v_mfma_f32_16x16x32_bf16 v[96:99], v[216:219], v[232:235], v[96:99]
    ds_read_b128 v[212:215], v184 offset:0
    ds_read_b64_tr_b16 v[200:201], v188 offset:0
    v_mfma_f32_16x16x32_bf16 v[88:91], v[216:219], v[228:231], v[88:91]
    ds_read_b64_tr_b16 v[202:203], v188 offset:2048
    ds_read_b64_tr_b16 v[196:197], v187 offset:0
    v_mfma_f32_16x16x32_bf16 v[80:83], v[216:219], v[224:227], v[80:83]
    ds_read_b64_tr_b16 v[198:199], v187 offset:2048
    ds_read_b128 v[216:219], v184 offset:2048
    v_mfma_f32_16x16x32_bf16 v[84:87], v[220:223], v[224:227], v[84:87]
    ds_read_b64_tr_b16 v[192:193], v186 offset:0
    ds_read_b64_tr_b16 v[194:195], v186 offset:2048
    v_mfma_f32_16x16x32_bf16 v[92:95], v[220:223], v[228:231], v[92:95]
    v_mfma_f32_16x16x32_bf16 v[100:103], v[220:223], v[232:235], v[100:103]
    v_mfma_f32_16x16x32_bf16 v[108:111], v[220:223], v[236:239], v[108:111]
    ds_read_b128 v[220:223], v184 offset:4096
    v_mfma_f32_16x16x32_bf16 v[136:139], v[252:255], v[236:239], v[136:139]
    v_mfma_f32_16x16x32_bf16 v[128:131], v[252:255], v[232:235], v[128:131]
    v_mfma_f32_16x16x32_bf16 v[120:123], v[252:255], v[228:231], v[120:123]
    v_mfma_f32_16x16x32_bf16 v[112:115], v[252:255], v[224:227], v[112:115]
    ds_read_b128 v[252:255], v184 offset:6144
    v_mfma_f32_16x16x32_bf16 v[116:119], v[208:211], v[224:227], v[116:119]
    v_mfma_f32_16x16x32_bf16 v[124:127], v[208:211], v[228:231], v[124:127]
    v_mfma_f32_16x16x32_bf16 v[132:135], v[208:211], v[232:235], v[132:135]
    v_mfma_f32_16x16x32_bf16 v[140:143], v[208:211], v[236:239], v[140:143]
    ds_read_b128 v[208:211], v184 offset:8192
    s_waitcnt lgkmcnt(3)
    v_mfma_f32_16x16x32_bf16 v[40:43], v[212:215], v[204:207], v[40:43]
    ds_read_b64_tr_b16 v[236:237], v189 offset:16384
    v_mfma_f32_16x16x32_bf16 v[32:35], v[212:215], v[200:203], v[32:35]
    ds_read_b64_tr_b16 v[238:239], v189 offset:18432
    v_mfma_f32_16x16x32_bf16 v[24:27], v[212:215], v[196:199], v[24:27]
    ds_read_b64_tr_b16 v[232:233], v188 offset:16384
    v_mfma_f32_16x16x32_bf16 v[16:19], v[212:215], v[192:195], v[16:19]
    ds_read_b128 v[212:215], v184 offset:10240
    v_mfma_f32_16x16x32_bf16 v[20:23], v[216:219], v[192:195], v[20:23]
    ds_read_b64_tr_b16 v[234:235], v188 offset:18432
    v_mfma_f32_16x16x32_bf16 v[28:31], v[216:219], v[196:199], v[28:31]
    ds_read_b64_tr_b16 v[228:229], v187 offset:16384
    v_mfma_f32_16x16x32_bf16 v[36:39], v[216:219], v[200:203], v[36:39]
    ds_read_b64_tr_b16 v[230:231], v187 offset:18432
    v_mfma_f32_16x16x32_bf16 v[44:47], v[216:219], v[204:207], v[44:47]
    ds_read_b128 v[216:219], v184 offset:12288
    s_waitcnt lgkmcnt(10)
    v_mfma_f32_16x16x32_bf16 v[72:75], v[220:223], v[204:207], v[72:75]
    ds_read_b64_tr_b16 v[224:225], v186 offset:16384
    s_mov_b32 s40, s4
    s_and_b32 s41, s5, 0xffff
    s_mov_b32 s42, 2621440
    s_mov_b32 s43, 0x20000
    v_mfma_f32_16x16x32_bf16 v[64:67], v[220:223], v[200:203], v[64:67]
    ds_read_b64_tr_b16 v[226:227], v186 offset:18432
    s_lshl_b32 s13, s2, 3
    v_mfma_f32_16x16x32_bf16 v[56:59], v[220:223], v[196:199], v[56:59]
    s_add_u32 s13, s13, s12
    v_mfma_f32_16x16x32_bf16 v[48:51], v[220:223], v[192:195], v[48:51]
    ds_read_b128 v[220:223], v184 offset:14336
    s_waitcnt lgkmcnt(12)
    v_mfma_f32_16x16x32_bf16 v[52:55], v[252:255], v[192:195], v[52:55]
    s_mul_i32 s13, s13, 1280
    v_mfma_f32_16x16x32_bf16 v[60:63], v[252:255], v[196:199], v[60:63]
    buffer_load_dword v166, v167, s[40:43], s13 offen
    v_mfma_f32_16x16x32_bf16 v[68:71], v[252:255], v[200:203], v[68:71]
    v_mfma_f32_16x16x32_bf16 v[76:79], v[252:255], v[204:207], v[76:79]
    ds_read_b128 v[252:255], v185 offset:0
    s_waitcnt lgkmcnt(12)
    v_mfma_f32_16x16x32_bf16 v[104:107], v[208:211], v[204:207], v[104:107]
    v_mfma_f32_16x16x32_bf16 v[96:99], v[208:211], v[200:203], v[96:99]
    v_mfma_f32_16x16x32_bf16 v[88:91], v[208:211], v[196:199], v[88:91]
    v_mfma_f32_16x16x32_bf16 v[80:83], v[208:211], v[192:195], v[80:83]
    ds_read_b128 v[208:211], v185 offset:2048
    s_waitcnt lgkmcnt(9)
    v_mfma_f32_16x16x32_bf16 v[84:87], v[212:215], v[192:195], v[84:87]
    v_mfma_f32_16x16x32_bf16 v[92:95], v[212:215], v[196:199], v[92:95]
    v_mfma_f32_16x16x32_bf16 v[100:103], v[212:215], v[200:203], v[100:103]
    v_mfma_f32_16x16x32_bf16 v[108:111], v[212:215], v[204:207], v[108:111]
    ds_read_b128 v[212:215], v185 offset:4096
    s_waitcnt lgkmcnt(6)
    v_mfma_f32_16x16x32_bf16 v[136:139], v[216:219], v[204:207], v[136:139]
    s_mov_b32 s40, s72
    s_and_b32 s41, s73, 0xffff
    s_mov_b32 s42, 5242880
    s_mov_b32 s43, 0x20000
    s_and_b32 s13, s2, 248
    v_mfma_f32_16x16x32_bf16 v[128:131], v[216:219], v[200:203], v[128:131]
    s_add_u32 s13, s13, s12
    s_lshl_b32 s13, s13, 13
    v_mfma_f32_16x16x32_bf16 v[120:123], v[216:219], v[196:199], v[120:123]
    s_and_b32 s14, s2, 7
    s_lshl_b32 s14, s14, 10
    v_mfma_f32_16x16x32_bf16 v[112:115], v[216:219], v[192:195], v[112:115]
    ds_read_b128 v[216:219], v185 offset:6144
    s_waitcnt lgkmcnt(4)
    v_mfma_f32_16x16x32_bf16 v[116:119], v[220:223], v[192:195], v[116:119]
    s_add_u32 s13, s13, s14
    buffer_load_dword v166, v1, s[40:43], s13 offen
    v_mfma_f32_16x16x32_bf16 v[124:127], v[220:223], v[196:199], v[124:127]
    v_mfma_f32_16x16x32_bf16 v[132:135], v[220:223], v[200:203], v[132:135]
    v_mfma_f32_16x16x32_bf16 v[140:143], v[220:223], v[204:207], v[140:143]
    ds_read_b128 v[220:223], v185 offset:8192
    s_waitcnt lgkmcnt(4)
    v_mfma_f32_16x16x32_bf16 v[40:43], v[252:255], v[236:239], v[40:43]
    v_mfma_f32_16x16x32_bf16 v[32:35], v[252:255], v[232:235], v[32:35]
    v_mfma_f32_16x16x32_bf16 v[24:27], v[252:255], v[228:231], v[24:27]
    v_mfma_f32_16x16x32_bf16 v[16:19], v[252:255], v[224:227], v[16:19]
    ds_read_b128 v[252:255], v185 offset:10240
    s_waitcnt lgkmcnt(4)
    v_mfma_f32_16x16x32_bf16 v[20:23], v[208:211], v[224:227], v[20:23]
    v_mfma_f32_16x16x32_bf16 v[28:31], v[208:211], v[228:231], v[28:31]
    v_mfma_f32_16x16x32_bf16 v[36:39], v[208:211], v[232:235], v[36:39]
    v_mfma_f32_16x16x32_bf16 v[44:47], v[208:211], v[236:239], v[44:47]
    ds_read_b128 v[208:211], v185 offset:12288
    s_waitcnt lgkmcnt(4)
    v_mfma_f32_16x16x32_bf16 v[72:75], v[212:215], v[236:239], v[72:75]
    v_mfma_f32_16x16x32_bf16 v[64:67], v[212:215], v[232:235], v[64:67]
    v_mfma_f32_16x16x32_bf16 v[56:59], v[212:215], v[228:231], v[56:59]
    v_mfma_f32_16x16x32_bf16 v[48:51], v[212:215], v[224:227], v[48:51]
    ds_read_b128 v[212:215], v185 offset:14336
    s_waitcnt lgkmcnt(4)
    v_mfma_f32_16x16x32_bf16 v[52:55], v[216:219], v[224:227], v[52:55]
    v_mfma_f32_16x16x32_bf16 v[60:63], v[216:219], v[228:231], v[60:63]
    v_mfma_f32_16x16x32_bf16 v[68:71], v[216:219], v[232:235], v[68:71]
    v_mfma_f32_16x16x32_bf16 v[76:79], v[216:219], v[236:239], v[76:79]
    s_waitcnt lgkmcnt(0)
    v_xor_b32 v184, 65536, v184
    v_xor_b32 v185, 65536, v185
    v_xor_b32 v186, 0x10000, v186
    v_xor_b32 v187, 0x10000, v187
    v_xor_b32 v188, 0x10000, v188
    v_xor_b32 v189, 0x10000, v189
    s_barrier
    v_mfma_f32_16x16x32_bf16 v[104:107], v[220:223], v[236:239], v[104:107]
    ds_read_b64_tr_b16 v[204:205], v189 offset:0
    ds_read_b64_tr_b16 v[206:207], v189 offset:2048
    v_mfma_f32_16x16x32_bf16 v[96:99], v[220:223], v[232:235], v[96:99]
    ds_read_b128 v[216:219], v184 offset:0
    ds_read_b64_tr_b16 v[200:201], v188 offset:0
    v_mfma_f32_16x16x32_bf16 v[88:91], v[220:223], v[228:231], v[88:91]
    ds_read_b64_tr_b16 v[202:203], v188 offset:2048
    ds_read_b64_tr_b16 v[196:197], v187 offset:0
    v_mfma_f32_16x16x32_bf16 v[80:83], v[220:223], v[224:227], v[80:83]
    ds_read_b64_tr_b16 v[198:199], v187 offset:2048
    ds_read_b128 v[220:223], v184 offset:2048
    v_mfma_f32_16x16x32_bf16 v[84:87], v[252:255], v[224:227], v[84:87]
    ds_read_b64_tr_b16 v[192:193], v186 offset:0
    ds_read_b64_tr_b16 v[194:195], v186 offset:2048
    v_mfma_f32_16x16x32_bf16 v[92:95], v[252:255], v[228:231], v[92:95]
    v_mfma_f32_16x16x32_bf16 v[100:103], v[252:255], v[232:235], v[100:103]
    v_mfma_f32_16x16x32_bf16 v[108:111], v[252:255], v[236:239], v[108:111]
    ds_read_b128 v[252:255], v184 offset:4096
    v_mfma_f32_16x16x32_bf16 v[136:139], v[208:211], v[236:239], v[136:139]
    v_mfma_f32_16x16x32_bf16 v[128:131], v[208:211], v[232:235], v[128:131]
    v_mfma_f32_16x16x32_bf16 v[120:123], v[208:211], v[228:231], v[120:123]
    v_mfma_f32_16x16x32_bf16 v[112:115], v[208:211], v[224:227], v[112:115]
    ds_read_b128 v[208:211], v184 offset:6144
    v_mfma_f32_16x16x32_bf16 v[116:119], v[212:215], v[224:227], v[116:119]
    v_mfma_f32_16x16x32_bf16 v[124:127], v[212:215], v[228:231], v[124:127]
    v_mfma_f32_16x16x32_bf16 v[132:135], v[212:215], v[232:235], v[132:135]
    v_mfma_f32_16x16x32_bf16 v[140:143], v[212:215], v[236:239], v[140:143]
    ds_read_b128 v[212:215], v184 offset:8192
    s_waitcnt lgkmcnt(3)
    v_mfma_f32_16x16x32_bf16 v[40:43], v[216:219], v[204:207], v[40:43]
    ds_read_b64_tr_b16 v[236:237], v189 offset:16384
    v_mfma_f32_16x16x32_bf16 v[32:35], v[216:219], v[200:203], v[32:35]
    ds_read_b64_tr_b16 v[238:239], v189 offset:18432
    v_mfma_f32_16x16x32_bf16 v[24:27], v[216:219], v[196:199], v[24:27]
    ds_read_b64_tr_b16 v[232:233], v188 offset:16384
    v_mfma_f32_16x16x32_bf16 v[16:19], v[216:219], v[192:195], v[16:19]
    ds_read_b128 v[216:219], v184 offset:10240
    v_mfma_f32_16x16x32_bf16 v[20:23], v[220:223], v[192:195], v[20:23]
    ds_read_b64_tr_b16 v[234:235], v188 offset:18432
    v_mfma_f32_16x16x32_bf16 v[28:31], v[220:223], v[196:199], v[28:31]
    ds_read_b64_tr_b16 v[228:229], v187 offset:16384
    v_mfma_f32_16x16x32_bf16 v[36:39], v[220:223], v[200:203], v[36:39]
    ds_read_b64_tr_b16 v[230:231], v187 offset:18432
    v_mfma_f32_16x16x32_bf16 v[44:47], v[220:223], v[204:207], v[44:47]
    ds_read_b128 v[220:223], v184 offset:12288
    s_waitcnt lgkmcnt(10)
    v_mfma_f32_16x16x32_bf16 v[72:75], v[252:255], v[204:207], v[72:75]
    ds_read_b64_tr_b16 v[224:225], v186 offset:16384
    s_mov_b32 s40, s72
    s_and_b32 s41, s73, 0xffff
    s_mov_b32 s42, 5242880
    s_mov_b32 s43, 0x20000
    s_and_b32 s13, s2, 248
    v_mfma_f32_16x16x32_bf16 v[64:67], v[252:255], v[200:203], v[64:67]
    ds_read_b64_tr_b16 v[226:227], v186 offset:18432
    s_add_u32 s13, s13, s12
    s_lshl_b32 s13, s13, 13
    v_mfma_f32_16x16x32_bf16 v[56:59], v[252:255], v[196:199], v[56:59]
    s_and_b32 s14, s2, 7
    s_lshl_b32 s14, s14, 10
    v_mfma_f32_16x16x32_bf16 v[48:51], v[252:255], v[192:195], v[48:51]
    ds_read_b128 v[252:255], v184 offset:14336
    s_waitcnt lgkmcnt(12)
    v_mfma_f32_16x16x32_bf16 v[52:55], v[208:211], v[192:195], v[52:55]
    s_add_u32 s13, s13, s14
    s_add_u32 s13, s13, 2097152
    v_mfma_f32_16x16x32_bf16 v[60:63], v[208:211], v[196:199], v[60:63]
    buffer_load_dword v166, v1, s[40:43], s13 offen
    v_mfma_f32_16x16x32_bf16 v[68:71], v[208:211], v[200:203], v[68:71]
    v_mfma_f32_16x16x32_bf16 v[76:79], v[208:211], v[204:207], v[76:79]
    ds_read_b128 v[208:211], v185 offset:0
    s_waitcnt lgkmcnt(12)
    v_mfma_f32_16x16x32_bf16 v[104:107], v[212:215], v[204:207], v[104:107]
    v_mfma_f32_16x16x32_bf16 v[96:99], v[212:215], v[200:203], v[96:99]
    v_mfma_f32_16x16x32_bf16 v[88:91], v[212:215], v[196:199], v[88:91]
    v_mfma_f32_16x16x32_bf16 v[80:83], v[212:215], v[192:195], v[80:83]
    ds_read_b128 v[212:215], v185 offset:2048
    s_waitcnt lgkmcnt(9)
    v_mfma_f32_16x16x32_bf16 v[84:87], v[216:219], v[192:195], v[84:87]
    v_mfma_f32_16x16x32_bf16 v[92:95], v[216:219], v[196:199], v[92:95]
    v_mfma_f32_16x16x32_bf16 v[100:103], v[216:219], v[200:203], v[100:103]
    v_mfma_f32_16x16x32_bf16 v[108:111], v[216:219], v[204:207], v[108:111]
    ds_read_b128 v[216:219], v185 offset:4096
    s_waitcnt lgkmcnt(6)
    v_mfma_f32_16x16x32_bf16 v[136:139], v[220:223], v[204:207], v[136:139]
    s_mov_b32 s40, s72
    s_and_b32 s41, s73, 0xffff
    s_mov_b32 s42, 5242880
    s_mov_b32 s43, 0x20000
    s_and_b32 s13, s2, 248
    v_mfma_f32_16x16x32_bf16 v[128:131], v[220:223], v[200:203], v[128:131]
    s_add_u32 s13, s13, s12
    s_lshl_b32 s13, s13, 13
    v_mfma_f32_16x16x32_bf16 v[120:123], v[220:223], v[196:199], v[120:123]
    s_and_b32 s14, s2, 7
    s_lshl_b32 s14, s14, 10
    v_mfma_f32_16x16x32_bf16 v[112:115], v[220:223], v[192:195], v[112:115]
    ds_read_b128 v[220:223], v185 offset:6144
    s_waitcnt lgkmcnt(4)
    v_mfma_f32_16x16x32_bf16 v[116:119], v[252:255], v[192:195], v[116:119]
    s_add_u32 s13, s13, s14
    s_add_u32 s13, s13, 4194304
    v_mfma_f32_16x16x32_bf16 v[124:127], v[252:255], v[196:199], v[124:127]
    buffer_load_dword v166, v1, s[40:43], s13 offen
    v_mfma_f32_16x16x32_bf16 v[132:135], v[252:255], v[200:203], v[132:135]
    v_mfma_f32_16x16x32_bf16 v[140:143], v[252:255], v[204:207], v[140:143]
    ds_read_b128 v[252:255], v185 offset:8192
    s_waitcnt lgkmcnt(4)
    v_mfma_f32_16x16x32_bf16 v[40:43], v[208:211], v[236:239], v[40:43]
    v_mfma_f32_16x16x32_bf16 v[32:35], v[208:211], v[232:235], v[32:35]
    v_mfma_f32_16x16x32_bf16 v[24:27], v[208:211], v[228:231], v[24:27]
    v_mfma_f32_16x16x32_bf16 v[16:19], v[208:211], v[224:227], v[16:19]
    ds_read_b128 v[208:211], v185 offset:10240
    s_waitcnt lgkmcnt(4)
    v_mfma_f32_16x16x32_bf16 v[20:23], v[212:215], v[224:227], v[20:23]
    v_mfma_f32_16x16x32_bf16 v[28:31], v[212:215], v[228:231], v[28:31]
    v_mfma_f32_16x16x32_bf16 v[36:39], v[212:215], v[232:235], v[36:39]
    v_mfma_f32_16x16x32_bf16 v[44:47], v[212:215], v[236:239], v[44:47]
    ds_read_b128 v[212:215], v185 offset:12288
    s_waitcnt lgkmcnt(4)
    v_mfma_f32_16x16x32_bf16 v[72:75], v[216:219], v[236:239], v[72:75]
    v_mfma_f32_16x16x32_bf16 v[64:67], v[216:219], v[232:235], v[64:67]
    v_mfma_f32_16x16x32_bf16 v[56:59], v[216:219], v[228:231], v[56:59]
    v_mfma_f32_16x16x32_bf16 v[48:51], v[216:219], v[224:227], v[48:51]
    ds_read_b128 v[216:219], v185 offset:14336
    s_waitcnt lgkmcnt(4)
    v_mfma_f32_16x16x32_bf16 v[52:55], v[220:223], v[224:227], v[52:55]
    v_mfma_f32_16x16x32_bf16 v[60:63], v[220:223], v[228:231], v[60:63]
    v_mfma_f32_16x16x32_bf16 v[68:71], v[220:223], v[232:235], v[68:71]
    v_mfma_f32_16x16x32_bf16 v[76:79], v[220:223], v[236:239], v[76:79]
    s_waitcnt lgkmcnt(0)
    v_xor_b32 v184, 65536, v184
    v_xor_b32 v185, 65536, v185
    v_xor_b32 v186, 0x10000, v186
    v_xor_b32 v187, 0x10000, v187
    v_xor_b32 v188, 0x10000, v188
    v_xor_b32 v189, 0x10000, v189
    s_barrier
    v_mfma_f32_16x16x32_bf16 v[104:107], v[252:255], v[236:239], v[104:107]
    ds_read_b64_tr_b16 v[204:205], v189 offset:0
    ds_read_b64_tr_b16 v[206:207], v189 offset:2048
    v_mfma_f32_16x16x32_bf16 v[96:99], v[252:255], v[232:235], v[96:99]
    ds_read_b128 v[220:223], v184 offset:0
    ds_read_b64_tr_b16 v[200:201], v188 offset:0
    v_mfma_f32_16x16x32_bf16 v[88:91], v[252:255], v[228:231], v[88:91]
    ds_read_b64_tr_b16 v[202:203], v188 offset:2048
    ds_read_b64_tr_b16 v[196:197], v187 offset:0
    v_mfma_f32_16x16x32_bf16 v[80:83], v[252:255], v[224:227], v[80:83]
    ds_read_b64_tr_b16 v[198:199], v187 offset:2048
    ds_read_b128 v[252:255], v184 offset:2048
    v_mfma_f32_16x16x32_bf16 v[84:87], v[208:211], v[224:227], v[84:87]
    ds_read_b64_tr_b16 v[192:193], v186 offset:0
    ds_read_b64_tr_b16 v[194:195], v186 offset:2048
    v_mfma_f32_16x16x32_bf16 v[92:95], v[208:211], v[228:231], v[92:95]
    v_mfma_f32_16x16x32_bf16 v[100:103], v[208:211], v[232:235], v[100:103]
    v_mfma_f32_16x16x32_bf16 v[108:111], v[208:211], v[236:239], v[108:111]
    ds_read_b128 v[208:211], v184 offset:4096
    v_mfma_f32_16x16x32_bf16 v[136:139], v[212:215], v[236:239], v[136:139]
    v_mfma_f32_16x16x32_bf16 v[128:131], v[212:215], v[232:235], v[128:131]
    v_mfma_f32_16x16x32_bf16 v[120:123], v[212:215], v[228:231], v[120:123]
    v_mfma_f32_16x16x32_bf16 v[112:115], v[212:215], v[224:227], v[112:115]
    ds_read_b128 v[212:215], v184 offset:6144
    v_mfma_f32_16x16x32_bf16 v[116:119], v[216:219], v[224:227], v[116:119]
    v_mfma_f32_16x16x32_bf16 v[124:127], v[216:219], v[228:231], v[124:127]
    v_mfma_f32_16x16x32_bf16 v[132:135], v[216:219], v[232:235], v[132:135]
    v_mfma_f32_16x16x32_bf16 v[140:143], v[216:219], v[236:239], v[140:143]
    ds_read_b128 v[216:219], v184 offset:8192
    s_waitcnt lgkmcnt(3)
    v_mfma_f32_16x16x32_bf16 v[40:43], v[220:223], v[204:207], v[40:43]
    ds_read_b64_tr_b16 v[236:237], v189 offset:16384
    v_mfma_f32_16x16x32_bf16 v[32:35], v[220:223], v[200:203], v[32:35]
    ds_read_b64_tr_b16 v[238:239], v189 offset:18432
    v_mfma_f32_16x16x32_bf16 v[24:27], v[220:223], v[196:199], v[24:27]
    ds_read_b64_tr_b16 v[232:233], v188 offset:16384
    v_mfma_f32_16x16x32_bf16 v[16:19], v[220:223], v[192:195], v[16:19]
    ds_read_b128 v[220:223], v184 offset:10240
    v_mfma_f32_16x16x32_bf16 v[20:23], v[252:255], v[192:195], v[20:23]
    ds_read_b64_tr_b16 v[234:235], v188 offset:18432
    v_mfma_f32_16x16x32_bf16 v[28:31], v[252:255], v[196:199], v[28:31]
    ds_read_b64_tr_b16 v[228:229], v187 offset:16384
    v_mfma_f32_16x16x32_bf16 v[36:39], v[252:255], v[200:203], v[36:39]
    ds_read_b64_tr_b16 v[230:231], v187 offset:18432
    v_mfma_f32_16x16x32_bf16 v[44:47], v[252:255], v[204:207], v[44:47]
    ds_read_b128 v[252:255], v184 offset:12288
    s_waitcnt lgkmcnt(10)
    v_mfma_f32_16x16x32_bf16 v[72:75], v[208:211], v[204:207], v[72:75]
    ds_read_b64_tr_b16 v[224:225], v186 offset:16384
    v_mfma_f32_16x16x32_bf16 v[64:67], v[208:211], v[200:203], v[64:67]
    ds_read_b64_tr_b16 v[226:227], v186 offset:18432
    v_mfma_f32_16x16x32_bf16 v[56:59], v[208:211], v[196:199], v[56:59]
    v_mfma_f32_16x16x32_bf16 v[48:51], v[208:211], v[192:195], v[48:51]
    ds_read_b128 v[208:211], v184 offset:14336
    s_waitcnt lgkmcnt(12)
    v_mfma_f32_16x16x32_bf16 v[52:55], v[212:215], v[192:195], v[52:55]
    v_mfma_f32_16x16x32_bf16 v[60:63], v[212:215], v[196:199], v[60:63]
    v_mfma_f32_16x16x32_bf16 v[68:71], v[212:215], v[200:203], v[68:71]
    v_mfma_f32_16x16x32_bf16 v[76:79], v[212:215], v[204:207], v[76:79]
    ds_read_b128 v[212:215], v185 offset:0
    s_waitcnt lgkmcnt(12)
    v_mfma_f32_16x16x32_bf16 v[104:107], v[216:219], v[204:207], v[104:107]
    v_mfma_f32_16x16x32_bf16 v[96:99], v[216:219], v[200:203], v[96:99]
    v_mfma_f32_16x16x32_bf16 v[88:91], v[216:219], v[196:199], v[88:91]
    v_mfma_f32_16x16x32_bf16 v[80:83], v[216:219], v[192:195], v[80:83]
    ds_read_b128 v[216:219], v185 offset:2048
    s_waitcnt lgkmcnt(9)
    v_mfma_f32_16x16x32_bf16 v[84:87], v[220:223], v[192:195], v[84:87]
    v_mfma_f32_16x16x32_bf16 v[92:95], v[220:223], v[196:199], v[92:95]
    v_mfma_f32_16x16x32_bf16 v[100:103], v[220:223], v[200:203], v[100:103]
    v_mfma_f32_16x16x32_bf16 v[108:111], v[220:223], v[204:207], v[108:111]
    ds_read_b128 v[220:223], v185 offset:4096
    s_waitcnt lgkmcnt(6)
    v_mfma_f32_16x16x32_bf16 v[136:139], v[252:255], v[204:207], v[136:139]
    v_mfma_f32_16x16x32_bf16 v[128:131], v[252:255], v[200:203], v[128:131]
    v_mfma_f32_16x16x32_bf16 v[120:123], v[252:255], v[196:199], v[120:123]
    v_mfma_f32_16x16x32_bf16 v[112:115], v[252:255], v[192:195], v[112:115]
    ds_read_b128 v[252:255], v185 offset:6144
    s_waitcnt lgkmcnt(4)
    v_mfma_f32_16x16x32_bf16 v[116:119], v[208:211], v[192:195], v[116:119]
    v_mfma_f32_16x16x32_bf16 v[124:127], v[208:211], v[196:199], v[124:127]
    v_mfma_f32_16x16x32_bf16 v[132:135], v[208:211], v[200:203], v[132:135]
    v_mfma_f32_16x16x32_bf16 v[140:143], v[208:211], v[204:207], v[140:143]
    ds_read_b128 v[208:211], v185 offset:8192
    s_waitcnt lgkmcnt(4)
    v_mfma_f32_16x16x32_bf16 v[40:43], v[212:215], v[236:239], v[40:43]
    v_mfma_f32_16x16x32_bf16 v[32:35], v[212:215], v[232:235], v[32:35]
    v_mfma_f32_16x16x32_bf16 v[24:27], v[212:215], v[228:231], v[24:27]
    v_mfma_f32_16x16x32_bf16 v[16:19], v[212:215], v[224:227], v[16:19]
    ds_read_b128 v[212:215], v185 offset:10240
    s_waitcnt lgkmcnt(4)
    v_mfma_f32_16x16x32_bf16 v[20:23], v[216:219], v[224:227], v[20:23]
    v_mfma_f32_16x16x32_bf16 v[28:31], v[216:219], v[228:231], v[28:31]
    v_mfma_f32_16x16x32_bf16 v[36:39], v[216:219], v[232:235], v[36:39]
    v_mfma_f32_16x16x32_bf16 v[44:47], v[216:219], v[236:239], v[44:47]
    ds_read_b128 v[216:219], v185 offset:12288
    s_waitcnt lgkmcnt(4)
    v_mfma_f32_16x16x32_bf16 v[72:75], v[220:223], v[236:239], v[72:75]
    v_mfma_f32_16x16x32_bf16 v[64:67], v[220:223], v[232:235], v[64:67]
    v_mfma_f32_16x16x32_bf16 v[56:59], v[220:223], v[228:231], v[56:59]
    v_mfma_f32_16x16x32_bf16 v[48:51], v[220:223], v[224:227], v[48:51]
    ds_read_b128 v[220:223], v185 offset:14336
    s_waitcnt lgkmcnt(4)
    v_mfma_f32_16x16x32_bf16 v[52:55], v[252:255], v[224:227], v[52:55]
    v_mfma_f32_16x16x32_bf16 v[60:63], v[252:255], v[228:231], v[60:63]
    v_mfma_f32_16x16x32_bf16 v[68:71], v[252:255], v[232:235], v[68:71]
    v_mfma_f32_16x16x32_bf16 v[76:79], v[252:255], v[236:239], v[76:79]
    s_waitcnt lgkmcnt(0)
    v_xor_b32 v184, 65536, v184
    v_xor_b32 v185, 65536, v185
    v_xor_b32 v186, 0x10000, v186
    v_xor_b32 v187, 0x10000, v187
    v_xor_b32 v188, 0x10000, v188
    v_xor_b32 v189, 0x10000, v189
    s_barrier
    v_mfma_f32_16x16x32_bf16 v[104:107], v[208:211], v[236:239], v[104:107]
    ds_read_b64_tr_b16 v[204:205], v189 offset:0
    ds_read_b64_tr_b16 v[206:207], v189 offset:2048
    v_mfma_f32_16x16x32_bf16 v[96:99], v[208:211], v[232:235], v[96:99]
    ds_read_b128 v[252:255], v184 offset:0
    ds_read_b64_tr_b16 v[200:201], v188 offset:0
    v_mfma_f32_16x16x32_bf16 v[88:91], v[208:211], v[228:231], v[88:91]
    ds_read_b64_tr_b16 v[202:203], v188 offset:2048
    ds_read_b64_tr_b16 v[196:197], v187 offset:0
    v_mfma_f32_16x16x32_bf16 v[80:83], v[208:211], v[224:227], v[80:83]
    ds_read_b64_tr_b16 v[198:199], v187 offset:2048
    ds_read_b128 v[208:211], v184 offset:2048
    v_mfma_f32_16x16x32_bf16 v[84:87], v[212:215], v[224:227], v[84:87]
    ds_read_b64_tr_b16 v[192:193], v186 offset:0
    ds_read_b64_tr_b16 v[194:195], v186 offset:2048
    v_mfma_f32_16x16x32_bf16 v[92:95], v[212:215], v[228:231], v[92:95]
    v_mfma_f32_16x16x32_bf16 v[100:103], v[212:215], v[232:235], v[100:103]
    v_mfma_f32_16x16x32_bf16 v[108:111], v[212:215], v[236:239], v[108:111]
    ds_read_b128 v[212:215], v184 offset:4096
    v_mfma_f32_16x16x32_bf16 v[136:139], v[216:219], v[236:239], v[136:139]
    v_mfma_f32_16x16x32_bf16 v[128:131], v[216:219], v[232:235], v[128:131]
    v_mfma_f32_16x16x32_bf16 v[120:123], v[216:219], v[228:231], v[120:123]
    v_mfma_f32_16x16x32_bf16 v[112:115], v[216:219], v[224:227], v[112:115]
    ds_read_b128 v[216:219], v184 offset:6144
    v_mfma_f32_16x16x32_bf16 v[116:119], v[220:223], v[224:227], v[116:119]
    v_mfma_f32_16x16x32_bf16 v[124:127], v[220:223], v[228:231], v[124:127]
    v_mfma_f32_16x16x32_bf16 v[132:135], v[220:223], v[232:235], v[132:135]
    v_mfma_f32_16x16x32_bf16 v[140:143], v[220:223], v[236:239], v[140:143]
    ds_read_b128 v[220:223], v184 offset:8192
    s_waitcnt lgkmcnt(3)
    v_mfma_f32_16x16x32_bf16 v[40:43], v[252:255], v[204:207], v[40:43]
    ds_read_b64_tr_b16 v[236:237], v189 offset:16384
    v_mfma_f32_16x16x32_bf16 v[32:35], v[252:255], v[200:203], v[32:35]
    ds_read_b64_tr_b16 v[238:239], v189 offset:18432
    v_mfma_f32_16x16x32_bf16 v[24:27], v[252:255], v[196:199], v[24:27]
    ds_read_b64_tr_b16 v[232:233], v188 offset:16384
    v_mfma_f32_16x16x32_bf16 v[16:19], v[252:255], v[192:195], v[16:19]
    ds_read_b128 v[252:255], v184 offset:10240
    v_mfma_f32_16x16x32_bf16 v[20:23], v[208:211], v[192:195], v[20:23]
    ds_read_b64_tr_b16 v[234:235], v188 offset:18432
    v_mfma_f32_16x16x32_bf16 v[28:31], v[208:211], v[196:199], v[28:31]
    ds_read_b64_tr_b16 v[228:229], v187 offset:16384
    v_mfma_f32_16x16x32_bf16 v[36:39], v[208:211], v[200:203], v[36:39]
    ds_read_b64_tr_b16 v[230:231], v187 offset:18432
    v_mfma_f32_16x16x32_bf16 v[44:47], v[208:211], v[204:207], v[44:47]
    ds_read_b128 v[208:211], v184 offset:12288
    s_waitcnt lgkmcnt(10)
    v_mfma_f32_16x16x32_bf16 v[72:75], v[212:215], v[204:207], v[72:75]
    ds_read_b64_tr_b16 v[224:225], v186 offset:16384
    v_mfma_f32_16x16x32_bf16 v[64:67], v[212:215], v[200:203], v[64:67]
    ds_read_b64_tr_b16 v[226:227], v186 offset:18432
    v_mfma_f32_16x16x32_bf16 v[56:59], v[212:215], v[196:199], v[56:59]
    v_mfma_f32_16x16x32_bf16 v[48:51], v[212:215], v[192:195], v[48:51]
    ds_read_b128 v[212:215], v184 offset:14336
    s_waitcnt lgkmcnt(12)
    v_mfma_f32_16x16x32_bf16 v[52:55], v[216:219], v[192:195], v[52:55]
    v_mfma_f32_16x16x32_bf16 v[60:63], v[216:219], v[196:199], v[60:63]
    v_mfma_f32_16x16x32_bf16 v[68:71], v[216:219], v[200:203], v[68:71]
    v_mfma_f32_16x16x32_bf16 v[76:79], v[216:219], v[204:207], v[76:79]
    ds_read_b128 v[216:219], v185 offset:0
    s_waitcnt lgkmcnt(12)
    v_mfma_f32_16x16x32_bf16 v[104:107], v[220:223], v[204:207], v[104:107]
    v_mfma_f32_16x16x32_bf16 v[96:99], v[220:223], v[200:203], v[96:99]
    v_mfma_f32_16x16x32_bf16 v[88:91], v[220:223], v[196:199], v[88:91]
    v_mfma_f32_16x16x32_bf16 v[80:83], v[220:223], v[192:195], v[80:83]
    ds_read_b128 v[220:223], v185 offset:2048
    s_waitcnt lgkmcnt(9)
    v_mfma_f32_16x16x32_bf16 v[84:87], v[252:255], v[192:195], v[84:87]
    v_mfma_f32_16x16x32_bf16 v[92:95], v[252:255], v[196:199], v[92:95]
    v_mfma_f32_16x16x32_bf16 v[100:103], v[252:255], v[200:203], v[100:103]
    v_mfma_f32_16x16x32_bf16 v[108:111], v[252:255], v[204:207], v[108:111]
    ds_read_b128 v[252:255], v185 offset:4096
    s_waitcnt lgkmcnt(6)
    v_mfma_f32_16x16x32_bf16 v[136:139], v[208:211], v[204:207], v[136:139]
    v_mfma_f32_16x16x32_bf16 v[128:131], v[208:211], v[200:203], v[128:131]
    v_mfma_f32_16x16x32_bf16 v[120:123], v[208:211], v[196:199], v[120:123]
    v_mfma_f32_16x16x32_bf16 v[112:115], v[208:211], v[192:195], v[112:115]
    ds_read_b128 v[208:211], v185 offset:6144
    s_waitcnt lgkmcnt(4)
    v_mfma_f32_16x16x32_bf16 v[116:119], v[212:215], v[192:195], v[116:119]
    v_mfma_f32_16x16x32_bf16 v[124:127], v[212:215], v[196:199], v[124:127]
    v_mfma_f32_16x16x32_bf16 v[132:135], v[212:215], v[200:203], v[132:135]
    v_mfma_f32_16x16x32_bf16 v[140:143], v[212:215], v[204:207], v[140:143]
    ds_read_b128 v[212:215], v185 offset:8192
    s_waitcnt lgkmcnt(4)
    v_mfma_f32_16x16x32_bf16 v[40:43], v[216:219], v[236:239], v[40:43]
    v_mfma_f32_16x16x32_bf16 v[32:35], v[216:219], v[232:235], v[32:35]
    v_mfma_f32_16x16x32_bf16 v[24:27], v[216:219], v[228:231], v[24:27]
    v_mfma_f32_16x16x32_bf16 v[16:19], v[216:219], v[224:227], v[16:19]
    ds_read_b128 v[216:219], v185 offset:10240
    s_waitcnt lgkmcnt(4)
    v_mfma_f32_16x16x32_bf16 v[20:23], v[220:223], v[224:227], v[20:23]
    v_mfma_f32_16x16x32_bf16 v[28:31], v[220:223], v[228:231], v[28:31]
    v_mfma_f32_16x16x32_bf16 v[36:39], v[220:223], v[232:235], v[36:39]
    v_mfma_f32_16x16x32_bf16 v[44:47], v[220:223], v[236:239], v[44:47]
    ds_read_b128 v[220:223], v185 offset:12288
    s_waitcnt lgkmcnt(4)
    v_mfma_f32_16x16x32_bf16 v[72:75], v[252:255], v[236:239], v[72:75]
    v_cvt_pk_bf16_f32 v16, v16, v17
    v_cvt_pk_bf16_f32 v17, v18, v19
    v_cvt_pk_bf16_f32 v18, v20, v21
    v_cvt_pk_bf16_f32 v19, v22, v23
    v_mfma_f32_16x16x32_bf16 v[64:67], v[252:255], v[232:235], v[64:67]
    v_cvt_pk_bf16_f32 v20, v24, v25
    v_cvt_pk_bf16_f32 v21, v26, v27
    v_cvt_pk_bf16_f32 v22, v28, v29
    v_cvt_pk_bf16_f32 v23, v30, v31
    v_mfma_f32_16x16x32_bf16 v[56:59], v[252:255], v[228:231], v[56:59]
    v_cvt_pk_bf16_f32 v24, v32, v33
    v_cvt_pk_bf16_f32 v25, v34, v35
    v_cvt_pk_bf16_f32 v26, v36, v37
    v_cvt_pk_bf16_f32 v27, v38, v39
    v_mfma_f32_16x16x32_bf16 v[48:51], v[252:255], v[224:227], v[48:51]
    ds_read_b128 v[252:255], v185 offset:14336
    v_cvt_pk_bf16_f32 v28, v40, v41
    v_cvt_pk_bf16_f32 v29, v42, v43
    v_cvt_pk_bf16_f32 v30, v44, v45
    v_cvt_pk_bf16_f32 v31, v46, v47
    s_waitcnt lgkmcnt(4)
    v_mfma_f32_16x16x32_bf16 v[52:55], v[208:211], v[224:227], v[52:55]
    v_mfma_f32_16x16x32_bf16 v[60:63], v[208:211], v[228:231], v[60:63]
    v_mfma_f32_16x16x32_bf16 v[68:71], v[208:211], v[232:235], v[68:71]
    v_mfma_f32_16x16x32_bf16 v[76:79], v[208:211], v[236:239], v[76:79]
    s_waitcnt lgkmcnt(0)
    s_barrier
    v_mfma_f32_16x16x32_bf16 v[104:107], v[212:215], v[236:239], v[104:107]
    ds_read_b128 v[192:195], v244 offset:0
    ds_read_b64_tr_b16 v[196:197], v248 offset:0
    ds_read_b64_tr_b16 v[198:199], v248 offset:1024
    v_cvt_pk_bf16_f32 v32, v48, v49
    v_cvt_pk_bf16_f32 v33, v50, v51
    v_cvt_pk_bf16_f32 v34, v52, v53
    v_cvt_pk_bf16_f32 v35, v54, v55
    v_mfma_f32_16x16x32_bf16 v[96:99], v[212:215], v[232:235], v[96:99]
    ds_read_b64_tr_b16 v[200:201], v249 offset:0
    ds_read_b64_tr_b16 v[202:203], v249 offset:1024
    v_cvt_pk_bf16_f32 v36, v56, v57
    v_cvt_pk_bf16_f32 v37, v58, v59
    v_cvt_pk_bf16_f32 v38, v60, v61
    v_cvt_pk_bf16_f32 v39, v62, v63
    v_mfma_f32_16x16x32_bf16 v[88:91], v[212:215], v[228:231], v[88:91]
    v_cvt_pk_bf16_f32 v40, v64, v65
    v_cvt_pk_bf16_f32 v41, v66, v67
    v_cvt_pk_bf16_f32 v42, v68, v69
    v_cvt_pk_bf16_f32 v43, v70, v71
    v_mfma_f32_16x16x32_bf16 v[80:83], v[212:215], v[224:227], v[80:83]
    v_cvt_pk_bf16_f32 v44, v72, v73
    v_cvt_pk_bf16_f32 v45, v74, v75
    v_cvt_pk_bf16_f32 v46, v76, v77
    v_cvt_pk_bf16_f32 v47, v78, v79
    v_mfma_f32_16x16x32_bf16 v[84:87], v[216:219], v[224:227], v[84:87]
    ds_read_b128 v[204:207], v245 offset:0
    ds_read_b64_tr_b16 v[208:209], v248 offset:8192
    ds_read_b64_tr_b16 v[210:211], v248 offset:9216
    v_mfma_f32_16x16x32_bf16 v[92:95], v[216:219], v[228:231], v[92:95]
    ds_read_b64_tr_b16 v[212:213], v249 offset:8192
    ds_read_b64_tr_b16 v[214:215], v249 offset:9216
    v_mfma_f32_16x16x32_bf16 v[100:103], v[216:219], v[232:235], v[100:103]
    v_mfma_f32_16x16x32_bf16 v[108:111], v[216:219], v[236:239], v[108:111]
    v_mfma_f32_16x16x32_bf16 v[136:139], v[220:223], v[236:239], v[136:139]
    ds_read_b128 v[216:219], v246 offset:0
    v_cvt_pk_bf16_f32 v48, v80, v81
    v_cvt_pk_bf16_f32 v49, v82, v83
    v_cvt_pk_bf16_f32 v50, v84, v85
    v_cvt_pk_bf16_f32 v51, v86, v87
    v_mfma_f32_16x16x32_bf16 v[128:131], v[220:223], v[232:235], v[128:131]
    v_cvt_pk_bf16_f32 v52, v88, v89
    v_cvt_pk_bf16_f32 v53, v90, v91
    v_cvt_pk_bf16_f32 v54, v92, v93
    v_cvt_pk_bf16_f32 v55, v94, v95
    v_mfma_f32_16x16x32_bf16 v[120:123], v[220:223], v[228:231], v[120:123]
    v_cvt_pk_bf16_f32 v56, v96, v97
    v_cvt_pk_bf16_f32 v57, v98, v99
    v_cvt_pk_bf16_f32 v58, v100, v101
    v_cvt_pk_bf16_f32 v59, v102, v103
    v_mfma_f32_16x16x32_bf16 v[112:115], v[220:223], v[224:227], v[112:115]
    v_cvt_pk_bf16_f32 v60, v104, v105
    v_cvt_pk_bf16_f32 v61, v106, v107
    v_cvt_pk_bf16_f32 v62, v108, v109
    v_cvt_pk_bf16_f32 v63, v110, v111
    v_mfma_f32_16x16x32_bf16 v[116:119], v[252:255], v[224:227], v[116:119]
    ds_read_b64_tr_b16 v[220:221], v248 offset:16384
    ds_read_b64_tr_b16 v[222:223], v248 offset:17408
    v_mfma_f32_16x16x32_bf16 v[124:127], v[252:255], v[228:231], v[124:127]
    v_mfma_f32_16x16x32_bf16 v[132:135], v[252:255], v[232:235], v[132:135]
    v_mfma_f32_16x16x32_bf16 v[140:143], v[252:255], v[236:239], v[140:143]
    ds_read_b64_tr_b16 v[224:225], v249 offset:16384
    ds_read_b64_tr_b16 v[226:227], v249 offset:17408
    ds_read_b128 v[228:231], v247 offset:0
    ds_read_b64_tr_b16 v[232:233], v248 offset:24576
    ds_read_b64_tr_b16 v[234:235], v248 offset:25600
    ds_read_b64_tr_b16 v[236:237], v249 offset:24576
    ds_read_b64_tr_b16 v[238:239], v249 offset:25600
    v_cvt_pk_bf16_f32 v64, v112, v113
    v_cvt_pk_bf16_f32 v65, v114, v115
    v_cvt_pk_bf16_f32 v66, v116, v117
    v_cvt_pk_bf16_f32 v67, v118, v119
    v_cvt_pk_bf16_f32 v68, v120, v121
    v_cvt_pk_bf16_f32 v69, v122, v123
    v_cvt_pk_bf16_f32 v70, v124, v125
    v_cvt_pk_bf16_f32 v71, v126, v127
    v_cvt_pk_bf16_f32 v72, v128, v129
    v_cvt_pk_bf16_f32 v73, v130, v131
    v_cvt_pk_bf16_f32 v74, v132, v133
    v_cvt_pk_bf16_f32 v75, v134, v135
    v_cvt_pk_bf16_f32 v76, v136, v137
    v_cvt_pk_bf16_f32 v77, v138, v139
    v_cvt_pk_bf16_f32 v78, v140, v141
    v_cvt_pk_bf16_f32 v79, v142, v143
mg_a1_r1:
    s_barrier
    s_waitcnt lgkmcnt(15)
    v_mfma_f32_32x32x16_bf16 v[144:159], v[196:199], v[192:195], 0
    ds_read_b128 v[80:83], v244 offset:32768
    ds_read_b64_tr_b16 v[84:85], v248 offset:32768
    ds_read_b64_tr_b16 v[86:87], v248 offset:33792
    v_mfma_f32_32x32x16_bf16 v[160:175], v[200:203], v[192:195], 0
    ds_read_b64_tr_b16 v[88:89], v249 offset:32768
    ds_read_b64_tr_b16 v[90:91], v249 offset:33792
    ds_read_b128 v[92:95], v245 offset:32768
    s_waitcnt lgkmcnt(15)
    v_mfma_f32_32x32x16_bf16 v[144:159], v[208:211], v[204:207], v[144:159]
    ds_read_b64_tr_b16 v[96:97], v248 offset:40960
    ds_read_b64_tr_b16 v[98:99], v248 offset:41984
    ds_read_b64_tr_b16 v[100:101], v249 offset:40960
    v_mfma_f32_32x32x16_bf16 v[160:175], v[212:215], v[204:207], v[160:175]
    ds_read_b64_tr_b16 v[102:103], v249 offset:41984
    ds_read_b128 v[104:107], v246 offset:32768
    ds_read_b64_tr_b16 v[108:109], v248 offset:49152
    s_waitcnt lgkmcnt(15)
    v_mfma_f32_32x32x16_bf16 v[144:159], v[220:223], v[216:219], v[144:159]
    ds_read_b64_tr_b16 v[110:111], v248 offset:50176
    ds_read_b64_tr_b16 v[112:113], v249 offset:49152
    ds_read_b64_tr_b16 v[114:115], v249 offset:50176
    v_mfma_f32_32x32x16_bf16 v[160:175], v[224:227], v[216:219], v[160:175]
    ds_read_b128 v[116:119], v247 offset:32768
    ds_read_b64_tr_b16 v[120:121], v248 offset:57344
    ds_read_b64_tr_b16 v[122:123], v248 offset:58368
    s_waitcnt lgkmcnt(15)
    v_mfma_f32_32x32x16_bf16 v[144:159], v[232:235], v[228:231], v[144:159]
    ds_read_b64_tr_b16 v[124:125], v249 offset:57344
    ds_read_b64_tr_b16 v[126:127], v249 offset:58368
    v_mfma_f32_32x32x16_bf16 v[160:175], v[236:239], v[228:231], v[160:175]
    buffer_store_dwordx4 v[16:19], v1, s[16:19], s74 offen offset:0 sc1
    v_xor_b32 v244, 0x10000, v244
    v_xor_b32 v245, 0x10000, v245
    v_xor_b32 v246, 0x10000, v246
    v_xor_b32 v247, 0x10000, v247
    v_xor_b32 v248, 0x10000, v248
    v_xor_b32 v249, 0x10000, v249
    s_barrier
    s_waitcnt lgkmcnt(15)
    v_mfma_f32_32x32x16_bf16 v[144:159], v[84:87], v[80:83], v[144:159]
    ds_read_b128 v[192:195], v244 offset:0
    ds_read_b64_tr_b16 v[196:197], v248 offset:0
    ds_read_b64_tr_b16 v[198:199], v248 offset:1024
    v_mfma_f32_32x32x16_bf16 v[160:175], v[88:91], v[80:83], v[160:175]
    ds_read_b64_tr_b16 v[200:201], v249 offset:0
    ds_read_b64_tr_b16 v[202:203], v249 offset:1024
    ds_read_b128 v[204:207], v245 offset:0
    s_waitcnt lgkmcnt(15)
    v_mfma_f32_32x32x16_bf16 v[144:159], v[96:99], v[92:95], v[144:159]
    ds_read_b64_tr_b16 v[208:209], v248 offset:8192
    ds_read_b64_tr_b16 v[210:211], v248 offset:9216
    ds_read_b64_tr_b16 v[212:213], v249 offset:8192
    v_mfma_f32_32x32x16_bf16 v[160:175], v[100:103], v[92:95], v[160:175]
    ds_read_b64_tr_b16 v[214:215], v249 offset:9216
    ds_read_b128 v[216:219], v246 offset:0
    ds_read_b64_tr_b16 v[220:221], v248 offset:16384
    s_waitcnt lgkmcnt(15)
    v_mfma_f32_32x32x16_bf16 v[144:159], v[108:111], v[104:107], v[144:159]
    ds_read_b64_tr_b16 v[222:223], v248 offset:17408
    ds_read_b64_tr_b16 v[224:225], v249 offset:16384
    ds_read_b64_tr_b16 v[226:227], v249 offset:17408
    v_mfma_f32_32x32x16_bf16 v[160:175], v[112:115], v[104:107], v[160:175]
    ds_read_b128 v[228:231], v247 offset:0
    ds_read_b64_tr_b16 v[232:233], v248 offset:24576
    ds_read_b64_tr_b16 v[234:235], v248 offset:25600
    s_waitcnt lgkmcnt(15)
    v_mfma_f32_32x32x16_bf16 v[144:159], v[120:123], v[116:119], v[144:159]
    ds_read_b64_tr_b16 v[236:237], v249 offset:24576
    ds_read_b64_tr_b16 v[238:239], v249 offset:25600
    v_mfma_f32_32x32x16_bf16 v[160:175], v[124:127], v[116:119], v[160:175]
    s_barrier
    s_waitcnt lgkmcnt(15)
    v_mfma_f32_32x32x16_bf16 v[144:159], v[196:199], v[192:195], v[144:159]
    ds_read_b128 v[80:83], v244 offset:32768
    ds_read_b64_tr_b16 v[84:85], v248 offset:32768
    ds_read_b64_tr_b16 v[86:87], v248 offset:33792
    v_mfma_f32_32x32x16_bf16 v[160:175], v[200:203], v[192:195], v[160:175]
    ds_read_b64_tr_b16 v[88:89], v249 offset:32768
    ds_read_b64_tr_b16 v[90:91], v249 offset:33792
    ds_read_b128 v[92:95], v245 offset:32768
    s_waitcnt lgkmcnt(15)
    v_mfma_f32_32x32x16_bf16 v[144:159], v[208:211], v[204:207], v[144:159]
    ds_read_b64_tr_b16 v[96:97], v248 offset:40960
    ds_read_b64_tr_b16 v[98:99], v248 offset:41984
    ds_read_b64_tr_b16 v[100:101], v249 offset:40960
    v_mfma_f32_32x32x16_bf16 v[160:175], v[212:215], v[204:207], v[160:175]
    ds_read_b64_tr_b16 v[102:103], v249 offset:41984
    ds_read_b128 v[104:107], v246 offset:32768
    ds_read_b64_tr_b16 v[108:109], v248 offset:49152
    s_waitcnt lgkmcnt(15)
    v_mfma_f32_32x32x16_bf16 v[144:159], v[220:223], v[216:219], v[144:159]
    ds_read_b64_tr_b16 v[110:111], v248 offset:50176
    ds_read_b64_tr_b16 v[112:113], v249 offset:49152
    ds_read_b64_tr_b16 v[114:115], v249 offset:50176
    v_mfma_f32_32x32x16_bf16 v[160:175], v[224:227], v[216:219], v[160:175]
    ds_read_b128 v[116:119], v247 offset:32768
    ds_read_b64_tr_b16 v[120:121], v248 offset:57344
    ds_read_b64_tr_b16 v[122:123], v248 offset:58368
    s_waitcnt lgkmcnt(15)
    v_mfma_f32_32x32x16_bf16 v[144:159], v[232:235], v[228:231], v[144:159]
    ds_read_b64_tr_b16 v[124:125], v249 offset:57344
    ds_read_b64_tr_b16 v[126:127], v249 offset:58368
    v_mfma_f32_32x32x16_bf16 v[160:175], v[236:239], v[228:231], v[160:175]
    buffer_store_dwordx4 v[20:23], v1, s[16:19], s74 offen offset:1024 sc1
    v_xor_b32 v244, 0x10000, v244
    v_xor_b32 v245, 0x10000, v245
    v_xor_b32 v246, 0x10000, v246
    v_xor_b32 v247, 0x10000, v247
    v_xor_b32 v248, 0x10000, v248
    v_xor_b32 v249, 0x10000, v249
    s_barrier
    s_waitcnt lgkmcnt(15)
    v_mfma_f32_32x32x16_bf16 v[144:159], v[84:87], v[80:83], v[144:159]
    ds_read_b128 v[192:195], v244 offset:0
    ds_read_b64_tr_b16 v[196:197], v248 offset:0
    ds_read_b64_tr_b16 v[198:199], v248 offset:1024
    v_and_b32 v8, 15, v0
    v_lshlrev_b32 v8, 7, v8
    s_add_u32 s13, s44, 81920
    v_mfma_f32_32x32x16_bf16 v[160:175], v[88:91], v[80:83], v[160:175]
    ds_read_b64_tr_b16 v[200:201], v249 offset:0
    ds_read_b64_tr_b16 v[202:203], v249 offset:1024
    ds_read_b128 v[204:207], v245 offset:0
    v_add_u32 v8, s13, v8
    v_bfe_u32 v9, v0, 1, 3
    v_lshrrev_b32 v12, 4, v0
    s_waitcnt lgkmcnt(15)
    v_mfma_f32_32x32x16_bf16 v[144:159], v[96:99], v[92:95], v[144:159]
    ds_read_b64_tr_b16 v[208:209], v248 offset:8192
    ds_read_b64_tr_b16 v[210:211], v248 offset:9216
    ds_read_b64_tr_b16 v[212:213], v249 offset:8192
    v_xor_b32 v9, v9, v12
    v_lshl_add_u32 v178, v9, 4, v8
    v_xor_b32 v179, 64, v178
    v_mfma_f32_32x32x16_bf16 v[160:175], v[100:103], v[92:95], v[160:175]
    ds_read_b64_tr_b16 v[214:215], v249 offset:9216
    ds_read_b128 v[216:219], v246 offset:0
    ds_read_b64_tr_b16 v[220:221], v248 offset:16384
    v_bfe_u32 v8, v0, 2, 2
    v_lshlrev_b32 v9, 11, v12
    v_lshl_add_u32 v9, v8, 7, v9
    s_waitcnt lgkmcnt(15)
    v_mfma_f32_32x32x16_bf16 v[144:159], v[108:111], v[104:107], v[144:159]
    ds_read_b64_tr_b16 v[222:223], v248 offset:17408
    ds_read_b64_tr_b16 v[224:225], v249 offset:16384
    ds_read_b64_tr_b16 v[226:227], v249 offset:17408
    v_and_b32 v11, 3, v0
    v_lshl_add_u32 v9, v11, 3, v9
    v_add_u32 v9, 98304, v9
    v_mfma_f32_32x32x16_bf16 v[160:175], v[112:115], v[104:107], v[160:175]
    ds_read_b128 v[228:231], v247 offset:0
    ds_read_b64_tr_b16 v[232:233], v248 offset:24576
    ds_read_b64_tr_b16 v[234:235], v248 offset:25600
    v_and_b32 v8, 2, v8
    v_and_or_b32 v8, v12, 1, v8
    v_lshl_add_u32 v180, v8, 5, v9
    s_waitcnt lgkmcnt(15)
    v_mfma_f32_32x32x16_bf16 v[144:159], v[120:123], v[116:119], v[144:159]
    ds_read_b64_tr_b16 v[236:237], v249 offset:24576
    ds_read_b64_tr_b16 v[238:239], v249 offset:25600
    v_xor_b32 v181, 32, v180
    v_xor_b32 v182, 64, v180
    v_xor_b32 v183, 96, v180
    v_mfma_f32_32x32x16_bf16 v[160:175], v[124:127], v[116:119], v[160:175]
    s_barrier
    s_waitcnt lgkmcnt(15)
    v_mfma_f32_32x32x16_bf16 v[144:159], v[196:199], v[192:195], v[144:159]
    ds_read_b128 v[80:83], v244 offset:32768
    ds_read_b64_tr_b16 v[84:85], v248 offset:32768
    ds_read_b64_tr_b16 v[86:87], v248 offset:33792
    v_bfe_u32 v8, v0, 2, 2
    v_mul_u32_u24 v8, 40, v8
    v_mfma_f32_32x32x16_bf16 v[160:175], v[200:203], v[192:195], v[160:175]
    ds_read_b64_tr_b16 v[88:89], v249 offset:32768
    ds_read_b64_tr_b16 v[90:91], v249 offset:33792
    ds_read_b128 v[92:95], v245 offset:32768
    v_bfe_u32 v9, v0, 4, 1
    v_bfe_u32 v11, v0, 1, 1
    s_waitcnt lgkmcnt(15)
    v_mfma_f32_32x32x16_bf16 v[144:159], v[208:211], v[204:207], v[144:159]
    ds_read_b64_tr_b16 v[96:97], v248 offset:40960
    ds_read_b64_tr_b16 v[98:99], v248 offset:41984
    ds_read_b64_tr_b16 v[100:101], v249 offset:40960
    v_lshl_add_u32 v9, v9, 1, v11
    v_lshl_add_u32 v8, v9, 3, v8
    v_mfma_f32_32x32x16_bf16 v[160:175], v[212:215], v[204:207], v[160:175]
    ds_read_b64_tr_b16 v[102:103], v249 offset:41984
    ds_read_b128 v[104:107], v246 offset:32768
    ds_read_b64_tr_b16 v[108:109], v248 offset:49152
    s_mul_i32 s13, s15, 800
    s_add_u32 s13, s13, 159744
    s_waitcnt lgkmcnt(15)
    v_mfma_f32_32x32x16_bf16 v[144:159], v[220:223], v[216:219], v[144:159]
    ds_read_b64_tr_b16 v[110:111], v248 offset:50176
    ds_read_b64_tr_b16 v[112:113], v249 offset:49152
    ds_read_b64_tr_b16 v[114:115], v249 offset:50176
    v_add_u32 v15, s13, v8
    v_mfma_f32_32x32x16_bf16 v[160:175], v[224:227], v[216:219], v[160:175]
    ds_read_b128 v[116:119], v247 offset:32768
    ds_read_b64_tr_b16 v[120:121], v248 offset:57344
    ds_read_b64_tr_b16 v[122:123], v248 offset:58368
    s_waitcnt lgkmcnt(15)
    v_mfma_f32_32x32x16_bf16 v[144:159], v[232:235], v[228:231], v[144:159]
    ds_read_b64_tr_b16 v[124:125], v249 offset:57344
    ds_read_b64_tr_b16 v[126:127], v249 offset:58368
    v_mfma_f32_32x32x16_bf16 v[160:175], v[236:239], v[228:231], v[160:175]
    buffer_store_dwordx4 v[24:27], v1, s[16:19], s75 offen offset:0 sc1
    v_xor_b32 v244, 0x10000, v244
    v_xor_b32 v245, 0x10000, v245
    v_xor_b32 v246, 0x10000, v246
    v_xor_b32 v247, 0x10000, v247
    v_xor_b32 v248, 0x10000, v248
    v_xor_b32 v249, 0x10000, v249
    s_barrier
    s_waitcnt lgkmcnt(15)
    v_mfma_f32_32x32x16_bf16 v[144:159], v[84:87], v[80:83], v[144:159]
    ds_read_b128 v[192:195], v244 offset:0
    ds_read_b64_tr_b16 v[196:197], v248 offset:0
    ds_read_b64_tr_b16 v[198:199], v248 offset:1024
    ds_read_b64_tr_b16 v[128:129], v15 offset:0
    v_mfma_f32_32x32x16_bf16 v[160:175], v[88:91], v[80:83], v[160:175]
    ds_read_b64_tr_b16 v[200:201], v249 offset:0
    ds_read_b64_tr_b16 v[202:203], v249 offset:1024
    ds_read_b128 v[204:207], v245 offset:0
    ds_read_b64_tr_b16 v[130:131], v15 offset:160
    s_waitcnt lgkmcnt(15)
    v_mfma_f32_32x32x16_bf16 v[144:159], v[96:99], v[92:95], v[144:159]
    ds_read_b64_tr_b16 v[208:209], v248 offset:8192
    ds_read_b64_tr_b16 v[210:211], v248 offset:9216
    ds_read_b64_tr_b16 v[212:213], v249 offset:8192
    ds_read_b64_tr_b16 v[132:133], v15 offset:320
    v_mfma_f32_32x32x16_bf16 v[160:175], v[100:103], v[92:95], v[160:175]
    ds_read_b64_tr_b16 v[214:215], v249 offset:9216
    ds_read_b128 v[216:219], v246 offset:0
    ds_read_b64_tr_b16 v[220:221], v248 offset:16384
    ds_read_b64_tr_b16 v[134:135], v15 offset:480
    s_waitcnt lgkmcnt(15)
    v_mfma_f32_32x32x16_bf16 v[144:159], v[108:111], v[104:107], v[144:159]
    ds_read_b64_tr_b16 v[222:223], v248 offset:17408
    ds_read_b64_tr_b16 v[224:225], v249 offset:16384
    ds_read_b64_tr_b16 v[226:227], v249 offset:17408
    ds_read_b64_tr_b16 v[136:137], v15 offset:640
    v_mfma_f32_32x32x16_bf16 v[160:175], v[112:115], v[104:107], v[160:175]
    ds_read_b128 v[228:231], v247 offset:0
    ds_read_b64_tr_b16 v[232:233], v248 offset:24576
    ds_read_b64_tr_b16 v[234:235], v248 offset:25600
    v_mfma_f32_32x32x16_bf16 v[144:159], v[120:123], v[116:119], v[144:159]
    ds_read_b64_tr_b16 v[236:237], v249 offset:24576
    ds_read_b64_tr_b16 v[238:239], v249 offset:25600
    v_mfma_f32_32x32x16_bf16 v[160:175], v[124:127], v[116:119], v[160:175]
    s_barrier
    s_waitcnt lgkmcnt(5)
    v_mfma_f32_32x32x16_bf16 v[144:159], v[196:199], v[192:195], v[144:159]
    ds_read_b128 v[80:83], v244 offset:32768
    ds_read_b64_tr_b16 v[84:85], v248 offset:32768
    ds_read_b64_tr_b16 v[86:87], v248 offset:33792
    v_bfe_u32 v8, v0, 2, 1
    v_cmp_eq_u32 vcc, v8, v10
    v_mfma_f32_32x32x16_bf16 v[160:175], v[200:203], v[192:195], v[160:175]
    ds_read_b64_tr_b16 v[88:89], v249 offset:32768
    ds_read_b64_tr_b16 v[90:91], v249 offset:33792
    ds_read_b128 v[92:95], v245 offset:32768
    s_nop 0
    v_cndmask_b32 v128, 0, v128, vcc
    v_mfma_f32_32x32x16_bf16 v[144:159], v[208:211], v[204:207], v[144:159]
    ds_read_b64_tr_b16 v[96:97], v248 offset:40960
    ds_read_b64_tr_b16 v[98:99], v248 offset:41984
    ds_read_b64_tr_b16 v[100:101], v249 offset:40960
    v_cndmask_b32 v129, 0, v129, vcc
    v_cndmask_b32 v130, 0, v130, vcc
    v_mfma_f32_32x32x16_bf16 v[160:175], v[212:215], v[204:207], v[160:175]
    ds_read_b64_tr_b16 v[102:103], v249 offset:41984
    ds_read_b128 v[104:107], v246 offset:32768
    ds_read_b64_tr_b16 v[108:109], v248 offset:49152
    v_cndmask_b32 v131, 0, v131, vcc
    v_cndmask_b32 v132, 0, v132, vcc
    v_mfma_f32_32x32x16_bf16 v[144:159], v[220:223], v[216:219], v[144:159]
    ds_read_b64_tr_b16 v[110:111], v248 offset:50176
    ds_read_b64_tr_b16 v[112:113], v249 offset:49152
    ds_read_b64_tr_b16 v[114:115], v249 offset:50176
    v_cndmask_b32 v133, 0, v133, vcc
    v_cndmask_b32 v134, 0, v134, vcc
    v_mfma_f32_32x32x16_bf16 v[160:175], v[224:227], v[216:219], v[160:175]
    ds_read_b128 v[116:119], v247 offset:32768
    ds_read_b64_tr_b16 v[120:121], v248 offset:57344
    ds_read_b64_tr_b16 v[122:123], v248 offset:58368
    v_cndmask_b32 v135, 0, v135, vcc
    v_cndmask_b32 v136, 0, v136, vcc
    s_waitcnt lgkmcnt(15)
    v_mfma_f32_32x32x16_bf16 v[144:159], v[232:235], v[228:231], v[144:159]
    ds_read_b64_tr_b16 v[124:125], v249 offset:57344
    ds_read_b64_tr_b16 v[126:127], v249 offset:58368
    v_cndmask_b32 v137, 0, v137, vcc
    v_mov_b32 v138, 0
    v_mfma_f32_32x32x16_bf16 v[160:175], v[236:239], v[228:231], v[160:175]
    buffer_store_dwordx4 v[28:31], v1, s[16:19], s75 offen offset:1024 sc1
    v_mov_b32 v139, 0
    v_xor_b32 v244, 0x10000, v244
    v_xor_b32 v245, 0x10000, v245
    v_xor_b32 v246, 0x10000, v246
    v_xor_b32 v247, 0x10000, v247
    v_xor_b32 v248, 0x10000, v248
    v_xor_b32 v249, 0x10000, v249
    s_barrier
    s_waitcnt lgkmcnt(15)
    v_mfma_f32_32x32x16_bf16 v[144:159], v[84:87], v[80:83], v[144:159]
    ds_read_b128 v[192:195], v244 offset:0
    ds_read_b64_tr_b16 v[196:197], v248 offset:0
    ds_read_b64_tr_b16 v[198:199], v248 offset:1024
    v_mfma_f32_32x32x16_bf16 v[160:175], v[88:91], v[80:83], v[160:175]
    ds_read_b64_tr_b16 v[200:201], v249 offset:0
    ds_read_b64_tr_b16 v[202:203], v249 offset:1024
    ds_read_b128 v[204:207], v245 offset:0
    s_waitcnt lgkmcnt(15)
    v_mfma_f32_32x32x16_bf16 v[144:159], v[96:99], v[92:95], v[144:159]
    ds_read_b64_tr_b16 v[208:209], v248 offset:8192
    ds_read_b64_tr_b16 v[210:211], v248 offset:9216
    ds_read_b64_tr_b16 v[212:213], v249 offset:8192
    v_mfma_f32_32x32x16_bf16 v[160:175], v[100:103], v[92:95], v[160:175]
    ds_read_b64_tr_b16 v[214:215], v249 offset:9216
    ds_read_b128 v[216:219], v246 offset:0
    ds_read_b64_tr_b16 v[220:221], v248 offset:16384
    s_waitcnt lgkmcnt(15)
    v_mfma_f32_32x32x16_bf16 v[144:159], v[108:111], v[104:107], v[144:159]
    ds_read_b64_tr_b16 v[222:223], v248 offset:17408
    ds_read_b64_tr_b16 v[224:225], v249 offset:16384
    ds_read_b64_tr_b16 v[226:227], v249 offset:17408
    v_mfma_f32_32x32x16_bf16 v[160:175], v[112:115], v[104:107], v[160:175]
    ds_read_b128 v[228:231], v247 offset:0
    ds_read_b64_tr_b16 v[232:233], v248 offset:24576
    ds_read_b64_tr_b16 v[234:235], v248 offset:25600
    s_waitcnt lgkmcnt(15)
    v_mfma_f32_32x32x16_bf16 v[144:159], v[120:123], v[116:119], v[144:159]
    ds_read_b64_tr_b16 v[236:237], v249 offset:24576
    ds_read_b64_tr_b16 v[238:239], v249 offset:25600
    v_mfma_f32_32x32x16_bf16 v[160:175], v[124:127], v[116:119], v[160:175]
    s_barrier
    s_waitcnt lgkmcnt(15)
    v_mfma_f32_32x32x16_bf16 v[144:159], v[196:199], v[192:195], v[144:159]
    ds_read_b128 v[80:83], v244 offset:32768
    ds_read_b64_tr_b16 v[84:85], v248 offset:32768
    ds_read_b64_tr_b16 v[86:87], v248 offset:33792
    v_mfma_f32_32x32x16_bf16 v[160:175], v[200:203], v[192:195], v[160:175]
    ds_read_b64_tr_b16 v[88:89], v249 offset:32768
    ds_read_b64_tr_b16 v[90:91], v249 offset:33792
    ds_read_b128 v[92:95], v245 offset:32768
    s_waitcnt lgkmcnt(15)
    v_mfma_f32_32x32x16_bf16 v[144:159], v[208:211], v[204:207], v[144:159]
    ds_read_b64_tr_b16 v[96:97], v248 offset:40960
    ds_read_b64_tr_b16 v[98:99], v248 offset:41984
    ds_read_b64_tr_b16 v[100:101], v249 offset:40960
    v_mfma_f32_32x32x16_bf16 v[160:175], v[212:215], v[204:207], v[160:175]
    ds_read_b64_tr_b16 v[102:103], v249 offset:41984
    ds_read_b128 v[104:107], v246 offset:32768
    ds_read_b64_tr_b16 v[108:109], v248 offset:49152
    ds_read_b64_tr_b16 v[192:193], v15 offset:32
    s_waitcnt lgkmcnt(15)
    v_mfma_f32_32x32x16_bf16 v[144:159], v[220:223], v[216:219], v[144:159]
    ds_read_b64_tr_b16 v[110:111], v248 offset:50176
    ds_read_b64_tr_b16 v[112:113], v249 offset:49152
    ds_read_b64_tr_b16 v[114:115], v249 offset:50176
    ds_read_b64_tr_b16 v[194:195], v15 offset:192
    v_mfma_f32_32x32x16_bf16 v[160:175], v[224:227], v[216:219], v[160:175]
    ds_read_b128 v[116:119], v247 offset:32768
    ds_read_b64_tr_b16 v[120:121], v248 offset:57344
    ds_read_b64_tr_b16 v[122:123], v248 offset:58368
    ds_read_b64_tr_b16 v[196:197], v15 offset:352
    s_waitcnt lgkmcnt(15)
    v_mfma_f32_32x32x16_bf16 v[144:159], v[232:235], v[228:231], v[144:159]
    ds_read_b64_tr_b16 v[124:125], v249 offset:57344
    ds_read_b64_tr_b16 v[126:127], v249 offset:58368
    ds_read_b64_tr_b16 v[198:199], v15 offset:512
    v_mfma_f32_32x32x16_bf16 v[160:175], v[236:239], v[228:231], v[160:175]
    buffer_store_dwordx4 v[32:35], v1, s[16:19], s76 offen offset:0 sc1
    ds_read_b64_tr_b16 v[200:201], v15 offset:672
    s_waitcnt lgkmcnt(0)
    s_barrier
    v_mfma_f32_32x32x16_bf16 v[144:159], v[84:87], v[80:83], v[144:159]
    v_cndmask_b32 v192, 0, v192, vcc
    v_cndmask_b32 v193, 0, v193, vcc
    v_mfma_f32_32x32x16_bf16 v[160:175], v[88:91], v[80:83], v[160:175]
    v_cndmask_b32 v194, 0, v194, vcc
    v_cndmask_b32 v195, 0, v195, vcc
    v_mfma_f32_32x32x16_bf16 v[144:159], v[96:99], v[92:95], v[144:159]
    v_cndmask_b32 v196, 0, v196, vcc
    v_cndmask_b32 v197, 0, v197, vcc
    v_mfma_f32_32x32x16_bf16 v[160:175], v[100:103], v[92:95], v[160:175]
    v_cndmask_b32 v198, 0, v198, vcc
    v_cndmask_b32 v199, 0, v199, vcc
    v_mfma_f32_32x32x16_bf16 v[144:159], v[108:111], v[104:107], v[144:159]
    v_cndmask_b32 v200, 0, v200, vcc
    v_cndmask_b32 v201, 0, v201, vcc
    v_mfma_f32_32x32x16_bf16 v[160:175], v[112:115], v[104:107], v[160:175]
    v_mov_b32 v202, 0
    v_mov_b32 v203, 0
    v_mfma_f32_32x32x16_bf16 v[144:159], v[120:123], v[116:119], v[144:159]
    v_mfma_f32_32x32x16_bf16 v[160:175], v[124:127], v[116:119], v[160:175]
    s_and_b32 s13, s12, 3
    s_lshl_b32 s13, s13, 12
    s_lshl_b32 s14, s15, 14
    s_add_u32 s13, s13, s14
    s_add_u32 s13, s13, 131072
    v_and_b32 v8, 31, v0
    v_lshlrev_b32 v8, 7, v8
    v_add_u32 v8, s13, v8
    v_bfe_u32 v9, v0, 1, 1
    v_and_b32 v11, 1, v0
    v_lshl_add_u32 v9, v9, 2, v11
    v_bfe_u32 v11, v0, 2, 1
    v_lshl_add_u32 v9, v11, 1, v9
    v_lshl_add_u32 v15, v9, 4, v8
    v_cvt_pk_bf16_f32 v224, v144, v145
    v_cvt_pk_bf16_f32 v225, v146, v147
    v_cvt_pk_bf16_f32 v226, v148, v149
    v_cvt_pk_bf16_f32 v227, v150, v151
    v_cvt_pk_bf16_f32 v228, v152, v153
    v_cvt_pk_bf16_f32 v229, v154, v155
    v_cvt_pk_bf16_f32 v230, v156, v157
    v_cvt_pk_bf16_f32 v231, v158, v159
    v_cvt_pk_bf16_f32 v232, v160, v161
    v_cvt_pk_bf16_f32 v233, v162, v163
    v_cvt_pk_bf16_f32 v234, v164, v165
    v_cvt_pk_bf16_f32 v235, v166, v167
    v_cvt_pk_bf16_f32 v236, v168, v169
    v_cvt_pk_bf16_f32 v237, v170, v171
    v_cvt_pk_bf16_f32 v238, v172, v173
    v_cvt_pk_bf16_f32 v239, v174, v175
    v_mfma_f32_32x32x16_bf16 v[80:95], v[128:131], v[224:227], 0
    v_mfma_f32_32x32x16_bf16 v[96:111], v[192:195], v[224:227], 0
    v_mfma_f32_32x32x16_bf16 v[80:95], v[132:135], v[228:231], v[80:95]
    v_mfma_f32_32x32x16_bf16 v[96:111], v[196:199], v[228:231], v[96:111]
    v_mfma_f32_32x32x16_bf16 v[80:95], v[136:139], v[232:235], v[80:95]
    v_mfma_f32_32x32x16_bf16 v[96:111], v[200:203], v[232:235], v[96:111]
    buffer_store_dwordx4 v[36:39], v1, s[16:19], s76 offen offset:1024 sc1
    buffer_store_dwordx4 v[40:43], v1, s[16:19], s77 offen offset:0 sc1
    buffer_store_dwordx4 v[44:47], v1, s[16:19], s77 offen offset:1024 sc1
    v_mov_b32 v11, 0x3f80
    v_cmp_eq_u32 vcc, 0, v10
    s_nop 0
    s_nop 0
    v_cndmask_b32 v238, v11, v238, vcc
    v_cndmask_b32 v239, 0, v239, vcc
    v_mul_u32_u24 v11, 56, v10
    v_xor_b32 v11, 80, v11
    v_xor_b32 v12, v11, v15
    ds_write_b64 v12, v[234:235]
    v_mul_u32_u24 v11, 40, v10
    v_xor_b32 v11, 88, v11
    v_xor_b32 v13, v11, v15
    ds_write_b64 v13, v[236:237]
    v_mul_u32_u24 v11, 24, v10
    v_xor_b32 v11, 96, v11
    v_xor_b32 v14, v11, v15
    ds_write_b64 v14, v[238:239]
    v_max3_f32 v8, v80, v81, v82
    v_min3_f32 v9, v80, v81, v82
    v_max3_f32 v8, v8, v83, v84
    v_min3_f32 v9, v9, v83, v84
    v_max3_f32 v8, v8, v85, v86
    v_min3_f32 v9, v9, v85, v86
    v_max3_f32 v8, v8, v87, v88
    v_min3_f32 v9, v9, v87, v88
    v_max3_f32 v8, v8, v89, v90
    v_min3_f32 v9, v9, v89, v90
    v_max3_f32 v8, v8, v91, v92
    v_min3_f32 v9, v9, v91, v92
    v_max3_f32 v8, v8, v93, v94
    v_min3_f32 v9, v9, v93, v94
    v_max3_f32 v8, v8, v95, v96
    v_min3_f32 v9, v9, v95, v96
    v_max3_f32 v8, v8, v97, v98
    v_min3_f32 v9, v9, v97, v98
    v_max_f32 v8, v8, v99
    v_min_f32 v9, v9, v99
    s_mov_b32 s56, 0x3fb8aa3b
    s_mov_b32 s57, 0x3fb8aa3b
    s_mov_b32 s58, 0xbfb8aa3b
    s_mov_b32 s59, 0xbfb8aa3b
    v_mul_f32 v152, s58, v8
    v_mul_f32 v153, s58, v8
    v_mul_f32 v154, s56, v9
    v_mul_f32 v155, s56, v9
    v_pk_fma_f32 v[112:113], v[80:81], s[56:57], v[152:153]
    v_pk_fma_f32 v[132:133], v[80:81], s[58:59], v[154:155]
    v_pk_fma_f32 v[114:115], v[82:83], s[56:57], v[152:153]
    v_pk_fma_f32 v[134:135], v[82:83], s[58:59], v[154:155]
    v_pk_fma_f32 v[116:117], v[84:85], s[56:57], v[152:153]
    v_pk_fma_f32 v[136:137], v[84:85], s[58:59], v[154:155]
    v_pk_fma_f32 v[118:119], v[86:87], s[56:57], v[152:153]
    v_pk_fma_f32 v[138:139], v[86:87], s[58:59], v[154:155]
    v_pk_fma_f32 v[120:121], v[88:89], s[56:57], v[152:153]
    v_pk_fma_f32 v[140:141], v[88:89], s[58:59], v[154:155]
    v_pk_fma_f32 v[122:123], v[90:91], s[56:57], v[152:153]
    v_pk_fma_f32 v[142:143], v[90:91], s[58:59], v[154:155]
    v_pk_fma_f32 v[124:125], v[92:93], s[56:57], v[152:153]
    v_pk_fma_f32 v[144:145], v[92:93], s[58:59], v[154:155]
    v_pk_fma_f32 v[126:127], v[94:95], s[56:57], v[152:153]
    v_pk_fma_f32 v[146:147], v[94:95], s[58:59], v[154:155]
    v_pk_fma_f32 v[128:129], v[96:97], s[56:57], v[152:153]
    v_pk_fma_f32 v[148:149], v[96:97], s[58:59], v[154:155]
    v_pk_fma_f32 v[130:131], v[98:99], s[56:57], v[152:153]
    v_pk_fma_f32 v[150:151], v[98:99], s[58:59], v[154:155]
    v_exp_f32 v112, v112
    v_exp_f32 v113, v113
    v_exp_f32 v114, v114
    v_exp_f32 v115, v115
    v_exp_f32 v116, v116
    v_exp_f32 v117, v117
    v_exp_f32 v118, v118
    v_exp_f32 v119, v119
    v_exp_f32 v120, v120
    v_exp_f32 v121, v121
    v_exp_f32 v122, v122
    v_exp_f32 v123, v123
    v_exp_f32 v124, v124
    v_exp_f32 v125, v125
    v_exp_f32 v126, v126
    v_exp_f32 v127, v127
    v_exp_f32 v128, v128
    v_exp_f32 v129, v129
    v_exp_f32 v130, v130
    v_exp_f32 v131, v131
    v_exp_f32 v132, v132
    v_exp_f32 v133, v133
    v_exp_f32 v134, v134
    v_exp_f32 v135, v135
    v_exp_f32 v136, v136
    v_exp_f32 v137, v137
    v_exp_f32 v138, v138
    v_exp_f32 v139, v139
    v_exp_f32 v140, v140
    v_exp_f32 v141, v141
    v_exp_f32 v142, v142
    v_exp_f32 v143, v143
    v_exp_f32 v144, v144
    v_exp_f32 v145, v145
    v_exp_f32 v146, v146
    v_exp_f32 v147, v147
    v_exp_f32 v148, v148
    v_exp_f32 v149, v149
    v_exp_f32 v150, v150
    v_exp_f32 v151, v151
    v_pk_add_f32 v[152:153], v[112:113], v[114:115]
    v_pk_add_f32 v[154:155], v[132:133], v[134:135]
    v_pk_add_f32 v[152:153], v[152:153], v[116:117]
    v_pk_add_f32 v[154:155], v[154:155], v[136:137]
    v_pk_add_f32 v[152:153], v[152:153], v[118:119]
    v_pk_add_f32 v[154:155], v[154:155], v[138:139]
    v_pk_add_f32 v[152:153], v[152:153], v[120:121]
    v_pk_add_f32 v[154:155], v[154:155], v[140:141]
    v_pk_add_f32 v[152:153], v[152:153], v[122:123]
    v_pk_add_f32 v[154:155], v[154:155], v[142:143]
    v_pk_add_f32 v[152:153], v[152:153], v[124:125]
    v_pk_add_f32 v[154:155], v[154:155], v[144:145]
    v_pk_add_f32 v[152:153], v[152:153], v[126:127]
    v_pk_add_f32 v[154:155], v[154:155], v[146:147]
    v_pk_add_f32 v[152:153], v[152:153], v[128:129]
    v_pk_add_f32 v[154:155], v[154:155], v[148:149]
    v_pk_add_f32 v[152:153], v[152:153], v[130:131]
    v_pk_add_f32 v[154:155], v[154:155], v[150:151]
    v_add_f32 v152, v152, v153
    v_add_f32 v154, v154, v155
    v_rcp_f32 v152, v152
    v_rcp_f32 v154, v154
    s_nop 0
    v_mov_b32 v153, v152
    v_mov_b32 v155, v154
    v_pk_mul_f32 v[112:113], v[112:113], v[152:153]
    v_pk_mul_f32 v[132:133], v[132:133], v[154:155]
    v_pk_mul_f32 v[114:115], v[114:115], v[152:153]
    v_pk_mul_f32 v[134:135], v[134:135], v[154:155]
    v_pk_mul_f32 v[116:117], v[116:117], v[152:153]
    v_pk_mul_f32 v[136:137], v[136:137], v[154:155]
    v_pk_mul_f32 v[118:119], v[118:119], v[152:153]
    v_pk_mul_f32 v[138:139], v[138:139], v[154:155]
    v_pk_mul_f32 v[120:121], v[120:121], v[152:153]
    v_pk_mul_f32 v[140:141], v[140:141], v[154:155]
    v_pk_mul_f32 v[122:123], v[122:123], v[152:153]
    v_pk_mul_f32 v[142:143], v[142:143], v[154:155]
    v_pk_mul_f32 v[124:125], v[124:125], v[152:153]
    v_pk_mul_f32 v[144:145], v[144:145], v[154:155]
    v_pk_mul_f32 v[126:127], v[126:127], v[152:153]
    v_pk_mul_f32 v[146:147], v[146:147], v[154:155]
    v_pk_mul_f32 v[128:129], v[128:129], v[152:153]
    v_pk_mul_f32 v[148:149], v[148:149], v[154:155]
    v_pk_mul_f32 v[130:131], v[130:131], v[152:153]
    v_pk_mul_f32 v[150:151], v[150:151], v[154:155]
    s_waitcnt lgkmcnt(0)
    v_cvt_pk_bf16_f32 v232, v112, v113
    v_cvt_pk_bf16_f32 v233, v114, v115
    v_cvt_pk_bf16_f32 v234, v116, v117
    v_cvt_pk_bf16_f32 v235, v118, v119
    v_cvt_pk_bf16_f32 v236, v120, v121
    v_cvt_pk_bf16_f32 v237, v122, v123
    v_cvt_pk_bf16_f32 v238, v124, v125
    v_cvt_pk_bf16_f32 v239, v126, v127
    v_cvt_pk_bf16_f32 v240, v128, v129
    v_cvt_pk_bf16_f32 v241, v130, v131
    v_cvt_pk_bf16_f32 v242, v132, v133
    v_cvt_pk_bf16_f32 v243, v134, v135
    v_cvt_pk_bf16_f32 v244, v136, v137
    v_cvt_pk_bf16_f32 v245, v138, v139
    v_cvt_pk_bf16_f32 v246, v140, v141
    v_cvt_pk_bf16_f32 v247, v142, v143
    v_cvt_pk_bf16_f32 v248, v144, v145
    v_cvt_pk_bf16_f32 v249, v146, v147
    v_cvt_pk_bf16_f32 v250, v148, v149
    v_cvt_pk_bf16_f32 v251, v150, v151
    v_xor_b32 v11, 16, v15
    v_xor_b32 v12, 32, v15
    v_xor_b32 v13, 48, v15
    v_xor_b32 v14, 64, v15
    s_mov_b32 exec_lo, 0
    ds_write_b128 v15, v[232:235]
    ds_write_b128 v11, v[236:239]
    ds_write_b128 v12, v[240:243]
    ds_write_b128 v13, v[244:247]
    ds_write_b128 v14, v[248:251]
    s_mov_b32 exec_lo, -1
    s_waitcnt lgkmcnt(0)
    s_barrier
    ds_read_b128 v[192:195], v178 offset:0
    ds_read_b64_tr_b16 v[208:209], v180 offset:0
    ds_read_b64_tr_b16 v[210:211], v180 offset:1024
    ds_read_b128 v[196:199], v178 offset:2048
    ds_read_b64_tr_b16 v[212:213], v181 offset:0
    ds_read_b64_tr_b16 v[214:215], v181 offset:1024
    ds_read_b64_tr_b16 v[216:217], v182 offset:0
    ds_read_b64_tr_b16 v[218:219], v182 offset:1024
    ds_read_b64_tr_b16 v[220:221], v183 offset:0
    ds_read_b64_tr_b16 v[222:223], v183 offset:1024
    ds_read_b64_tr_b16 v[224:225], v180 offset:512
    ds_read_b64_tr_b16 v[226:227], v180 offset:1536
    ds_read_b64_tr_b16 v[228:229], v181 offset:512
    ds_read_b64_tr_b16 v[230:231], v181 offset:1536
    s_waitcnt lgkmcnt(10)
    v_mfma_f32_16x16x32_bf16 v[80:83], v[208:211], v[192:195], 0
    ds_read_b128 v[200:203], v179 offset:0
    s_and_b32 s13, s2, 7
    s_lshr_b32 s14, s2, 3
    v_mfma_f32_16x16x32_bf16 v[88:91], v[208:211], v[196:199], 0
    ds_read_b64_tr_b16 v[208:209], v182 offset:512
    ds_read_b64_tr_b16 v[210:211], v182 offset:1536
    s_lshl_b32 s61, s13, 2
    s_and_b32 s13, s14, 3
    s_waitcnt lgkmcnt(11)
    v_mfma_f32_16x16x32_bf16 v[92:95], v[212:215], v[196:199], 0
    ds_read_b128 v[204:207], v179 offset:2048
    s_add_u32 s61, s61, s13
    s_andn2_b32 s13, s14, 3
    v_mfma_f32_16x16x32_bf16 v[84:87], v[212:215], v[192:195], 0
    ds_read_b64_tr_b16 v[212:213], v183 offset:512
    ds_read_b64_tr_b16 v[214:215], v183 offset:1536
    s_sub_u32 s14, s12, s13
    s_add_u32 s14, s14, 60
    s_waitcnt lgkmcnt(10)
    v_mfma_f32_16x16x32_bf16 v[96:99], v[216:219], v[192:195], 0
    s_sub_u32 s13, s13, s12
    s_add_u32 s13, s13, 7
    v_mfma_f32_16x16x32_bf16 v[104:107], v[216:219], v[196:199], 0
    ds_read_b64_tr_b16 v[216:217], v180 offset:8192
    ds_read_b64_tr_b16 v[218:219], v180 offset:9216
    s_cmp_eq_u32 s15, 0
    s_cselect_b32 s44, s14, s13
    s_lshr_b32 s46, s44, 1
    v_mfma_f32_16x16x32_bf16 v[108:111], v[220:223], v[196:199], 0
    v_mfma_f32_16x16x32_bf16 v[100:103], v[220:223], v[192:195], 0
    ds_read_b64_tr_b16 v[220:221], v181 offset:8192
    ds_read_b64_tr_b16 v[222:223], v181 offset:9216
    s_waitcnt lgkmcnt(10)
    v_mfma_f32_16x16x32_bf16 v[112:115], v[224:227], v[192:195], 0
    s_add_u32 s46, s46, 1
    s_lshr_b32 s45, s2, 5
    v_mfma_f32_16x16x32_bf16 v[120:123], v[224:227], v[196:199], 0
    ds_read_b64_tr_b16 v[224:225], v182 offset:8192
    ds_read_b64_tr_b16 v[226:227], v182 offset:9216
    s_lshl_b32 s45, s45, 1
    s_sub_u32 s45, 32, s45
    v_mfma_f32_16x16x32_bf16 v[124:127], v[228:231], v[196:199], 0
    s_and_b32 s13, s12, 3
    s_lshl_b32 s13, s13, 12
    v_mfma_f32_16x16x32_bf16 v[116:119], v[228:231], v[192:195], 0
    ds_read_b64_tr_b16 v[228:229], v183 offset:8192
    ds_read_b64_tr_b16 v[230:231], v183 offset:9216
    s_mov_b32 s50, s13
    s_add_u32 s51, s13, 114688
    s_waitcnt lgkmcnt(8)
    v_mfma_f32_16x16x32_bf16 v[128:131], v[208:211], v[192:195], 0
    s_lshl_b32 s14, s61, 19
    s_add_u32 s52, s13, s14
    v_mfma_f32_16x16x32_bf16 v[136:139], v[208:211], v[196:199], 0
    ds_read_b64_tr_b16 v[208:209], v180 offset:8704
    ds_read_b64_tr_b16 v[210:211], v180 offset:9728
    s_add_u32 s53, s52, 16777216
    s_lshl_b32 s13, s61, 19
    v_mfma_f32_16x16x32_bf16 v[140:143], v[212:215], v[196:199], 0
    v_mfma_f32_16x16x32_bf16 v[132:135], v[212:215], v[192:195], 0
    ds_read_b64_tr_b16 v[212:213], v181 offset:8704
    ds_read_b64_tr_b16 v[214:215], v181 offset:9728
    s_waitcnt lgkmcnt(8)
    v_mfma_f32_16x16x32_bf16 v[80:83], v[216:219], v[200:203], v[80:83]
    s_lshl_b32 s14, s45, 14
    s_add_u32 s32, s6, s13
    s_addc_u32 s33, s7, 0
    s_and_b32 s33, s33, 0xffff
    s_mov_b32 s34, s14
    s_mov_b32 s35, 0x20000
    v_mfma_f32_16x16x32_bf16 v[88:91], v[216:219], v[204:207], v[88:91]
    ds_read_b64_tr_b16 v[216:217], v182 offset:8704
    ds_read_b64_tr_b16 v[218:219], v182 offset:9728
    s_add_u32 s13, s13, 16777216
    s_add_u32 s36, s6, s13
    s_addc_u32 s37, s7, 0
    s_and_b32 s37, s37, 0xffff
    s_mov_b32 s38, s14
    s_mov_b32 s39, 0x20000
    v_mfma_f32_16x16x32_bf16 v[92:95], v[220:223], v[204:207], v[92:95]
    s_mov_b32 s54, 0
    s_mov_b32 s55, 0x2f800000
    v_mfma_f32_16x16x32_bf16 v[84:87], v[220:223], v[200:203], v[84:87]
    ds_read_b64_tr_b16 v[220:221], v183 offset:8704
    ds_read_b64_tr_b16 v[222:223], v183 offset:9728
    s_mov_b32 s47, s46
    s_lshl_b32 s56, s46, 15
    s_waitcnt lgkmcnt(8)
    v_mfma_f32_16x16x32_bf16 v[96:99], v[224:227], v[200:203], v[96:99]
    s_and_b32 s56, s56, 32768
    s_or_b32 s56, s56, 16384
    v_mfma_f32_16x16x32_bf16 v[104:107], v[224:227], v[204:207], v[104:107]
    s_xor_b32 s57, s56, 32768
    s_lshr_b32 s58, s46, 1
    v_mfma_f32_16x16x32_bf16 v[108:111], v[228:231], v[204:207], v[108:111]
    s_sub_u32 s58, s58, 1
    s_and_b32 s60, s44, 1
    v_mfma_f32_16x16x32_bf16 v[100:103], v[228:231], v[200:203], v[100:103]
    s_mov_b32 s48, 16384
    s_mov_b32 s49, 2576980380
    s_waitcnt lgkmcnt(4)
    v_mfma_f32_16x16x32_bf16 v[112:115], v[208:211], v[200:203], v[112:115]
    buffer_store_dwordx4 v[48:51], v3, s[16:19], s74 offen offset:0 sc1
    v_add_u32 v178, 4294901760, v178
    v_add_u32 v179, 4294901760, v179
    v_add_u32 v180, 16384, v180
    v_add_u32 v181, 16384, v181
    v_add_u32 v182, 16384, v182
    v_add_u32 v183, 16384, v183
    s_waitcnt lgkmcnt(0)
    s_barrier
    v_mfma_f32_16x16x32_bf16 v[120:123], v[208:211], v[204:207], v[120:123]
    ds_read_b128 v[192:195], v178 offset:0
    ds_read_b64_tr_b16 v[224:225], v180 offset:0
    ds_read_b64_tr_b16 v[226:227], v180 offset:1024
    v_mfma_f32_16x16x32_bf16 v[124:127], v[212:215], v[204:207], v[124:127]
    ds_read_b128 v[196:199], v178 offset:2048
    ds_read_b64_tr_b16 v[228:229], v181 offset:0
    ds_read_b64_tr_b16 v[230:231], v181 offset:1024
    v_mfma_f32_16x16x32_bf16 v[116:119], v[212:215], v[200:203], v[116:119]
    ds_read_b64_tr_b16 v[208:209], v182 offset:0
    ds_read_b64_tr_b16 v[210:211], v182 offset:1024
    v_mfma_f32_16x16x32_bf16 v[128:131], v[216:219], v[200:203], v[128:131]
    ds_read_b64_tr_b16 v[212:213], v183 offset:0
    ds_read_b64_tr_b16 v[214:215], v183 offset:1024
    v_mfma_f32_16x16x32_bf16 v[136:139], v[216:219], v[204:207], v[136:139]
    ds_read_b64_tr_b16 v[216:217], v180 offset:512
    ds_read_b64_tr_b16 v[218:219], v180 offset:1536
    v_mfma_f32_16x16x32_bf16 v[140:143], v[220:223], v[204:207], v[140:143]
    v_mfma_f32_16x16x32_bf16 v[132:135], v[220:223], v[200:203], v[132:135]
    ds_read_b64_tr_b16 v[220:221], v181 offset:512
    ds_read_b64_tr_b16 v[222:223], v181 offset:1536
    s_waitcnt lgkmcnt(10)
    v_mfma_f32_16x16x32_bf16 v[80:83], v[224:227], v[192:195], v[80:83]
    ds_read_b128 v[200:203], v179 offset:0
    s_lshl_b32 s13, s12, 5
    s_mov_b32 s14, 147456
    v_and_b32 v8, 31, v0
    v_mfma_f32_16x16x32_bf16 v[88:91], v[224:227], v[196:199], v[88:91]
    ds_read_b64_tr_b16 v[224:225], v182 offset:512
    ds_read_b64_tr_b16 v[226:227], v182 offset:1536
    v_add_u32 v8, s13, v8
    v_min_u32 v8, 251, v8
    v_lshlrev_b32 v8, 4, v8
    s_waitcnt lgkmcnt(11)
    v_mfma_f32_16x16x32_bf16 v[92:95], v[228:231], v[196:199], v[92:95]
    ds_read_b128 v[204:207], v179 offset:2048
    v_lshl_add_u32 v8, v10, 12, v8
    v_and_b32 v11, 15, v0
    v_lshl_add_u32 v11, v10, 4, v11
    v_mfma_f32_16x16x32_bf16 v[84:87], v[228:231], v[192:195], v[84:87]
    ds_read_b64_tr_b16 v[228:229], v183 offset:512
    ds_read_b64_tr_b16 v[230:231], v183 offset:1536
    v_add_u32 v11, s13, v11
    v_min_u32 v11, 251, v11
    v_mul_u32_u24 v9, 3121, v11
    s_waitcnt lgkmcnt(10)
    v_mfma_f32_16x16x32_bf16 v[96:99], v[208:211], v[192:195], v[96:99]
    v_lshrrev_b32 v9, 16, v9
    v_and_b32 v9, 1, v9
    v_mul_u32_u24 v9, 328, v9
    v_mfma_f32_16x16x32_bf16 v[104:107], v[208:211], v[196:199], v[104:107]
    ds_read_b64_tr_b16 v[208:209], v180 offset:8192
    ds_read_b64_tr_b16 v[210:211], v180 offset:9216
    v_lshlrev_b32 v11, 4, v11
    v_sub_u32 v11, v11, v9
    v_bfe_u32 v9, v0, 4, 1
    v_mfma_f32_16x16x32_bf16 v[108:111], v[212:215], v[196:199], v[108:111]
    v_mul_u32_u24 v9, 336, v9
    v_add3_u32 v11, v11, v9, s14
    s_mul_i32 s13, s15, 2016
    v_mfma_f32_16x16x32_bf16 v[100:103], v[212:215], v[192:195], v[100:103]
    ds_read_b64_tr_b16 v[212:213], v181 offset:8192
    ds_read_b64_tr_b16 v[214:215], v181 offset:9216
    s_waitcnt lgkmcnt(10)
    v_mfma_f32_16x16x32_bf16 v[112:115], v[216:219], v[192:195], v[112:115]
    s_add_u32 s13, s13, 147456
    v_and_b32 v12, 31, v0
    v_mfma_f32_16x16x32_bf16 v[120:123], v[216:219], v[196:199], v[120:123]
    ds_read_b64_tr_b16 v[216:217], v182 offset:8192
    ds_read_b64_tr_b16 v[218:219], v182 offset:9216
    v_min_u32 v13, 20, v12
    v_lshlrev_b32 v13, 4, v13
    v_mfma_f32_16x16x32_bf16 v[124:127], v[220:223], v[196:199], v[124:127]
    v_lshl_add_u32 v13, v10, 12, v13
    v_add_u32 v13, s13, v13
    v_mfma_f32_16x16x32_bf16 v[116:119], v[220:223], v[192:195], v[116:119]
    ds_read_b64_tr_b16 v[220:221], v183 offset:8192
    ds_read_b64_tr_b16 v[222:223], v183 offset:9216
    s_lshl_b32 s13, s62, 2
    s_and_b32 s14, s12, 3
    s_waitcnt lgkmcnt(8)
    v_mfma_f32_16x16x32_bf16 v[128:131], v[224:227], v[192:195], v[128:131]
    s_add_u32 s13, s13, s14
    s_mul_i32 s13, s13, 40960
    v_mfma_f32_16x16x32_bf16 v[136:139], v[224:227], v[196:199], v[136:139]
    ds_read_b64_tr_b16 v[224:225], v180 offset:8704
    ds_read_b64_tr_b16 v[226:227], v180 offset:9728
    s_mul_i32 s14, s63, 1280
    s_add_u32 s13, s13, s14
    v_mfma_f32_16x16x32_bf16 v[140:143], v[228:231], v[196:199], v[140:143]
    s_add_u32 s71, s13, 62914560
    s_mul_i32 s14, s15, 5
    v_mfma_f32_16x16x32_bf16 v[132:135], v[228:231], v[192:195], v[132:135]
    ds_read_b64_tr_b16 v[228:229], v181 offset:8704
    ds_read_b64_tr_b16 v[230:231], v181 offset:9728
    s_waitcnt lgkmcnt(8)
    v_mfma_f32_16x16x32_bf16 v[80:83], v[208:211], v[200:203], v[80:83]
    v_add_u32 v14, s14, v10
    v_bfe_u32 v12, v0, 4, 1
    v_mfma_f32_16x16x32_bf16 v[88:91], v[208:211], v[204:207], v[88:91]
    ds_read_b64_tr_b16 v[208:209], v182 offset:8704
    ds_read_b64_tr_b16 v[210:211], v182 offset:9728
    v_mul_u32_u24 v12, 20480, v12
    v_and_b32 v15, 15, v0
    v_mfma_f32_16x16x32_bf16 v[92:95], v[212:215], v[204:207], v[92:95]
    v_lshl_add_u32 v12, v15, 4, v12
    v_lshrrev_b32 v15, 1, v14
    v_mfma_f32_16x16x32_bf16 v[84:87], v[212:215], v[200:203], v[84:87]
    ds_read_b64_tr_b16 v[212:213], v183 offset:8704
    ds_read_b64_tr_b16 v[214:215], v183 offset:9728
    v_lshl_add_u32 v12, v15, 8, v12
    v_and_b32 v15, 1, v14
    s_waitcnt lgkmcnt(8)
    v_mfma_f32_16x16x32_bf16 v[96:99], v[216:219], v[200:203], v[96:99]
    v_lshl_add_u32 v12, v15, 3, v12
    v_lshl_add_u32 v14, v10, 30, v12
    v_mfma_f32_16x16x32_bf16 v[104:107], v[216:219], v[204:207], v[104:107]
    s_and_b32 s13, s2, 7
    s_lshl_b32 s13, s13, 1
    v_mfma_f32_16x16x32_bf16 v[108:111], v[220:223], v[204:207], v[108:111]
    s_lshr_b32 s14, s2, 6
    s_lshr_b32 s14, 9, s14
    s_and_b32 s14, s14, 1
    s_add_u32 s13, s13, s14
    v_mfma_f32_16x16x32_bf16 v[100:103], v[220:223], v[200:203], v[100:103]
    v_lshlrev_b32 v4, 2, s13
    v_mov_b32 v5, 1
    s_waitcnt lgkmcnt(4)
    v_mfma_f32_16x16x32_bf16 v[112:115], v[224:227], v[200:203], v[112:115]
    buffer_store_dwordx4 v[52:55], v3, s[16:19], s74 offen offset:1024 sc1
    v_add_u32 v178, 32768, v178
    v_add_u32 v179, 32768, v179
    v_add_u32 v180, 16384, v180
    v_add_u32 v181, 16384, v181
    v_add_u32 v182, 16384, v182
    v_add_u32 v183, 16384, v183
    s_waitcnt vmcnt(2)
    s_waitcnt lgkmcnt(0)
    s_barrier
    v_mfma_f32_16x16x32_bf16 v[120:123], v[224:227], v[204:207], v[120:123]
    ds_read_b128 v[192:195], v178 offset:0
    ds_read_b64_tr_b16 v[216:217], v180 offset:0
    ds_read_b64_tr_b16 v[218:219], v180 offset:1024
    v_mfma_f32_16x16x32_bf16 v[124:127], v[228:231], v[204:207], v[124:127]
    ds_read_b128 v[196:199], v178 offset:2048
    ds_read_b64_tr_b16 v[220:221], v181 offset:0
    ds_read_b64_tr_b16 v[222:223], v181 offset:1024
    v_mfma_f32_16x16x32_bf16 v[116:119], v[228:231], v[200:203], v[116:119]
    ds_read_b64_tr_b16 v[224:225], v182 offset:0
    ds_read_b64_tr_b16 v[226:227], v182 offset:1024
    v_mfma_f32_16x16x32_bf16 v[128:131], v[208:211], v[200:203], v[128:131]
    ds_read_b64_tr_b16 v[228:229], v183 offset:0
    ds_read_b64_tr_b16 v[230:231], v183 offset:1024
    v_mfma_f32_16x16x32_bf16 v[136:139], v[208:211], v[204:207], v[136:139]
    ds_read_b64_tr_b16 v[208:209], v180 offset:512
    ds_read_b64_tr_b16 v[210:211], v180 offset:1536
    v_mfma_f32_16x16x32_bf16 v[140:143], v[212:215], v[204:207], v[140:143]
    v_mfma_f32_16x16x32_bf16 v[132:135], v[212:215], v[200:203], v[132:135]
    ds_read_b64_tr_b16 v[212:213], v181 offset:512
    ds_read_b64_tr_b16 v[214:215], v181 offset:1536
    s_waitcnt lgkmcnt(10)
    v_mfma_f32_16x16x32_bf16 v[80:83], v[216:219], v[192:195], v[80:83]
    ds_read_b128 v[200:203], v179 offset:0
    s_load_dwordx2 s[40:41], s[0:1], 80
    s_lshl_b32 s13, s44, 5
    v_mfma_f32_16x16x32_bf16 v[88:91], v[216:219], v[196:199], v[88:91]
    ds_read_b64_tr_b16 v[216:217], v182 offset:512
    ds_read_b64_tr_b16 v[218:219], v182 offset:1536
    s_add_u32 s13, s13, s61
    s_lshl_b32 s13, s13, 4
    s_waitcnt lgkmcnt(11)
    v_mfma_f32_16x16x32_bf16 v[92:95], v[220:223], v[196:199], v[92:95]
    ds_read_b128 v[204:207], v179 offset:2048
    s_add_u32 s9, s13, 75497472
    v_mov_b32 v190, 0
    v_mfma_f32_16x16x32_bf16 v[84:87], v[220:223], v[192:195], v[84:87]
    ds_read_b64_tr_b16 v[220:221], v183 offset:512
    ds_read_b64_tr_b16 v[222:223], v183 offset:1536
    s_mov_b64 exec, 1
    buffer_store_dword v190, off, s[16:19], s9 sc1
    s_mov_b64 exec, -1
    s_bfe_u32 s13, s2, 262146
    s_waitcnt lgkmcnt(10)
    v_mfma_f32_16x16x32_bf16 v[96:99], v[224:227], v[192:195], v[96:99]
    s_lshl_b32 s13, s13, 8
    s_add_u32 s13, s13, 75563008
    v_mfma_f32_16x16x32_bf16 v[104:107], v[224:227], v[196:199], v[104:107]
    ds_read_b64_tr_b16 v[224:225], v180 offset:8192
    ds_read_b64_tr_b16 v[226:227], v180 offset:9216
    s_and_b32 s14, s2, 195
    s_or_b32 s14, s14, s12
    s_cselect_b64 exec, 0, 1
    buffer_store_dword v190, off, s[16:19], s13 sc1
    s_mov_b64 exec, -1
    v_mfma_f32_16x16x32_bf16 v[108:111], v[228:231], v[196:199], v[108:111]
    v_mfma_f32_16x16x32_bf16 v[100:103], v[228:231], v[192:195], v[100:103]
    ds_read_b64_tr_b16 v[228:229], v181 offset:8192
    ds_read_b64_tr_b16 v[230:231], v181 offset:9216
    s_waitcnt lgkmcnt(10)
    v_mfma_f32_16x16x32_bf16 v[112:115], v[208:211], v[192:195], v[112:115]
    v_mfma_f32_16x16x32_bf16 v[120:123], v[208:211], v[196:199], v[120:123]
    ds_read_b64_tr_b16 v[208:209], v182 offset:8192
    ds_read_b64_tr_b16 v[210:211], v182 offset:9216
    v_mfma_f32_16x16x32_bf16 v[124:127], v[212:215], v[196:199], v[124:127]
    v_mfma_f32_16x16x32_bf16 v[116:119], v[212:215], v[192:195], v[116:119]
    ds_read_b64_tr_b16 v[212:213], v183 offset:8192
    ds_read_b64_tr_b16 v[214:215], v183 offset:9216
    s_waitcnt lgkmcnt(8)
    v_mfma_f32_16x16x32_bf16 v[128:131], v[216:219], v[192:195], v[128:131]
    v_mfma_f32_16x16x32_bf16 v[136:139], v[216:219], v[196:199], v[136:139]
    ds_read_b64_tr_b16 v[216:217], v180 offset:8704
    ds_read_b64_tr_b16 v[218:219], v180 offset:9728
    v_mfma_f32_16x16x32_bf16 v[140:143], v[220:223], v[196:199], v[140:143]
    v_mfma_f32_16x16x32_bf16 v[132:135], v[220:223], v[192:195], v[132:135]
    ds_read_b64_tr_b16 v[220:221], v181 offset:8704
    ds_read_b64_tr_b16 v[222:223], v181 offset:9728
    s_waitcnt lgkmcnt(8)
    v_mfma_f32_16x16x32_bf16 v[80:83], v[224:227], v[200:203], v[80:83]
    v_mfma_f32_16x16x32_bf16 v[88:91], v[224:227], v[204:207], v[88:91]
    ds_read_b64_tr_b16 v[224:225], v182 offset:8704
    ds_read_b64_tr_b16 v[226:227], v182 offset:9728
    v_mfma_f32_16x16x32_bf16 v[92:95], v[228:231], v[204:207], v[92:95]
    v_mfma_f32_16x16x32_bf16 v[84:87], v[228:231], v[200:203], v[84:87]
    ds_read_b64_tr_b16 v[228:229], v183 offset:8704
    ds_read_b64_tr_b16 v[230:231], v183 offset:9728
    s_waitcnt lgkmcnt(8)
    v_mfma_f32_16x16x32_bf16 v[96:99], v[208:211], v[200:203], v[96:99]
    v_mfma_f32_16x16x32_bf16 v[104:107], v[208:211], v[204:207], v[104:107]
    v_mfma_f32_16x16x32_bf16 v[108:111], v[212:215], v[204:207], v[108:111]
    v_mfma_f32_16x16x32_bf16 v[100:103], v[212:215], v[200:203], v[100:103]
    s_waitcnt lgkmcnt(4)
    v_mfma_f32_16x16x32_bf16 v[112:115], v[216:219], v[200:203], v[112:115]
    buffer_store_dwordx4 v[56:59], v3, s[16:19], s75 offen offset:0 sc1
    v_add_u32 v178, 32768, v178
    v_add_u32 v179, 32768, v179
    v_add_u32 v180, 4294934528, v180
    v_add_u32 v181, 4294934528, v181
    v_add_u32 v182, 4294934528, v182
    v_add_u32 v183, 4294934528, v183
    s_waitcnt lgkmcnt(0)
    s_barrier
    v_mfma_f32_16x16x32_bf16 v[120:123], v[216:219], v[204:207], v[120:123]
    ds_read_b128 v[192:195], v178 offset:0
    ds_read_b64_tr_b16 v[208:209], v180 offset:0
    ds_read_b64_tr_b16 v[210:211], v180 offset:1024
    v_mfma_f32_16x16x32_bf16 v[124:127], v[220:223], v[204:207], v[124:127]
    ds_read_b128 v[196:199], v178 offset:2048
    ds_read_b64_tr_b16 v[212:213], v181 offset:0
    ds_read_b64_tr_b16 v[214:215], v181 offset:1024
    v_mfma_f32_16x16x32_bf16 v[116:119], v[220:223], v[200:203], v[116:119]
    ds_read_b64_tr_b16 v[216:217], v182 offset:0
    ds_read_b64_tr_b16 v[218:219], v182 offset:1024
    v_mfma_f32_16x16x32_bf16 v[128:131], v[224:227], v[200:203], v[128:131]
    ds_read_b64_tr_b16 v[220:221], v183 offset:0
    ds_read_b64_tr_b16 v[222:223], v183 offset:1024
    v_mfma_f32_16x16x32_bf16 v[136:139], v[224:227], v[204:207], v[136:139]
    ds_read_b64_tr_b16 v[224:225], v180 offset:512
    ds_read_b64_tr_b16 v[226:227], v180 offset:1536
    v_mfma_f32_16x16x32_bf16 v[140:143], v[228:231], v[204:207], v[140:143]
    v_mfma_f32_16x16x32_bf16 v[132:135], v[228:231], v[200:203], v[132:135]
    ds_read_b64_tr_b16 v[228:229], v181 offset:512
    ds_read_b64_tr_b16 v[230:231], v181 offset:1536
    s_waitcnt lgkmcnt(10)
    v_mfma_f32_16x16x32_bf16 v[80:83], v[208:211], v[192:195], v[80:83]
    ds_read_b128 v[200:203], v179 offset:0
    v_bfe_u32 v144, v0, 4, 1
    v_and_b32 v145, 15, v0
    v_lshlrev_b32 v144, 3, v144
    v_mfma_f32_16x16x32_bf16 v[88:91], v[208:211], v[196:199], v[88:91]
    ds_read_b64_tr_b16 v[208:209], v182 offset:512
    ds_read_b64_tr_b16 v[210:211], v182 offset:1536
    v_sub_u32 v144, v145, v144
    v_and_b32 v145, 1, v0
    v_lshlrev_b32 v145, 4, v145
    s_waitcnt lgkmcnt(11)
    v_mfma_f32_16x16x32_bf16 v[92:95], v[212:215], v[196:199], v[92:95]
    ds_read_b128 v[204:207], v179 offset:2048
    v_mov_b32 v146, 0x3f80
    v_lshlrev_b32 v145, v145, v146
    v_lshrrev_b32 v144, 1, v144
    v_mfma_f32_16x16x32_bf16 v[84:87], v[212:215], v[192:195], v[84:87]
    ds_read_b64_tr_b16 v[212:213], v183 offset:512
    ds_read_b64_tr_b16 v[214:215], v183 offset:1536
    v_cmp_eq_u32 vcc, 0, v144
    s_nop 1
    v_cndmask_b32 v148, 0, v145, vcc
    v_cmp_eq_u32 vcc, 1, v144
    s_nop 1
    v_cndmask_b32 v149, 0, v145, vcc
    v_cmp_eq_u32 vcc, 2, v144
    s_nop 1
    v_cndmask_b32 v150, 0, v145, vcc
    s_waitcnt lgkmcnt(10)
    v_mfma_f32_16x16x32_bf16 v[96:99], v[216:219], v[192:195], v[96:99]
    v_cmp_eq_u32 vcc, 3, v144
    s_nop 1
    v_cndmask_b32 v151, 0, v145, vcc
    s_lshl_b32 s13, s12, 9
    s_add_u32 s13, s13, 151552
    v_mfma_f32_16x16x32_bf16 v[104:107], v[216:219], v[196:199], v[104:107]
    ds_read_b64_tr_b16 v[216:217], v180 offset:8192
    ds_read_b64_tr_b16 v[218:219], v180 offset:9216
    v_lshl_add_u32 v144, v0, 3, s13
    v_mov_b32 v146, 0
    v_mov_b32 v147, 0
    v_mfma_f32_16x16x32_bf16 v[108:111], v[220:223], v[196:199], v[108:111]
    ds_write_b64 v144, v[146:147]
    s_lshl_b32 s70, s63, 16
    s_add_u32 s70, s70, 58720256
    v_mfma_f32_16x16x32_bf16 v[100:103], v[220:223], v[192:195], v[100:103]
    ds_read_b64_tr_b16 v[220:221], v181 offset:8192
    ds_read_b64_tr_b16 v[222:223], v181 offset:9216
    s_waitcnt lgkmcnt(11)
    v_mfma_f32_16x16x32_bf16 v[112:115], v[224:227], v[192:195], v[112:115]
    v_mfma_f32_16x16x32_bf16 v[120:123], v[224:227], v[196:199], v[120:123]
    ds_read_b64_tr_b16 v[224:225], v182 offset:8192
    ds_read_b64_tr_b16 v[226:227], v182 offset:9216
    v_mfma_f32_16x16x32_bf16 v[124:127], v[228:231], v[196:199], v[124:127]
    v_mfma_f32_16x16x32_bf16 v[116:119], v[228:231], v[192:195], v[116:119]
    ds_read_b64_tr_b16 v[228:229], v183 offset:8192
    ds_read_b64_tr_b16 v[230:231], v183 offset:9216
    s_waitcnt lgkmcnt(9)
    v_mfma_f32_16x16x32_bf16 v[128:131], v[208:211], v[192:195], v[128:131]
    v_mfma_f32_16x16x32_bf16 v[136:139], v[208:211], v[196:199], v[136:139]
    ds_read_b64_tr_b16 v[208:209], v180 offset:8704
    ds_read_b64_tr_b16 v[210:211], v180 offset:9728
    v_mfma_f32_16x16x32_bf16 v[140:143], v[212:215], v[196:199], v[140:143]
    v_mfma_f32_16x16x32_bf16 v[132:135], v[212:215], v[192:195], v[132:135]
    ds_read_b64_tr_b16 v[212:213], v181 offset:8704
    ds_read_b64_tr_b16 v[214:215], v181 offset:9728
    s_waitcnt lgkmcnt(8)
    v_mfma_f32_16x16x32_bf16 v[80:83], v[216:219], v[200:203], v[80:83]
    v_mfma_f32_16x16x32_bf16 v[88:91], v[216:219], v[204:207], v[88:91]
    ds_read_b64_tr_b16 v[216:217], v182 offset:8704
    ds_read_b64_tr_b16 v[218:219], v182 offset:9728
    v_mfma_f32_16x16x32_bf16 v[92:95], v[220:223], v[204:207], v[92:95]
    v_mfma_f32_16x16x32_bf16 v[84:87], v[220:223], v[200:203], v[84:87]
    ds_read_b64_tr_b16 v[220:221], v183 offset:8704
    ds_read_b64_tr_b16 v[222:223], v183 offset:9728
    s_waitcnt lgkmcnt(8)
    v_mfma_f32_16x16x32_bf16 v[96:99], v[224:227], v[200:203], v[96:99]
    v_mfma_f32_16x16x32_bf16 v[104:107], v[224:227], v[204:207], v[104:107]
    v_mfma_f32_16x16x32_bf16 v[108:111], v[228:231], v[204:207], v[108:111]
    v_mfma_f32_16x16x32_bf16 v[100:103], v[228:231], v[200:203], v[100:103]
    s_waitcnt lgkmcnt(4)
    v_mfma_f32_16x16x32_bf16 v[112:115], v[208:211], v[200:203], v[112:115]
    buffer_store_dwordx4 v[60:63], v3, s[16:19], s75 offen offset:1024 sc1
    v_add_u32 v178, 4294901760, v178
    v_add_u32 v179, 4294901760, v179
    v_add_u32 v180, 16384, v180
    v_add_u32 v181, 16384, v181
    v_add_u32 v182, 16384, v182
    v_add_u32 v183, 16384, v183
    s_waitcnt lgkmcnt(0)
    s_barrier
    v_mfma_f32_16x16x32_bf16 v[120:123], v[208:211], v[204:207], v[120:123]
    ds_read_b128 v[192:195], v178 offset:0
    ds_read_b64_tr_b16 v[224:225], v180 offset:0
    ds_read_b64_tr_b16 v[226:227], v180 offset:1024
    v_mfma_f32_16x16x32_bf16 v[124:127], v[212:215], v[204:207], v[124:127]
    ds_read_b128 v[196:199], v178 offset:2048
    ds_read_b64_tr_b16 v[228:229], v181 offset:0
    ds_read_b64_tr_b16 v[230:231], v181 offset:1024
    v_mfma_f32_16x16x32_bf16 v[116:119], v[212:215], v[200:203], v[116:119]
    ds_read_b64_tr_b16 v[208:209], v182 offset:0
    ds_read_b64_tr_b16 v[210:211], v182 offset:1024
    v_mfma_f32_16x16x32_bf16 v[128:131], v[216:219], v[200:203], v[128:131]
    ds_read_b64_tr_b16 v[212:213], v183 offset:0
    ds_read_b64_tr_b16 v[214:215], v183 offset:1024
    v_mfma_f32_16x16x32_bf16 v[136:139], v[216:219], v[204:207], v[136:139]
    ds_read_b64_tr_b16 v[216:217], v180 offset:512
    ds_read_b64_tr_b16 v[218:219], v180 offset:1536
    v_mfma_f32_16x16x32_bf16 v[140:143], v[220:223], v[204:207], v[140:143]
    v_mfma_f32_16x16x32_bf16 v[132:135], v[220:223], v[200:203], v[132:135]
    ds_read_b64_tr_b16 v[220:221], v181 offset:512
    ds_read_b64_tr_b16 v[222:223], v181 offset:1536
    s_waitcnt lgkmcnt(10)
    v_mfma_f32_16x16x32_bf16 v[80:83], v[224:227], v[192:195], v[80:83]
    ds_read_b128 v[200:203], v179 offset:0
    v_mfma_f32_16x16x32_bf16 v[88:91], v[224:227], v[196:199], v[88:91]
    ds_read_b64_tr_b16 v[224:225], v182 offset:512
    ds_read_b64_tr_b16 v[226:227], v182 offset:1536
    s_waitcnt lgkmcnt(11)
    v_mfma_f32_16x16x32_bf16 v[92:95], v[228:231], v[196:199], v[92:95]
    ds_read_b128 v[204:207], v179 offset:2048
    v_mfma_f32_16x16x32_bf16 v[84:87], v[228:231], v[192:195], v[84:87]
    ds_read_b64_tr_b16 v[228:229], v183 offset:512
    ds_read_b64_tr_b16 v[230:231], v183 offset:1536
    s_waitcnt lgkmcnt(10)
    v_mfma_f32_16x16x32_bf16 v[96:99], v[208:211], v[192:195], v[96:99]
    v_mfma_f32_16x16x32_bf16 v[104:107], v[208:211], v[196:199], v[104:107]
    ds_read_b64_tr_b16 v[208:209], v180 offset:8192
    ds_read_b64_tr_b16 v[210:211], v180 offset:9216
    v_mfma_f32_16x16x32_bf16 v[108:111], v[212:215], v[196:199], v[108:111]
    v_mfma_f32_16x16x32_bf16 v[100:103], v[212:215], v[192:195], v[100:103]
    ds_read_b64_tr_b16 v[212:213], v181 offset:8192
    ds_read_b64_tr_b16 v[214:215], v181 offset:9216
    s_waitcnt lgkmcnt(10)
    v_mfma_f32_16x16x32_bf16 v[112:115], v[216:219], v[192:195], v[112:115]
    v_mfma_f32_16x16x32_bf16 v[120:123], v[216:219], v[196:199], v[120:123]
    ds_read_b64_tr_b16 v[216:217], v182 offset:8192
    ds_read_b64_tr_b16 v[218:219], v182 offset:9216
    v_mfma_f32_16x16x32_bf16 v[124:127], v[220:223], v[196:199], v[124:127]
    v_mfma_f32_16x16x32_bf16 v[116:119], v[220:223], v[192:195], v[116:119]
    ds_read_b64_tr_b16 v[220:221], v183 offset:8192
    ds_read_b64_tr_b16 v[222:223], v183 offset:9216
    s_waitcnt lgkmcnt(8)
    v_mfma_f32_16x16x32_bf16 v[128:131], v[224:227], v[192:195], v[128:131]
    v_mfma_f32_16x16x32_bf16 v[136:139], v[224:227], v[196:199], v[136:139]
    ds_read_b64_tr_b16 v[224:225], v180 offset:8704
    ds_read_b64_tr_b16 v[226:227], v180 offset:9728
    v_mfma_f32_16x16x32_bf16 v[140:143], v[228:231], v[196:199], v[140:143]
    v_mfma_f32_16x16x32_bf16 v[132:135], v[228:231], v[192:195], v[132:135]
    ds_read_b64_tr_b16 v[228:229], v181 offset:8704
    ds_read_b64_tr_b16 v[230:231], v181 offset:9728
    s_waitcnt lgkmcnt(8)
    v_mfma_f32_16x16x32_bf16 v[80:83], v[208:211], v[200:203], v[80:83]
    v_mfma_f32_16x16x32_bf16 v[88:91], v[208:211], v[204:207], v[88:91]
    ds_read_b64_tr_b16 v[208:209], v182 offset:8704
    ds_read_b64_tr_b16 v[210:211], v182 offset:9728
    v_mfma_f32_16x16x32_bf16 v[92:95], v[212:215], v[204:207], v[92:95]
    v_mfma_f32_16x16x32_bf16 v[84:87], v[212:215], v[200:203], v[84:87]
    ds_read_b64_tr_b16 v[212:213], v183 offset:8704
    ds_read_b64_tr_b16 v[214:215], v183 offset:9728
    s_waitcnt lgkmcnt(8)
    v_mfma_f32_16x16x32_bf16 v[96:99], v[216:219], v[200:203], v[96:99]
    v_mfma_f32_16x16x32_bf16 v[104:107], v[216:219], v[204:207], v[104:107]
    v_mfma_f32_16x16x32_bf16 v[108:111], v[220:223], v[204:207], v[108:111]
    v_mfma_f32_16x16x32_bf16 v[100:103], v[220:223], v[200:203], v[100:103]
    s_waitcnt lgkmcnt(4)
    v_mfma_f32_16x16x32_bf16 v[112:115], v[224:227], v[200:203], v[112:115]
    buffer_store_dwordx4 v[64:67], v3, s[16:19], s76 offen offset:0 sc1
    v_add_u32 v178, 32768, v178
    v_add_u32 v179, 32768, v179
    v_add_u32 v180, 16384, v180
    v_add_u32 v181, 16384, v181
    v_add_u32 v182, 16384, v182
    v_add_u32 v183, 16384, v183
    s_waitcnt lgkmcnt(0)
    s_barrier
    v_mfma_f32_16x16x32_bf16 v[120:123], v[224:227], v[204:207], v[120:123]
    ds_read_b128 v[192:195], v178 offset:0
    ds_read_b64_tr_b16 v[216:217], v180 offset:0
    ds_read_b64_tr_b16 v[218:219], v180 offset:1024
    v_mfma_f32_16x16x32_bf16 v[124:127], v[228:231], v[204:207], v[124:127]
    ds_read_b128 v[196:199], v178 offset:2048
    ds_read_b64_tr_b16 v[220:221], v181 offset:0
    ds_read_b64_tr_b16 v[222:223], v181 offset:1024
    v_mfma_f32_16x16x32_bf16 v[116:119], v[228:231], v[200:203], v[116:119]
    ds_read_b64_tr_b16 v[224:225], v182 offset:0
    ds_read_b64_tr_b16 v[226:227], v182 offset:1024
    v_mfma_f32_16x16x32_bf16 v[128:131], v[208:211], v[200:203], v[128:131]
    ds_read_b64_tr_b16 v[228:229], v183 offset:0
    ds_read_b64_tr_b16 v[230:231], v183 offset:1024
    v_mfma_f32_16x16x32_bf16 v[136:139], v[208:211], v[204:207], v[136:139]
    ds_read_b64_tr_b16 v[208:209], v180 offset:512
    ds_read_b64_tr_b16 v[210:211], v180 offset:1536
    v_mfma_f32_16x16x32_bf16 v[140:143], v[212:215], v[204:207], v[140:143]
    v_mfma_f32_16x16x32_bf16 v[132:135], v[212:215], v[200:203], v[132:135]
    ds_read_b64_tr_b16 v[212:213], v181 offset:512
    ds_read_b64_tr_b16 v[214:215], v181 offset:1536
    s_waitcnt lgkmcnt(10)
    v_mfma_f32_16x16x32_bf16 v[80:83], v[216:219], v[192:195], v[80:83]
    ds_read_b128 v[200:203], v179 offset:0
    buffer_load_dwordx4 v[16:19], v8, s[16:19], s70 offen sc1
    v_mfma_f32_16x16x32_bf16 v[88:91], v[216:219], v[196:199], v[88:91]
    ds_read_b64_tr_b16 v[216:217], v182 offset:512
    ds_read_b64_tr_b16 v[218:219], v182 offset:1536
    s_waitcnt lgkmcnt(11)
    v_mfma_f32_16x16x32_bf16 v[92:95], v[220:223], v[196:199], v[92:95]
    ds_read_b128 v[204:207], v179 offset:2048
    s_add_u32 s70, s70, 8192
    buffer_load_dwordx4 v[20:23], v8, s[16:19], s70 offen sc1
    v_mfma_f32_16x16x32_bf16 v[84:87], v[220:223], v[192:195], v[84:87]
    ds_read_b64_tr_b16 v[220:221], v183 offset:512
    ds_read_b64_tr_b16 v[222:223], v183 offset:1536
    s_waitcnt lgkmcnt(10)
    v_mfma_f32_16x16x32_bf16 v[96:99], v[224:227], v[192:195], v[96:99]
    s_add_u32 s70, s70, 8192
    buffer_load_dwordx4 v[24:27], v8, s[16:19], s70 offen sc1
    v_mfma_f32_16x16x32_bf16 v[104:107], v[224:227], v[196:199], v[104:107]
    ds_read_b64_tr_b16 v[224:225], v180 offset:8192
    ds_read_b64_tr_b16 v[226:227], v180 offset:9216
    v_mfma_f32_16x16x32_bf16 v[108:111], v[228:231], v[196:199], v[108:111]
    s_add_u32 s70, s70, 8192
    buffer_load_dwordx4 v[28:31], v8, s[16:19], s70 offen sc1
    v_mfma_f32_16x16x32_bf16 v[100:103], v[228:231], v[192:195], v[100:103]
    ds_read_b64_tr_b16 v[228:229], v181 offset:8192
    ds_read_b64_tr_b16 v[230:231], v181 offset:9216
    s_waitcnt lgkmcnt(10)
    v_mfma_f32_16x16x32_bf16 v[112:115], v[208:211], v[192:195], v[112:115]
    s_add_u32 s70, s70, 8192
    buffer_load_dwordx4 v[32:35], v8, s[16:19], s70 offen sc1
    v_mfma_f32_16x16x32_bf16 v[120:123], v[208:211], v[196:199], v[120:123]
    ds_read_b64_tr_b16 v[208:209], v182 offset:8192
    ds_read_b64_tr_b16 v[210:211], v182 offset:9216
    v_mfma_f32_16x16x32_bf16 v[124:127], v[212:215], v[196:199], v[124:127]
    s_add_u32 s70, s70, 8192
    buffer_load_dwordx4 v[36:39], v8, s[16:19], s70 offen sc1
    v_mfma_f32_16x16x32_bf16 v[116:119], v[212:215], v[192:195], v[116:119]
    ds_read_b64_tr_b16 v[212:213], v183 offset:8192
    ds_read_b64_tr_b16 v[214:215], v183 offset:9216
    s_waitcnt lgkmcnt(8)
    v_mfma_f32_16x16x32_bf16 v[128:131], v[216:219], v[192:195], v[128:131]
    s_add_u32 s70, s70, 8192
    buffer_load_dwordx4 v[40:43], v8, s[16:19], s70 offen sc1
    v_mfma_f32_16x16x32_bf16 v[136:139], v[216:219], v[196:199], v[136:139]
    ds_read_b64_tr_b16 v[216:217], v180 offset:8704
    ds_read_b64_tr_b16 v[218:219], v180 offset:9728
    v_mfma_f32_16x16x32_bf16 v[140:143], v[220:223], v[196:199], v[140:143]
    s_add_u32 s70, s70, 8192
    buffer_load_dwordx4 v[44:47], v8, s[16:19], s70 offen sc1
    s_add_u32 s70, s70, 8192
    v_mfma_f32_16x16x32_bf16 v[132:135], v[220:223], v[192:195], v[132:135]
    ds_read_b64_tr_b16 v[220:221], v181 offset:8704
    ds_read_b64_tr_b16 v[222:223], v181 offset:9728
    s_waitcnt lgkmcnt(8)
    v_mfma_f32_16x16x32_bf16 v[80:83], v[224:227], v[200:203], v[80:83]
    v_mfma_f32_16x16x32_bf16 v[88:91], v[224:227], v[204:207], v[88:91]
    ds_read_b64_tr_b16 v[224:225], v182 offset:8704
    ds_read_b64_tr_b16 v[226:227], v182 offset:9728
    v_mfma_f32_16x16x32_bf16 v[92:95], v[228:231], v[204:207], v[92:95]
    v_mfma_f32_16x16x32_bf16 v[84:87], v[228:231], v[200:203], v[84:87]
    ds_read_b64_tr_b16 v[228:229], v183 offset:8704
    ds_read_b64_tr_b16 v[230:231], v183 offset:9728
    s_waitcnt lgkmcnt(8)
    v_mfma_f32_16x16x32_bf16 v[96:99], v[208:211], v[200:203], v[96:99]
    v_mfma_f32_16x16x32_bf16 v[104:107], v[208:211], v[204:207], v[104:107]
    v_mfma_f32_16x16x32_bf16 v[108:111], v[212:215], v[204:207], v[108:111]
    v_mfma_f32_16x16x32_bf16 v[100:103], v[212:215], v[200:203], v[100:103]
    s_waitcnt lgkmcnt(4)
    v_mfma_f32_16x16x32_bf16 v[112:115], v[216:219], v[200:203], v[112:115]
    buffer_store_dwordx4 v[68:71], v3, s[16:19], s76 offen offset:1024 sc1
    v_add_u32 v178, 32768, v178
    v_add_u32 v179, 32768, v179
    v_add_u32 v180, 4294934528, v180
    v_add_u32 v181, 4294934528, v181
    v_add_u32 v182, 4294934528, v182
    v_add_u32 v183, 4294934528, v183
    s_waitcnt lgkmcnt(0)
    s_barrier
    v_mfma_f32_16x16x32_bf16 v[120:123], v[216:219], v[204:207], v[120:123]
    ds_read_b128 v[192:195], v178 offset:0
    ds_read_b64_tr_b16 v[208:209], v180 offset:0
    ds_read_b64_tr_b16 v[210:211], v180 offset:1024
    v_mfma_f32_16x16x32_bf16 v[124:127], v[220:223], v[204:207], v[124:127]
    ds_read_b128 v[196:199], v178 offset:2048
    ds_read_b64_tr_b16 v[212:213], v181 offset:0
    ds_read_b64_tr_b16 v[214:215], v181 offset:1024
    v_mfma_f32_16x16x32_bf16 v[116:119], v[220:223], v[200:203], v[116:119]
    ds_read_b64_tr_b16 v[216:217], v182 offset:0
    ds_read_b64_tr_b16 v[218:219], v182 offset:1024
    v_mfma_f32_16x16x32_bf16 v[128:131], v[224:227], v[200:203], v[128:131]
    ds_read_b64_tr_b16 v[220:221], v183 offset:0
    ds_read_b64_tr_b16 v[222:223], v183 offset:1024
    v_mfma_f32_16x16x32_bf16 v[136:139], v[224:227], v[204:207], v[136:139]
    ds_read_b64_tr_b16 v[224:225], v180 offset:512
    ds_read_b64_tr_b16 v[226:227], v180 offset:1536
    v_mfma_f32_16x16x32_bf16 v[140:143], v[228:231], v[204:207], v[140:143]
    v_mfma_f32_16x16x32_bf16 v[132:135], v[228:231], v[200:203], v[132:135]
    ds_read_b64_tr_b16 v[228:229], v181 offset:512
    ds_read_b64_tr_b16 v[230:231], v181 offset:1536
    s_waitcnt lgkmcnt(10)
    v_mfma_f32_16x16x32_bf16 v[80:83], v[208:211], v[192:195], v[80:83]
    ds_read_b128 v[200:203], v179 offset:0
    v_mfma_f32_16x16x32_bf16 v[88:91], v[208:211], v[196:199], v[88:91]
    ds_read_b64_tr_b16 v[208:209], v182 offset:512
    ds_read_b64_tr_b16 v[210:211], v182 offset:1536
    s_waitcnt lgkmcnt(11)
    v_mfma_f32_16x16x32_bf16 v[92:95], v[212:215], v[196:199], v[92:95]
    ds_read_b128 v[204:207], v179 offset:2048
    v_mfma_f32_16x16x32_bf16 v[84:87], v[212:215], v[192:195], v[84:87]
    ds_read_b64_tr_b16 v[212:213], v183 offset:512
    ds_read_b64_tr_b16 v[214:215], v183 offset:1536
    s_waitcnt lgkmcnt(10)
    v_mfma_f32_16x16x32_bf16 v[96:99], v[216:219], v[192:195], v[96:99]
    v_mfma_f32_16x16x32_bf16 v[104:107], v[216:219], v[196:199], v[104:107]
    ds_read_b64_tr_b16 v[216:217], v180 offset:8192
    ds_read_b64_tr_b16 v[218:219], v180 offset:9216
    v_mfma_f32_16x16x32_bf16 v[108:111], v[220:223], v[196:199], v[108:111]
    v_mfma_f32_16x16x32_bf16 v[100:103], v[220:223], v[192:195], v[100:103]
    ds_read_b64_tr_b16 v[220:221], v181 offset:8192
    ds_read_b64_tr_b16 v[222:223], v181 offset:9216
    s_waitcnt lgkmcnt(10)
    v_mfma_f32_16x16x32_bf16 v[112:115], v[224:227], v[192:195], v[112:115]
    s_waitcnt vmcnt(1)
    v_mfma_f32_16x16x32_bf16 v[144:147], v[148:151], v[16:19], 0
    v_mfma_f32_16x16x32_bf16 v[120:123], v[224:227], v[196:199], v[120:123]
    ds_read_b64_tr_b16 v[224:225], v182 offset:8192
    ds_read_b64_tr_b16 v[226:227], v182 offset:9216
    v_mfma_f32_16x16x32_bf16 v[144:147], v[148:151], v[20:23], v[144:147]
    v_mfma_f32_16x16x32_bf16 v[124:127], v[228:231], v[196:199], v[124:127]
    v_mfma_f32_16x16x32_bf16 v[144:147], v[148:151], v[24:27], v[144:147]
    v_mfma_f32_16x16x32_bf16 v[116:119], v[228:231], v[192:195], v[116:119]
    ds_read_b64_tr_b16 v[228:229], v183 offset:8192
    ds_read_b64_tr_b16 v[230:231], v183 offset:9216
    v_mfma_f32_16x16x32_bf16 v[144:147], v[148:151], v[28:31], v[144:147]
    s_waitcnt lgkmcnt(8)
    v_mfma_f32_16x16x32_bf16 v[128:131], v[208:211], v[192:195], v[128:131]
    v_mfma_f32_16x16x32_bf16 v[144:147], v[148:151], v[32:35], v[144:147]
    v_mfma_f32_16x16x32_bf16 v[136:139], v[208:211], v[196:199], v[136:139]
    ds_read_b64_tr_b16 v[208:209], v180 offset:8704
    ds_read_b64_tr_b16 v[210:211], v180 offset:9728
    v_mfma_f32_16x16x32_bf16 v[144:147], v[148:151], v[36:39], v[144:147]
    v_mfma_f32_16x16x32_bf16 v[140:143], v[212:215], v[196:199], v[140:143]
    v_mfma_f32_16x16x32_bf16 v[144:147], v[148:151], v[40:43], v[144:147]
    v_mfma_f32_16x16x32_bf16 v[132:135], v[212:215], v[192:195], v[132:135]
    ds_read_b64_tr_b16 v[212:213], v181 offset:8704
    ds_read_b64_tr_b16 v[214:215], v181 offset:9728
    v_mfma_f32_16x16x32_bf16 v[144:147], v[148:151], v[44:47], v[144:147]
    s_waitcnt lgkmcnt(8)
    v_mfma_f32_16x16x32_bf16 v[80:83], v[216:219], v[200:203], v[80:83]
    v_mfma_f32_16x16x32_bf16 v[88:91], v[216:219], v[204:207], v[88:91]
    ds_read_b64_tr_b16 v[216:217], v182 offset:8704
    ds_read_b64_tr_b16 v[218:219], v182 offset:9728
    v_mfma_f32_16x16x32_bf16 v[92:95], v[220:223], v[204:207], v[92:95]
    v_cmp_u_f32 vcc, v144, v145
    v_mfma_f32_16x16x32_bf16 v[84:87], v[220:223], v[200:203], v[84:87]
    ds_read_b64_tr_b16 v[220:221], v183 offset:8704
    ds_read_b64_tr_b16 v[222:223], v183 offset:9728
    s_waitcnt lgkmcnt(8)
    v_mfma_f32_16x16x32_bf16 v[96:99], v[224:227], v[200:203], v[96:99]
    s_cbranch_vccnz mg_kpw_r1
mg_kpr_r1:
    v_cvt_pk_bf16_f32 v144, v144, v145
    v_cvt_pk_bf16_f32 v145, v146, v147
    v_mfma_f32_16x16x32_bf16 v[104:107], v[224:227], v[204:207], v[104:107]
    ds_write_b64 v11, v[144:145]
    v_mfma_f32_16x16x32_bf16 v[108:111], v[228:231], v[204:207], v[108:111]
    v_mfma_f32_16x16x32_bf16 v[100:103], v[228:231], v[200:203], v[100:103]
    s_waitcnt lgkmcnt(5)
    v_mfma_f32_16x16x32_bf16 v[112:115], v[208:211], v[200:203], v[112:115]
    buffer_store_dwordx4 v[72:75], v3, s[16:19], s77 offen offset:0 sc1
    v_add_u32 v178, 4294901760, v178
    v_add_u32 v179, 4294901760, v179
    v_add_u32 v180, 16384, v180
    v_add_u32 v181, 16384, v181
    v_add_u32 v182, 16384, v182
    v_add_u32 v183, 16384, v183
    s_waitcnt lgkmcnt(0)
    s_barrier
    v_mfma_f32_16x16x32_bf16 v[120:123], v[208:211], v[204:207], v[120:123]
    ds_read_b128 v[192:195], v178 offset:0
    ds_read_b64_tr_b16 v[224:225], v180 offset:0
    ds_read_b64_tr_b16 v[226:227], v180 offset:1024
    v_mfma_f32_16x16x32_bf16 v[124:127], v[212:215], v[204:207], v[124:127]
    ds_read_b128 v[196:199], v178 offset:2048
    ds_read_b64_tr_b16 v[228:229], v181 offset:0
    ds_read_b64_tr_b16 v[230:231], v181 offset:1024
    v_mfma_f32_16x16x32_bf16 v[116:119], v[212:215], v[200:203], v[116:119]
    ds_read_b64_tr_b16 v[208:209], v182 offset:0
    ds_read_b64_tr_b16 v[210:211], v182 offset:1024
    v_mfma_f32_16x16x32_bf16 v[128:131], v[216:219], v[200:203], v[128:131]
    ds_read_b64_tr_b16 v[212:213], v183 offset:0
    ds_read_b64_tr_b16 v[214:215], v183 offset:1024
    v_mfma_f32_16x16x32_bf16 v[136:139], v[216:219], v[204:207], v[136:139]
    ds_read_b64_tr_b16 v[216:217], v180 offset:512
    ds_read_b64_tr_b16 v[218:219], v180 offset:1536
    v_mfma_f32_16x16x32_bf16 v[140:143], v[220:223], v[204:207], v[140:143]
    v_mfma_f32_16x16x32_bf16 v[132:135], v[220:223], v[200:203], v[132:135]
    ds_read_b64_tr_b16 v[220:221], v181 offset:512
    ds_read_b64_tr_b16 v[222:223], v181 offset:1536
    s_waitcnt lgkmcnt(10)
    v_mfma_f32_16x16x32_bf16 v[80:83], v[224:227], v[192:195], v[80:83]
    ds_read_b128 v[200:203], v179 offset:0
    s_lshr_b32 s72, s61, 1
    s_lshl_b32 s72, s72, 2
    v_mfma_f32_16x16x32_bf16 v[88:91], v[224:227], v[196:199], v[88:91]
    ds_read_b64_tr_b16 v[224:225], v182 offset:512
    ds_read_b64_tr_b16 v[226:227], v182 offset:1536
    s_waitcnt lgkmcnt(11)
    v_mfma_f32_16x16x32_bf16 v[92:95], v[228:231], v[196:199], v[92:95]
    ds_read_b128 v[204:207], v179 offset:2048
    ds_read_b128 v[20:23], v13 offset:0
    ds_read_b128 v[24:27], v13 offset:336
    v_mfma_f32_16x16x32_bf16 v[84:87], v[228:231], v[192:195], v[84:87]
    ds_read_b64_tr_b16 v[228:229], v183 offset:512
    ds_read_b64_tr_b16 v[230:231], v183 offset:1536
    ds_read_b128 v[28:31], v13 offset:672
    ds_read_b128 v[32:35], v13 offset:1008
    s_waitcnt lgkmcnt(14)
    v_mfma_f32_16x16x32_bf16 v[96:99], v[208:211], v[192:195], v[96:99]
    ds_read_b128 v[36:39], v13 offset:1344
    v_mfma_f32_16x16x32_bf16 v[104:107], v[208:211], v[196:199], v[104:107]
    ds_read_b64_tr_b16 v[208:209], v180 offset:8192
    ds_read_b64_tr_b16 v[210:211], v180 offset:9216
    v_mfma_f32_16x16x32_bf16 v[108:111], v[212:215], v[196:199], v[108:111]
    v_mfma_f32_16x16x32_bf16 v[100:103], v[212:215], v[192:195], v[100:103]
    ds_read_b64_tr_b16 v[212:213], v181 offset:8192
    ds_read_b64_tr_b16 v[214:215], v181 offset:9216
    s_waitcnt lgkmcnt(15)
    v_mfma_f32_16x16x32_bf16 v[112:115], v[216:219], v[192:195], v[112:115]
    s_waitcnt lgkmcnt(4)
    v_mfma_f32_16x16x32_bf16 v[120:123], v[216:219], v[196:199], v[120:123]
    ds_read_b64_tr_b16 v[216:217], v182 offset:8192
    ds_read_b64_tr_b16 v[218:219], v182 offset:9216
    v_mfma_f32_32x32x16_bf16 v[144:159], v[20:23], v[232:235], 0
    v_mfma_f32_16x16x32_bf16 v[124:127], v[220:223], v[196:199], v[124:127]
    v_mfma_f32_32x32x16_bf16 v[144:159], v[24:27], v[236:239], v[144:159]
    v_mfma_f32_16x16x32_bf16 v[116:119], v[220:223], v[192:195], v[116:119]
    ds_read_b64_tr_b16 v[220:221], v183 offset:8192
    ds_read_b64_tr_b16 v[222:223], v183 offset:9216
    v_mfma_f32_32x32x16_bf16 v[144:159], v[28:31], v[240:243], v[144:159]
    v_mfma_f32_16x16x32_bf16 v[128:131], v[224:227], v[192:195], v[128:131]
    v_mfma_f32_32x32x16_bf16 v[144:159], v[32:35], v[244:247], v[144:159]
    v_mfma_f32_16x16x32_bf16 v[136:139], v[224:227], v[196:199], v[136:139]
    ds_read_b64_tr_b16 v[224:225], v180 offset:8704
    ds_read_b64_tr_b16 v[226:227], v180 offset:9728
    v_mfma_f32_32x32x16_bf16 v[144:159], v[36:39], v[248:251], v[144:159]
    v_mfma_f32_16x16x32_bf16 v[140:143], v[228:231], v[196:199], v[140:143]
    v_mfma_f32_16x16x32_bf16 v[132:135], v[228:231], v[192:195], v[132:135]
    ds_read_b64_tr_b16 v[228:229], v181 offset:8704
    ds_read_b64_tr_b16 v[230:231], v181 offset:9728
    s_waitcnt lgkmcnt(8)
    v_mfma_f32_16x16x32_bf16 v[80:83], v[208:211], v[200:203], v[80:83]
    v_add_f32 v8, 0x358637bd, v156
    v_rcp_f32 v8, v8
    s_nop 0
    v_mfma_f32_16x16x32_bf16 v[88:91], v[208:211], v[204:207], v[88:91]
    ds_read_b64_tr_b16 v[208:209], v182 offset:8704
    ds_read_b64_tr_b16 v[210:211], v182 offset:9728
    v_mul_f32 v144, v144, v8
    v_mul_f32 v145, v145, v8
    v_mul_f32 v146, v146, v8
    v_mfma_f32_16x16x32_bf16 v[92:95], v[212:215], v[204:207], v[92:95]
    v_mul_f32 v147, v147, v8
    v_mul_f32 v148, v148, v8
    v_mul_f32 v149, v149, v8
    v_mfma_f32_16x16x32_bf16 v[84:87], v[212:215], v[200:203], v[84:87]
    ds_read_b64_tr_b16 v[212:213], v183 offset:8704
    ds_read_b64_tr_b16 v[214:215], v183 offset:9728
    v_mul_f32 v150, v150, v8
    v_mul_f32 v151, v151, v8
    v_mul_f32 v152, v152, v8
    s_waitcnt lgkmcnt(8)
    v_mfma_f32_16x16x32_bf16 v[96:99], v[216:219], v[200:203], v[96:99]
    v_mul_f32 v153, v153, v8
    v_mul_f32 v154, v154, v8
    v_mul_f32 v155, v155, v8
    v_mfma_f32_16x16x32_bf16 v[104:107], v[216:219], v[204:207], v[104:107]
    v_cvt_pk_bf16_f32 v160, v144, v145
    v_cvt_pk_bf16_f32 v161, v146, v147
    v_cvt_pk_bf16_f32 v162, v148, v149
    v_mfma_f32_16x16x32_bf16 v[108:111], v[220:223], v[204:207], v[108:111]
    v_cvt_pk_bf16_f32 v163, v150, v151
    v_cvt_pk_bf16_f32 v164, v152, v153
    v_cvt_pk_bf16_f32 v165, v154, v155
    v_mfma_f32_16x16x32_bf16 v[100:103], v[220:223], v[200:203], v[100:103]
    buffer_store_dwordx2 v[160:161], v12, s[16:19], s71 offen offset:0 sc1
    buffer_store_dwordx2 v[162:163], v12, s[16:19], s71 offen offset:256 sc1
    buffer_store_dwordx2 v[164:165], v14, s[16:19], s71 offen offset:512 sc1
    s_waitcnt lgkmcnt(4)
    v_mfma_f32_16x16x32_bf16 v[112:115], v[224:227], v[200:203], v[112:115]
    buffer_store_dwordx4 v[76:79], v3, s[16:19], s77 offen offset:1024 sc1
    v_add_u32 v178, 32768, v178
    v_add_u32 v179, 32768, v179
    v_add_u32 v180, 16384, v180
    v_add_u32 v181, 16384, v181
    v_add_u32 v182, 16384, v182
    v_add_u32 v183, 16384, v183
    s_waitcnt lgkmcnt(0)
    s_barrier
    v_mfma_f32_16x16x32_bf16 v[120:123], v[224:227], v[204:207], v[120:123]
    ds_read_b128 v[192:195], v178 offset:0
    ds_read_b64_tr_b16 v[216:217], v180 offset:0
    ds_read_b64_tr_b16 v[218:219], v180 offset:1024
    v_mfma_f32_16x16x32_bf16 v[124:127], v[228:231], v[204:207], v[124:127]
    ds_read_b128 v[196:199], v178 offset:2048
    ds_read_b64_tr_b16 v[220:221], v181 offset:0
    ds_read_b64_tr_b16 v[222:223], v181 offset:1024
    s_mov_b32 m0, s50
    s_add_u32 s50, s50, 16384
    buffer_load_dwordx4 v1, s[16:19], s52 offen offset:0 sc1 lds
    buffer_load_dwordx4 v1, s[16:19], s52 offen offset:1024 sc1 lds
    buffer_load_dwordx4 v1, s[16:19], s52 offen offset:2048 sc1 lds
    buffer_load_dwordx4 v1, s[16:19], s52 offen offset:3072 sc1 lds
    s_and_b32 s50, s50, 65535
    s_add_u32 s52, s52, 16384
    v_mfma_f32_16x16x32_bf16 v[116:119], v[228:231], v[200:203], v[116:119]
    ds_read_b64_tr_b16 v[224:225], v182 offset:0
    ds_read_b64_tr_b16 v[226:227], v182 offset:1024
    v_mfma_f32_16x16x32_bf16 v[128:131], v[208:211], v[200:203], v[128:131]
    ds_read_b64_tr_b16 v[228:229], v183 offset:0
    ds_read_b64_tr_b16 v[230:231], v183 offset:1024
    v_mfma_f32_16x16x32_bf16 v[136:139], v[208:211], v[204:207], v[136:139]
    ds_read_b64_tr_b16 v[208:209], v180 offset:512
    ds_read_b64_tr_b16 v[210:211], v180 offset:1536
    v_mfma_f32_16x16x32_bf16 v[140:143], v[212:215], v[204:207], v[140:143]
    v_mfma_f32_16x16x32_bf16 v[132:135], v[212:215], v[200:203], v[132:135]
    ds_read_b64_tr_b16 v[212:213], v181 offset:512
    ds_read_b64_tr_b16 v[214:215], v181 offset:1536
    s_waitcnt lgkmcnt(10)
    v_mfma_f32_16x16x32_bf16 v[80:83], v[216:219], v[192:195], v[80:83]
    ds_read_b128 v[200:203], v179 offset:0
    v_mov_b32 v16, 0
    v_mov_b32 v17, 0
    v_mfma_f32_16x16x32_bf16 v[88:91], v[216:219], v[196:199], v[88:91]
    ds_read_b64_tr_b16 v[216:217], v182 offset:512
    ds_read_b64_tr_b16 v[218:219], v182 offset:1536
    v_mov_b32 v18, 0
    v_mov_b32 v19, 0
    s_waitcnt lgkmcnt(11)
    v_mfma_f32_16x16x32_bf16 v[92:95], v[220:223], v[196:199], v[92:95]
    ds_read_b128 v[204:207], v179 offset:2048
    s_mov_b32 m0, s50
    s_add_u32 s50, s50, 16384
    buffer_load_dwordx4 v1, s[16:19], s52 offen offset:0 sc1 lds
    buffer_load_dwordx4 v1, s[16:19], s52 offen offset:1024 sc1 lds
    buffer_load_dwordx4 v1, s[16:19], s52 offen offset:2048 sc1 lds
    buffer_load_dwordx4 v1, s[16:19], s52 offen offset:3072 sc1 lds
    s_and_b32 s50, s50, 65535
    s_add_u32 s52, s52, 16384
    v_mov_b32 v20, 0
    v_mov_b32 v21, 0
    v_mfma_f32_16x16x32_bf16 v[84:87], v[220:223], v[192:195], v[84:87]
    ds_read_b64_tr_b16 v[220:221], v183 offset:512
    ds_read_b64_tr_b16 v[222:223], v183 offset:1536
    v_mov_b32 v22, 0
    v_mov_b32 v23, 0
    s_waitcnt lgkmcnt(10)
    v_mfma_f32_16x16x32_bf16 v[96:99], v[224:227], v[192:195], v[96:99]
    v_mov_b32 v24, 0
    v_mov_b32 v25, 0
    v_mfma_f32_16x16x32_bf16 v[104:107], v[224:227], v[196:199], v[104:107]
    ds_read_b64_tr_b16 v[224:225], v180 offset:8192
    ds_read_b64_tr_b16 v[226:227], v180 offset:9216
    v_mov_b32 v26, 0
    v_mov_b32 v27, 0
    v_mfma_f32_16x16x32_bf16 v[108:111], v[228:231], v[196:199], v[108:111]
    v_mov_b32 v28, 0
    v_mov_b32 v29, 0
    v_mfma_f32_16x16x32_bf16 v[100:103], v[228:231], v[192:195], v[100:103]
    ds_read_b64_tr_b16 v[228:229], v181 offset:8192
    ds_read_b64_tr_b16 v[230:231], v181 offset:9216
    v_mov_b32 v30, 0
    v_mov_b32 v31, 0
    s_waitcnt lgkmcnt(10)
    v_mfma_f32_16x16x32_bf16 v[112:115], v[208:211], v[192:195], v[112:115]
    v_mov_b32 v32, 0
    v_mov_b32 v33, 0
    v_mfma_f32_16x16x32_bf16 v[120:123], v[208:211], v[196:199], v[120:123]
    ds_read_b64_tr_b16 v[208:209], v182 offset:8192
    ds_read_b64_tr_b16 v[210:211], v182 offset:9216
    v_mov_b32 v34, 0
    v_mov_b32 v35, 0
    v_mfma_f32_16x16x32_bf16 v[124:127], v[212:215], v[196:199], v[124:127]
    s_mov_b32 m0, s51
    s_add_u32 s51, s51, 16384
    buffer_load_dwordx4 v1, s[16:19], s53 offen offset:0 sc1 lds
    buffer_load_dwordx4 v1, s[16:19], s53 offen offset:1024 sc1 lds
    buffer_load_dwordx4 v1, s[16:19], s53 offen offset:2048 sc1 lds
    buffer_load_dwordx4 v1, s[16:19], s53 offen offset:3072 sc1 lds
    s_sub_u32 s14, s51, 81920
    s_cmp_ge_u32 s51, 147456
    s_cselect_b32 s51, s14, s51
    s_add_u32 s53, s53, 16384
    v_mov_b32 v36, 0
    v_mov_b32 v37, 0
    v_mfma_f32_16x16x32_bf16 v[116:119], v[212:215], v[192:195], v[116:119]
    ds_read_b64_tr_b16 v[212:213], v183 offset:8192
    ds_read_b64_tr_b16 v[214:215], v183 offset:9216
    v_mov_b32 v38, 0
    v_mov_b32 v39, 0
    s_waitcnt lgkmcnt(8)
    v_mfma_f32_16x16x32_bf16 v[128:131], v[216:219], v[192:195], v[128:131]
    v_mov_b32 v40, 0
    v_mov_b32 v41, 0
    v_mfma_f32_16x16x32_bf16 v[136:139], v[216:219], v[196:199], v[136:139]
    ds_read_b64_tr_b16 v[216:217], v180 offset:8704
    ds_read_b64_tr_b16 v[218:219], v180 offset:9728
    v_mov_b32 v42, 0
    v_mov_b32 v43, 0
    v_mfma_f32_16x16x32_bf16 v[140:143], v[220:223], v[196:199], v[140:143]
    v_mov_b32 v44, 0
    v_mov_b32 v45, 0
    v_mfma_f32_16x16x32_bf16 v[132:135], v[220:223], v[192:195], v[132:135]
    ds_read_b64_tr_b16 v[220:221], v181 offset:8704
    ds_read_b64_tr_b16 v[222:223], v181 offset:9728
    v_mov_b32 v46, 0
    v_mov_b32 v47, 0
    s_waitcnt lgkmcnt(8)
    v_mfma_f32_16x16x32_bf16 v[80:83], v[224:227], v[200:203], v[80:83]
    v_mov_b32 v48, 0
    v_mov_b32 v49, 0
    v_mfma_f32_16x16x32_bf16 v[88:91], v[224:227], v[204:207], v[88:91]
    ds_read_b64_tr_b16 v[224:225], v182 offset:8704
    ds_read_b64_tr_b16 v[226:227], v182 offset:9728
    v_mov_b32 v50, 0
    v_mov_b32 v51, 0
    v_mfma_f32_16x16x32_bf16 v[92:95], v[228:231], v[204:207], v[92:95]
    v_mov_b32 v52, 0
    v_mov_b32 v53, 0
    v_mfma_f32_16x16x32_bf16 v[84:87], v[228:231], v[200:203], v[84:87]
    ds_read_b64_tr_b16 v[228:229], v183 offset:8704
    ds_read_b64_tr_b16 v[230:231], v183 offset:9728
    v_mov_b32 v54, 0
    v_mov_b32 v55, 0
    s_waitcnt lgkmcnt(8)
    v_mfma_f32_16x16x32_bf16 v[96:99], v[208:211], v[200:203], v[96:99]
    v_mov_b32 v56, 0
    v_mov_b32 v57, 0
    v_mfma_f32_16x16x32_bf16 v[104:107], v[208:211], v[204:207], v[104:107]
    v_mov_b32 v58, 0
    v_mov_b32 v59, 0
    v_mfma_f32_16x16x32_bf16 v[108:111], v[212:215], v[204:207], v[108:111]
    v_mov_b32 v60, 0
    v_mov_b32 v61, 0
    v_mfma_f32_16x16x32_bf16 v[100:103], v[212:215], v[200:203], v[100:103]
    v_mov_b32 v62, 0
    v_mov_b32 v63, 0
    s_waitcnt lgkmcnt(4)
    v_mfma_f32_16x16x32_bf16 v[112:115], v[216:219], v[200:203], v[112:115]
    v_add_u32 v178, 32768, v178
    v_add_u32 v179, 32768, v179
    v_add_u32 v180, 4294934528, v180
    v_add_u32 v181, 4294934528, v181
    v_add_u32 v182, 4294934528, v182
    v_add_u32 v183, 4294934528, v183
    s_waitcnt lgkmcnt(0)
    s_barrier
    v_mfma_f32_16x16x32_bf16 v[120:123], v[216:219], v[204:207], v[120:123]
    ds_read_b128 v[192:195], v178 offset:0
    ds_read_b64_tr_b16 v[208:209], v180 offset:0
    ds_read_b64_tr_b16 v[210:211], v180 offset:1024
    v_mfma_f32_16x16x32_bf16 v[124:127], v[220:223], v[204:207], v[124:127]
    ds_read_b128 v[196:199], v178 offset:2048
    ds_read_b64_tr_b16 v[212:213], v181 offset:0
    ds_read_b64_tr_b16 v[214:215], v181 offset:1024
    s_mov_b32 m0, s50
    s_add_u32 s50, s50, 16384
    buffer_load_dwordx4 v1, s[16:19], s52 offen offset:0 sc1 lds
    buffer_load_dwordx4 v1, s[16:19], s52 offen offset:1024 sc1 lds
    buffer_load_dwordx4 v1, s[16:19], s52 offen offset:2048 sc1 lds
    buffer_load_dwordx4 v1, s[16:19], s52 offen offset:3072 sc1 lds
    s_and_b32 s50, s50, 65535
    s_add_u32 s52, s52, 16384
    v_mfma_f32_16x16x32_bf16 v[116:119], v[220:223], v[200:203], v[116:119]
    ds_read_b64_tr_b16 v[216:217], v182 offset:0
    ds_read_b64_tr_b16 v[218:219], v182 offset:1024
    v_mfma_f32_16x16x32_bf16 v[128:131], v[224:227], v[200:203], v[128:131]
    ds_read_b64_tr_b16 v[220:221], v183 offset:0
    ds_read_b64_tr_b16 v[222:223], v183 offset:1024
    v_mfma_f32_16x16x32_bf16 v[136:139], v[224:227], v[204:207], v[136:139]
    ds_read_b64_tr_b16 v[224:225], v180 offset:512
    ds_read_b64_tr_b16 v[226:227], v180 offset:1536
    v_mfma_f32_16x16x32_bf16 v[140:143], v[228:231], v[204:207], v[140:143]
    v_mfma_f32_16x16x32_bf16 v[132:135], v[228:231], v[200:203], v[132:135]
    ds_read_b64_tr_b16 v[228:229], v181 offset:512
    ds_read_b64_tr_b16 v[230:231], v181 offset:1536
    s_waitcnt lgkmcnt(10)
    v_mfma_f32_16x16x32_bf16 v[80:83], v[208:211], v[192:195], v[80:83]
    ds_read_b128 v[200:203], v179 offset:0
    v_mov_b32 v64, 0
    v_mov_b32 v65, 0
    v_mfma_f32_16x16x32_bf16 v[88:91], v[208:211], v[196:199], v[88:91]
    ds_read_b64_tr_b16 v[208:209], v182 offset:512
    ds_read_b64_tr_b16 v[210:211], v182 offset:1536
    v_mov_b32 v66, 0
    v_mov_b32 v67, 0
    s_waitcnt lgkmcnt(11)
    v_mfma_f32_16x16x32_bf16 v[92:95], v[212:215], v[196:199], v[92:95]
    ds_read_b128 v[204:207], v179 offset:2048
    s_mov_b32 m0, s51
    s_add_u32 s51, s51, 16384
    buffer_load_dwordx4 v1, s[16:19], s53 offen offset:0 sc1 lds
    buffer_load_dwordx4 v1, s[16:19], s53 offen offset:1024 sc1 lds
    buffer_load_dwordx4 v1, s[16:19], s53 offen offset:2048 sc1 lds
    buffer_load_dwordx4 v1, s[16:19], s53 offen offset:3072 sc1 lds
    s_sub_u32 s14, s51, 81920
    s_cmp_ge_u32 s51, 147456
    s_cselect_b32 s51, s14, s51
    s_add_u32 s53, s53, 16384
    v_mov_b32 v68, 0
    v_mov_b32 v69, 0
    v_mfma_f32_16x16x32_bf16 v[84:87], v[212:215], v[192:195], v[84:87]
    ds_read_b64_tr_b16 v[212:213], v183 offset:512
    ds_read_b64_tr_b16 v[214:215], v183 offset:1536
    v_mov_b32 v70, 0
    v_mov_b32 v71, 0
    s_waitcnt lgkmcnt(10)
    v_mfma_f32_16x16x32_bf16 v[96:99], v[216:219], v[192:195], v[96:99]
    v_mov_b32 v72, 0
    v_mov_b32 v73, 0
    v_mfma_f32_16x16x32_bf16 v[104:107], v[216:219], v[196:199], v[104:107]
    ds_read_b64_tr_b16 v[216:217], v180 offset:8192
    ds_read_b64_tr_b16 v[218:219], v180 offset:9216
    v_mov_b32 v74, 0
    v_mov_b32 v75, 0
    v_mfma_f32_16x16x32_bf16 v[108:111], v[220:223], v[196:199], v[108:111]
    v_mov_b32 v76, 0
    v_mov_b32 v77, 0
    v_mfma_f32_16x16x32_bf16 v[100:103], v[220:223], v[192:195], v[100:103]
    ds_read_b64_tr_b16 v[220:221], v181 offset:8192
    ds_read_b64_tr_b16 v[222:223], v181 offset:9216
    v_mov_b32 v78, 0
    v_mov_b32 v79, 0
    s_waitcnt lgkmcnt(10)
    v_mfma_f32_16x16x32_bf16 v[112:115], v[224:227], v[192:195], v[112:115]
    v_and_b32 v12, 3, v0
    v_mfma_f32_16x16x32_bf16 v[120:123], v[224:227], v[196:199], v[120:123]
    ds_read_b64_tr_b16 v[224:225], v182 offset:8192
    ds_read_b64_tr_b16 v[226:227], v182 offset:9216
    v_cmp_eq_u32 vcc, 0, v12
    v_mfma_f32_16x16x32_bf16 v[124:127], v[228:231], v[196:199], v[124:127]
    s_mov_b32 m0, s50
    s_add_u32 s50, s50, 16384
    buffer_load_dwordx4 v1, s[16:19], s52 offen offset:0 sc1 lds
    buffer_load_dwordx4 v1, s[16:19], s52 offen offset:1024 sc1 lds
    buffer_load_dwordx4 v1, s[16:19], s52 offen offset:2048 sc1 lds
    buffer_load_dwordx4 v1, s[16:19], s52 offen offset:3072 sc1 lds
    s_and_b32 s50, s50, 65535
    s_add_u32 s52, s52, 16384
    v_mov_b32 v12, 0x3f803f80
    v_mfma_f32_16x16x32_bf16 v[116:119], v[228:231], v[192:195], v[116:119]
    ds_read_b64_tr_b16 v[228:229], v183 offset:8192
    ds_read_b64_tr_b16 v[230:231], v183 offset:9216
    v_mov_b32 v10, 0xff800000
    s_waitcnt lgkmcnt(8)
    v_mfma_f32_16x16x32_bf16 v[128:131], v[208:211], v[192:195], v[128:131]
    v_cndmask_b32 v6, 0, v12, vcc
    v_mfma_f32_16x16x32_bf16 v[136:139], v[208:211], v[196:199], v[136:139]
    ds_read_b64_tr_b16 v[208:209], v180 offset:8704
    ds_read_b64_tr_b16 v[210:211], v180 offset:9728
    v_cndmask_b32 v7, 0, v12, vcc
    v_mfma_f32_16x16x32_bf16 v[140:143], v[212:215], v[196:199], v[140:143]
    v_mfma_f32_16x16x32_bf16 v[132:135], v[212:215], v[192:195], v[132:135]
    ds_read_b64_tr_b16 v[212:213], v181 offset:8704
    ds_read_b64_tr_b16 v[214:215], v181 offset:9728
    s_waitcnt lgkmcnt(8)
    v_mfma_f32_16x16x32_bf16 v[80:83], v[216:219], v[200:203], v[80:83]
    s_mov_b32 s42, 5242880
    s_lshr_b32 s13, s2, 5
    s_lshl_b32 s13, s13, 1
    s_and_b32 s14, s2, 1
    s_add_u32 s13, s13, s14
    s_mul_i32 s63, s13, 327680
    s_and_b32 s13, s12, 3
    s_lshl_b32 s13, s13, 12
    s_add_u32 s63, s63, s13
    v_mfma_f32_16x16x32_bf16 v[88:91], v[216:219], v[204:207], v[88:91]
    ds_read_b64_tr_b16 v[216:217], v182 offset:8704
    ds_read_b64_tr_b16 v[218:219], v182 offset:9728
    s_lshl_b32 s65, s61, 19
    s_add_u32 s65, s65, s13
    s_lshl_b32 s13, s45, 14
    s_add_u32 s65, s65, s13
    s_add_u32 s66, s65, 16777216
    s_mul_i32 s62, s15, 163840
    s_add_u32 s62, s62, s63
    s_add_u32 s62, s62, 50331648
    s_add_u32 s64, s63, 50429952
    v_mfma_f32_16x16x32_bf16 v[92:95], v[220:223], v[204:207], v[92:95]
    s_add_u32 s63, s63, 50364416
    s_bfe_u32 s13, s2, 0x20001
    s_lshl_b32 s13, s13, 2
    s_bfe_u32 s67, s2, 0x20003
    s_add_u32 s13, s13, s67
    s_lshl_b32 s13, s13, 1
    s_add_u32 s13, s13, s14
    s_lshl_b32 s68, s13, 3
    s_add_u32 s68, s68, s12
    v_mfma_f32_16x16x32_bf16 v[84:87], v[220:223], v[200:203], v[84:87]
    ds_read_b64_tr_b16 v[220:221], v183 offset:8704
    ds_read_b64_tr_b16 v[222:223], v183 offset:9728
    s_lshl_b32 s68, s68, 5
    s_add_u32 s68, s68, 75497472
    s_lshl_b32 s67, s13, 17
    s_lshl_b32 s13, s14, 3
    s_add_u32 s13, s13, s12
    s_lshl_b32 s13, s13, 13
    s_add_u32 s67, s67, s13
    s_add_u32 s67, s67, 33554432
    s_mov_b32 s24, s40
    s_and_b32 s25, s41, 0xffff
    s_mov_b32 s26, 5242880
    s_mov_b32 s27, 0x20000
    s_waitcnt lgkmcnt(8)
    v_mfma_f32_16x16x32_bf16 v[96:99], v[224:227], v[200:203], v[96:99]
    s_sub_u32 s30, s45, 10
    s_max_u32 s30, s30, 15
    s_lshl_b32 s11, 6, s30
    s_or_b32 s11, s11, 0x80
    s_cmp_eq_u32 s12, 4
    s_cselect_b32 s11, s11, 0
    s_cmp_lt_u32 s2, 96
    s_cselect_b32 s7, 1, 0
    s_cmp_ge_u32 s46, s30
    s_cselect_b32 s31, 1, 0
    s_lshr_b32 s13, s2, 5
    s_cmp_eq_u32 s13, 2
    s_cselect_b32 s13, 24, 72
    s_cselect_b32 s42, 819200, s42
    v_mfma_f32_16x16x32_bf16 v[104:107], v[224:227], v[204:207], v[104:107]
    s_load_dwordx2 s[40:41], s[0:1], s13
    s_lshr_b32 s13, s2, 3
    s_sub_u32 s13, s13, 12
    s_mul_i32 s8, s13, 52
    s_lshr_b32 s8, s8, 8
    s_mul_i32 s8, s8, 155
    s_add_u32 s8, s8, s13
    s_and_b32 s13, s2, 7
    s_lshl_b32 s13, s13, 2
    v_mfma_f32_16x16x32_bf16 v[108:111], v[228:231], v[204:207], v[108:111]
    s_add_u32 s13, s13, s12
    s_mul_i32 s13, s13, 5
    s_add_u32 s8, s8, s13
    s_sub_u32 s8, s8, 20
    s_lshl_b32 s8, s8, 13
    s_lshl_b32 s13, s2, 2
    s_add_u32 s13, s13, s12
    s_sub_u32 s13, s13, 260
    s_lshl_b32 s13, s13, 13
    v_mfma_f32_16x16x32_bf16 v[100:103], v[228:231], v[200:203], v[100:103]
    s_and_b32 s13, s13, 2147483647
    s_cmp_lt_u32 s2, 96
    s_cselect_b32 s8, s13, s8
    s_waitcnt lgkmcnt(4)
    v_mfma_f32_16x16x32_bf16 v[112:115], v[208:211], v[200:203], v[112:115]
    s_waitcnt vmcnt(20) lgkmcnt(0)
    v_mov_b32 v2, v1
    s_barrier
    v_mfma_f32_16x16x32_bf16 v[120:123], v[208:211], v[204:207], v[120:123]
    ds_read_b128 v[192:195], v2 offset:0
    ds_read_b128 v[196:199], v2 offset:1024
    ds_read_b128 v[208:211], v2 offset:4096
    v_mfma_f32_16x16x32_bf16 v[124:127], v[212:215], v[204:207], v[124:127]
    ds_read_b128 v[224:227], v2 offset:8192
    ds_read_b128 v[228:231], v2 offset:9216
    ds_read_b128 v[232:235], v2 offset:10240
    v_mfma_f32_16x16x32_bf16 v[116:119], v[212:215], v[200:203], v[116:119]
    ds_read_b128 v[236:239], v2 offset:11264
    ds_read_b128 v[240:243], v2 offset:12288
    ds_read_b128 v[244:247], v2 offset:13312
    v_mfma_f32_16x16x32_bf16 v[128:131], v[216:219], v[200:203], v[128:131]
    ds_read_b128 v[248:251], v2 offset:14336
    ds_read_b128 v[252:255], v2 offset:15360
    ds_read_b128 v[212:215], v2 offset:5120
    v_mfma_f32_16x16x32_bf16 v[136:139], v[216:219], v[204:207], v[136:139]
    ds_read_b128 v[216:219], v2 offset:6144
    v_mfma_f32_16x16x32_bf16 v[140:143], v[220:223], v[204:207], v[140:143]
    v_mfma_f32_16x16x32_bf16 v[132:135], v[220:223], v[200:203], v[132:135]
    ds_read_b128 v[200:203], v2 offset:2048
    ds_read_b128 v[204:207], v2 offset:3072
    ds_read_b128 v[220:223], v2 offset:7168
    s_mov_b32 m0, s51
    s_add_u32 s51, s51, 16384
    buffer_load_dwordx4 v1, s[16:19], s53 offen offset:0 sc1 lds
    buffer_load_dwordx4 v1, s[16:19], s53 offen offset:1024 sc1 lds
    buffer_load_dwordx4 v1, s[16:19], s53 offen offset:2048 sc1 lds
    buffer_load_dwordx4 v1, s[16:19], s53 offen offset:3072 sc1 lds
    s_sub_u32 s14, s51, 81920
    s_cmp_ge_u32 s51, 147456
    s_cselect_b32 s51, s14, s51
    s_add_u32 s53, s53, 16384
    s_branch mg_att
mg_gk_r0:
    s_waitcnt lgkmcnt(4)
    v_mfma_f32_16x16x32_bf16 v[28:31], v[204:207], v[216:219], 0
    ds_read_b64_tr_b16 v[236:237], v189 offset:16384
    v_mfma_f32_16x16x32_bf16 v[24:27], v[200:203], v[216:219], 0
    ds_read_b64_tr_b16 v[238:239], v189 offset:18432
    v_mfma_f32_16x16x32_bf16 v[20:23], v[196:199], v[216:219], 0
    ds_read_b64_tr_b16 v[232:233], v188 offset:16384
    v_mfma_f32_16x16x32_bf16 v[16:19], v[192:195], v[216:219], 0
    ds_read_b128 v[216:219], v184 offset:10240
    s_waitcnt lgkmcnt(7)
    v_mfma_f32_16x16x32_bf16 v[32:35], v[192:195], v[220:223], 0
    ds_read_b64_tr_b16 v[234:235], v188 offset:18432
    v_mfma_f32_16x16x32_bf16 v[36:39], v[196:199], v[220:223], 0
    ds_read_b64_tr_b16 v[228:229], v187 offset:16384
    v_mfma_f32_16x16x32_bf16 v[40:43], v[200:203], v[220:223], 0
    ds_read_b64_tr_b16 v[230:231], v187 offset:18432
    v_mfma_f32_16x16x32_bf16 v[44:47], v[204:207], v[220:223], 0
    ds_read_b128 v[220:223], v184 offset:12288
    s_waitcnt lgkmcnt(10)
    v_mfma_f32_16x16x32_bf16 v[60:63], v[204:207], v[252:255], 0
    ds_read_b64_tr_b16 v[224:225], v186 offset:16384
    v_mfma_f32_16x16x32_bf16 v[56:59], v[200:203], v[252:255], 0
    ds_read_b64_tr_b16 v[226:227], v186 offset:18432
    v_mfma_f32_16x16x32_bf16 v[52:55], v[196:199], v[252:255], 0
    v_mfma_f32_16x16x32_bf16 v[48:51], v[192:195], v[252:255], 0
    ds_read_b128 v[252:255], v184 offset:14336
    s_waitcnt lgkmcnt(12)
    v_mfma_f32_16x16x32_bf16 v[64:67], v[192:195], v[208:211], 0
    v_mfma_f32_16x16x32_bf16 v[68:71], v[196:199], v[208:211], 0
    v_mfma_f32_16x16x32_bf16 v[72:75], v[200:203], v[208:211], 0
    v_mfma_f32_16x16x32_bf16 v[76:79], v[204:207], v[208:211], 0
    ds_read_b128 v[208:211], v185 offset:0
    s_waitcnt lgkmcnt(12)
    v_mfma_f32_16x16x32_bf16 v[92:95], v[204:207], v[212:215], 0
    v_mfma_f32_16x16x32_bf16 v[88:91], v[200:203], v[212:215], 0
    v_mfma_f32_16x16x32_bf16 v[84:87], v[196:199], v[212:215], 0
    v_mfma_f32_16x16x32_bf16 v[80:83], v[192:195], v[212:215], 0
    ds_read_b128 v[212:215], v185 offset:2048
    s_waitcnt lgkmcnt(9)
    v_mfma_f32_16x16x32_bf16 v[96:99], v[192:195], v[216:219], 0
    v_mfma_f32_16x16x32_bf16 v[100:103], v[196:199], v[216:219], 0
    v_mfma_f32_16x16x32_bf16 v[104:107], v[200:203], v[216:219], 0
    v_mfma_f32_16x16x32_bf16 v[108:111], v[204:207], v[216:219], 0
    ds_read_b128 v[216:219], v185 offset:4096
    s_waitcnt lgkmcnt(6)
    v_mfma_f32_16x16x32_bf16 v[124:127], v[204:207], v[220:223], 0
    s_mul_i32 s13, s63, 1600
    s_add_u32 s40, s8, s13
    s_addc_u32 s41, s9, 0
    s_and_b32 s41, s41, 0xffff
    s_mov_b32 s42, 1600
    s_mov_b32 s43, 0x20000
    v_mfma_f32_16x16x32_bf16 v[120:123], v[200:203], v[220:223], 0
    s_lshl_b32 s13, s12, 10
    s_min_u32 s14, s13, 2048
    v_mfma_f32_16x16x32_bf16 v[116:119], v[196:199], v[220:223], 0
    s_add_u32 m0, s14, 159744
    s_nop 0
    v_mfma_f32_16x16x32_bf16 v[112:115], v[192:195], v[220:223], 0
    ds_read_b128 v[220:223], v185 offset:6144
    s_waitcnt lgkmcnt(4)
    v_mfma_f32_16x16x32_bf16 v[128:131], v[192:195], v[252:255], 0
    buffer_load_dwordx4 v1, s[40:43], s13 offen lds
    v_mfma_f32_16x16x32_bf16 v[132:135], v[196:199], v[252:255], 0
    v_mfma_f32_16x16x32_bf16 v[136:139], v[200:203], v[252:255], 0
    v_mfma_f32_16x16x32_bf16 v[140:143], v[204:207], v[252:255], 0
    ds_read_b128 v[252:255], v185 offset:8192
    s_waitcnt lgkmcnt(4)
    v_mfma_f32_16x16x32_bf16 v[28:31], v[236:239], v[208:211], v[28:31]
    v_mfma_f32_16x16x32_bf16 v[24:27], v[232:235], v[208:211], v[24:27]
    v_mfma_f32_16x16x32_bf16 v[20:23], v[228:231], v[208:211], v[20:23]
    v_mfma_f32_16x16x32_bf16 v[16:19], v[224:227], v[208:211], v[16:19]
    ds_read_b128 v[208:211], v185 offset:10240
    s_waitcnt lgkmcnt(4)
    v_mfma_f32_16x16x32_bf16 v[32:35], v[224:227], v[212:215], v[32:35]
    v_mfma_f32_16x16x32_bf16 v[36:39], v[228:231], v[212:215], v[36:39]
    v_mfma_f32_16x16x32_bf16 v[40:43], v[232:235], v[212:215], v[40:43]
    v_mfma_f32_16x16x32_bf16 v[44:47], v[236:239], v[212:215], v[44:47]
    ds_read_b128 v[212:215], v185 offset:12288
    s_waitcnt lgkmcnt(4)
    v_mfma_f32_16x16x32_bf16 v[60:63], v[236:239], v[216:219], v[60:63]
    s_lshl_b32 s13, s62, 3
    s_and_b32 s14, s12, 3
    s_add_u32 s13, s13, s14
    s_mul_i32 s13, s13, 20480
    v_lshrrev_b32 v8, 3, v0
    v_mul_u32_u24 v8, 1280, v8
    v_and_b32 v9, 7, v0
    v_lshrrev_b32 v11, 4, v0
    v_mfma_f32_16x16x32_bf16 v[56:59], v[232:235], v[216:219], v[56:59]
    v_xor_b32 v9, v9, v11
    v_lshlrev_b32 v9, 4, v9
    v_add3_u32 v240, v8, v9, s13
    v_xor_b32 v9, 64, v9
    s_add_u32 s13, s13, 9216
    v_add3_u32 v241, v8, v9, s13
    s_mul_i32 s55, s63, 163840
    s_lshl_b32 s13, s14, 11
    v_mfma_f32_16x16x32_bf16 v[52:55], v[228:231], v[216:219], v[52:55]
    s_add_u32 s55, s55, s13
    s_add_u32 s55, s55, 79691776
    v_add_u32 v243, s55, v1
    s_bfe_u32 s13, s2, 0x20003
    s_mul_i32 s13, s13, 5
    s_lshr_b32 s13, s13, 1
    s_lshr_b32 s54, s2, 5
    s_add_u32 s54, s54, s13
    v_mfma_f32_16x16x32_bf16 v[48:51], v[224:227], v[216:219], v[48:51]
    ds_read_b128 v[216:219], v185 offset:14336
    s_waitcnt lgkmcnt(4)
    v_mfma_f32_16x16x32_bf16 v[64:67], v[224:227], v[220:223], v[64:67]
    s_sub_u32 s13, s54, 10
    s_cselect_b32 s54, s54, s13
    s_lshl_b32 s54, s54, 7
    s_lshl_b32 s55, s54, 7
    s_lshl_b32 s64, s64, 10
    s_mul_i32 s13, s63, 163840
    s_add_u32 s64, s64, s13
    s_add_u32 s64, s64, 79691776
    s_add_u32 s65, s64, 8192
    v_mfma_f32_16x16x32_bf16 v[68:71], v[228:231], v[220:223], v[68:71]
    s_cmp_lt_u32 s12, 2
    s_cselect_b32 s65, s65, 2147418112
    s_lshl_b32 s13, s63, 4
    s_add_u32 s13, s13, s62
    s_lshl_b32 s13, s13, 2
    s_add_u32 s13, s13, s12
    s_lshl_b32 s13, s13, 10
    s_add_u32 s13, s13, 58716160
    s_sub_u32 s66, 0, s15
    v_mfma_f32_16x16x32_bf16 v[72:75], v[232:235], v[220:223], v[72:75]
    s_cmp_eq_u32 s15, 0
    s_cselect_b32 s65, s65, s13
    s_lshl_b32 s67, s63, 2
    v_mov_b32 v5, 0x10000
    v_mfma_f32_16x16x32_bf16 v[76:79], v[236:239], v[220:223], v[76:79]
    s_waitcnt vmcnt(3)
    s_waitcnt lgkmcnt(0)
    v_xor_b32 v184, 65536, v184
    v_xor_b32 v185, 65536, v185
    v_xor_b32 v186, 0x10000, v186
    v_xor_b32 v187, 0x10000, v187
    v_xor_b32 v188, 0x10000, v188
    v_xor_b32 v189, 0x10000, v189
    s_barrier
    v_mfma_f32_16x16x32_bf16 v[92:95], v[236:239], v[252:255], v[92:95]
    ds_read_b64_tr_b16 v[204:205], v189 offset:0
    ds_read_b64_tr_b16 v[206:207], v189 offset:2048
    s_add_u32 m0, s44, 0
    s_nop 0
    buffer_load_dwordx4 v176, s[24:27], s45 offen offset:0 lds
    v_mfma_f32_16x16x32_bf16 v[88:91], v[232:235], v[252:255], v[88:91]
    ds_read_b128 v[220:223], v184 offset:0
    ds_read_b64_tr_b16 v[200:201], v188 offset:0
    buffer_load_dwordx4 v177, s[24:27], s45 offen offset:1024 lds
    v_mfma_f32_16x16x32_bf16 v[84:87], v[228:231], v[252:255], v[84:87]
    ds_read_b64_tr_b16 v[202:203], v188 offset:2048
    ds_read_b64_tr_b16 v[196:197], v187 offset:0
    buffer_load_dwordx4 v178, s[24:27], s45 offen offset:2048 lds
    v_mfma_f32_16x16x32_bf16 v[80:83], v[224:227], v[252:255], v[80:83]
    ds_read_b64_tr_b16 v[198:199], v187 offset:2048
    ds_read_b128 v[252:255], v184 offset:2048
    buffer_load_dwordx4 v179, s[24:27], s45 offen offset:3072 lds
    v_mfma_f32_16x16x32_bf16 v[96:99], v[224:227], v[208:211], v[96:99]
    ds_read_b64_tr_b16 v[192:193], v186 offset:0
    ds_read_b64_tr_b16 v[194:195], v186 offset:2048
    s_add_u32 m0, s44, 16384
    s_add_u32 s47, s45, 65536
    buffer_load_dwordx4 v176, s[24:27], s47 offen offset:0 lds
    v_mfma_f32_16x16x32_bf16 v[100:103], v[228:231], v[208:211], v[100:103]
    buffer_load_dwordx4 v177, s[24:27], s47 offen offset:1024 lds
    v_mfma_f32_16x16x32_bf16 v[104:107], v[232:235], v[208:211], v[104:107]
    buffer_load_dwordx4 v178, s[24:27], s47 offen offset:2048 lds
    v_mfma_f32_16x16x32_bf16 v[108:111], v[236:239], v[208:211], v[108:111]
    ds_read_b128 v[208:211], v184 offset:4096
    buffer_load_dwordx4 v179, s[24:27], s47 offen offset:3072 lds
    s_add_u32 s45, s45, 128
    s_and_b32 s45, s45, 1023
    v_mfma_f32_16x16x32_bf16 v[124:127], v[236:239], v[212:215], v[124:127]
    s_add_u32 m0, s44, 32768
    s_nop 0
    buffer_load_dwordx4 v180, s[28:31], s46 offen offset:0 lds
    v_mfma_f32_16x16x32_bf16 v[120:123], v[232:235], v[212:215], v[120:123]
    buffer_load_dwordx4 v181, s[28:31], s46 offen offset:1024 lds
    v_mfma_f32_16x16x32_bf16 v[116:119], v[228:231], v[212:215], v[116:119]
    buffer_load_dwordx4 v182, s[28:31], s46 offen offset:2048 lds
    v_mfma_f32_16x16x32_bf16 v[112:115], v[224:227], v[212:215], v[112:115]
    ds_read_b128 v[212:215], v184 offset:6144
    buffer_load_dwordx4 v183, s[28:31], s46 offen offset:3072 lds
    v_mfma_f32_16x16x32_bf16 v[128:131], v[224:227], v[216:219], v[128:131]
    s_add_u32 m0, s44, 49152
    s_add_u32 s47, s46, 262144
    buffer_load_dwordx4 v180, s[28:31], s47 offen offset:0 lds
    v_mfma_f32_16x16x32_bf16 v[132:135], v[228:231], v[216:219], v[132:135]
    buffer_load_dwordx4 v181, s[28:31], s47 offen offset:1024 lds
    v_mfma_f32_16x16x32_bf16 v[136:139], v[232:235], v[216:219], v[136:139]
    buffer_load_dwordx4 v182, s[28:31], s47 offen offset:2048 lds
    v_mfma_f32_16x16x32_bf16 v[140:143], v[236:239], v[216:219], v[140:143]
    ds_read_b128 v[216:219], v184 offset:8192
    buffer_load_dwordx4 v183, s[28:31], s47 offen offset:3072 lds
    s_add_u32 s46, s46, 524288
    s_and_b32 s46, s46, 0x3fffff
    s_waitcnt lgkmcnt(3)
    v_mfma_f32_16x16x32_bf16 v[28:31], v[204:207], v[220:223], v[28:31]
    ds_read_b64_tr_b16 v[236:237], v189 offset:16384
    v_mfma_f32_16x16x32_bf16 v[24:27], v[200:203], v[220:223], v[24:27]
    ds_read_b64_tr_b16 v[238:239], v189 offset:18432
    v_mfma_f32_16x16x32_bf16 v[20:23], v[196:199], v[220:223], v[20:23]
    ds_read_b64_tr_b16 v[232:233], v188 offset:16384
    v_mfma_f32_16x16x32_bf16 v[16:19], v[192:195], v[220:223], v[16:19]
    ds_read_b128 v[220:223], v184 offset:10240
    v_mfma_f32_16x16x32_bf16 v[32:35], v[192:195], v[252:255], v[32:35]
    ds_read_b64_tr_b16 v[234:235], v188 offset:18432
    v_mfma_f32_16x16x32_bf16 v[36:39], v[196:199], v[252:255], v[36:39]
    ds_read_b64_tr_b16 v[228:229], v187 offset:16384
    v_mfma_f32_16x16x32_bf16 v[40:43], v[200:203], v[252:255], v[40:43]
    ds_read_b64_tr_b16 v[230:231], v187 offset:18432
    v_mfma_f32_16x16x32_bf16 v[44:47], v[204:207], v[252:255], v[44:47]
    ds_read_b128 v[252:255], v184 offset:12288
    s_waitcnt lgkmcnt(10)
    v_mfma_f32_16x16x32_bf16 v[60:63], v[204:207], v[208:211], v[60:63]
    ds_read_b64_tr_b16 v[224:225], v186 offset:16384
    s_waitcnt vmcnt(17)
    v_mfma_f32_16x16x32_bf16 v[56:59], v[200:203], v[208:211], v[56:59]
    ds_read_b64_tr_b16 v[226:227], v186 offset:18432
    buffer_store_dwordx4 v[144:147], v1, s[16:19], s64 offen sc1
    v_mfma_f32_16x16x32_bf16 v[52:55], v[196:199], v[208:211], v[52:55]
    v_or_b32 v148, s66, v148
    v_mfma_f32_16x16x32_bf16 v[48:51], v[192:195], v[208:211], v[48:51]
    ds_read_b128 v[208:211], v184 offset:14336
    s_waitcnt lgkmcnt(12)
    v_mfma_f32_16x16x32_bf16 v[64:67], v[192:195], v[212:215], v[64:67]
    v_or_b32 v149, s66, v149
    v_mfma_f32_16x16x32_bf16 v[68:71], v[196:199], v[212:215], v[68:71]
    v_or_b32 v150, s66, v150
    v_mfma_f32_16x16x32_bf16 v[72:75], v[200:203], v[212:215], v[72:75]
    v_or_b32 v151, s66, v151
    v_mfma_f32_16x16x32_bf16 v[76:79], v[204:207], v[212:215], v[76:79]
    ds_read_b128 v[212:215], v185 offset:0
    s_waitcnt lgkmcnt(12)
    v_mfma_f32_16x16x32_bf16 v[92:95], v[204:207], v[216:219], v[92:95]
    v_mfma_f32_16x16x32_bf16 v[88:91], v[200:203], v[216:219], v[88:91]
    v_mfma_f32_16x16x32_bf16 v[84:87], v[196:199], v[216:219], v[84:87]
    v_mfma_f32_16x16x32_bf16 v[80:83], v[192:195], v[216:219], v[80:83]
    ds_read_b128 v[216:219], v185 offset:2048
    s_waitcnt lgkmcnt(9)
    v_mfma_f32_16x16x32_bf16 v[96:99], v[192:195], v[220:223], v[96:99]
    v_mfma_f32_16x16x32_bf16 v[100:103], v[196:199], v[220:223], v[100:103]
    v_mfma_f32_16x16x32_bf16 v[104:107], v[200:203], v[220:223], v[104:107]
    v_mfma_f32_16x16x32_bf16 v[108:111], v[204:207], v[220:223], v[108:111]
    ds_read_b128 v[220:223], v185 offset:4096
    s_waitcnt lgkmcnt(6)
    v_mfma_f32_16x16x32_bf16 v[124:127], v[204:207], v[252:255], v[124:127]
    buffer_store_dwordx4 v[148:151], v1, s[16:19], s65 offen sc1
    v_mfma_f32_16x16x32_bf16 v[120:123], v[200:203], v[252:255], v[120:123]
    v_mfma_f32_16x16x32_bf16 v[116:119], v[196:199], v[252:255], v[116:119]
    v_mfma_f32_16x16x32_bf16 v[112:115], v[192:195], v[252:255], v[112:115]
    ds_read_b128 v[252:255], v185 offset:6144
    s_waitcnt lgkmcnt(4)
    v_mfma_f32_16x16x32_bf16 v[128:131], v[192:195], v[208:211], v[128:131]
    v_mfma_f32_16x16x32_bf16 v[132:135], v[196:199], v[208:211], v[132:135]
    v_mfma_f32_16x16x32_bf16 v[136:139], v[200:203], v[208:211], v[136:139]
    v_mfma_f32_16x16x32_bf16 v[140:143], v[204:207], v[208:211], v[140:143]
    ds_read_b128 v[208:211], v185 offset:8192
    s_waitcnt lgkmcnt(4)
    v_mfma_f32_16x16x32_bf16 v[28:31], v[236:239], v[212:215], v[28:31]
    v_mfma_f32_16x16x32_bf16 v[24:27], v[232:235], v[212:215], v[24:27]
    v_mfma_f32_16x16x32_bf16 v[20:23], v[228:231], v[212:215], v[20:23]
    v_mfma_f32_16x16x32_bf16 v[16:19], v[224:227], v[212:215], v[16:19]
    ds_read_b128 v[212:215], v185 offset:10240
    s_waitcnt lgkmcnt(4)
    v_mfma_f32_16x16x32_bf16 v[32:35], v[224:227], v[216:219], v[32:35]
    v_mfma_f32_16x16x32_bf16 v[36:39], v[228:231], v[216:219], v[36:39]
    v_mfma_f32_16x16x32_bf16 v[40:43], v[232:235], v[216:219], v[40:43]
    v_mfma_f32_16x16x32_bf16 v[44:47], v[236:239], v[216:219], v[44:47]
    ds_read_b128 v[216:219], v185 offset:12288
    s_waitcnt lgkmcnt(4)
    v_mfma_f32_16x16x32_bf16 v[60:63], v[236:239], v[220:223], v[60:63]
    v_mfma_f32_16x16x32_bf16 v[56:59], v[232:235], v[220:223], v[56:59]
    v_mfma_f32_16x16x32_bf16 v[52:55], v[228:231], v[220:223], v[52:55]
    v_mfma_f32_16x16x32_bf16 v[48:51], v[224:227], v[220:223], v[48:51]
    ds_read_b128 v[220:223], v185 offset:14336
    s_waitcnt lgkmcnt(4)
    v_mfma_f32_16x16x32_bf16 v[64:67], v[224:227], v[252:255], v[64:67]
    v_mfma_f32_16x16x32_bf16 v[68:71], v[228:231], v[252:255], v[68:71]
    v_mfma_f32_16x16x32_bf16 v[72:75], v[232:235], v[252:255], v[72:75]
    v_mfma_f32_16x16x32_bf16 v[76:79], v[236:239], v[252:255], v[76:79]
    s_waitcnt vmcnt(2)
    s_waitcnt lgkmcnt(0)
    v_xor_b32 v184, 65536, v184
    v_xor_b32 v185, 65536, v185
    v_xor_b32 v186, 0x10000, v186
    v_xor_b32 v187, 0x10000, v187
    v_xor_b32 v188, 0x10000, v188
    v_xor_b32 v189, 0x10000, v189
    s_barrier
    v_mfma_f32_16x16x32_bf16 v[92:95], v[236:239], v[208:211], v[92:95]
    ds_read_b64_tr_b16 v[204:205], v189 offset:0
    ds_read_b64_tr_b16 v[206:207], v189 offset:2048
    s_add_u32 m0, s44, 65536
    s_nop 0
    buffer_load_dwordx4 v176, s[24:27], s45 offen offset:0 lds
    v_mfma_f32_16x16x32_bf16 v[88:91], v[232:235], v[208:211], v[88:91]
    ds_read_b128 v[252:255], v184 offset:0
    ds_read_b64_tr_b16 v[200:201], v188 offset:0
    buffer_load_dwordx4 v177, s[24:27], s45 offen offset:1024 lds
    v_mfma_f32_16x16x32_bf16 v[84:87], v[228:231], v[208:211], v[84:87]
    ds_read_b64_tr_b16 v[202:203], v188 offset:2048
    ds_read_b64_tr_b16 v[196:197], v187 offset:0
    buffer_load_dwordx4 v178, s[24:27], s45 offen offset:2048 lds
    v_mfma_f32_16x16x32_bf16 v[80:83], v[224:227], v[208:211], v[80:83]
    ds_read_b64_tr_b16 v[198:199], v187 offset:2048
    ds_read_b128 v[208:211], v184 offset:2048
    buffer_load_dwordx4 v179, s[24:27], s45 offen offset:3072 lds
    v_mfma_f32_16x16x32_bf16 v[96:99], v[224:227], v[212:215], v[96:99]
    ds_read_b64_tr_b16 v[192:193], v186 offset:0
    ds_read_b64_tr_b16 v[194:195], v186 offset:2048
    s_add_u32 m0, s44, 81920
    s_add_u32 s47, s45, 65536
    buffer_load_dwordx4 v176, s[24:27], s47 offen offset:0 lds
    v_mfma_f32_16x16x32_bf16 v[100:103], v[228:231], v[212:215], v[100:103]
    buffer_load_dwordx4 v177, s[24:27], s47 offen offset:1024 lds
    v_mfma_f32_16x16x32_bf16 v[104:107], v[232:235], v[212:215], v[104:107]
    buffer_load_dwordx4 v178, s[24:27], s47 offen offset:2048 lds
    v_mfma_f32_16x16x32_bf16 v[108:111], v[236:239], v[212:215], v[108:111]
    ds_read_b128 v[212:215], v184 offset:4096
    buffer_load_dwordx4 v179, s[24:27], s47 offen offset:3072 lds
    s_add_u32 s45, s45, 128
    s_and_b32 s45, s45, 1023
    v_mfma_f32_16x16x32_bf16 v[124:127], v[236:239], v[216:219], v[124:127]
    s_add_u32 m0, s44, 98304
    s_nop 0
    buffer_load_dwordx4 v180, s[28:31], s46 offen offset:0 lds
    v_mfma_f32_16x16x32_bf16 v[120:123], v[232:235], v[216:219], v[120:123]
    buffer_load_dwordx4 v181, s[28:31], s46 offen offset:1024 lds
    v_mfma_f32_16x16x32_bf16 v[116:119], v[228:231], v[216:219], v[116:119]
    buffer_load_dwordx4 v182, s[28:31], s46 offen offset:2048 lds
    v_mfma_f32_16x16x32_bf16 v[112:115], v[224:227], v[216:219], v[112:115]
    ds_read_b128 v[216:219], v184 offset:6144
    buffer_load_dwordx4 v183, s[28:31], s46 offen offset:3072 lds
    v_mfma_f32_16x16x32_bf16 v[128:131], v[224:227], v[220:223], v[128:131]
    s_add_u32 m0, s44, 114688
    s_add_u32 s47, s46, 262144
    buffer_load_dwordx4 v180, s[28:31], s47 offen offset:0 lds
    v_mfma_f32_16x16x32_bf16 v[132:135], v[228:231], v[220:223], v[132:135]
    buffer_load_dwordx4 v181, s[28:31], s47 offen offset:1024 lds
    v_mfma_f32_16x16x32_bf16 v[136:139], v[232:235], v[220:223], v[136:139]
    buffer_load_dwordx4 v182, s[28:31], s47 offen offset:2048 lds
    v_mfma_f32_16x16x32_bf16 v[140:143], v[236:239], v[220:223], v[140:143]
    ds_read_b128 v[220:223], v184 offset:8192
    buffer_load_dwordx4 v183, s[28:31], s47 offen offset:3072 lds
    s_add_u32 s46, s46, 524288
    s_and_b32 s46, s46, 0x3fffff
    s_waitcnt lgkmcnt(3)
    v_mfma_f32_16x16x32_bf16 v[28:31], v[204:207], v[252:255], v[28:31]
    ds_read_b64_tr_b16 v[236:237], v189 offset:16384
    v_mfma_f32_16x16x32_bf16 v[24:27], v[200:203], v[252:255], v[24:27]
    ds_read_b64_tr_b16 v[238:239], v189 offset:18432
    v_mfma_f32_16x16x32_bf16 v[20:23], v[196:199], v[252:255], v[20:23]
    ds_read_b64_tr_b16 v[232:233], v188 offset:16384
    v_mfma_f32_16x16x32_bf16 v[16:19], v[192:195], v[252:255], v[16:19]
    ds_read_b128 v[252:255], v184 offset:10240
    v_mfma_f32_16x16x32_bf16 v[32:35], v[192:195], v[208:211], v[32:35]
    ds_read_b64_tr_b16 v[234:235], v188 offset:18432
    v_mfma_f32_16x16x32_bf16 v[36:39], v[196:199], v[208:211], v[36:39]
    ds_read_b64_tr_b16 v[228:229], v187 offset:16384
    v_mfma_f32_16x16x32_bf16 v[40:43], v[200:203], v[208:211], v[40:43]
    ds_read_b64_tr_b16 v[230:231], v187 offset:18432
    v_mfma_f32_16x16x32_bf16 v[44:47], v[204:207], v[208:211], v[44:47]
    ds_read_b128 v[208:211], v184 offset:12288
    s_waitcnt lgkmcnt(10)
    v_mfma_f32_16x16x32_bf16 v[60:63], v[204:207], v[212:215], v[60:63]
    ds_read_b64_tr_b16 v[224:225], v186 offset:16384
    s_and_b32 s13, s2, 3
    s_lshl_b32 s13, s13, 8
    v_mfma_f32_16x16x32_bf16 v[56:59], v[200:203], v[212:215], v[56:59]
    ds_read_b64_tr_b16 v[226:227], v186 offset:18432
    s_andn2_b32 s14, s2, 3
    s_add_u32 s13, s13, s14
    v_mfma_f32_16x16x32_bf16 v[52:55], v[196:199], v[212:215], v[52:55]
    s_lshl_b32 s13, s13, 1
    s_add_u32 s13, s13, s12
    v_mfma_f32_16x16x32_bf16 v[48:51], v[192:195], v[212:215], v[48:51]
    ds_read_b128 v[212:215], v184 offset:14336
    s_waitcnt lgkmcnt(12)
    v_mfma_f32_16x16x32_bf16 v[64:67], v[192:195], v[216:219], v[64:67]
    s_mul_i32 s13, s13, 1280
    buffer_load_dword v166, v167, s[32:35], s13 offen
    v_mfma_f32_16x16x32_bf16 v[68:71], v[196:199], v[216:219], v[68:71]
    v_mfma_f32_16x16x32_bf16 v[72:75], v[200:203], v[216:219], v[72:75]
    v_mfma_f32_16x16x32_bf16 v[76:79], v[204:207], v[216:219], v[76:79]
    ds_read_b128 v[216:219], v185 offset:0
    s_waitcnt lgkmcnt(12)
    v_mfma_f32_16x16x32_bf16 v[92:95], v[204:207], v[220:223], v[92:95]
    v_mfma_f32_16x16x32_bf16 v[88:91], v[200:203], v[220:223], v[88:91]
    v_mfma_f32_16x16x32_bf16 v[84:87], v[196:199], v[220:223], v[84:87]
    v_mfma_f32_16x16x32_bf16 v[80:83], v[192:195], v[220:223], v[80:83]
    ds_read_b128 v[220:223], v185 offset:2048
    s_waitcnt lgkmcnt(9)
    v_mfma_f32_16x16x32_bf16 v[96:99], v[192:195], v[252:255], v[96:99]
    v_mfma_f32_16x16x32_bf16 v[100:103], v[196:199], v[252:255], v[100:103]
    v_mfma_f32_16x16x32_bf16 v[104:107], v[200:203], v[252:255], v[104:107]
    v_mfma_f32_16x16x32_bf16 v[108:111], v[204:207], v[252:255], v[108:111]
    ds_read_b128 v[252:255], v185 offset:4096
    s_waitcnt lgkmcnt(6)
    v_mfma_f32_16x16x32_bf16 v[124:127], v[204:207], v[208:211], v[124:127]
    v_mfma_f32_16x16x32_bf16 v[120:123], v[200:203], v[208:211], v[120:123]
    v_mfma_f32_16x16x32_bf16 v[116:119], v[196:199], v[208:211], v[116:119]
    v_mfma_f32_16x16x32_bf16 v[112:115], v[192:195], v[208:211], v[112:115]
    ds_read_b128 v[208:211], v185 offset:6144
    s_waitcnt lgkmcnt(4)
    v_mfma_f32_16x16x32_bf16 v[128:131], v[192:195], v[212:215], v[128:131]
    v_mfma_f32_16x16x32_bf16 v[132:135], v[196:199], v[212:215], v[132:135]
    v_mfma_f32_16x16x32_bf16 v[136:139], v[200:203], v[212:215], v[136:139]
    v_mfma_f32_16x16x32_bf16 v[140:143], v[204:207], v[212:215], v[140:143]
    ds_read_b128 v[212:215], v185 offset:8192
    s_waitcnt lgkmcnt(4)
    v_mfma_f32_16x16x32_bf16 v[28:31], v[236:239], v[216:219], v[28:31]
    v_mfma_f32_16x16x32_bf16 v[24:27], v[232:235], v[216:219], v[24:27]
    v_mfma_f32_16x16x32_bf16 v[20:23], v[228:231], v[216:219], v[20:23]
    v_mfma_f32_16x16x32_bf16 v[16:19], v[224:227], v[216:219], v[16:19]
    ds_read_b128 v[216:219], v185 offset:10240
    s_waitcnt lgkmcnt(4)
    v_mfma_f32_16x16x32_bf16 v[32:35], v[224:227], v[220:223], v[32:35]
    v_mfma_f32_16x16x32_bf16 v[36:39], v[228:231], v[220:223], v[36:39]
    v_mfma_f32_16x16x32_bf16 v[40:43], v[232:235], v[220:223], v[40:43]
    v_mfma_f32_16x16x32_bf16 v[44:47], v[236:239], v[220:223], v[44:47]
    ds_read_b128 v[220:223], v185 offset:12288
    s_waitcnt lgkmcnt(4)
    v_mfma_f32_16x16x32_bf16 v[60:63], v[236:239], v[252:255], v[60:63]
    s_and_b32 s13, s12, 3
    s_lshl_b32 s13, s13, 13
    s_add_u32 s13, s13, 2048
    v_mfma_f32_16x16x32_bf16 v[56:59], v[232:235], v[252:255], v[56:59]
    v_bfe_u32 v8, v0, 4, 1
    v_lshlrev_b32 v8, 12, v8
    v_and_b32 v9, 15, v0
    v_mfma_f32_16x16x32_bf16 v[52:55], v[228:231], v[252:255], v[52:55]
    v_lshl_add_u32 v8, v9, 7, v8
    v_add_u32 v8, s13, v8
    v_bfe_u32 v9, v0, 1, 3
    v_mfma_f32_16x16x32_bf16 v[48:51], v[224:227], v[252:255], v[48:51]
    ds_read_b128 v[252:255], v185 offset:14336
    s_waitcnt lgkmcnt(4)
    v_mfma_f32_16x16x32_bf16 v[64:67], v[224:227], v[208:211], v[64:67]
    v_xor_b32 v9, v9, v10
    v_xor_b32 v11, 0, v9
    v_lshl_add_u32 v244, v11, 4, v8
    v_mfma_f32_16x16x32_bf16 v[68:71], v[228:231], v[208:211], v[68:71]
    v_xor_b32 v11, 2, v9
    v_lshl_add_u32 v245, v11, 4, v8
    v_xor_b32 v11, 4, v9
    v_mfma_f32_16x16x32_bf16 v[72:75], v[232:235], v[208:211], v[72:75]
    v_lshl_add_u32 v246, v11, 4, v8
    v_xor_b32 v11, 6, v9
    v_lshl_add_u32 v247, v11, 4, v8
    v_mfma_f32_16x16x32_bf16 v[76:79], v[236:239], v[208:211], v[76:79]
    s_waitcnt vmcnt(1)
    s_waitcnt lgkmcnt(0)
    v_xor_b32 v184, 65536, v184
    v_xor_b32 v185, 65536, v185
    v_xor_b32 v186, 0x10000, v186
    v_xor_b32 v187, 0x10000, v187
    v_xor_b32 v188, 0x10000, v188
    v_xor_b32 v189, 0x10000, v189
    s_barrier
    v_mfma_f32_16x16x32_bf16 v[92:95], v[236:239], v[212:215], v[92:95]
    ds_read_b64_tr_b16 v[204:205], v189 offset:0
    ds_read_b64_tr_b16 v[206:207], v189 offset:2048
    s_add_u32 m0, s44, 0
    s_nop 0
    buffer_load_dwordx4 v176, s[24:27], s45 offen offset:0 lds
    v_mfma_f32_16x16x32_bf16 v[88:91], v[232:235], v[212:215], v[88:91]
    ds_read_b128 v[208:211], v184 offset:0
    ds_read_b64_tr_b16 v[200:201], v188 offset:0
    buffer_load_dwordx4 v177, s[24:27], s45 offen offset:1024 lds
    v_mfma_f32_16x16x32_bf16 v[84:87], v[228:231], v[212:215], v[84:87]
    ds_read_b64_tr_b16 v[202:203], v188 offset:2048
    ds_read_b64_tr_b16 v[196:197], v187 offset:0
    buffer_load_dwordx4 v178, s[24:27], s45 offen offset:2048 lds
    v_mfma_f32_16x16x32_bf16 v[80:83], v[224:227], v[212:215], v[80:83]
    ds_read_b64_tr_b16 v[198:199], v187 offset:2048
    ds_read_b128 v[212:215], v184 offset:2048
    buffer_load_dwordx4 v179, s[24:27], s45 offen offset:3072 lds
    v_mfma_f32_16x16x32_bf16 v[96:99], v[224:227], v[216:219], v[96:99]
    ds_read_b64_tr_b16 v[192:193], v186 offset:0
    ds_read_b64_tr_b16 v[194:195], v186 offset:2048
    s_add_u32 m0, s44, 16384
    s_add_u32 s47, s45, 65536
    buffer_load_dwordx4 v176, s[24:27], s47 offen offset:0 lds
    v_mfma_f32_16x16x32_bf16 v[100:103], v[228:231], v[216:219], v[100:103]
    buffer_load_dwordx4 v177, s[24:27], s47 offen offset:1024 lds
    v_mfma_f32_16x16x32_bf16 v[104:107], v[232:235], v[216:219], v[104:107]
    buffer_load_dwordx4 v178, s[24:27], s47 offen offset:2048 lds
    v_mfma_f32_16x16x32_bf16 v[108:111], v[236:239], v[216:219], v[108:111]
    ds_read_b128 v[216:219], v184 offset:4096
    buffer_load_dwordx4 v179, s[24:27], s47 offen offset:3072 lds
    s_add_u32 s45, s45, 128
    s_and_b32 s45, s45, 1023
    v_mfma_f32_16x16x32_bf16 v[124:127], v[236:239], v[220:223], v[124:127]
    s_add_u32 m0, s44, 32768
    s_nop 0
    buffer_load_dwordx4 v180, s[28:31], s46 offen offset:0 lds
    v_mfma_f32_16x16x32_bf16 v[120:123], v[232:235], v[220:223], v[120:123]
    buffer_load_dwordx4 v181, s[28:31], s46 offen offset:1024 lds
    v_mfma_f32_16x16x32_bf16 v[116:119], v[228:231], v[220:223], v[116:119]
    buffer_load_dwordx4 v182, s[28:31], s46 offen offset:2048 lds
    v_mfma_f32_16x16x32_bf16 v[112:115], v[224:227], v[220:223], v[112:115]
    ds_read_b128 v[220:223], v184 offset:6144
    buffer_load_dwordx4 v183, s[28:31], s46 offen offset:3072 lds
    v_mfma_f32_16x16x32_bf16 v[128:131], v[224:227], v[252:255], v[128:131]
    s_add_u32 m0, s44, 49152
    s_add_u32 s47, s46, 262144
    buffer_load_dwordx4 v180, s[28:31], s47 offen offset:0 lds
    v_mfma_f32_16x16x32_bf16 v[132:135], v[228:231], v[252:255], v[132:135]
    buffer_load_dwordx4 v181, s[28:31], s47 offen offset:1024 lds
    v_mfma_f32_16x16x32_bf16 v[136:139], v[232:235], v[252:255], v[136:139]
    buffer_load_dwordx4 v182, s[28:31], s47 offen offset:2048 lds
    v_mfma_f32_16x16x32_bf16 v[140:143], v[236:239], v[252:255], v[140:143]
    ds_read_b128 v[252:255], v184 offset:8192
    buffer_load_dwordx4 v183, s[28:31], s47 offen offset:3072 lds
    s_add_u32 s46, s46, 524288
    s_and_b32 s46, s46, 0x3fffff
    s_waitcnt lgkmcnt(3)
    v_mfma_f32_16x16x32_bf16 v[28:31], v[204:207], v[208:211], v[28:31]
    ds_read_b64_tr_b16 v[236:237], v189 offset:16384
    v_mfma_f32_16x16x32_bf16 v[24:27], v[200:203], v[208:211], v[24:27]
    ds_read_b64_tr_b16 v[238:239], v189 offset:18432
    v_mfma_f32_16x16x32_bf16 v[20:23], v[196:199], v[208:211], v[20:23]
    ds_read_b64_tr_b16 v[232:233], v188 offset:16384
    v_mfma_f32_16x16x32_bf16 v[16:19], v[192:195], v[208:211], v[16:19]
    ds_read_b128 v[208:211], v184 offset:10240
    v_mfma_f32_16x16x32_bf16 v[32:35], v[192:195], v[212:215], v[32:35]
    ds_read_b64_tr_b16 v[234:235], v188 offset:18432
    v_mfma_f32_16x16x32_bf16 v[36:39], v[196:199], v[212:215], v[36:39]
    ds_read_b64_tr_b16 v[228:229], v187 offset:16384
    v_mfma_f32_16x16x32_bf16 v[40:43], v[200:203], v[212:215], v[40:43]
    ds_read_b64_tr_b16 v[230:231], v187 offset:18432
    v_mfma_f32_16x16x32_bf16 v[44:47], v[204:207], v[212:215], v[44:47]
    ds_read_b128 v[212:215], v184 offset:12288
    s_waitcnt lgkmcnt(10)
    v_mfma_f32_16x16x32_bf16 v[60:63], v[204:207], v[216:219], v[60:63]
    ds_read_b64_tr_b16 v[224:225], v186 offset:16384
    s_cmp_eq_u32 s12, 3
    s_cbranch_scc0 mg_w3u_5_r0
    s_mov_b64 exec, 1
    buffer_atomic_add v5, off, s[20:23], s67 sc1
    s_mov_b64 exec, -1
mg_w3u_5_r0:
    v_mfma_f32_16x16x32_bf16 v[56:59], v[200:203], v[216:219], v[56:59]
    ds_read_b64_tr_b16 v[226:227], v186 offset:18432
    v_mfma_f32_16x16x32_bf16 v[52:55], v[196:199], v[216:219], v[52:55]
    v_mfma_f32_16x16x32_bf16 v[48:51], v[192:195], v[216:219], v[48:51]
    ds_read_b128 v[216:219], v184 offset:14336
    s_waitcnt lgkmcnt(12)
    v_mfma_f32_16x16x32_bf16 v[64:67], v[192:195], v[220:223], v[64:67]
    v_mfma_f32_16x16x32_bf16 v[68:71], v[196:199], v[220:223], v[68:71]
    v_mfma_f32_16x16x32_bf16 v[72:75], v[200:203], v[220:223], v[72:75]
    v_mfma_f32_16x16x32_bf16 v[76:79], v[204:207], v[220:223], v[76:79]
    ds_read_b128 v[220:223], v185 offset:0
    s_waitcnt lgkmcnt(12)
    v_mfma_f32_16x16x32_bf16 v[92:95], v[204:207], v[252:255], v[92:95]
    v_mfma_f32_16x16x32_bf16 v[88:91], v[200:203], v[252:255], v[88:91]
    v_mfma_f32_16x16x32_bf16 v[84:87], v[196:199], v[252:255], v[84:87]
    v_mfma_f32_16x16x32_bf16 v[80:83], v[192:195], v[252:255], v[80:83]
    ds_read_b128 v[252:255], v185 offset:2048
    s_waitcnt lgkmcnt(9)
    v_mfma_f32_16x16x32_bf16 v[96:99], v[192:195], v[208:211], v[96:99]
    v_mfma_f32_16x16x32_bf16 v[100:103], v[196:199], v[208:211], v[100:103]
    v_mfma_f32_16x16x32_bf16 v[104:107], v[200:203], v[208:211], v[104:107]
    v_mfma_f32_16x16x32_bf16 v[108:111], v[204:207], v[208:211], v[108:111]
    ds_read_b128 v[208:211], v185 offset:4096
    s_waitcnt lgkmcnt(6)
    v_mfma_f32_16x16x32_bf16 v[124:127], v[204:207], v[212:215], v[124:127]
    v_mfma_f32_16x16x32_bf16 v[120:123], v[200:203], v[212:215], v[120:123]
    v_mfma_f32_16x16x32_bf16 v[116:119], v[196:199], v[212:215], v[116:119]
    v_mfma_f32_16x16x32_bf16 v[112:115], v[192:195], v[212:215], v[112:115]
    ds_read_b128 v[212:215], v185 offset:6144
    s_waitcnt lgkmcnt(4)
    v_mfma_f32_16x16x32_bf16 v[128:131], v[192:195], v[216:219], v[128:131]
    v_mfma_f32_16x16x32_bf16 v[132:135], v[196:199], v[216:219], v[132:135]
    v_mfma_f32_16x16x32_bf16 v[136:139], v[200:203], v[216:219], v[136:139]
    v_mfma_f32_16x16x32_bf16 v[140:143], v[204:207], v[216:219], v[140:143]
    ds_read_b128 v[216:219], v185 offset:8192
    s_waitcnt lgkmcnt(4)
    v_mfma_f32_16x16x32_bf16 v[28:31], v[236:239], v[220:223], v[28:31]
    v_mfma_f32_16x16x32_bf16 v[24:27], v[232:235], v[220:223], v[24:27]
    v_mfma_f32_16x16x32_bf16 v[20:23], v[228:231], v[220:223], v[20:23]
    v_mfma_f32_16x16x32_bf16 v[16:19], v[224:227], v[220:223], v[16:19]
    ds_read_b128 v[220:223], v185 offset:10240
    s_waitcnt lgkmcnt(4)
    v_mfma_f32_16x16x32_bf16 v[32:35], v[224:227], v[252:255], v[32:35]
    v_mfma_f32_16x16x32_bf16 v[36:39], v[228:231], v[252:255], v[36:39]
    v_mfma_f32_16x16x32_bf16 v[40:43], v[232:235], v[252:255], v[40:43]
    v_mfma_f32_16x16x32_bf16 v[44:47], v[236:239], v[252:255], v[44:47]
    ds_read_b128 v[252:255], v185 offset:12288
    s_waitcnt lgkmcnt(4)
    v_mfma_f32_16x16x32_bf16 v[60:63], v[236:239], v[208:211], v[60:63]
    v_bfe_u32 v8, v0, 4, 1
    v_and_b32 v9, 3, v0
    v_lshl_add_u32 v8, v8, 2, v9
    v_lshlrev_b32 v8, 3, v8
    v_mfma_f32_16x16x32_bf16 v[56:59], v[232:235], v[208:211], v[56:59]
    v_bfe_u32 v9, v0, 2, 2
    v_lshlrev_b32 v11, 8, v9
    v_lshl_add_u32 v11, v10, 12, v11
    s_mov_b32 s58, 0x70506848
    v_mfma_f32_16x16x32_bf16 v[52:55], v[228:231], v[208:211], v[52:55]
    s_mov_b32 s59, 0xa0807858
    s_cmp_eq_u32 s15, 0
    s_cselect_b32 s56, 0x28082000, s58
    s_cselect_b32 s57, 0x38183010, s59
    v_lshrrev_b64 v[12:13], v8, s[56:57]
    v_lshl_add_u32 v12, v9, 6, v12
    v_mfma_f32_16x16x32_bf16 v[48:51], v[224:227], v[208:211], v[48:51]
    ds_read_b128 v[208:211], v185 offset:14336
    s_waitcnt lgkmcnt(4)
    v_mfma_f32_16x16x32_bf16 v[64:67], v[224:227], v[212:215], v[64:67]
    v_and_b32 v12, 255, v12
    v_add_u32 v248, v12, v11
    s_mov_b32 s58, 0xb0d8a888
    s_mov_b32 s59, 0xe8e8b8e0
    v_mfma_f32_16x16x32_bf16 v[68:71], v[228:231], v[212:215], v[68:71]
    s_cmp_eq_u32 s15, 0
    s_cselect_b32 s56, 0x98c06040, s58
    s_cselect_b32 s57, 0x9090d0c8, s59
    v_lshrrev_b64 v[12:13], v8, s[56:57]
    v_lshl_add_u32 v12, v9, 6, v12
    v_and_b32 v12, 255, v12
    v_mfma_f32_16x16x32_bf16 v[72:75], v[232:235], v[212:215], v[72:75]
    v_add_u32 v249, v12, v11
    v_mfma_f32_16x16x32_bf16 v[76:79], v[236:239], v[212:215], v[76:79]
    s_waitcnt vmcnt(0)
    s_waitcnt lgkmcnt(0)
    v_xor_b32 v184, 65536, v184
    v_xor_b32 v185, 65536, v185
    v_xor_b32 v186, 0x10000, v186
    v_xor_b32 v187, 0x10000, v187
    v_xor_b32 v188, 0x10000, v188
    v_xor_b32 v189, 0x10000, v189
    s_barrier
    v_mfma_f32_16x16x32_bf16 v[92:95], v[236:239], v[216:219], v[92:95]
    ds_read_b64_tr_b16 v[204:205], v189 offset:0
    ds_read_b64_tr_b16 v[206:207], v189 offset:2048
    s_add_u32 m0, s44, 65536
    s_nop 0
    buffer_load_dwordx4 v176, s[24:27], s45 offen offset:0 lds
    v_mfma_f32_16x16x32_bf16 v[88:91], v[232:235], v[216:219], v[88:91]
    ds_read_b128 v[212:215], v184 offset:0
    ds_read_b64_tr_b16 v[200:201], v188 offset:0
    buffer_load_dwordx4 v177, s[24:27], s45 offen offset:1024 lds
    v_mfma_f32_16x16x32_bf16 v[84:87], v[228:231], v[216:219], v[84:87]
    ds_read_b64_tr_b16 v[202:203], v188 offset:2048
    ds_read_b64_tr_b16 v[196:197], v187 offset:0
    buffer_load_dwordx4 v178, s[24:27], s45 offen offset:2048 lds
    v_mfma_f32_16x16x32_bf16 v[80:83], v[224:227], v[216:219], v[80:83]
    ds_read_b64_tr_b16 v[198:199], v187 offset:2048
    ds_read_b128 v[216:219], v184 offset:2048
    buffer_load_dwordx4 v179, s[24:27], s45 offen offset:3072 lds
    v_mfma_f32_16x16x32_bf16 v[96:99], v[224:227], v[220:223], v[96:99]
    ds_read_b64_tr_b16 v[192:193], v186 offset:0
    ds_read_b64_tr_b16 v[194:195], v186 offset:2048
    s_add_u32 m0, s44, 81920
    s_add_u32 s47, s45, 65536
    buffer_load_dwordx4 v176, s[24:27], s47 offen offset:0 lds
    v_mfma_f32_16x16x32_bf16 v[100:103], v[228:231], v[220:223], v[100:103]
    buffer_load_dwordx4 v177, s[24:27], s47 offen offset:1024 lds
    v_mfma_f32_16x16x32_bf16 v[104:107], v[232:235], v[220:223], v[104:107]
    buffer_load_dwordx4 v178, s[24:27], s47 offen offset:2048 lds
    v_mfma_f32_16x16x32_bf16 v[108:111], v[236:239], v[220:223], v[108:111]
    ds_read_b128 v[220:223], v184 offset:4096
    buffer_load_dwordx4 v179, s[24:27], s47 offen offset:3072 lds
    s_add_u32 s45, s45, 128
    s_and_b32 s45, s45, 1023
    v_mfma_f32_16x16x32_bf16 v[124:127], v[236:239], v[252:255], v[124:127]
    s_add_u32 m0, s44, 98304
    s_nop 0
    buffer_load_dwordx4 v180, s[28:31], s46 offen offset:0 lds
    v_mfma_f32_16x16x32_bf16 v[120:123], v[232:235], v[252:255], v[120:123]
    buffer_load_dwordx4 v181, s[28:31], s46 offen offset:1024 lds
    v_mfma_f32_16x16x32_bf16 v[116:119], v[228:231], v[252:255], v[116:119]
    buffer_load_dwordx4 v182, s[28:31], s46 offen offset:2048 lds
    v_mfma_f32_16x16x32_bf16 v[112:115], v[224:227], v[252:255], v[112:115]
    ds_read_b128 v[252:255], v184 offset:6144
    buffer_load_dwordx4 v183, s[28:31], s46 offen offset:3072 lds
    v_mfma_f32_16x16x32_bf16 v[128:131], v[224:227], v[208:211], v[128:131]
    s_add_u32 m0, s44, 114688
    s_add_u32 s47, s46, 262144
    buffer_load_dwordx4 v180, s[28:31], s47 offen offset:0 lds
    v_mfma_f32_16x16x32_bf16 v[132:135], v[228:231], v[208:211], v[132:135]
    buffer_load_dwordx4 v181, s[28:31], s47 offen offset:1024 lds
    v_mfma_f32_16x16x32_bf16 v[136:139], v[232:235], v[208:211], v[136:139]
    buffer_load_dwordx4 v182, s[28:31], s47 offen offset:2048 lds
    v_mfma_f32_16x16x32_bf16 v[140:143], v[236:239], v[208:211], v[140:143]
    ds_read_b128 v[208:211], v184 offset:8192
    buffer_load_dwordx4 v183, s[28:31], s47 offen offset:3072 lds
    s_add_u32 s46, s46, 524288
    s_and_b32 s46, s46, 0x3fffff
    s_waitcnt lgkmcnt(3)
    v_mfma_f32_16x16x32_bf16 v[28:31], v[204:207], v[212:215], v[28:31]
    ds_read_b64_tr_b16 v[236:237], v189 offset:16384
    v_mfma_f32_16x16x32_bf16 v[24:27], v[200:203], v[212:215], v[24:27]
    ds_read_b64_tr_b16 v[238:239], v189 offset:18432
    v_mfma_f32_16x16x32_bf16 v[20:23], v[196:199], v[212:215], v[20:23]
    ds_read_b64_tr_b16 v[232:233], v188 offset:16384
    v_mfma_f32_16x16x32_bf16 v[16:19], v[192:195], v[212:215], v[16:19]
    ds_read_b128 v[212:215], v184 offset:10240
    v_mfma_f32_16x16x32_bf16 v[32:35], v[192:195], v[216:219], v[32:35]
    ds_read_b64_tr_b16 v[234:235], v188 offset:18432
    v_mfma_f32_16x16x32_bf16 v[36:39], v[196:199], v[216:219], v[36:39]
    ds_read_b64_tr_b16 v[228:229], v187 offset:16384
    v_mfma_f32_16x16x32_bf16 v[40:43], v[200:203], v[216:219], v[40:43]
    ds_read_b64_tr_b16 v[230:231], v187 offset:18432
    v_mfma_f32_16x16x32_bf16 v[44:47], v[204:207], v[216:219], v[44:47]
    ds_read_b128 v[216:219], v184 offset:12288
    s_waitcnt lgkmcnt(10)
    v_mfma_f32_16x16x32_bf16 v[60:63], v[204:207], v[220:223], v[60:63]
    ds_read_b64_tr_b16 v[224:225], v186 offset:16384
    s_mov_b32 s40, s4
    s_and_b32 s41, s5, 0xffff
    s_mov_b32 s42, 2621440
    s_mov_b32 s43, 0x20000
    v_mfma_f32_16x16x32_bf16 v[56:59], v[200:203], v[220:223], v[56:59]
    ds_read_b64_tr_b16 v[226:227], v186 offset:18432
    s_lshl_b32 s13, s2, 3
    v_mfma_f32_16x16x32_bf16 v[52:55], v[196:199], v[220:223], v[52:55]
    s_add_u32 s13, s13, s12
    v_mfma_f32_16x16x32_bf16 v[48:51], v[192:195], v[220:223], v[48:51]
    ds_read_b128 v[220:223], v184 offset:14336
    s_waitcnt lgkmcnt(12)
    v_mfma_f32_16x16x32_bf16 v[64:67], v[192:195], v[252:255], v[64:67]
    s_mul_i32 s13, s13, 1280
    v_mfma_f32_16x16x32_bf16 v[68:71], v[196:199], v[252:255], v[68:71]
    buffer_load_dword v166, v167, s[40:43], s13 offen
    v_mfma_f32_16x16x32_bf16 v[72:75], v[200:203], v[252:255], v[72:75]
    v_mfma_f32_16x16x32_bf16 v[76:79], v[204:207], v[252:255], v[76:79]
    ds_read_b128 v[252:255], v185 offset:0
    s_waitcnt lgkmcnt(12)
    v_mfma_f32_16x16x32_bf16 v[92:95], v[204:207], v[208:211], v[92:95]
    v_mfma_f32_16x16x32_bf16 v[88:91], v[200:203], v[208:211], v[88:91]
    v_mfma_f32_16x16x32_bf16 v[84:87], v[196:199], v[208:211], v[84:87]
    v_mfma_f32_16x16x32_bf16 v[80:83], v[192:195], v[208:211], v[80:83]
    ds_read_b128 v[208:211], v185 offset:2048
    s_waitcnt lgkmcnt(9)
    v_mfma_f32_16x16x32_bf16 v[96:99], v[192:195], v[212:215], v[96:99]
    v_mfma_f32_16x16x32_bf16 v[100:103], v[196:199], v[212:215], v[100:103]
    v_mfma_f32_16x16x32_bf16 v[104:107], v[200:203], v[212:215], v[104:107]
    v_mfma_f32_16x16x32_bf16 v[108:111], v[204:207], v[212:215], v[108:111]
    ds_read_b128 v[212:215], v185 offset:4096
    s_waitcnt lgkmcnt(6)
    v_mfma_f32_16x16x32_bf16 v[124:127], v[204:207], v[216:219], v[124:127]
    s_mov_b32 s40, s72
    s_and_b32 s41, s73, 0xffff
    s_mov_b32 s42, 5242880
    s_mov_b32 s43, 0x20000
    s_and_b32 s13, s2, 248
    v_mfma_f32_16x16x32_bf16 v[120:123], v[200:203], v[216:219], v[120:123]
    s_add_u32 s13, s13, s12
    s_lshl_b32 s13, s13, 13
    v_mfma_f32_16x16x32_bf16 v[116:119], v[196:199], v[216:219], v[116:119]
    s_and_b32 s14, s2, 7
    s_lshl_b32 s14, s14, 10
    v_mfma_f32_16x16x32_bf16 v[112:115], v[192:195], v[216:219], v[112:115]
    ds_read_b128 v[216:219], v185 offset:6144
    s_waitcnt lgkmcnt(4)
    v_mfma_f32_16x16x32_bf16 v[128:131], v[192:195], v[220:223], v[128:131]
    s_add_u32 s13, s13, s14
    buffer_load_dword v166, v1, s[40:43], s13 offen
    v_mfma_f32_16x16x32_bf16 v[132:135], v[196:199], v[220:223], v[132:135]
    v_mfma_f32_16x16x32_bf16 v[136:139], v[200:203], v[220:223], v[136:139]
    v_mfma_f32_16x16x32_bf16 v[140:143], v[204:207], v[220:223], v[140:143]
    ds_read_b128 v[220:223], v185 offset:8192
    s_waitcnt lgkmcnt(4)
    v_mfma_f32_16x16x32_bf16 v[28:31], v[236:239], v[252:255], v[28:31]
    v_mfma_f32_16x16x32_bf16 v[24:27], v[232:235], v[252:255], v[24:27]
    v_mfma_f32_16x16x32_bf16 v[20:23], v[228:231], v[252:255], v[20:23]
    v_mfma_f32_16x16x32_bf16 v[16:19], v[224:227], v[252:255], v[16:19]
    ds_read_b128 v[252:255], v185 offset:10240
    s_waitcnt lgkmcnt(4)
    v_mfma_f32_16x16x32_bf16 v[32:35], v[224:227], v[208:211], v[32:35]
    v_mfma_f32_16x16x32_bf16 v[36:39], v[228:231], v[208:211], v[36:39]
    v_mfma_f32_16x16x32_bf16 v[40:43], v[232:235], v[208:211], v[40:43]
    v_mfma_f32_16x16x32_bf16 v[44:47], v[236:239], v[208:211], v[44:47]
    ds_read_b128 v[208:211], v185 offset:12288
    s_waitcnt lgkmcnt(4)
    v_mfma_f32_16x16x32_bf16 v[60:63], v[236:239], v[212:215], v[60:63]
    v_mfma_f32_16x16x32_bf16 v[56:59], v[232:235], v[212:215], v[56:59]
    v_mfma_f32_16x16x32_bf16 v[52:55], v[228:231], v[212:215], v[52:55]
    v_mfma_f32_16x16x32_bf16 v[48:51], v[224:227], v[212:215], v[48:51]
    ds_read_b128 v[212:215], v185 offset:14336
    s_waitcnt lgkmcnt(4)
    v_mfma_f32_16x16x32_bf16 v[64:67], v[224:227], v[216:219], v[64:67]
    v_mfma_f32_16x16x32_bf16 v[68:71], v[228:231], v[216:219], v[68:71]
    v_mfma_f32_16x16x32_bf16 v[72:75], v[232:235], v[216:219], v[72:75]
    v_mfma_f32_16x16x32_bf16 v[76:79], v[236:239], v[216:219], v[76:79]
    s_waitcnt vmcnt(2)
    s_waitcnt lgkmcnt(0)
    v_xor_b32 v184, 65536, v184
    v_xor_b32 v185, 65536, v185
    v_xor_b32 v186, 0x10000, v186
    v_xor_b32 v187, 0x10000, v187
    v_xor_b32 v188, 0x10000, v188
    v_xor_b32 v189, 0x10000, v189
    s_barrier
    v_mfma_f32_16x16x32_bf16 v[92:95], v[236:239], v[220:223], v[92:95]
    ds_read_b64_tr_b16 v[204:205], v189 offset:0
    ds_read_b64_tr_b16 v[206:207], v189 offset:2048
    s_add_u32 m0, s44, 0
    s_nop 0
    buffer_load_dwordx4 v176, s[24:27], s45 offen offset:0 lds
    v_mfma_f32_16x16x32_bf16 v[88:91], v[232:235], v[220:223], v[88:91]
    ds_read_b128 v[216:219], v184 offset:0
    ds_read_b64_tr_b16 v[200:201], v188 offset:0
    buffer_load_dwordx4 v177, s[24:27], s45 offen offset:1024 lds
    v_mfma_f32_16x16x32_bf16 v[84:87], v[228:231], v[220:223], v[84:87]
    ds_read_b64_tr_b16 v[202:203], v188 offset:2048
    ds_read_b64_tr_b16 v[196:197], v187 offset:0
    buffer_load_dwordx4 v178, s[24:27], s45 offen offset:2048 lds
    v_mfma_f32_16x16x32_bf16 v[80:83], v[224:227], v[220:223], v[80:83]
    ds_read_b64_tr_b16 v[198:199], v187 offset:2048
    ds_read_b128 v[220:223], v184 offset:2048
    buffer_load_dwordx4 v179, s[24:27], s45 offen offset:3072 lds
    v_mfma_f32_16x16x32_bf16 v[96:99], v[224:227], v[252:255], v[96:99]
    ds_read_b64_tr_b16 v[192:193], v186 offset:0
    ds_read_b64_tr_b16 v[194:195], v186 offset:2048
    s_add_u32 m0, s44, 16384
    s_add_u32 s47, s45, 65536
    buffer_load_dwordx4 v176, s[24:27], s47 offen offset:0 lds
    v_mfma_f32_16x16x32_bf16 v[100:103], v[228:231], v[252:255], v[100:103]
    buffer_load_dwordx4 v177, s[24:27], s47 offen offset:1024 lds
    v_mfma_f32_16x16x32_bf16 v[104:107], v[232:235], v[252:255], v[104:107]
    buffer_load_dwordx4 v178, s[24:27], s47 offen offset:2048 lds
    v_mfma_f32_16x16x32_bf16 v[108:111], v[236:239], v[252:255], v[108:111]
    ds_read_b128 v[252:255], v184 offset:4096
    buffer_load_dwordx4 v179, s[24:27], s47 offen offset:3072 lds
    s_add_u32 s45, s45, 128
    s_and_b32 s45, s45, 1023
    v_mfma_f32_16x16x32_bf16 v[124:127], v[236:239], v[208:211], v[124:127]
    s_add_u32 m0, s44, 32768
    s_nop 0
    buffer_load_dwordx4 v180, s[28:31], s46 offen offset:0 lds
    v_mfma_f32_16x16x32_bf16 v[120:123], v[232:235], v[208:211], v[120:123]
    buffer_load_dwordx4 v181, s[28:31], s46 offen offset:1024 lds
    v_mfma_f32_16x16x32_bf16 v[116:119], v[228:231], v[208:211], v[116:119]
    buffer_load_dwordx4 v182, s[28:31], s46 offen offset:2048 lds
    v_mfma_f32_16x16x32_bf16 v[112:115], v[224:227], v[208:211], v[112:115]
    ds_read_b128 v[208:211], v184 offset:6144
    buffer_load_dwordx4 v183, s[28:31], s46 offen offset:3072 lds
    v_mfma_f32_16x16x32_bf16 v[128:131], v[224:227], v[212:215], v[128:131]
    s_add_u32 m0, s44, 49152
    s_add_u32 s47, s46, 262144
    buffer_load_dwordx4 v180, s[28:31], s47 offen offset:0 lds
    v_mfma_f32_16x16x32_bf16 v[132:135], v[228:231], v[212:215], v[132:135]
    buffer_load_dwordx4 v181, s[28:31], s47 offen offset:1024 lds
    v_mfma_f32_16x16x32_bf16 v[136:139], v[232:235], v[212:215], v[136:139]
    buffer_load_dwordx4 v182, s[28:31], s47 offen offset:2048 lds
    v_mfma_f32_16x16x32_bf16 v[140:143], v[236:239], v[212:215], v[140:143]
    ds_read_b128 v[212:215], v184 offset:8192
    buffer_load_dwordx4 v183, s[28:31], s47 offen offset:3072 lds
    s_add_u32 s46, s46, 524288
    s_and_b32 s46, s46, 0x3fffff
    s_waitcnt lgkmcnt(3)
    v_mfma_f32_16x16x32_bf16 v[28:31], v[204:207], v[216:219], v[28:31]
    ds_read_b64_tr_b16 v[236:237], v189 offset:16384
    v_mfma_f32_16x16x32_bf16 v[24:27], v[200:203], v[216:219], v[24:27]
    ds_read_b64_tr_b16 v[238:239], v189 offset:18432
    v_mfma_f32_16x16x32_bf16 v[20:23], v[196:199], v[216:219], v[20:23]
    ds_read_b64_tr_b16 v[232:233], v188 offset:16384
    v_mfma_f32_16x16x32_bf16 v[16:19], v[192:195], v[216:219], v[16:19]
    ds_read_b128 v[216:219], v184 offset:10240
    v_mfma_f32_16x16x32_bf16 v[32:35], v[192:195], v[220:223], v[32:35]
    ds_read_b64_tr_b16 v[234:235], v188 offset:18432
    v_mfma_f32_16x16x32_bf16 v[36:39], v[196:199], v[220:223], v[36:39]
    ds_read_b64_tr_b16 v[228:229], v187 offset:16384
    v_mfma_f32_16x16x32_bf16 v[40:43], v[200:203], v[220:223], v[40:43]
    ds_read_b64_tr_b16 v[230:231], v187 offset:18432
    v_mfma_f32_16x16x32_bf16 v[44:47], v[204:207], v[220:223], v[44:47]
    ds_read_b128 v[220:223], v184 offset:12288
    s_waitcnt lgkmcnt(10)
    v_mfma_f32_16x16x32_bf16 v[60:63], v[204:207], v[252:255], v[60:63]
    ds_read_b64_tr_b16 v[224:225], v186 offset:16384
    s_mov_b32 s40, s72
    s_and_b32 s41, s73, 0xffff
    s_mov_b32 s42, 5242880
    s_mov_b32 s43, 0x20000
    s_and_b32 s13, s2, 248
    v_mfma_f32_16x16x32_bf16 v[56:59], v[200:203], v[252:255], v[56:59]
    ds_read_b64_tr_b16 v[226:227], v186 offset:18432
    s_add_u32 s13, s13, s12
    s_lshl_b32 s13, s13, 13
    v_mfma_f32_16x16x32_bf16 v[52:55], v[196:199], v[252:255], v[52:55]
    s_and_b32 s14, s2, 7
    s_lshl_b32 s14, s14, 10
    v_mfma_f32_16x16x32_bf16 v[48:51], v[192:195], v[252:255], v[48:51]
    ds_read_b128 v[252:255], v184 offset:14336
    s_waitcnt lgkmcnt(12)
    v_mfma_f32_16x16x32_bf16 v[64:67], v[192:195], v[208:211], v[64:67]
    s_add_u32 s13, s13, s14
    s_add_u32 s13, s13, 2097152
    v_mfma_f32_16x16x32_bf16 v[68:71], v[196:199], v[208:211], v[68:71]
    buffer_load_dword v166, v1, s[40:43], s13 offen
    s_cmp_eq_u32 s12, 3
    s_cbranch_scc0 mg_w3u_6_r0
    buffer_load_dword v5, off, s[20:23], s67 sc1
mg_w3u_6_r0:
    v_mfma_f32_16x16x32_bf16 v[72:75], v[200:203], v[208:211], v[72:75]
    v_mfma_f32_16x16x32_bf16 v[76:79], v[204:207], v[208:211], v[76:79]
    ds_read_b128 v[208:211], v185 offset:0
    s_waitcnt lgkmcnt(12)
    v_mfma_f32_16x16x32_bf16 v[92:95], v[204:207], v[212:215], v[92:95]
    v_mfma_f32_16x16x32_bf16 v[88:91], v[200:203], v[212:215], v[88:91]
    v_mfma_f32_16x16x32_bf16 v[84:87], v[196:199], v[212:215], v[84:87]
    v_mfma_f32_16x16x32_bf16 v[80:83], v[192:195], v[212:215], v[80:83]
    ds_read_b128 v[212:215], v185 offset:2048
    s_waitcnt lgkmcnt(9)
    v_mfma_f32_16x16x32_bf16 v[96:99], v[192:195], v[216:219], v[96:99]
    v_mfma_f32_16x16x32_bf16 v[100:103], v[196:199], v[216:219], v[100:103]
    v_mfma_f32_16x16x32_bf16 v[104:107], v[200:203], v[216:219], v[104:107]
    v_mfma_f32_16x16x32_bf16 v[108:111], v[204:207], v[216:219], v[108:111]
    ds_read_b128 v[216:219], v185 offset:4096
    s_waitcnt lgkmcnt(6)
    v_mfma_f32_16x16x32_bf16 v[124:127], v[204:207], v[220:223], v[124:127]
    s_mov_b32 s40, s72
    s_and_b32 s41, s73, 0xffff
    s_mov_b32 s42, 5242880
    s_mov_b32 s43, 0x20000
    s_and_b32 s13, s2, 248
    v_mfma_f32_16x16x32_bf16 v[120:123], v[200:203], v[220:223], v[120:123]
    s_add_u32 s13, s13, s12
    s_lshl_b32 s13, s13, 13
    v_mfma_f32_16x16x32_bf16 v[116:119], v[196:199], v[220:223], v[116:119]
    s_and_b32 s14, s2, 7
    s_lshl_b32 s14, s14, 10
    v_mfma_f32_16x16x32_bf16 v[112:115], v[192:195], v[220:223], v[112:115]
    ds_read_b128 v[220:223], v185 offset:6144
    s_waitcnt lgkmcnt(4)
    v_mfma_f32_16x16x32_bf16 v[128:131], v[192:195], v[252:255], v[128:131]
    s_add_u32 s13, s13, s14
    s_add_u32 s13, s13, 4194304
    v_mfma_f32_16x16x32_bf16 v[132:135], v[196:199], v[252:255], v[132:135]
    buffer_load_dword v166, v1, s[40:43], s13 offen
    v_mfma_f32_16x16x32_bf16 v[136:139], v[200:203], v[252:255], v[136:139]
    v_mfma_f32_16x16x32_bf16 v[140:143], v[204:207], v[252:255], v[140:143]
    ds_read_b128 v[252:255], v185 offset:8192
    s_waitcnt lgkmcnt(4)
    v_mfma_f32_16x16x32_bf16 v[28:31], v[236:239], v[208:211], v[28:31]
    v_mfma_f32_16x16x32_bf16 v[24:27], v[232:235], v[208:211], v[24:27]
    v_mfma_f32_16x16x32_bf16 v[20:23], v[228:231], v[208:211], v[20:23]
    v_mfma_f32_16x16x32_bf16 v[16:19], v[224:227], v[208:211], v[16:19]
    ds_read_b128 v[208:211], v185 offset:10240
    s_waitcnt lgkmcnt(4)
    v_mfma_f32_16x16x32_bf16 v[32:35], v[224:227], v[212:215], v[32:35]
    v_mfma_f32_16x16x32_bf16 v[36:39], v[228:231], v[212:215], v[36:39]
    v_mfma_f32_16x16x32_bf16 v[40:43], v[232:235], v[212:215], v[40:43]
    v_mfma_f32_16x16x32_bf16 v[44:47], v[236:239], v[212:215], v[44:47]
    ds_read_b128 v[212:215], v185 offset:12288
    s_waitcnt lgkmcnt(4)
    v_mfma_f32_16x16x32_bf16 v[60:63], v[236:239], v[216:219], v[60:63]
    v_mfma_f32_16x16x32_bf16 v[56:59], v[232:235], v[216:219], v[56:59]
    v_mfma_f32_16x16x32_bf16 v[52:55], v[228:231], v[216:219], v[52:55]
    v_mfma_f32_16x16x32_bf16 v[48:51], v[224:227], v[216:219], v[48:51]
    ds_read_b128 v[216:219], v185 offset:14336
    s_waitcnt lgkmcnt(4)
    v_mfma_f32_16x16x32_bf16 v[64:67], v[224:227], v[220:223], v[64:67]
    v_mfma_f32_16x16x32_bf16 v[68:71], v[228:231], v[220:223], v[68:71]
    v_mfma_f32_16x16x32_bf16 v[72:75], v[232:235], v[220:223], v[72:75]
    v_mfma_f32_16x16x32_bf16 v[76:79], v[236:239], v[220:223], v[76:79]
    s_waitcnt vmcnt(2)
    s_waitcnt lgkmcnt(0)
    v_xor_b32 v184, 65536, v184
    v_xor_b32 v185, 65536, v185
    v_xor_b32 v186, 0x10000, v186
    v_xor_b32 v187, 0x10000, v187
    v_xor_b32 v188, 0x10000, v188
    v_xor_b32 v189, 0x10000, v189
    s_cmp_eq_u32 s12, 3
    s_cbranch_scc0 mg_w3rpk_r0
    s_waitcnt vmcnt(1)
    v_readfirstlane_b32 s13, v5
    s_mov_b32 s14, 0
    s_cmp_lt_u32 s13, 0x100000
    s_cbranch_scc1 mg_pwrpk_r0
mg_w3rpk_r0:
    s_barrier
    v_mfma_f32_16x16x32_bf16 v[92:95], v[236:239], v[252:255], v[92:95]
    ds_read_b64_tr_b16 v[204:205], v189 offset:0
    ds_read_b64_tr_b16 v[206:207], v189 offset:2048
    s_add_u32 m0, s44, 65536
    s_nop 0
    buffer_load_dwordx4 v176, s[24:27], s45 offen offset:0 lds
    v_mfma_f32_16x16x32_bf16 v[88:91], v[232:235], v[252:255], v[88:91]
    ds_read_b128 v[220:223], v184 offset:0
    ds_read_b64_tr_b16 v[200:201], v188 offset:0
    buffer_load_dwordx4 v177, s[24:27], s45 offen offset:1024 lds
    v_mfma_f32_16x16x32_bf16 v[84:87], v[228:231], v[252:255], v[84:87]
    ds_read_b64_tr_b16 v[202:203], v188 offset:2048
    ds_read_b64_tr_b16 v[196:197], v187 offset:0
    buffer_load_dwordx4 v178, s[24:27], s45 offen offset:2048 lds
    v_mfma_f32_16x16x32_bf16 v[80:83], v[224:227], v[252:255], v[80:83]
    ds_read_b64_tr_b16 v[198:199], v187 offset:2048
    ds_read_b128 v[252:255], v184 offset:2048
    buffer_load_dwordx4 v179, s[24:27], s45 offen offset:3072 lds
    v_mfma_f32_16x16x32_bf16 v[96:99], v[224:227], v[208:211], v[96:99]
    ds_read_b64_tr_b16 v[192:193], v186 offset:0
    ds_read_b64_tr_b16 v[194:195], v186 offset:2048
    s_add_u32 m0, s44, 81920
    s_add_u32 s47, s45, 65536
    buffer_load_dwordx4 v176, s[24:27], s47 offen offset:0 lds
    v_mfma_f32_16x16x32_bf16 v[100:103], v[228:231], v[208:211], v[100:103]
    buffer_load_dwordx4 v177, s[24:27], s47 offen offset:1024 lds
    v_mfma_f32_16x16x32_bf16 v[104:107], v[232:235], v[208:211], v[104:107]
    buffer_load_dwordx4 v178, s[24:27], s47 offen offset:2048 lds
    v_mfma_f32_16x16x32_bf16 v[108:111], v[236:239], v[208:211], v[108:111]
    ds_read_b128 v[208:211], v184 offset:4096
    buffer_load_dwordx4 v179, s[24:27], s47 offen offset:3072 lds
    s_add_u32 s45, s45, 128
    s_and_b32 s45, s45, 1023
    v_mfma_f32_16x16x32_bf16 v[124:127], v[236:239], v[212:215], v[124:127]
    s_add_u32 m0, s44, 98304
    s_nop 0
    buffer_load_dwordx4 v180, s[28:31], s46 offen offset:0 lds
    v_mfma_f32_16x16x32_bf16 v[120:123], v[232:235], v[212:215], v[120:123]
    buffer_load_dwordx4 v181, s[28:31], s46 offen offset:1024 lds
    v_mfma_f32_16x16x32_bf16 v[116:119], v[228:231], v[212:215], v[116:119]
    buffer_load_dwordx4 v182, s[28:31], s46 offen offset:2048 lds
    v_mfma_f32_16x16x32_bf16 v[112:115], v[224:227], v[212:215], v[112:115]
    ds_read_b128 v[212:215], v184 offset:6144
    buffer_load_dwordx4 v183, s[28:31], s46 offen offset:3072 lds
    v_mfma_f32_16x16x32_bf16 v[128:131], v[224:227], v[216:219], v[128:131]
    s_add_u32 m0, s44, 114688
    s_add_u32 s47, s46, 262144
    buffer_load_dwordx4 v180, s[28:31], s47 offen offset:0 lds
    v_mfma_f32_16x16x32_bf16 v[132:135], v[228:231], v[216:219], v[132:135]
    buffer_load_dwordx4 v181, s[28:31], s47 offen offset:1024 lds
    v_mfma_f32_16x16x32_bf16 v[136:139], v[232:235], v[216:219], v[136:139]
    buffer_load_dwordx4 v182, s[28:31], s47 offen offset:2048 lds
    v_mfma_f32_16x16x32_bf16 v[140:143], v[236:239], v[216:219], v[140:143]
    ds_read_b128 v[216:219], v184 offset:8192
    buffer_load_dwordx4 v183, s[28:31], s47 offen offset:3072 lds
    s_add_u32 s46, s46, 524288
    s_and_b32 s46, s46, 0x3fffff
    s_waitcnt lgkmcnt(3)
    v_mfma_f32_16x16x32_bf16 v[28:31], v[204:207], v[220:223], v[28:31]
    ds_read_b64_tr_b16 v[236:237], v189 offset:16384
    v_mfma_f32_16x16x32_bf16 v[24:27], v[200:203], v[220:223], v[24:27]
    ds_read_b64_tr_b16 v[238:239], v189 offset:18432
    v_mfma_f32_16x16x32_bf16 v[20:23], v[196:199], v[220:223], v[20:23]
    ds_read_b64_tr_b16 v[232:233], v188 offset:16384
    v_mfma_f32_16x16x32_bf16 v[16:19], v[192:195], v[220:223], v[16:19]
    ds_read_b128 v[220:223], v184 offset:10240
    v_mfma_f32_16x16x32_bf16 v[32:35], v[192:195], v[252:255], v[32:35]
    ds_read_b64_tr_b16 v[234:235], v188 offset:18432
    v_mfma_f32_16x16x32_bf16 v[36:39], v[196:199], v[252:255], v[36:39]
    ds_read_b64_tr_b16 v[228:229], v187 offset:16384
    v_mfma_f32_16x16x32_bf16 v[40:43], v[200:203], v[252:255], v[40:43]
    ds_read_b64_tr_b16 v[230:231], v187 offset:18432
    v_mfma_f32_16x16x32_bf16 v[44:47], v[204:207], v[252:255], v[44:47]
    ds_read_b128 v[252:255], v184 offset:12288
    s_waitcnt lgkmcnt(10)
    v_mfma_f32_16x16x32_bf16 v[60:63], v[204:207], v[208:211], v[60:63]
    ds_read_b64_tr_b16 v[224:225], v186 offset:16384
    v_mfma_f32_16x16x32_bf16 v[56:59], v[200:203], v[208:211], v[56:59]
    ds_read_b64_tr_b16 v[226:227], v186 offset:18432
    v_mfma_f32_16x16x32_bf16 v[52:55], v[196:199], v[208:211], v[52:55]
    v_mfma_f32_16x16x32_bf16 v[48:51], v[192:195], v[208:211], v[48:51]
    ds_read_b128 v[208:211], v184 offset:14336
    s_waitcnt lgkmcnt(12)
    v_mfma_f32_16x16x32_bf16 v[64:67], v[192:195], v[212:215], v[64:67]
    v_mfma_f32_16x16x32_bf16 v[68:71], v[196:199], v[212:215], v[68:71]
    v_mfma_f32_16x16x32_bf16 v[72:75], v[200:203], v[212:215], v[72:75]
    v_mfma_f32_16x16x32_bf16 v[76:79], v[204:207], v[212:215], v[76:79]
    ds_read_b128 v[212:215], v185 offset:0
    s_waitcnt lgkmcnt(12)
    v_mfma_f32_16x16x32_bf16 v[92:95], v[204:207], v[216:219], v[92:95]
    v_mfma_f32_16x16x32_bf16 v[88:91], v[200:203], v[216:219], v[88:91]
    v_mfma_f32_16x16x32_bf16 v[84:87], v[196:199], v[216:219], v[84:87]
    v_mfma_f32_16x16x32_bf16 v[80:83], v[192:195], v[216:219], v[80:83]
    ds_read_b128 v[216:219], v185 offset:2048
    s_waitcnt lgkmcnt(9)
    v_mfma_f32_16x16x32_bf16 v[96:99], v[192:195], v[220:223], v[96:99]
    v_mfma_f32_16x16x32_bf16 v[100:103], v[196:199], v[220:223], v[100:103]
    v_mfma_f32_16x16x32_bf16 v[104:107], v[200:203], v[220:223], v[104:107]
    v_mfma_f32_16x16x32_bf16 v[108:111], v[204:207], v[220:223], v[108:111]
    ds_read_b128 v[220:223], v185 offset:4096
    s_waitcnt lgkmcnt(6)
    v_mfma_f32_16x16x32_bf16 v[124:127], v[204:207], v[252:255], v[124:127]
    v_mfma_f32_16x16x32_bf16 v[120:123], v[200:203], v[252:255], v[120:123]
    v_mfma_f32_16x16x32_bf16 v[116:119], v[196:199], v[252:255], v[116:119]
    v_mfma_f32_16x16x32_bf16 v[112:115], v[192:195], v[252:255], v[112:115]
    ds_read_b128 v[252:255], v185 offset:6144
    s_waitcnt lgkmcnt(4)
    v_mfma_f32_16x16x32_bf16 v[128:131], v[192:195], v[208:211], v[128:131]
    v_mfma_f32_16x16x32_bf16 v[132:135], v[196:199], v[208:211], v[132:135]
    v_mfma_f32_16x16x32_bf16 v[136:139], v[200:203], v[208:211], v[136:139]
    v_mfma_f32_16x16x32_bf16 v[140:143], v[204:207], v[208:211], v[140:143]
    ds_read_b128 v[208:211], v185 offset:8192
    s_waitcnt lgkmcnt(4)
    v_mfma_f32_16x16x32_bf16 v[28:31], v[236:239], v[212:215], v[28:31]
    v_mfma_f32_16x16x32_bf16 v[24:27], v[232:235], v[212:215], v[24:27]
    v_mfma_f32_16x16x32_bf16 v[20:23], v[228:231], v[212:215], v[20:23]
    v_mfma_f32_16x16x32_bf16 v[16:19], v[224:227], v[212:215], v[16:19]
    ds_read_b128 v[212:215], v185 offset:10240
    s_waitcnt lgkmcnt(4)
    v_mfma_f32_16x16x32_bf16 v[32:35], v[224:227], v[216:219], v[32:35]
    v_mfma_f32_16x16x32_bf16 v[36:39], v[228:231], v[216:219], v[36:39]
    v_mfma_f32_16x16x32_bf16 v[40:43], v[232:235], v[216:219], v[40:43]
    v_mfma_f32_16x16x32_bf16 v[44:47], v[236:239], v[216:219], v[44:47]
    ds_read_b128 v[216:219], v185 offset:12288
    s_waitcnt lgkmcnt(4)
    v_mfma_f32_16x16x32_bf16 v[60:63], v[236:239], v[220:223], v[60:63]
    v_mfma_f32_16x16x32_bf16 v[56:59], v[232:235], v[220:223], v[56:59]
    v_mfma_f32_16x16x32_bf16 v[52:55], v[228:231], v[220:223], v[52:55]
    v_mfma_f32_16x16x32_bf16 v[48:51], v[224:227], v[220:223], v[48:51]
    ds_read_b128 v[220:223], v185 offset:14336
    s_waitcnt lgkmcnt(4)
    v_mfma_f32_16x16x32_bf16 v[64:67], v[224:227], v[252:255], v[64:67]
    v_mfma_f32_16x16x32_bf16 v[68:71], v[228:231], v[252:255], v[68:71]
    v_mfma_f32_16x16x32_bf16 v[72:75], v[232:235], v[252:255], v[72:75]
    v_mfma_f32_16x16x32_bf16 v[76:79], v[236:239], v[252:255], v[76:79]
    s_waitcnt vmcnt(0)
    s_waitcnt lgkmcnt(0)
    v_xor_b32 v184, 65536, v184
    v_xor_b32 v185, 65536, v185
    v_xor_b32 v186, 0x10000, v186
    v_xor_b32 v187, 0x10000, v187
    v_xor_b32 v188, 0x10000, v188
    v_xor_b32 v189, 0x10000, v189
    s_barrier
    v_mfma_f32_16x16x32_bf16 v[92:95], v[236:239], v[208:211], v[92:95]
    ds_read_b64_tr_b16 v[204:205], v189 offset:0
    ds_read_b64_tr_b16 v[206:207], v189 offset:2048
    s_add_u32 m0, s44, 0
    s_nop 0
    buffer_load_dwordx4 v243, s[16:19], s55 offen offset:0 sc1 lds
    v_mfma_f32_16x16x32_bf16 v[88:91], v[232:235], v[208:211], v[88:91]
    ds_read_b128 v[252:255], v184 offset:0
    ds_read_b64_tr_b16 v[200:201], v188 offset:0
    buffer_load_dwordx4 v243, s[16:19], s55 offen offset:1024 sc1 lds
    v_mfma_f32_16x16x32_bf16 v[84:87], v[228:231], v[208:211], v[84:87]
    ds_read_b64_tr_b16 v[202:203], v188 offset:2048
    ds_read_b64_tr_b16 v[196:197], v187 offset:0
    s_add_u32 m0, s44, 2048
    s_nop 0
    buffer_load_dwordx4 v240, s[32:35], s54 offen offset:0 lds
    v_mfma_f32_16x16x32_bf16 v[80:83], v[224:227], v[208:211], v[80:83]
    ds_read_b64_tr_b16 v[198:199], v187 offset:2048
    ds_read_b128 v[208:211], v184 offset:2048
    buffer_load_dwordx4 v241, s[32:35], s54 offen offset:1024 lds
    v_mfma_f32_16x16x32_bf16 v[96:99], v[224:227], v[212:215], v[96:99]
    ds_read_b64_tr_b16 v[192:193], v186 offset:0
    ds_read_b64_tr_b16 v[194:195], v186 offset:2048
    s_add_u32 m0, s44, 16384
    s_add_u32 s47, s55, 8192
    buffer_load_dwordx4 v243, s[16:19], s47 offen offset:0 sc1 lds
    v_mfma_f32_16x16x32_bf16 v[100:103], v[228:231], v[212:215], v[100:103]
    buffer_load_dwordx4 v243, s[16:19], s47 offen offset:1024 sc1 lds
    v_mfma_f32_16x16x32_bf16 v[104:107], v[232:235], v[212:215], v[104:107]
    s_add_u32 m0, s44, 18432
    s_add_u32 s47, s54, 81920
    buffer_load_dwordx4 v240, s[32:35], s47 offen offset:0 lds
    v_mfma_f32_16x16x32_bf16 v[108:111], v[236:239], v[212:215], v[108:111]
    ds_read_b128 v[212:215], v184 offset:4096
    buffer_load_dwordx4 v241, s[32:35], s47 offen offset:1024 lds
    s_add_u32 s54, s54, 128
    s_cmp_eq_u32 s54, 1280
    s_cselect_b32 s54, 0, s54
    s_lshl_b32 s55, s54, 7
    v_mfma_f32_16x16x32_bf16 v[124:127], v[236:239], v[216:219], v[124:127]
    s_add_u32 m0, s44, 32768
    s_nop 0
    buffer_load_dwordx4 v243, s[16:19], s55 offen offset:0 sc1 lds
    v_mfma_f32_16x16x32_bf16 v[120:123], v[232:235], v[216:219], v[120:123]
    buffer_load_dwordx4 v243, s[16:19], s55 offen offset:1024 sc1 lds
    v_mfma_f32_16x16x32_bf16 v[116:119], v[228:231], v[216:219], v[116:119]
    s_add_u32 m0, s44, 34816
    s_nop 0
    buffer_load_dwordx4 v240, s[32:35], s54 offen offset:0 lds
    v_mfma_f32_16x16x32_bf16 v[112:115], v[224:227], v[216:219], v[112:115]
    ds_read_b128 v[216:219], v184 offset:6144
    buffer_load_dwordx4 v241, s[32:35], s54 offen offset:1024 lds
    v_mfma_f32_16x16x32_bf16 v[128:131], v[224:227], v[220:223], v[128:131]
    s_add_u32 m0, s44, 49152
    s_add_u32 s47, s55, 8192
    buffer_load_dwordx4 v243, s[16:19], s47 offen offset:0 sc1 lds
    v_mfma_f32_16x16x32_bf16 v[132:135], v[228:231], v[220:223], v[132:135]
    buffer_load_dwordx4 v243, s[16:19], s47 offen offset:1024 sc1 lds
    v_mfma_f32_16x16x32_bf16 v[136:139], v[232:235], v[220:223], v[136:139]
    s_add_u32 m0, s44, 51200
    s_add_u32 s47, s54, 81920
    buffer_load_dwordx4 v240, s[32:35], s47 offen offset:0 lds
    v_mfma_f32_16x16x32_bf16 v[140:143], v[236:239], v[220:223], v[140:143]
    ds_read_b128 v[220:223], v184 offset:8192
    buffer_load_dwordx4 v241, s[32:35], s47 offen offset:1024 lds
    s_add_u32 s54, s54, 128
    s_cmp_eq_u32 s54, 1280
    s_cselect_b32 s54, 0, s54
    s_lshl_b32 s55, s54, 7
    s_waitcnt lgkmcnt(3)
    v_mfma_f32_16x16x32_bf16 v[28:31], v[204:207], v[252:255], v[28:31]
    ds_read_b64_tr_b16 v[236:237], v189 offset:16384
    v_mfma_f32_16x16x32_bf16 v[24:27], v[200:203], v[252:255], v[24:27]
    ds_read_b64_tr_b16 v[238:239], v189 offset:18432
    v_mfma_f32_16x16x32_bf16 v[20:23], v[196:199], v[252:255], v[20:23]
    ds_read_b64_tr_b16 v[232:233], v188 offset:16384
    v_mfma_f32_16x16x32_bf16 v[16:19], v[192:195], v[252:255], v[16:19]
    ds_read_b128 v[252:255], v184 offset:10240
    v_mfma_f32_16x16x32_bf16 v[32:35], v[192:195], v[208:211], v[32:35]
    ds_read_b64_tr_b16 v[234:235], v188 offset:18432
    v_mfma_f32_16x16x32_bf16 v[36:39], v[196:199], v[208:211], v[36:39]
    ds_read_b64_tr_b16 v[228:229], v187 offset:16384
    v_mfma_f32_16x16x32_bf16 v[40:43], v[200:203], v[208:211], v[40:43]
    ds_read_b64_tr_b16 v[230:231], v187 offset:18432
    v_mfma_f32_16x16x32_bf16 v[44:47], v[204:207], v[208:211], v[44:47]
    ds_read_b128 v[208:211], v184 offset:12288
    s_waitcnt lgkmcnt(10)
    v_mfma_f32_16x16x32_bf16 v[60:63], v[204:207], v[212:215], v[60:63]
    ds_read_b64_tr_b16 v[224:225], v186 offset:16384
    v_mfma_f32_16x16x32_bf16 v[56:59], v[200:203], v[212:215], v[56:59]
    ds_read_b64_tr_b16 v[226:227], v186 offset:18432
    v_mfma_f32_16x16x32_bf16 v[52:55], v[196:199], v[212:215], v[52:55]
    v_mfma_f32_16x16x32_bf16 v[48:51], v[192:195], v[212:215], v[48:51]
    ds_read_b128 v[212:215], v184 offset:14336
    s_waitcnt lgkmcnt(12)
    v_mfma_f32_16x16x32_bf16 v[64:67], v[192:195], v[216:219], v[64:67]
    v_mfma_f32_16x16x32_bf16 v[68:71], v[196:199], v[216:219], v[68:71]
    v_mfma_f32_16x16x32_bf16 v[72:75], v[200:203], v[216:219], v[72:75]
    v_mfma_f32_16x16x32_bf16 v[76:79], v[204:207], v[216:219], v[76:79]
    ds_read_b128 v[216:219], v185 offset:0
    s_waitcnt lgkmcnt(12)
    v_mfma_f32_16x16x32_bf16 v[92:95], v[204:207], v[220:223], v[92:95]
    v_mfma_f32_16x16x32_bf16 v[88:91], v[200:203], v[220:223], v[88:91]
    v_mfma_f32_16x16x32_bf16 v[84:87], v[196:199], v[220:223], v[84:87]
    v_mfma_f32_16x16x32_bf16 v[80:83], v[192:195], v[220:223], v[80:83]
    ds_read_b128 v[220:223], v185 offset:2048
    s_waitcnt lgkmcnt(9)
    v_mfma_f32_16x16x32_bf16 v[96:99], v[192:195], v[252:255], v[96:99]
    v_mfma_f32_16x16x32_bf16 v[100:103], v[196:199], v[252:255], v[100:103]
    v_mfma_f32_16x16x32_bf16 v[104:107], v[200:203], v[252:255], v[104:107]
    v_mfma_f32_16x16x32_bf16 v[108:111], v[204:207], v[252:255], v[108:111]
    ds_read_b128 v[252:255], v185 offset:4096
    s_waitcnt lgkmcnt(6)
    v_mfma_f32_16x16x32_bf16 v[124:127], v[204:207], v[208:211], v[124:127]
    v_mfma_f32_16x16x32_bf16 v[120:123], v[200:203], v[208:211], v[120:123]
    v_mfma_f32_16x16x32_bf16 v[116:119], v[196:199], v[208:211], v[116:119]
    v_mfma_f32_16x16x32_bf16 v[112:115], v[192:195], v[208:211], v[112:115]
    ds_read_b128 v[208:211], v185 offset:6144
    s_waitcnt lgkmcnt(4)
    v_mfma_f32_16x16x32_bf16 v[128:131], v[192:195], v[212:215], v[128:131]
    v_mfma_f32_16x16x32_bf16 v[132:135], v[196:199], v[212:215], v[132:135]
    v_mfma_f32_16x16x32_bf16 v[136:139], v[200:203], v[212:215], v[136:139]
    v_mfma_f32_16x16x32_bf16 v[140:143], v[204:207], v[212:215], v[140:143]
    ds_read_b128 v[212:215], v185 offset:8192
    s_waitcnt lgkmcnt(4)
    v_mfma_f32_16x16x32_bf16 v[28:31], v[236:239], v[216:219], v[28:31]
    v_mfma_f32_16x16x32_bf16 v[24:27], v[232:235], v[216:219], v[24:27]
    v_mfma_f32_16x16x32_bf16 v[20:23], v[228:231], v[216:219], v[20:23]
    v_mfma_f32_16x16x32_bf16 v[16:19], v[224:227], v[216:219], v[16:19]
    ds_read_b128 v[216:219], v185 offset:10240
    s_waitcnt lgkmcnt(4)
    v_mfma_f32_16x16x32_bf16 v[32:35], v[224:227], v[220:223], v[32:35]
    v_mfma_f32_16x16x32_bf16 v[36:39], v[228:231], v[220:223], v[36:39]
    s_nop 1
    v_cvt_pk_bf16_f32 v16, v16, v17
    v_cvt_pk_bf16_f32 v17, v18, v19
    v_cvt_pk_bf16_f32 v18, v20, v21
    v_cvt_pk_bf16_f32 v19, v22, v23
    v_mfma_f32_16x16x32_bf16 v[40:43], v[232:235], v[220:223], v[40:43]
    v_cvt_pk_bf16_f32 v20, v24, v25
    v_cvt_pk_bf16_f32 v21, v26, v27
    v_cvt_pk_bf16_f32 v22, v28, v29
    v_cvt_pk_bf16_f32 v23, v30, v31
    v_mfma_f32_16x16x32_bf16 v[44:47], v[236:239], v[220:223], v[44:47]
    ds_read_b128 v[220:223], v185 offset:12288
    s_waitcnt lgkmcnt(4)
    v_mfma_f32_16x16x32_bf16 v[60:63], v[236:239], v[252:255], v[60:63]
    v_mfma_f32_16x16x32_bf16 v[56:59], v[232:235], v[252:255], v[56:59]
    v_cvt_pk_bf16_f32 v24, v32, v33
    v_cvt_pk_bf16_f32 v25, v34, v35
    v_cvt_pk_bf16_f32 v26, v36, v37
    v_cvt_pk_bf16_f32 v27, v38, v39
    v_mfma_f32_16x16x32_bf16 v[52:55], v[228:231], v[252:255], v[52:55]
    v_cvt_pk_bf16_f32 v28, v40, v41
    v_cvt_pk_bf16_f32 v29, v42, v43
    v_cvt_pk_bf16_f32 v30, v44, v45
    v_cvt_pk_bf16_f32 v31, v46, v47
    v_mfma_f32_16x16x32_bf16 v[48:51], v[224:227], v[252:255], v[48:51]
    ds_read_b128 v[252:255], v185 offset:14336
    s_waitcnt lgkmcnt(4)
    v_mfma_f32_16x16x32_bf16 v[64:67], v[224:227], v[208:211], v[64:67]
    v_mfma_f32_16x16x32_bf16 v[68:71], v[228:231], v[208:211], v[68:71]
    s_nop 1
    v_cvt_pk_bf16_f32 v32, v48, v49
    v_cvt_pk_bf16_f32 v33, v50, v51
    v_cvt_pk_bf16_f32 v34, v52, v53
    v_cvt_pk_bf16_f32 v35, v54, v55
    v_mfma_f32_16x16x32_bf16 v[72:75], v[232:235], v[208:211], v[72:75]
    v_cvt_pk_bf16_f32 v36, v56, v57
    v_cvt_pk_bf16_f32 v37, v58, v59
    v_cvt_pk_bf16_f32 v38, v60, v61
    v_cvt_pk_bf16_f32 v39, v62, v63
    v_mfma_f32_16x16x32_bf16 v[76:79], v[236:239], v[208:211], v[76:79]
    s_waitcnt vmcnt(8)
    s_waitcnt lgkmcnt(0)
    s_barrier
    v_mfma_f32_16x16x32_bf16 v[92:95], v[236:239], v[212:215], v[92:95]
    ds_read_b128 v[192:195], v244 offset:0
    ds_read_b64_tr_b16 v[196:197], v248 offset:0
    ds_read_b64_tr_b16 v[198:199], v248 offset:1024
    s_add_u32 m0, s44, 65536
    s_nop 0
    buffer_load_dwordx4 v243, s[16:19], s55 offen offset:0 sc1 lds
    v_mfma_f32_16x16x32_bf16 v[88:91], v[232:235], v[212:215], v[88:91]
    ds_read_b64_tr_b16 v[200:201], v249 offset:0
    ds_read_b64_tr_b16 v[202:203], v249 offset:1024
    buffer_load_dwordx4 v243, s[16:19], s55 offen offset:1024 sc1 lds
    v_cvt_pk_bf16_f32 v40, v64, v65
    v_cvt_pk_bf16_f32 v41, v66, v67
    v_cvt_pk_bf16_f32 v42, v68, v69
    v_cvt_pk_bf16_f32 v43, v70, v71
    v_mfma_f32_16x16x32_bf16 v[84:87], v[228:231], v[212:215], v[84:87]
    s_add_u32 m0, s44, 67584
    s_nop 0
    buffer_load_dwordx4 v240, s[32:35], s54 offen offset:0 lds
    v_cvt_pk_bf16_f32 v44, v72, v73
    v_cvt_pk_bf16_f32 v45, v74, v75
    v_cvt_pk_bf16_f32 v46, v76, v77
    v_cvt_pk_bf16_f32 v47, v78, v79
    v_mfma_f32_16x16x32_bf16 v[80:83], v[224:227], v[212:215], v[80:83]
    buffer_load_dwordx4 v241, s[32:35], s54 offen offset:1024 lds
    v_mfma_f32_16x16x32_bf16 v[96:99], v[224:227], v[216:219], v[96:99]
    ds_read_b128 v[204:207], v245 offset:0
    ds_read_b64_tr_b16 v[208:209], v248 offset:8192
    ds_read_b64_tr_b16 v[210:211], v248 offset:9216
    s_add_u32 m0, s44, 81920
    s_add_u32 s47, s55, 8192
    buffer_load_dwordx4 v243, s[16:19], s47 offen offset:0 sc1 lds
    v_mfma_f32_16x16x32_bf16 v[100:103], v[228:231], v[216:219], v[100:103]
    ds_read_b64_tr_b16 v[212:213], v249 offset:8192
    ds_read_b64_tr_b16 v[214:215], v249 offset:9216
    buffer_load_dwordx4 v243, s[16:19], s47 offen offset:1024 sc1 lds
    v_cvt_pk_bf16_f32 v48, v80, v81
    v_cvt_pk_bf16_f32 v49, v82, v83
    v_cvt_pk_bf16_f32 v50, v84, v85
    v_cvt_pk_bf16_f32 v51, v86, v87
    v_mfma_f32_16x16x32_bf16 v[104:107], v[232:235], v[216:219], v[104:107]
    s_add_u32 m0, s44, 83968
    s_add_u32 s47, s54, 81920
    buffer_load_dwordx4 v240, s[32:35], s47 offen offset:0 lds
    v_cvt_pk_bf16_f32 v52, v88, v89
    v_cvt_pk_bf16_f32 v53, v90, v91
    v_cvt_pk_bf16_f32 v54, v92, v93
    v_cvt_pk_bf16_f32 v55, v94, v95
    v_mfma_f32_16x16x32_bf16 v[108:111], v[236:239], v[216:219], v[108:111]
    buffer_load_dwordx4 v241, s[32:35], s47 offen offset:1024 lds
    s_add_u32 s54, s54, 128
    s_cmp_eq_u32 s54, 1280
    s_cselect_b32 s54, 0, s54
    s_lshl_b32 s55, s54, 7
    v_mfma_f32_16x16x32_bf16 v[124:127], v[236:239], v[220:223], v[124:127]
    ds_read_b128 v[216:219], v246 offset:0
    s_add_u32 m0, s44, 98304
    s_nop 0
    buffer_load_dwordx4 v243, s[16:19], s55 offen offset:0 sc1 lds
    v_mfma_f32_16x16x32_bf16 v[120:123], v[232:235], v[220:223], v[120:123]
    buffer_load_dwordx4 v243, s[16:19], s55 offen offset:1024 sc1 lds
    v_cvt_pk_bf16_f32 v56, v96, v97
    v_cvt_pk_bf16_f32 v57, v98, v99
    v_cvt_pk_bf16_f32 v58, v100, v101
    v_cvt_pk_bf16_f32 v59, v102, v103
    v_mfma_f32_16x16x32_bf16 v[116:119], v[228:231], v[220:223], v[116:119]
    s_add_u32 m0, s44, 100352
    s_nop 0
    buffer_load_dwordx4 v240, s[32:35], s54 offen offset:0 lds
    v_cvt_pk_bf16_f32 v60, v104, v105
    v_cvt_pk_bf16_f32 v61, v106, v107
    v_cvt_pk_bf16_f32 v62, v108, v109
    v_cvt_pk_bf16_f32 v63, v110, v111
    v_mfma_f32_16x16x32_bf16 v[112:115], v[224:227], v[220:223], v[112:115]
    buffer_load_dwordx4 v241, s[32:35], s54 offen offset:1024 lds
    v_mfma_f32_16x16x32_bf16 v[128:131], v[224:227], v[252:255], v[128:131]
    ds_read_b64_tr_b16 v[220:221], v248 offset:16384
    ds_read_b64_tr_b16 v[222:223], v248 offset:17408
    s_add_u32 m0, s44, 114688
    s_add_u32 s47, s55, 8192
    buffer_load_dwordx4 v243, s[16:19], s47 offen offset:0 sc1 lds
    v_mfma_f32_16x16x32_bf16 v[132:135], v[228:231], v[252:255], v[132:135]
    buffer_load_dwordx4 v243, s[16:19], s47 offen offset:1024 sc1 lds
    v_cvt_pk_bf16_f32 v64, v112, v113
    v_cvt_pk_bf16_f32 v65, v114, v115
    v_cvt_pk_bf16_f32 v66, v116, v117
    v_cvt_pk_bf16_f32 v67, v118, v119
    v_mfma_f32_16x16x32_bf16 v[136:139], v[232:235], v[252:255], v[136:139]
    s_add_u32 m0, s44, 116736
    s_add_u32 s47, s54, 81920
    buffer_load_dwordx4 v240, s[32:35], s47 offen offset:0 lds
    v_cvt_pk_bf16_f32 v68, v120, v121
    v_cvt_pk_bf16_f32 v69, v122, v123
    v_cvt_pk_bf16_f32 v70, v124, v125
    v_cvt_pk_bf16_f32 v71, v126, v127
    v_mfma_f32_16x16x32_bf16 v[140:143], v[236:239], v[252:255], v[140:143]
    ds_read_b64_tr_b16 v[224:225], v249 offset:16384
    ds_read_b64_tr_b16 v[226:227], v249 offset:17408
    ds_read_b128 v[228:231], v247 offset:0
    ds_read_b64_tr_b16 v[232:233], v248 offset:24576
    ds_read_b64_tr_b16 v[234:235], v248 offset:25600
    ds_read_b64_tr_b16 v[236:237], v249 offset:24576
    ds_read_b64_tr_b16 v[238:239], v249 offset:25600
    buffer_load_dwordx4 v241, s[32:35], s47 offen offset:1024 lds
    s_add_u32 s54, s54, 128
    s_cmp_eq_u32 s54, 1280
    s_cselect_b32 s54, 0, s54
    s_lshl_b32 s55, s54, 7
    v_cvt_pk_bf16_f32 v72, v128, v129
    v_cvt_pk_bf16_f32 v73, v130, v131
    v_cvt_pk_bf16_f32 v74, v132, v133
    v_cvt_pk_bf16_f32 v75, v134, v135
    v_cvt_pk_bf16_f32 v76, v136, v137
    v_cvt_pk_bf16_f32 v77, v138, v139
    v_cvt_pk_bf16_f32 v78, v140, v141
    v_cvt_pk_bf16_f32 v79, v142, v143
    s_branch mg_a1_r0
mg_gv_r0:
    s_waitcnt lgkmcnt(4)
    v_mfma_f32_16x16x32_bf16 v[40:43], v[216:219], v[204:207], 0
    ds_read_b64_tr_b16 v[236:237], v189 offset:16384
    v_mfma_f32_16x16x32_bf16 v[32:35], v[216:219], v[200:203], 0
    ds_read_b64_tr_b16 v[238:239], v189 offset:18432
    v_mfma_f32_16x16x32_bf16 v[24:27], v[216:219], v[196:199], 0
    ds_read_b64_tr_b16 v[232:233], v188 offset:16384
    v_mfma_f32_16x16x32_bf16 v[16:19], v[216:219], v[192:195], 0
    ds_read_b128 v[216:219], v184 offset:10240
    s_waitcnt lgkmcnt(7)
    v_mfma_f32_16x16x32_bf16 v[20:23], v[220:223], v[192:195], 0
    ds_read_b64_tr_b16 v[234:235], v188 offset:18432
    v_mfma_f32_16x16x32_bf16 v[28:31], v[220:223], v[196:199], 0
    ds_read_b64_tr_b16 v[228:229], v187 offset:16384
    v_mfma_f32_16x16x32_bf16 v[36:39], v[220:223], v[200:203], 0
    ds_read_b64_tr_b16 v[230:231], v187 offset:18432
    v_mfma_f32_16x16x32_bf16 v[44:47], v[220:223], v[204:207], 0
    ds_read_b128 v[220:223], v184 offset:12288
    s_waitcnt lgkmcnt(10)
    v_mfma_f32_16x16x32_bf16 v[72:75], v[252:255], v[204:207], 0
    ds_read_b64_tr_b16 v[224:225], v186 offset:16384
    v_mfma_f32_16x16x32_bf16 v[64:67], v[252:255], v[200:203], 0
    ds_read_b64_tr_b16 v[226:227], v186 offset:18432
    v_mfma_f32_16x16x32_bf16 v[56:59], v[252:255], v[196:199], 0
    v_mfma_f32_16x16x32_bf16 v[48:51], v[252:255], v[192:195], 0
    ds_read_b128 v[252:255], v184 offset:14336
    s_waitcnt lgkmcnt(12)
    v_mfma_f32_16x16x32_bf16 v[52:55], v[208:211], v[192:195], 0
    v_mfma_f32_16x16x32_bf16 v[60:63], v[208:211], v[196:199], 0
    v_mfma_f32_16x16x32_bf16 v[68:71], v[208:211], v[200:203], 0
    v_mfma_f32_16x16x32_bf16 v[76:79], v[208:211], v[204:207], 0
    ds_read_b128 v[208:211], v185 offset:0
    s_waitcnt lgkmcnt(12)
    v_mfma_f32_16x16x32_bf16 v[104:107], v[212:215], v[204:207], 0
    v_mfma_f32_16x16x32_bf16 v[96:99], v[212:215], v[200:203], 0
    v_mfma_f32_16x16x32_bf16 v[88:91], v[212:215], v[196:199], 0
    v_mfma_f32_16x16x32_bf16 v[80:83], v[212:215], v[192:195], 0
    ds_read_b128 v[212:215], v185 offset:2048
    s_waitcnt lgkmcnt(9)
    v_mfma_f32_16x16x32_bf16 v[84:87], v[216:219], v[192:195], 0
    v_mfma_f32_16x16x32_bf16 v[92:95], v[216:219], v[196:199], 0
    v_mfma_f32_16x16x32_bf16 v[100:103], v[216:219], v[200:203], 0
    v_mfma_f32_16x16x32_bf16 v[108:111], v[216:219], v[204:207], 0
    ds_read_b128 v[216:219], v185 offset:4096
    s_waitcnt lgkmcnt(6)
    v_mfma_f32_16x16x32_bf16 v[136:139], v[220:223], v[204:207], 0
    s_mul_i32 s13, s63, 1600
    s_add_u32 s40, s8, s13
    s_addc_u32 s41, s9, 0
    s_and_b32 s41, s41, 0xffff
    s_mov_b32 s42, 1600
    s_mov_b32 s43, 0x20000
    v_mfma_f32_16x16x32_bf16 v[128:131], v[220:223], v[200:203], 0
    s_lshl_b32 s13, s12, 10
    s_min_u32 s14, s13, 2048
    v_mfma_f32_16x16x32_bf16 v[120:123], v[220:223], v[196:199], 0
    s_add_u32 m0, s14, 159744
    s_nop 0
    v_mfma_f32_16x16x32_bf16 v[112:115], v[220:223], v[192:195], 0
    ds_read_b128 v[220:223], v185 offset:6144
    s_waitcnt lgkmcnt(4)
    v_mfma_f32_16x16x32_bf16 v[116:119], v[252:255], v[192:195], 0
    buffer_load_dwordx4 v1, s[40:43], s13 offen lds
    v_mfma_f32_16x16x32_bf16 v[124:127], v[252:255], v[196:199], 0
    v_mfma_f32_16x16x32_bf16 v[132:135], v[252:255], v[200:203], 0
    v_mfma_f32_16x16x32_bf16 v[140:143], v[252:255], v[204:207], 0
    ds_read_b128 v[252:255], v185 offset:8192
    s_waitcnt lgkmcnt(4)
    v_mfma_f32_16x16x32_bf16 v[40:43], v[208:211], v[236:239], v[40:43]
    v_mfma_f32_16x16x32_bf16 v[32:35], v[208:211], v[232:235], v[32:35]
    v_mfma_f32_16x16x32_bf16 v[24:27], v[208:211], v[228:231], v[24:27]
    v_mfma_f32_16x16x32_bf16 v[16:19], v[208:211], v[224:227], v[16:19]
    ds_read_b128 v[208:211], v185 offset:10240
    s_waitcnt lgkmcnt(4)
    v_mfma_f32_16x16x32_bf16 v[20:23], v[212:215], v[224:227], v[20:23]
    v_mfma_f32_16x16x32_bf16 v[28:31], v[212:215], v[228:231], v[28:31]
    v_mfma_f32_16x16x32_bf16 v[36:39], v[212:215], v[232:235], v[36:39]
    v_mfma_f32_16x16x32_bf16 v[44:47], v[212:215], v[236:239], v[44:47]
    ds_read_b128 v[212:215], v185 offset:12288
    s_waitcnt lgkmcnt(4)
    v_mfma_f32_16x16x32_bf16 v[72:75], v[216:219], v[236:239], v[72:75]
    s_lshl_b32 s13, s62, 3
    s_and_b32 s14, s12, 3
    s_add_u32 s13, s13, s14
    s_mul_i32 s13, s13, 20480
    v_lshrrev_b32 v8, 3, v0
    v_mul_u32_u24 v8, 1280, v8
    v_and_b32 v9, 7, v0
    v_lshrrev_b32 v11, 4, v0
    v_mfma_f32_16x16x32_bf16 v[64:67], v[216:219], v[232:235], v[64:67]
    v_xor_b32 v9, v9, v11
    v_lshlrev_b32 v9, 4, v9
    v_add3_u32 v240, v8, v9, s13
    v_xor_b32 v9, 64, v9
    s_add_u32 s13, s13, 9216
    v_add3_u32 v241, v8, v9, s13
    s_mul_i32 s55, s63, 163840
    s_lshl_b32 s13, s14, 11
    v_mfma_f32_16x16x32_bf16 v[56:59], v[216:219], v[228:231], v[56:59]
    s_add_u32 s55, s55, s13
    s_add_u32 s55, s55, 79691776
    v_add_u32 v243, s55, v1
    s_bfe_u32 s13, s2, 0x20003
    s_mul_i32 s13, s13, 5
    s_lshr_b32 s13, s13, 1
    s_lshr_b32 s54, s2, 5
    s_add_u32 s54, s54, s13
    v_mfma_f32_16x16x32_bf16 v[48:51], v[216:219], v[224:227], v[48:51]
    ds_read_b128 v[216:219], v185 offset:14336
    s_waitcnt lgkmcnt(4)
    v_mfma_f32_16x16x32_bf16 v[52:55], v[220:223], v[224:227], v[52:55]
    s_sub_u32 s13, s54, 10
    s_cselect_b32 s54, s54, s13
    s_lshl_b32 s54, s54, 7
    s_lshl_b32 s55, s54, 7
    s_lshl_b32 s64, s64, 10
    s_mul_i32 s13, s63, 163840
    s_add_u32 s64, s64, s13
    s_add_u32 s64, s64, 79691776
    s_add_u32 s65, s64, 8192
    v_mfma_f32_16x16x32_bf16 v[60:63], v[220:223], v[228:231], v[60:63]
    s_cmp_lt_u32 s12, 2
    s_cselect_b32 s65, s65, 2147418112
    s_lshl_b32 s13, s63, 4
    s_add_u32 s13, s13, s62
    s_lshl_b32 s13, s13, 2
    s_add_u32 s13, s13, s12
    s_lshl_b32 s13, s13, 10
    s_add_u32 s13, s13, 58716160
    s_sub_u32 s66, 0, s15
    v_mfma_f32_16x16x32_bf16 v[68:71], v[220:223], v[232:235], v[68:71]
    s_cmp_eq_u32 s15, 0
    s_cselect_b32 s65, s65, s13
    s_lshl_b32 s67, s63, 2
    v_mov_b32 v5, 0x10000
    v_mfma_f32_16x16x32_bf16 v[76:79], v[220:223], v[236:239], v[76:79]
    s_waitcnt vmcnt(3)
    s_waitcnt lgkmcnt(0)
    v_xor_b32 v184, 65536, v184
    v_xor_b32 v185, 65536, v185
    v_xor_b32 v186, 0x10000, v186
    v_xor_b32 v187, 0x10000, v187
    v_xor_b32 v188, 0x10000, v188
    v_xor_b32 v189, 0x10000, v189
    s_barrier
    v_mfma_f32_16x16x32_bf16 v[104:107], v[252:255], v[236:239], v[104:107]
    ds_read_b64_tr_b16 v[204:205], v189 offset:0
    ds_read_b64_tr_b16 v[206:207], v189 offset:2048
    s_add_u32 m0, s44, 0
    s_nop 0
    buffer_load_dwordx4 v176, s[24:27], s45 offen offset:0 lds
    v_mfma_f32_16x16x32_bf16 v[96:99], v[252:255], v[232:235], v[96:99]
    ds_read_b128 v[220:223], v184 offset:0
    ds_read_b64_tr_b16 v[200:201], v188 offset:0
    buffer_load_dwordx4 v177, s[24:27], s45 offen offset:1024 lds
    v_mfma_f32_16x16x32_bf16 v[88:91], v[252:255], v[228:231], v[88:91]
    ds_read_b64_tr_b16 v[202:203], v188 offset:2048
    ds_read_b64_tr_b16 v[196:197], v187 offset:0
    buffer_load_dwordx4 v178, s[24:27], s45 offen offset:2048 lds
    v_mfma_f32_16x16x32_bf16 v[80:83], v[252:255], v[224:227], v[80:83]
    ds_read_b64_tr_b16 v[198:199], v187 offset:2048
    ds_read_b128 v[252:255], v184 offset:2048
    buffer_load_dwordx4 v179, s[24:27], s45 offen offset:3072 lds
    v_mfma_f32_16x16x32_bf16 v[84:87], v[208:211], v[224:227], v[84:87]
    ds_read_b64_tr_b16 v[192:193], v186 offset:0
    ds_read_b64_tr_b16 v[194:195], v186 offset:2048
    s_add_u32 m0, s44, 16384
    s_add_u32 s47, s45, 65536
    buffer_load_dwordx4 v176, s[24:27], s47 offen offset:0 lds
    v_mfma_f32_16x16x32_bf16 v[92:95], v[208:211], v[228:231], v[92:95]
    buffer_load_dwordx4 v177, s[24:27], s47 offen offset:1024 lds
    v_mfma_f32_16x16x32_bf16 v[100:103], v[208:211], v[232:235], v[100:103]
    buffer_load_dwordx4 v178, s[24:27], s47 offen offset:2048 lds
    v_mfma_f32_16x16x32_bf16 v[108:111], v[208:211], v[236:239], v[108:111]
    ds_read_b128 v[208:211], v184 offset:4096
    buffer_load_dwordx4 v179, s[24:27], s47 offen offset:3072 lds
    s_add_u32 s45, s45, 128
    s_and_b32 s45, s45, 1023
    v_mfma_f32_16x16x32_bf16 v[136:139], v[212:215], v[236:239], v[136:139]
    s_add_u32 m0, s44, 32768
    s_nop 0
    buffer_load_dwordx4 v180, s[28:31], s46 offen offset:0 lds
    v_mfma_f32_16x16x32_bf16 v[128:131], v[212:215], v[232:235], v[128:131]
    buffer_load_dwordx4 v181, s[28:31], s46 offen offset:1024 lds
    v_mfma_f32_16x16x32_bf16 v[120:123], v[212:215], v[228:231], v[120:123]
    buffer_load_dwordx4 v182, s[28:31], s46 offen offset:2048 lds
    v_mfma_f32_16x16x32_bf16 v[112:115], v[212:215], v[224:227], v[112:115]
    ds_read_b128 v[212:215], v184 offset:6144
    buffer_load_dwordx4 v183, s[28:31], s46 offen offset:3072 lds
    v_mfma_f32_16x16x32_bf16 v[116:119], v[216:219], v[224:227], v[116:119]
    s_add_u32 m0, s44, 49152
    s_add_u32 s47, s46, 262144
    buffer_load_dwordx4 v180, s[28:31], s47 offen offset:0 lds
    v_mfma_f32_16x16x32_bf16 v[124:127], v[216:219], v[228:231], v[124:127]
    buffer_load_dwordx4 v181, s[28:31], s47 offen offset:1024 lds
    v_mfma_f32_16x16x32_bf16 v[132:135], v[216:219], v[232:235], v[132:135]
    buffer_load_dwordx4 v182, s[28:31], s47 offen offset:2048 lds
    v_mfma_f32_16x16x32_bf16 v[140:143], v[216:219], v[236:239], v[140:143]
    ds_read_b128 v[216:219], v184 offset:8192
    buffer_load_dwordx4 v183, s[28:31], s47 offen offset:3072 lds
    s_add_u32 s46, s46, 524288
    s_and_b32 s46, s46, 0x3fffff
    s_waitcnt lgkmcnt(3)
    v_mfma_f32_16x16x32_bf16 v[40:43], v[220:223], v[204:207], v[40:43]
    ds_read_b64_tr_b16 v[236:237], v189 offset:16384
    v_mfma_f32_16x16x32_bf16 v[32:35], v[220:223], v[200:203], v[32:35]
    ds_read_b64_tr_b16 v[238:239], v189 offset:18432
    v_mfma_f32_16x16x32_bf16 v[24:27], v[220:223], v[196:199], v[24:27]
    ds_read_b64_tr_b16 v[232:233], v188 offset:16384
    v_mfma_f32_16x16x32_bf16 v[16:19], v[220:223], v[192:195], v[16:19]
    ds_read_b128 v[220:223], v184 offset:10240
    v_mfma_f32_16x16x32_bf16 v[20:23], v[252:255], v[192:195], v[20:23]
    ds_read_b64_tr_b16 v[234:235], v188 offset:18432
    v_mfma_f32_16x16x32_bf16 v[28:31], v[252:255], v[196:199], v[28:31]
    ds_read_b64_tr_b16 v[228:229], v187 offset:16384
    v_mfma_f32_16x16x32_bf16 v[36:39], v[252:255], v[200:203], v[36:39]
    ds_read_b64_tr_b16 v[230:231], v187 offset:18432
    v_mfma_f32_16x16x32_bf16 v[44:47], v[252:255], v[204:207], v[44:47]
    ds_read_b128 v[252:255], v184 offset:12288
    s_waitcnt lgkmcnt(10)
    v_mfma_f32_16x16x32_bf16 v[72:75], v[208:211], v[204:207], v[72:75]
    ds_read_b64_tr_b16 v[224:225], v186 offset:16384
    s_waitcnt vmcnt(17)
    v_mfma_f32_16x16x32_bf16 v[64:67], v[208:211], v[200:203], v[64:67]
    ds_read_b64_tr_b16 v[226:227], v186 offset:18432
    buffer_store_dwordx4 v[144:147], v1, s[16:19], s64 offen sc1
    v_mfma_f32_16x16x32_bf16 v[56:59], v[208:211], v[196:199], v[56:59]
    v_or_b32 v148, s66, v148
    v_mfma_f32_16x16x32_bf16 v[48:51], v[208:211], v[192:195], v[48:51]
    ds_read_b128 v[208:211], v184 offset:14336
    s_waitcnt lgkmcnt(12)
    v_mfma_f32_16x16x32_bf16 v[52:55], v[212:215], v[192:195], v[52:55]
    v_or_b32 v149, s66, v149
    v_mfma_f32_16x16x32_bf16 v[60:63], v[212:215], v[196:199], v[60:63]
    v_or_b32 v150, s66, v150
    v_mfma_f32_16x16x32_bf16 v[68:71], v[212:215], v[200:203], v[68:71]
    v_or_b32 v151, s66, v151
    v_mfma_f32_16x16x32_bf16 v[76:79], v[212:215], v[204:207], v[76:79]
    ds_read_b128 v[212:215], v185 offset:0
    s_waitcnt lgkmcnt(12)
    v_mfma_f32_16x16x32_bf16 v[104:107], v[216:219], v[204:207], v[104:107]
    v_mfma_f32_16x16x32_bf16 v[96:99], v[216:219], v[200:203], v[96:99]
    v_mfma_f32_16x16x32_bf16 v[88:91], v[216:219], v[196:199], v[88:91]
    v_mfma_f32_16x16x32_bf16 v[80:83], v[216:219], v[192:195], v[80:83]
    ds_read_b128 v[216:219], v185 offset:2048
    s_waitcnt lgkmcnt(9)
    v_mfma_f32_16x16x32_bf16 v[84:87], v[220:223], v[192:195], v[84:87]
    v_mfma_f32_16x16x32_bf16 v[92:95], v[220:223], v[196:199], v[92:95]
    v_mfma_f32_16x16x32_bf16 v[100:103], v[220:223], v[200:203], v[100:103]
    v_mfma_f32_16x16x32_bf16 v[108:111], v[220:223], v[204:207], v[108:111]
    ds_read_b128 v[220:223], v185 offset:4096
    s_waitcnt lgkmcnt(6)
    v_mfma_f32_16x16x32_bf16 v[136:139], v[252:255], v[204:207], v[136:139]
    buffer_store_dwordx4 v[148:151], v1, s[16:19], s65 offen sc1
    v_mfma_f32_16x16x32_bf16 v[128:131], v[252:255], v[200:203], v[128:131]
    v_mfma_f32_16x16x32_bf16 v[120:123], v[252:255], v[196:199], v[120:123]
    v_mfma_f32_16x16x32_bf16 v[112:115], v[252:255], v[192:195], v[112:115]
    ds_read_b128 v[252:255], v185 offset:6144
    s_waitcnt lgkmcnt(4)
    v_mfma_f32_16x16x32_bf16 v[116:119], v[208:211], v[192:195], v[116:119]
    v_mfma_f32_16x16x32_bf16 v[124:127], v[208:211], v[196:199], v[124:127]
    v_mfma_f32_16x16x32_bf16 v[132:135], v[208:211], v[200:203], v[132:135]
    v_mfma_f32_16x16x32_bf16 v[140:143], v[208:211], v[204:207], v[140:143]
    ds_read_b128 v[208:211], v185 offset:8192
    s_waitcnt lgkmcnt(4)
    v_mfma_f32_16x16x32_bf16 v[40:43], v[212:215], v[236:239], v[40:43]
    v_mfma_f32_16x16x32_bf16 v[32:35], v[212:215], v[232:235], v[32:35]
    v_mfma_f32_16x16x32_bf16 v[24:27], v[212:215], v[228:231], v[24:27]
    v_mfma_f32_16x16x32_bf16 v[16:19], v[212:215], v[224:227], v[16:19]
    ds_read_b128 v[212:215], v185 offset:10240
    s_waitcnt lgkmcnt(4)
    v_mfma_f32_16x16x32_bf16 v[20:23], v[216:219], v[224:227], v[20:23]
    v_mfma_f32_16x16x32_bf16 v[28:31], v[216:219], v[228:231], v[28:31]
    v_mfma_f32_16x16x32_bf16 v[36:39], v[216:219], v[232:235], v[36:39]
    v_mfma_f32_16x16x32_bf16 v[44:47], v[216:219], v[236:239], v[44:47]
    ds_read_b128 v[216:219], v185 offset:12288
    s_waitcnt lgkmcnt(4)
    v_mfma_f32_16x16x32_bf16 v[72:75], v[220:223], v[236:239], v[72:75]
    v_mfma_f32_16x16x32_bf16 v[64:67], v[220:223], v[232:235], v[64:67]
    v_mfma_f32_16x16x32_bf16 v[56:59], v[220:223], v[228:231], v[56:59]
    v_mfma_f32_16x16x32_bf16 v[48:51], v[220:223], v[224:227], v[48:51]
    ds_read_b128 v[220:223], v185 offset:14336
    s_waitcnt lgkmcnt(4)
    v_mfma_f32_16x16x32_bf16 v[52:55], v[252:255], v[224:227], v[52:55]
    v_mfma_f32_16x16x32_bf16 v[60:63], v[252:255], v[228:231], v[60:63]
    v_mfma_f32_16x16x32_bf16 v[68:71], v[252:255], v[232:235], v[68:71]
    v_mfma_f32_16x16x32_bf16 v[76:79], v[252:255], v[236:239], v[76:79]
    s_waitcnt vmcnt(2)
    s_waitcnt lgkmcnt(0)
    v_xor_b32 v184, 65536, v184
    v_xor_b32 v185, 65536, v185
    v_xor_b32 v186, 0x10000, v186
    v_xor_b32 v187, 0x10000, v187
    v_xor_b32 v188, 0x10000, v188
    v_xor_b32 v189, 0x10000, v189
    s_barrier
    v_mfma_f32_16x16x32_bf16 v[104:107], v[208:211], v[236:239], v[104:107]
    ds_read_b64_tr_b16 v[204:205], v189 offset:0
    ds_read_b64_tr_b16 v[206:207], v189 offset:2048
    s_add_u32 m0, s44, 65536
    s_nop 0
    buffer_load_dwordx4 v176, s[24:27], s45 offen offset:0 lds
    v_mfma_f32_16x16x32_bf16 v[96:99], v[208:211], v[232:235], v[96:99]
    ds_read_b128 v[252:255], v184 offset:0
    ds_read_b64_tr_b16 v[200:201], v188 offset:0
    buffer_load_dwordx4 v177, s[24:27], s45 offen offset:1024 lds
    v_mfma_f32_16x16x32_bf16 v[88:91], v[208:211], v[228:231], v[88:91]
    ds_read_b64_tr_b16 v[202:203], v188 offset:2048
    ds_read_b64_tr_b16 v[196:197], v187 offset:0
    buffer_load_dwordx4 v178, s[24:27], s45 offen offset:2048 lds
    v_mfma_f32_16x16x32_bf16 v[80:83], v[208:211], v[224:227], v[80:83]
    ds_read_b64_tr_b16 v[198:199], v187 offset:2048
    ds_read_b128 v[208:211], v184 offset:2048
    buffer_load_dwordx4 v179, s[24:27], s45 offen offset:3072 lds
    v_mfma_f32_16x16x32_bf16 v[84:87], v[212:215], v[224:227], v[84:87]
    ds_read_b64_tr_b16 v[192:193], v186 offset:0
    ds_read_b64_tr_b16 v[194:195], v186 offset:2048
    s_add_u32 m0, s44, 81920
    s_add_u32 s47, s45, 65536
    buffer_load_dwordx4 v176, s[24:27], s47 offen offset:0 lds
    v_mfma_f32_16x16x32_bf16 v[92:95], v[212:215], v[228:231], v[92:95]
    buffer_load_dwordx4 v177, s[24:27], s47 offen offset:1024 lds
    v_mfma_f32_16x16x32_bf16 v[100:103], v[212:215], v[232:235], v[100:103]
    buffer_load_dwordx4 v178, s[24:27], s47 offen offset:2048 lds
    v_mfma_f32_16x16x32_bf16 v[108:111], v[212:215], v[236:239], v[108:111]
    ds_read_b128 v[212:215], v184 offset:4096
    buffer_load_dwordx4 v179, s[24:27], s47 offen offset:3072 lds
    s_add_u32 s45, s45, 128
    s_and_b32 s45, s45, 1023
    v_mfma_f32_16x16x32_bf16 v[136:139], v[216:219], v[236:239], v[136:139]
    s_add_u32 m0, s44, 98304
    s_nop 0
    buffer_load_dwordx4 v180, s[28:31], s46 offen offset:0 lds
    v_mfma_f32_16x16x32_bf16 v[128:131], v[216:219], v[232:235], v[128:131]
    buffer_load_dwordx4 v181, s[28:31], s46 offen offset:1024 lds
    v_mfma_f32_16x16x32_bf16 v[120:123], v[216:219], v[228:231], v[120:123]
    buffer_load_dwordx4 v182, s[28:31], s46 offen offset:2048 lds
    v_mfma_f32_16x16x32_bf16 v[112:115], v[216:219], v[224:227], v[112:115]
    ds_read_b128 v[216:219], v184 offset:6144
    buffer_load_dwordx4 v183, s[28:31], s46 offen offset:3072 lds
    v_mfma_f32_16x16x32_bf16 v[116:119], v[220:223], v[224:227], v[116:119]
    s_add_u32 m0, s44, 114688
    s_add_u32 s47, s46, 262144
    buffer_load_dwordx4 v180, s[28:31], s47 offen offset:0 lds
    v_mfma_f32_16x16x32_bf16 v[124:127], v[220:223], v[228:231], v[124:127]
    buffer_load_dwordx4 v181, s[28:31], s47 offen offset:1024 lds
    v_mfma_f32_16x16x32_bf16 v[132:135], v[220:223], v[232:235], v[132:135]
    buffer_load_dwordx4 v182, s[28:31], s47 offen offset:2048 lds
    v_mfma_f32_16x16x32_bf16 v[140:143], v[220:223], v[236:239], v[140:143]
    ds_read_b128 v[220:223], v184 offset:8192
    buffer_load_dwordx4 v183, s[28:31], s47 offen offset:3072 lds
    s_add_u32 s46, s46, 524288
    s_and_b32 s46, s46, 0x3fffff
    s_waitcnt lgkmcnt(3)
    v_mfma_f32_16x16x32_bf16 v[40:43], v[252:255], v[204:207], v[40:43]
    ds_read_b64_tr_b16 v[236:237], v189 offset:16384
    v_mfma_f32_16x16x32_bf16 v[32:35], v[252:255], v[200:203], v[32:35]
    ds_read_b64_tr_b16 v[238:239], v189 offset:18432
    v_mfma_f32_16x16x32_bf16 v[24:27], v[252:255], v[196:199], v[24:27]
    ds_read_b64_tr_b16 v[232:233], v188 offset:16384
    v_mfma_f32_16x16x32_bf16 v[16:19], v[252:255], v[192:195], v[16:19]
    ds_read_b128 v[252:255], v184 offset:10240
    v_mfma_f32_16x16x32_bf16 v[20:23], v[208:211], v[192:195], v[20:23]
    ds_read_b64_tr_b16 v[234:235], v188 offset:18432
    v_mfma_f32_16x16x32_bf16 v[28:31], v[208:211], v[196:199], v[28:31]
    ds_read_b64_tr_b16 v[228:229], v187 offset:16384
    v_mfma_f32_16x16x32_bf16 v[36:39], v[208:211], v[200:203], v[36:39]
    ds_read_b64_tr_b16 v[230:231], v187 offset:18432
    v_mfma_f32_16x16x32_bf16 v[44:47], v[208:211], v[204:207], v[44:47]
    ds_read_b128 v[208:211], v184 offset:12288
    s_waitcnt lgkmcnt(10)
    v_mfma_f32_16x16x32_bf16 v[72:75], v[212:215], v[204:207], v[72:75]
    ds_read_b64_tr_b16 v[224:225], v186 offset:16384
    s_and_b32 s13, s2, 3
    s_lshl_b32 s13, s13, 8
    v_mfma_f32_16x16x32_bf16 v[64:67], v[212:215], v[200:203], v[64:67]
    ds_read_b64_tr_b16 v[226:227], v186 offset:18432
    s_andn2_b32 s14, s2, 3
    s_add_u32 s13, s13, s14
    v_mfma_f32_16x16x32_bf16 v[56:59], v[212:215], v[196:199], v[56:59]
    s_lshl_b32 s13, s13, 1
    s_add_u32 s13, s13, s12
    v_mfma_f32_16x16x32_bf16 v[48:51], v[212:215], v[192:195], v[48:51]
    ds_read_b128 v[212:215], v184 offset:14336
    s_waitcnt lgkmcnt(12)
    v_mfma_f32_16x16x32_bf16 v[52:55], v[216:219], v[192:195], v[52:55]
    s_mul_i32 s13, s13, 1280
    buffer_load_dword v166, v167, s[32:35], s13 offen
    v_mfma_f32_16x16x32_bf16 v[60:63], v[216:219], v[196:199], v[60:63]
    v_mfma_f32_16x16x32_bf16 v[68:71], v[216:219], v[200:203], v[68:71]
    v_mfma_f32_16x16x32_bf16 v[76:79], v[216:219], v[204:207], v[76:79]
    ds_read_b128 v[216:219], v185 offset:0
    s_waitcnt lgkmcnt(12)
    v_mfma_f32_16x16x32_bf16 v[104:107], v[220:223], v[204:207], v[104:107]
    v_mfma_f32_16x16x32_bf16 v[96:99], v[220:223], v[200:203], v[96:99]
    v_mfma_f32_16x16x32_bf16 v[88:91], v[220:223], v[196:199], v[88:91]
    v_mfma_f32_16x16x32_bf16 v[80:83], v[220:223], v[192:195], v[80:83]
    ds_read_b128 v[220:223], v185 offset:2048
    s_waitcnt lgkmcnt(9)
    v_mfma_f32_16x16x32_bf16 v[84:87], v[252:255], v[192:195], v[84:87]
    v_mfma_f32_16x16x32_bf16 v[92:95], v[252:255], v[196:199], v[92:95]
    v_mfma_f32_16x16x32_bf16 v[100:103], v[252:255], v[200:203], v[100:103]
    v_mfma_f32_16x16x32_bf16 v[108:111], v[252:255], v[204:207], v[108:111]
    ds_read_b128 v[252:255], v185 offset:4096
    s_waitcnt lgkmcnt(6)
    v_mfma_f32_16x16x32_bf16 v[136:139], v[208:211], v[204:207], v[136:139]
    v_mfma_f32_16x16x32_bf16 v[128:131], v[208:211], v[200:203], v[128:131]
    v_mfma_f32_16x16x32_bf16 v[120:123], v[208:211], v[196:199], v[120:123]
    v_mfma_f32_16x16x32_bf16 v[112:115], v[208:211], v[192:195], v[112:115]
    ds_read_b128 v[208:211], v185 offset:6144
    s_waitcnt lgkmcnt(4)
    v_mfma_f32_16x16x32_bf16 v[116:119], v[212:215], v[192:195], v[116:119]
    v_mfma_f32_16x16x32_bf16 v[124:127], v[212:215], v[196:199], v[124:127]
    v_mfma_f32_16x16x32_bf16 v[132:135], v[212:215], v[200:203], v[132:135]
    v_mfma_f32_16x16x32_bf16 v[140:143], v[212:215], v[204:207], v[140:143]
    ds_read_b128 v[212:215], v185 offset:8192
    s_waitcnt lgkmcnt(4)
    v_mfma_f32_16x16x32_bf16 v[40:43], v[216:219], v[236:239], v[40:43]
    v_mfma_f32_16x16x32_bf16 v[32:35], v[216:219], v[232:235], v[32:35]
    v_mfma_f32_16x16x32_bf16 v[24:27], v[216:219], v[228:231], v[24:27]
    v_mfma_f32_16x16x32_bf16 v[16:19], v[216:219], v[224:227], v[16:19]
    ds_read_b128 v[216:219], v185 offset:10240
    s_waitcnt lgkmcnt(4)
    v_mfma_f32_16x16x32_bf16 v[20:23], v[220:223], v[224:227], v[20:23]
    v_mfma_f32_16x16x32_bf16 v[28:31], v[220:223], v[228:231], v[28:31]
    v_mfma_f32_16x16x32_bf16 v[36:39], v[220:223], v[232:235], v[36:39]
    v_mfma_f32_16x16x32_bf16 v[44:47], v[220:223], v[236:239], v[44:47]
    ds_read_b128 v[220:223], v185 offset:12288
    s_waitcnt lgkmcnt(4)
    v_mfma_f32_16x16x32_bf16 v[72:75], v[252:255], v[236:239], v[72:75]
    s_and_b32 s13, s12, 3
    s_lshl_b32 s13, s13, 13
    s_add_u32 s13, s13, 2048
    v_mfma_f32_16x16x32_bf16 v[64:67], v[252:255], v[232:235], v[64:67]
    v_bfe_u32 v8, v0, 4, 1
    v_lshlrev_b32 v8, 12, v8
    v_and_b32 v9, 15, v0
    v_mfma_f32_16x16x32_bf16 v[56:59], v[252:255], v[228:231], v[56:59]
    v_lshl_add_u32 v8, v9, 7, v8
    v_add_u32 v8, s13, v8
    v_bfe_u32 v9, v0, 1, 3
    v_mfma_f32_16x16x32_bf16 v[48:51], v[252:255], v[224:227], v[48:51]
    ds_read_b128 v[252:255], v185 offset:14336
    s_waitcnt lgkmcnt(4)
    v_mfma_f32_16x16x32_bf16 v[52:55], v[208:211], v[224:227], v[52:55]
    v_xor_b32 v9, v9, v10
    v_xor_b32 v11, 0, v9
    v_lshl_add_u32 v244, v11, 4, v8
    v_mfma_f32_16x16x32_bf16 v[60:63], v[208:211], v[228:231], v[60:63]
    v_xor_b32 v11, 2, v9
    v_lshl_add_u32 v245, v11, 4, v8
    v_xor_b32 v11, 4, v9
    v_mfma_f32_16x16x32_bf16 v[68:71], v[208:211], v[232:235], v[68:71]
    v_lshl_add_u32 v246, v11, 4, v8
    v_xor_b32 v11, 6, v9
    v_lshl_add_u32 v247, v11, 4, v8
    v_mfma_f32_16x16x32_bf16 v[76:79], v[208:211], v[236:239], v[76:79]
    s_waitcnt vmcnt(1)
    s_waitcnt lgkmcnt(0)
    v_xor_b32 v184, 65536, v184
    v_xor_b32 v185, 65536, v185
    v_xor_b32 v186, 0x10000, v186
    v_xor_b32 v187, 0x10000, v187
    v_xor_b32 v188, 0x10000, v188
    v_xor_b32 v189, 0x10000, v189
    s_barrier
    v_mfma_f32_16x16x32_bf16 v[104:107], v[212:215], v[236:239], v[104:107]
    ds_read_b64_tr_b16 v[204:205], v189 offset:0
    ds_read_b64_tr_b16 v[206:207], v189 offset:2048
    s_add_u32 m0, s44, 0
    s_nop 0
    buffer_load_dwordx4 v176, s[24:27], s45 offen offset:0 lds
    v_mfma_f32_16x16x32_bf16 v[96:99], v[212:215], v[232:235], v[96:99]
    ds_read_b128 v[208:211], v184 offset:0
    ds_read_b64_tr_b16 v[200:201], v188 offset:0
    buffer_load_dwordx4 v177, s[24:27], s45 offen offset:1024 lds
    v_mfma_f32_16x16x32_bf16 v[88:91], v[212:215], v[228:231], v[88:91]
    ds_read_b64_tr_b16 v[202:203], v188 offset:2048
    ds_read_b64_tr_b16 v[196:197], v187 offset:0
    buffer_load_dwordx4 v178, s[24:27], s45 offen offset:2048 lds
    v_mfma_f32_16x16x32_bf16 v[80:83], v[212:215], v[224:227], v[80:83]
    ds_read_b64_tr_b16 v[198:199], v187 offset:2048
    ds_read_b128 v[212:215], v184 offset:2048
    buffer_load_dwordx4 v179, s[24:27], s45 offen offset:3072 lds
    v_mfma_f32_16x16x32_bf16 v[84:87], v[216:219], v[224:227], v[84:87]
    ds_read_b64_tr_b16 v[192:193], v186 offset:0
    ds_read_b64_tr_b16 v[194:195], v186 offset:2048
    s_add_u32 m0, s44, 16384
    s_add_u32 s47, s45, 65536
    buffer_load_dwordx4 v176, s[24:27], s47 offen offset:0 lds
    v_mfma_f32_16x16x32_bf16 v[92:95], v[216:219], v[228:231], v[92:95]
    buffer_load_dwordx4 v177, s[24:27], s47 offen offset:1024 lds
    v_mfma_f32_16x16x32_bf16 v[100:103], v[216:219], v[232:235], v[100:103]
    buffer_load_dwordx4 v178, s[24:27], s47 offen offset:2048 lds
    v_mfma_f32_16x16x32_bf16 v[108:111], v[216:219], v[236:239], v[108:111]
    ds_read_b128 v[216:219], v184 offset:4096
    buffer_load_dwordx4 v179, s[24:27], s47 offen offset:3072 lds
    s_add_u32 s45, s45, 128
    s_and_b32 s45, s45, 1023
    v_mfma_f32_16x16x32_bf16 v[136:139], v[220:223], v[236:239], v[136:139]
    s_add_u32 m0, s44, 32768
    s_nop 0
    buffer_load_dwordx4 v180, s[28:31], s46 offen offset:0 lds
    v_mfma_f32_16x16x32_bf16 v[128:131], v[220:223], v[232:235], v[128:131]
    buffer_load_dwordx4 v181, s[28:31], s46 offen offset:1024 lds
    v_mfma_f32_16x16x32_bf16 v[120:123], v[220:223], v[228:231], v[120:123]
    buffer_load_dwordx4 v182, s[28:31], s46 offen offset:2048 lds
    v_mfma_f32_16x16x32_bf16 v[112:115], v[220:223], v[224:227], v[112:115]
    ds_read_b128 v[220:223], v184 offset:6144
    buffer_load_dwordx4 v183, s[28:31], s46 offen offset:3072 lds
    v_mfma_f32_16x16x32_bf16 v[116:119], v[252:255], v[224:227], v[116:119]
    s_add_u32 m0, s44, 49152
    s_add_u32 s47, s46, 262144
    buffer_load_dwordx4 v180, s[28:31], s47 offen offset:0 lds
    v_mfma_f32_16x16x32_bf16 v[124:127], v[252:255], v[228:231], v[124:127]
    buffer_load_dwordx4 v181, s[28:31], s47 offen offset:1024 lds
    v_mfma_f32_16x16x32_bf16 v[132:135], v[252:255], v[232:235], v[132:135]
    buffer_load_dwordx4 v182, s[28:31], s47 offen offset:2048 lds
    v_mfma_f32_16x16x32_bf16 v[140:143], v[252:255], v[236:239], v[140:143]
    ds_read_b128 v[252:255], v184 offset:8192
    buffer_load_dwordx4 v183, s[28:31], s47 offen offset:3072 lds
    s_add_u32 s46, s46, 524288
    s_and_b32 s46, s46, 0x3fffff
    s_waitcnt lgkmcnt(3)
    v_mfma_f32_16x16x32_bf16 v[40:43], v[208:211], v[204:207], v[40:43]
    ds_read_b64_tr_b16 v[236:237], v189 offset:16384
    v_mfma_f32_16x16x32_bf16 v[32:35], v[208:211], v[200:203], v[32:35]
    ds_read_b64_tr_b16 v[238:239], v189 offset:18432
    v_mfma_f32_16x16x32_bf16 v[24:27], v[208:211], v[196:199], v[24:27]
    ds_read_b64_tr_b16 v[232:233], v188 offset:16384
    v_mfma_f32_16x16x32_bf16 v[16:19], v[208:211], v[192:195], v[16:19]
    ds_read_b128 v[208:211], v184 offset:10240
    v_mfma_f32_16x16x32_bf16 v[20:23], v[212:215], v[192:195], v[20:23]
    ds_read_b64_tr_b16 v[234:235], v188 offset:18432
    v_mfma_f32_16x16x32_bf16 v[28:31], v[212:215], v[196:199], v[28:31]
    ds_read_b64_tr_b16 v[228:229], v187 offset:16384
    v_mfma_f32_16x16x32_bf16 v[36:39], v[212:215], v[200:203], v[36:39]
    ds_read_b64_tr_b16 v[230:231], v187 offset:18432
    v_mfma_f32_16x16x32_bf16 v[44:47], v[212:215], v[204:207], v[44:47]
    ds_read_b128 v[212:215], v184 offset:12288
    s_waitcnt lgkmcnt(10)
    v_mfma_f32_16x16x32_bf16 v[72:75], v[216:219], v[204:207], v[72:75]
    ds_read_b64_tr_b16 v[224:225], v186 offset:16384
    s_cmp_eq_u32 s12, 3
    s_cbranch_scc0 mg_w3u_7_r0
    s_mov_b64 exec, 1
    buffer_atomic_add v5, off, s[20:23], s67 sc1
    s_mov_b64 exec, -1
mg_w3u_7_r0:
    v_mfma_f32_16x16x32_bf16 v[64:67], v[216:219], v[200:203], v[64:67]
    ds_read_b64_tr_b16 v[226:227], v186 offset:18432
    v_mfma_f32_16x16x32_bf16 v[56:59], v[216:219], v[196:199], v[56:59]
    v_mfma_f32_16x16x32_bf16 v[48:51], v[216:219], v[192:195], v[48:51]
    ds_read_b128 v[216:219], v184 offset:14336
    s_waitcnt lgkmcnt(12)
    v_mfma_f32_16x16x32_bf16 v[52:55], v[220:223], v[192:195], v[52:55]
    v_mfma_f32_16x16x32_bf16 v[60:63], v[220:223], v[196:199], v[60:63]
    v_mfma_f32_16x16x32_bf16 v[68:71], v[220:223], v[200:203], v[68:71]
    v_mfma_f32_16x16x32_bf16 v[76:79], v[220:223], v[204:207], v[76:79]
    ds_read_b128 v[220:223], v185 offset:0
    s_waitcnt lgkmcnt(12)
    v_mfma_f32_16x16x32_bf16 v[104:107], v[252:255], v[204:207], v[104:107]
    v_mfma_f32_16x16x32_bf16 v[96:99], v[252:255], v[200:203], v[96:99]
    v_mfma_f32_16x16x32_bf16 v[88:91], v[252:255], v[196:199], v[88:91]
    v_mfma_f32_16x16x32_bf16 v[80:83], v[252:255], v[192:195], v[80:83]
    ds_read_b128 v[252:255], v185 offset:2048
    s_waitcnt lgkmcnt(9)
    v_mfma_f32_16x16x32_bf16 v[84:87], v[208:211], v[192:195], v[84:87]
    v_mfma_f32_16x16x32_bf16 v[92:95], v[208:211], v[196:199], v[92:95]
    v_mfma_f32_16x16x32_bf16 v[100:103], v[208:211], v[200:203], v[100:103]
    v_mfma_f32_16x16x32_bf16 v[108:111], v[208:211], v[204:207], v[108:111]
    ds_read_b128 v[208:211], v185 offset:4096
    s_waitcnt lgkmcnt(6)
    v_mfma_f32_16x16x32_bf16 v[136:139], v[212:215], v[204:207], v[136:139]
    v_mfma_f32_16x16x32_bf16 v[128:131], v[212:215], v[200:203], v[128:131]
    v_mfma_f32_16x16x32_bf16 v[120:123], v[212:215], v[196:199], v[120:123]
    v_mfma_f32_16x16x32_bf16 v[112:115], v[212:215], v[192:195], v[112:115]
    ds_read_b128 v[212:215], v185 offset:6144
    s_waitcnt lgkmcnt(4)
    v_mfma_f32_16x16x32_bf16 v[116:119], v[216:219], v[192:195], v[116:119]
    v_mfma_f32_16x16x32_bf16 v[124:127], v[216:219], v[196:199], v[124:127]
    v_mfma_f32_16x16x32_bf16 v[132:135], v[216:219], v[200:203], v[132:135]
    v_mfma_f32_16x16x32_bf16 v[140:143], v[216:219], v[204:207], v[140:143]
    ds_read_b128 v[216:219], v185 offset:8192
    s_waitcnt lgkmcnt(4)
    v_mfma_f32_16x16x32_bf16 v[40:43], v[220:223], v[236:239], v[40:43]
    v_mfma_f32_16x16x32_bf16 v[32:35], v[220:223], v[232:235], v[32:35]
    v_mfma_f32_16x16x32_bf16 v[24:27], v[220:223], v[228:231], v[24:27]
    v_mfma_f32_16x16x32_bf16 v[16:19], v[220:223], v[224:227], v[16:19]
    ds_read_b128 v[220:223], v185 offset:10240
    s_waitcnt lgkmcnt(4)
    v_mfma_f32_16x16x32_bf16 v[20:23], v[252:255], v[224:227], v[20:23]
    v_mfma_f32_16x16x32_bf16 v[28:31], v[252:255], v[228:231], v[28:31]
    v_mfma_f32_16x16x32_bf16 v[36:39], v[252:255], v[232:235], v[36:39]
    v_mfma_f32_16x16x32_bf16 v[44:47], v[252:255], v[236:239], v[44:47]
    ds_read_b128 v[252:255], v185 offset:12288
    s_waitcnt lgkmcnt(4)
    v_mfma_f32_16x16x32_bf16 v[72:75], v[208:211], v[236:239], v[72:75]
    v_bfe_u32 v8, v0, 4, 1
    v_and_b32 v9, 3, v0
    v_lshl_add_u32 v8, v8, 2, v9
    v_lshlrev_b32 v8, 3, v8
    v_mfma_f32_16x16x32_bf16 v[64:67], v[208:211], v[232:235], v[64:67]
    v_bfe_u32 v9, v0, 2, 2
    v_lshlrev_b32 v11, 8, v9
    v_lshl_add_u32 v11, v10, 12, v11
    s_mov_b32 s58, 0x70506848
    v_mfma_f32_16x16x32_bf16 v[56:59], v[208:211], v[228:231], v[56:59]
    s_mov_b32 s59, 0xa0807858
    s_cmp_eq_u32 s15, 0
    s_cselect_b32 s56, 0x28082000, s58
    s_cselect_b32 s57, 0x38183010, s59
    v_lshrrev_b64 v[12:13], v8, s[56:57]
    v_lshl_add_u32 v12, v9, 6, v12
    v_mfma_f32_16x16x32_bf16 v[48:51], v[208:211], v[224:227], v[48:51]
    ds_read_b128 v[208:211], v185 offset:14336
    s_waitcnt lgkmcnt(4)
    v_mfma_f32_16x16x32_bf16 v[52:55], v[212:215], v[224:227], v[52:55]
    v_and_b32 v12, 255, v12
    v_add_u32 v248, v12, v11
    s_mov_b32 s58, 0xb0d8a888
    s_mov_b32 s59, 0xe8e8b8e0
    v_mfma_f32_16x16x32_bf16 v[60:63], v[212:215], v[228:231], v[60:63]
    s_cmp_eq_u32 s15, 0
    s_cselect_b32 s56, 0x98c06040, s58
    s_cselect_b32 s57, 0x9090d0c8, s59
    v_lshrrev_b64 v[12:13], v8, s[56:57]
    v_lshl_add_u32 v12, v9, 6, v12
    v_and_b32 v12, 255, v12
    v_mfma_f32_16x16x32_bf16 v[68:71], v[212:215], v[232:235], v[68:71]
    v_add_u32 v249, v12, v11
    v_mfma_f32_16x16x32_bf16 v[76:79], v[212:215], v[236:239], v[76:79]
    s_waitcnt vmcnt(0)
    s_waitcnt lgkmcnt(0)
    v_xor_b32 v184, 65536, v184
    v_xor_b32 v185, 65536, v185
    v_xor_b32 v186, 0x10000, v186
    v_xor_b32 v187, 0x10000, v187
    v_xor_b32 v188, 0x10000, v188
    v_xor_b32 v189, 0x10000, v189
    s_barrier
    v_mfma_f32_16x16x32_bf16 v[104:107], v[216:219], v[236:239], v[104:107]
    ds_read_b64_tr_b16 v[204:205], v189 offset:0
    ds_read_b64_tr_b16 v[206:207], v189 offset:2048
    s_add_u32 m0, s44, 65536
    s_nop 0
    buffer_load_dwordx4 v176, s[24:27], s45 offen offset:0 lds
    v_mfma_f32_16x16x32_bf16 v[96:99], v[216:219], v[232:235], v[96:99]
    ds_read_b128 v[212:215], v184 offset:0
    ds_read_b64_tr_b16 v[200:201], v188 offset:0
    buffer_load_dwordx4 v177, s[24:27], s45 offen offset:1024 lds
    v_mfma_f32_16x16x32_bf16 v[88:91], v[216:219], v[228:231], v[88:91]
    ds_read_b64_tr_b16 v[202:203], v188 offset:2048
    ds_read_b64_tr_b16 v[196:197], v187 offset:0
    buffer_load_dwordx4 v178, s[24:27], s45 offen offset:2048 lds
    v_mfma_f32_16x16x32_bf16 v[80:83], v[216:219], v[224:227], v[80:83]
    ds_read_b64_tr_b16 v[198:199], v187 offset:2048
    ds_read_b128 v[216:219], v184 offset:2048
    buffer_load_dwordx4 v179, s[24:27], s45 offen offset:3072 lds
    v_mfma_f32_16x16x32_bf16 v[84:87], v[220:223], v[224:227], v[84:87]
    ds_read_b64_tr_b16 v[192:193], v186 offset:0
    ds_read_b64_tr_b16 v[194:195], v186 offset:2048
    s_add_u32 m0, s44, 81920
    s_add_u32 s47, s45, 65536
    buffer_load_dwordx4 v176, s[24:27], s47 offen offset:0 lds
    v_mfma_f32_16x16x32_bf16 v[92:95], v[220:223], v[228:231], v[92:95]
    buffer_load_dwordx4 v177, s[24:27], s47 offen offset:1024 lds
    v_mfma_f32_16x16x32_bf16 v[100:103], v[220:223], v[232:235], v[100:103]
    buffer_load_dwordx4 v178, s[24:27], s47 offen offset:2048 lds
    v_mfma_f32_16x16x32_bf16 v[108:111], v[220:223], v[236:239], v[108:111]
    ds_read_b128 v[220:223], v184 offset:4096
    buffer_load_dwordx4 v179, s[24:27], s47 offen offset:3072 lds
    s_add_u32 s45, s45, 128
    s_and_b32 s45, s45, 1023
    v_mfma_f32_16x16x32_bf16 v[136:139], v[252:255], v[236:239], v[136:139]
    s_add_u32 m0, s44, 98304
    s_nop 0
    buffer_load_dwordx4 v180, s[28:31], s46 offen offset:0 lds
    v_mfma_f32_16x16x32_bf16 v[128:131], v[252:255], v[232:235], v[128:131]
    buffer_load_dwordx4 v181, s[28:31], s46 offen offset:1024 lds
    v_mfma_f32_16x16x32_bf16 v[120:123], v[252:255], v[228:231], v[120:123]
    buffer_load_dwordx4 v182, s[28:31], s46 offen offset:2048 lds
    v_mfma_f32_16x16x32_bf16 v[112:115], v[252:255], v[224:227], v[112:115]
    ds_read_b128 v[252:255], v184 offset:6144
    buffer_load_dwordx4 v183, s[28:31], s46 offen offset:3072 lds
    v_mfma_f32_16x16x32_bf16 v[116:119], v[208:211], v[224:227], v[116:119]
    s_add_u32 m0, s44, 114688
    s_add_u32 s47, s46, 262144
    buffer_load_dwordx4 v180, s[28:31], s47 offen offset:0 lds
    v_mfma_f32_16x16x32_bf16 v[124:127], v[208:211], v[228:231], v[124:127]
    buffer_load_dwordx4 v181, s[28:31], s47 offen offset:1024 lds
    v_mfma_f32_16x16x32_bf16 v[132:135], v[208:211], v[232:235], v[132:135]
    buffer_load_dwordx4 v182, s[28:31], s47 offen offset:2048 lds
    v_mfma_f32_16x16x32_bf16 v[140:143], v[208:211], v[236:239], v[140:143]
    ds_read_b128 v[208:211], v184 offset:8192
    buffer_load_dwordx4 v183, s[28:31], s47 offen offset:3072 lds
    s_add_u32 s46, s46, 524288
    s_and_b32 s46, s46, 0x3fffff
    s_waitcnt lgkmcnt(3)
    v_mfma_f32_16x16x32_bf16 v[40:43], v[212:215], v[204:207], v[40:43]
    ds_read_b64_tr_b16 v[236:237], v189 offset:16384
    v_mfma_f32_16x16x32_bf16 v[32:35], v[212:215], v[200:203], v[32:35]
    ds_read_b64_tr_b16 v[238:239], v189 offset:18432
    v_mfma_f32_16x16x32_bf16 v[24:27], v[212:215], v[196:199], v[24:27]
    ds_read_b64_tr_b16 v[232:233], v188 offset:16384
    v_mfma_f32_16x16x32_bf16 v[16:19], v[212:215], v[192:195], v[16:19]
    ds_read_b128 v[212:215], v184 offset:10240
    v_mfma_f32_16x16x32_bf16 v[20:23], v[216:219], v[192:195], v[20:23]
    ds_read_b64_tr_b16 v[234:235], v188 offset:18432
    v_mfma_f32_16x16x32_bf16 v[28:31], v[216:219], v[196:199], v[28:31]
    ds_read_b64_tr_b16 v[228:229], v187 offset:16384
    v_mfma_f32_16x16x32_bf16 v[36:39], v[216:219], v[200:203], v[36:39]
    ds_read_b64_tr_b16 v[230:231], v187 offset:18432
    v_mfma_f32_16x16x32_bf16 v[44:47], v[216:219], v[204:207], v[44:47]
    ds_read_b128 v[216:219], v184 offset:12288
    s_waitcnt lgkmcnt(10)
    v_mfma_f32_16x16x32_bf16 v[72:75], v[220:223], v[204:207], v[72:75]
    ds_read_b64_tr_b16 v[224:225], v186 offset:16384
    s_mov_b32 s40, s4
    s_and_b32 s41, s5, 0xffff
    s_mov_b32 s42, 2621440
    s_mov_b32 s43, 0x20000
    v_mfma_f32_16x16x32_bf16 v[64:67], v[220:223], v[200:203], v[64:67]
    ds_read_b64_tr_b16 v[226:227], v186 offset:18432
    s_lshl_b32 s13, s2, 3
    v_mfma_f32_16x16x32_bf16 v[56:59], v[220:223], v[196:199], v[56:59]
    s_add_u32 s13, s13, s12
    v_mfma_f32_16x16x32_bf16 v[48:51], v[220:223], v[192:195], v[48:51]
    ds_read_b128 v[220:223], v184 offset:14336
    s_waitcnt lgkmcnt(12)
    v_mfma_f32_16x16x32_bf16 v[52:55], v[252:255], v[192:195], v[52:55]
    s_mul_i32 s13, s13, 1280
    v_mfma_f32_16x16x32_bf16 v[60:63], v[252:255], v[196:199], v[60:63]
    buffer_load_dword v166, v167, s[40:43], s13 offen
    v_mfma_f32_16x16x32_bf16 v[68:71], v[252:255], v[200:203], v[68:71]
    v_mfma_f32_16x16x32_bf16 v[76:79], v[252:255], v[204:207], v[76:79]
    ds_read_b128 v[252:255], v185 offset:0
    s_waitcnt lgkmcnt(12)
    v_mfma_f32_16x16x32_bf16 v[104:107], v[208:211], v[204:207], v[104:107]
    v_mfma_f32_16x16x32_bf16 v[96:99], v[208:211], v[200:203], v[96:99]
    v_mfma_f32_16x16x32_bf16 v[88:91], v[208:211], v[196:199], v[88:91]
    v_mfma_f32_16x16x32_bf16 v[80:83], v[208:211], v[192:195], v[80:83]
    ds_read_b128 v[208:211], v185 offset:2048
    s_waitcnt lgkmcnt(9)
    v_mfma_f32_16x16x32_bf16 v[84:87], v[212:215], v[192:195], v[84:87]
    v_mfma_f32_16x16x32_bf16 v[92:95], v[212:215], v[196:199], v[92:95]
    v_mfma_f32_16x16x32_bf16 v[100:103], v[212:215], v[200:203], v[100:103]
    v_mfma_f32_16x16x32_bf16 v[108:111], v[212:215], v[204:207], v[108:111]
    ds_read_b128 v[212:215], v185 offset:4096
    s_waitcnt lgkmcnt(6)
    v_mfma_f32_16x16x32_bf16 v[136:139], v[216:219], v[204:207], v[136:139]
    s_mov_b32 s40, s72
    s_and_b32 s41, s73, 0xffff
    s_mov_b32 s42, 5242880
    s_mov_b32 s43, 0x20000
    s_and_b32 s13, s2, 248
    v_mfma_f32_16x16x32_bf16 v[128:131], v[216:219], v[200:203], v[128:131]
    s_add_u32 s13, s13, s12
    s_lshl_b32 s13, s13, 13
    v_mfma_f32_16x16x32_bf16 v[120:123], v[216:219], v[196:199], v[120:123]
    s_and_b32 s14, s2, 7
    s_lshl_b32 s14, s14, 10
    v_mfma_f32_16x16x32_bf16 v[112:115], v[216:219], v[192:195], v[112:115]
    ds_read_b128 v[216:219], v185 offset:6144
    s_waitcnt lgkmcnt(4)
    v_mfma_f32_16x16x32_bf16 v[116:119], v[220:223], v[192:195], v[116:119]
    s_add_u32 s13, s13, s14
    buffer_load_dword v166, v1, s[40:43], s13 offen
    v_mfma_f32_16x16x32_bf16 v[124:127], v[220:223], v[196:199], v[124:127]
    v_mfma_f32_16x16x32_bf16 v[132:135], v[220:223], v[200:203], v[132:135]
    v_mfma_f32_16x16x32_bf16 v[140:143], v[220:223], v[204:207], v[140:143]
    ds_read_b128 v[220:223], v185 offset:8192
    s_waitcnt lgkmcnt(4)
    v_mfma_f32_16x16x32_bf16 v[40:43], v[252:255], v[236:239], v[40:43]
    v_mfma_f32_16x16x32_bf16 v[32:35], v[252:255], v[232:235], v[32:35]
    v_mfma_f32_16x16x32_bf16 v[24:27], v[252:255], v[228:231], v[24:27]
    v_mfma_f32_16x16x32_bf16 v[16:19], v[252:255], v[224:227], v[16:19]
    ds_read_b128 v[252:255], v185 offset:10240
    s_waitcnt lgkmcnt(4)
    v_mfma_f32_16x16x32_bf16 v[20:23], v[208:211], v[224:227], v[20:23]
    v_mfma_f32_16x16x32_bf16 v[28:31], v[208:211], v[228:231], v[28:31]
    v_mfma_f32_16x16x32_bf16 v[36:39], v[208:211], v[232:235], v[36:39]
    v_mfma_f32_16x16x32_bf16 v[44:47], v[208:211], v[236:239], v[44:47]
    ds_read_b128 v[208:211], v185 offset:12288
    s_waitcnt lgkmcnt(4)
    v_mfma_f32_16x16x32_bf16 v[72:75], v[212:215], v[236:239], v[72:75]
    v_mfma_f32_16x16x32_bf16 v[64:67], v[212:215], v[232:235], v[64:67]
    v_mfma_f32_16x16x32_bf16 v[56:59], v[212:215], v[228:231], v[56:59]
    v_mfma_f32_16x16x32_bf16 v[48:51], v[212:215], v[224:227], v[48:51]
    ds_read_b128 v[212:215], v185 offset:14336
    s_waitcnt lgkmcnt(4)
    v_mfma_f32_16x16x32_bf16 v[52:55], v[216:219], v[224:227], v[52:55]
    v_mfma_f32_16x16x32_bf16 v[60:63], v[216:219], v[228:231], v[60:63]
    v_mfma_f32_16x16x32_bf16 v[68:71], v[216:219], v[232:235], v[68:71]
    v_mfma_f32_16x16x32_bf16 v[76:79], v[216:219], v[236:239], v[76:79]
    s_waitcnt vmcnt(2)
    s_waitcnt lgkmcnt(0)
    v_xor_b32 v184, 65536, v184
    v_xor_b32 v185, 65536, v185
    v_xor_b32 v186, 0x10000, v186
    v_xor_b32 v187, 0x10000, v187
    v_xor_b32 v188, 0x10000, v188
    v_xor_b32 v189, 0x10000, v189
    s_barrier
    v_mfma_f32_16x16x32_bf16 v[104:107], v[220:223], v[236:239], v[104:107]
    ds_read_b64_tr_b16 v[204:205], v189 offset:0
    ds_read_b64_tr_b16 v[206:207], v189 offset:2048
    s_add_u32 m0, s44, 0
    s_nop 0
    buffer_load_dwordx4 v176, s[24:27], s45 offen offset:0 lds
    v_mfma_f32_16x16x32_bf16 v[96:99], v[220:223], v[232:235], v[96:99]
    ds_read_b128 v[216:219], v184 offset:0
    ds_read_b64_tr_b16 v[200:201], v188 offset:0
    buffer_load_dwordx4 v177, s[24:27], s45 offen offset:1024 lds
    v_mfma_f32_16x16x32_bf16 v[88:91], v[220:223], v[228:231], v[88:91]
    ds_read_b64_tr_b16 v[202:203], v188 offset:2048
    ds_read_b64_tr_b16 v[196:197], v187 offset:0
    buffer_load_dwordx4 v178, s[24:27], s45 offen offset:2048 lds
    v_mfma_f32_16x16x32_bf16 v[80:83], v[220:223], v[224:227], v[80:83]
    ds_read_b64_tr_b16 v[198:199], v187 offset:2048
    ds_read_b128 v[220:223], v184 offset:2048
    buffer_load_dwordx4 v179, s[24:27], s45 offen offset:3072 lds
    v_mfma_f32_16x16x32_bf16 v[84:87], v[252:255], v[224:227], v[84:87]
    ds_read_b64_tr_b16 v[192:193], v186 offset:0
    ds_read_b64_tr_b16 v[194:195], v186 offset:2048
    s_add_u32 m0, s44, 16384
    s_add_u32 s47, s45, 65536
    buffer_load_dwordx4 v176, s[24:27], s47 offen offset:0 lds
    v_mfma_f32_16x16x32_bf16 v[92:95], v[252:255], v[228:231], v[92:95]
    buffer_load_dwordx4 v177, s[24:27], s47 offen offset:1024 lds
    v_mfma_f32_16x16x32_bf16 v[100:103], v[252:255], v[232:235], v[100:103]
    buffer_load_dwordx4 v178, s[24:27], s47 offen offset:2048 lds
    v_mfma_f32_16x16x32_bf16 v[108:111], v[252:255], v[236:239], v[108:111]
    ds_read_b128 v[252:255], v184 offset:4096
    buffer_load_dwordx4 v179, s[24:27], s47 offen offset:3072 lds
    s_add_u32 s45, s45, 128
    s_and_b32 s45, s45, 1023
    v_mfma_f32_16x16x32_bf16 v[136:139], v[208:211], v[236:239], v[136:139]
    s_add_u32 m0, s44, 32768
    s_nop 0
    buffer_load_dwordx4 v180, s[28:31], s46 offen offset:0 lds
    v_mfma_f32_16x16x32_bf16 v[128:131], v[208:211], v[232:235], v[128:131]
    buffer_load_dwordx4 v181, s[28:31], s46 offen offset:1024 lds
    v_mfma_f32_16x16x32_bf16 v[120:123], v[208:211], v[228:231], v[120:123]
    buffer_load_dwordx4 v182, s[28:31], s46 offen offset:2048 lds
    v_mfma_f32_16x16x32_bf16 v[112:115], v[208:211], v[224:227], v[112:115]
    ds_read_b128 v[208:211], v184 offset:6144
    buffer_load_dwordx4 v183, s[28:31], s46 offen offset:3072 lds
    v_mfma_f32_16x16x32_bf16 v[116:119], v[212:215], v[224:227], v[116:119]
    s_add_u32 m0, s44, 49152
    s_add_u32 s47, s46, 262144
    buffer_load_dwordx4 v180, s[28:31], s47 offen offset:0 lds
    v_mfma_f32_16x16x32_bf16 v[124:127], v[212:215], v[228:231], v[124:127]
    buffer_load_dwordx4 v181, s[28:31], s47 offen offset:1024 lds
    v_mfma_f32_16x16x32_bf16 v[132:135], v[212:215], v[232:235], v[132:135]
    buffer_load_dwordx4 v182, s[28:31], s47 offen offset:2048 lds
    v_mfma_f32_16x16x32_bf16 v[140:143], v[212:215], v[236:239], v[140:143]
    ds_read_b128 v[212:215], v184 offset:8192
    buffer_load_dwordx4 v183, s[28:31], s47 offen offset:3072 lds
    s_add_u32 s46, s46, 524288
    s_and_b32 s46, s46, 0x3fffff
    s_waitcnt lgkmcnt(3)
    v_mfma_f32_16x16x32_bf16 v[40:43], v[216:219], v[204:207], v[40:43]
    ds_read_b64_tr_b16 v[236:237], v189 offset:16384
    v_mfma_f32_16x16x32_bf16 v[32:35], v[216:219], v[200:203], v[32:35]
    ds_read_b64_tr_b16 v[238:239], v189 offset:18432
    v_mfma_f32_16x16x32_bf16 v[24:27], v[216:219], v[196:199], v[24:27]
    ds_read_b64_tr_b16 v[232:233], v188 offset:16384
    v_mfma_f32_16x16x32_bf16 v[16:19], v[216:219], v[192:195], v[16:19]
    ds_read_b128 v[216:219], v184 offset:10240
    v_mfma_f32_16x16x32_bf16 v[20:23], v[220:223], v[192:195], v[20:23]
    ds_read_b64_tr_b16 v[234:235], v188 offset:18432
    v_mfma_f32_16x16x32_bf16 v[28:31], v[220:223], v[196:199], v[28:31]
    ds_read_b64_tr_b16 v[228:229], v187 offset:16384
    v_mfma_f32_16x16x32_bf16 v[36:39], v[220:223], v[200:203], v[36:39]
    ds_read_b64_tr_b16 v[230:231], v187 offset:18432
    v_mfma_f32_16x16x32_bf16 v[44:47], v[220:223], v[204:207], v[44:47]
    ds_read_b128 v[220:223], v184 offset:12288
    s_waitcnt lgkmcnt(10)
    v_mfma_f32_16x16x32_bf16 v[72:75], v[252:255], v[204:207], v[72:75]
    ds_read_b64_tr_b16 v[224:225], v186 offset:16384
    s_mov_b32 s40, s72
    s_and_b32 s41, s73, 0xffff
    s_mov_b32 s42, 5242880
    s_mov_b32 s43, 0x20000
    s_and_b32 s13, s2, 248
    v_mfma_f32_16x16x32_bf16 v[64:67], v[252:255], v[200:203], v[64:67]
    ds_read_b64_tr_b16 v[226:227], v186 offset:18432
    s_add_u32 s13, s13, s12
    s_lshl_b32 s13, s13, 13
    v_mfma_f32_16x16x32_bf16 v[56:59], v[252:255], v[196:199], v[56:59]
    s_and_b32 s14, s2, 7
    s_lshl_b32 s14, s14, 10
    v_mfma_f32_16x16x32_bf16 v[48:51], v[252:255], v[192:195], v[48:51]
    ds_read_b128 v[252:255], v184 offset:14336
    s_waitcnt lgkmcnt(12)
    v_mfma_f32_16x16x32_bf16 v[52:55], v[208:211], v[192:195], v[52:55]
    s_add_u32 s13, s13, s14
    s_add_u32 s13, s13, 2097152
    v_mfma_f32_16x16x32_bf16 v[60:63], v[208:211], v[196:199], v[60:63]
    buffer_load_dword v166, v1, s[40:43], s13 offen
    s_cmp_eq_u32 s12, 3
    s_cbranch_scc0 mg_w3u_8_r0
    buffer_load_dword v5, off, s[20:23], s67 sc1
mg_w3u_8_r0:
    v_mfma_f32_16x16x32_bf16 v[68:71], v[208:211], v[200:203], v[68:71]
    v_mfma_f32_16x16x32_bf16 v[76:79], v[208:211], v[204:207], v[76:79]
    ds_read_b128 v[208:211], v185 offset:0
    s_waitcnt lgkmcnt(12)
    v_mfma_f32_16x16x32_bf16 v[104:107], v[212:215], v[204:207], v[104:107]
    v_mfma_f32_16x16x32_bf16 v[96:99], v[212:215], v[200:203], v[96:99]
    v_mfma_f32_16x16x32_bf16 v[88:91], v[212:215], v[196:199], v[88:91]
    v_mfma_f32_16x16x32_bf16 v[80:83], v[212:215], v[192:195], v[80:83]
    ds_read_b128 v[212:215], v185 offset:2048
    s_waitcnt lgkmcnt(9)
    v_mfma_f32_16x16x32_bf16 v[84:87], v[216:219], v[192:195], v[84:87]
    v_mfma_f32_16x16x32_bf16 v[92:95], v[216:219], v[196:199], v[92:95]
    v_mfma_f32_16x16x32_bf16 v[100:103], v[216:219], v[200:203], v[100:103]
    v_mfma_f32_16x16x32_bf16 v[108:111], v[216:219], v[204:207], v[108:111]
    ds_read_b128 v[216:219], v185 offset:4096
    s_waitcnt lgkmcnt(6)
    v_mfma_f32_16x16x32_bf16 v[136:139], v[220:223], v[204:207], v[136:139]
    s_mov_b32 s40, s72
    s_and_b32 s41, s73, 0xffff
    s_mov_b32 s42, 5242880
    s_mov_b32 s43, 0x20000
    s_and_b32 s13, s2, 248
    v_mfma_f32_16x16x32_bf16 v[128:131], v[220:223], v[200:203], v[128:131]
    s_add_u32 s13, s13, s12
    s_lshl_b32 s13, s13, 13
    v_mfma_f32_16x16x32_bf16 v[120:123], v[220:223], v[196:199], v[120:123]
    s_and_b32 s14, s2, 7
    s_lshl_b32 s14, s14, 10
    v_mfma_f32_16x16x32_bf16 v[112:115], v[220:223], v[192:195], v[112:115]
    ds_read_b128 v[220:223], v185 offset:6144
    s_waitcnt lgkmcnt(4)
    v_mfma_f32_16x16x32_bf16 v[116:119], v[252:255], v[192:195], v[116:119]
    s_add_u32 s13, s13, s14
    s_add_u32 s13, s13, 4194304
    v_mfma_f32_16x16x32_bf16 v[124:127], v[252:255], v[196:199], v[124:127]
    buffer_load_dword v166, v1, s[40:43], s13 offen
    v_mfma_f32_16x16x32_bf16 v[132:135], v[252:255], v[200:203], v[132:135]
    v_mfma_f32_16x16x32_bf16 v[140:143], v[252:255], v[204:207], v[140:143]
    ds_read_b128 v[252:255], v185 offset:8192
    s_waitcnt lgkmcnt(4)
    v_mfma_f32_16x16x32_bf16 v[40:43], v[208:211], v[236:239], v[40:43]
    v_mfma_f32_16x16x32_bf16 v[32:35], v[208:211], v[232:235], v[32:35]
    v_mfma_f32_16x16x32_bf16 v[24:27], v[208:211], v[228:231], v[24:27]
    v_mfma_f32_16x16x32_bf16 v[16:19], v[208:211], v[224:227], v[16:19]
    ds_read_b128 v[208:211], v185 offset:10240
    s_waitcnt lgkmcnt(4)
    v_mfma_f32_16x16x32_bf16 v[20:23], v[212:215], v[224:227], v[20:23]
    v_mfma_f32_16x16x32_bf16 v[28:31], v[212:215], v[228:231], v[28:31]
    v_mfma_f32_16x16x32_bf16 v[36:39], v[212:215], v[232:235], v[36:39]
    v_mfma_f32_16x16x32_bf16 v[44:47], v[212:215], v[236:239], v[44:47]
    ds_read_b128 v[212:215], v185 offset:12288
    s_waitcnt lgkmcnt(4)
    v_mfma_f32_16x16x32_bf16 v[72:75], v[216:219], v[236:239], v[72:75]
    v_mfma_f32_16x16x32_bf16 v[64:67], v[216:219], v[232:235], v[64:67]
    v_mfma_f32_16x16x32_bf16 v[56:59], v[216:219], v[228:231], v[56:59]
    v_mfma_f32_16x16x32_bf16 v[48:51], v[216:219], v[224:227], v[48:51]
    ds_read_b128 v[216:219], v185 offset:14336
    s_waitcnt lgkmcnt(4)
    v_mfma_f32_16x16x32_bf16 v[52:55], v[220:223], v[224:227], v[52:55]
    v_mfma_f32_16x16x32_bf16 v[60:63], v[220:223], v[228:231], v[60:63]
    v_mfma_f32_16x16x32_bf16 v[68:71], v[220:223], v[232:235], v[68:71]
    v_mfma_f32_16x16x32_bf16 v[76:79], v[220:223], v[236:239], v[76:79]
    s_waitcnt vmcnt(2)
    s_waitcnt lgkmcnt(0)
    v_xor_b32 v184, 65536, v184
    v_xor_b32 v185, 65536, v185
    v_xor_b32 v186, 0x10000, v186
    v_xor_b32 v187, 0x10000, v187
    v_xor_b32 v188, 0x10000, v188
    v_xor_b32 v189, 0x10000, v189
    s_cmp_eq_u32 s12, 3
    s_cbranch_scc0 mg_w3rpv_r0
    s_waitcnt vmcnt(1)
    v_readfirstlane_b32 s13, v5
    s_mov_b32 s14, 0
    s_cmp_lt_u32 s13, 0x100000
    s_cbranch_scc1 mg_pwrpv_r0
mg_w3rpv_r0:
    s_barrier
    v_mfma_f32_16x16x32_bf16 v[104:107], v[252:255], v[236:239], v[104:107]
    ds_read_b64_tr_b16 v[204:205], v189 offset:0
    ds_read_b64_tr_b16 v[206:207], v189 offset:2048
    s_add_u32 m0, s44, 65536
    s_nop 0
    buffer_load_dwordx4 v176, s[24:27], s45 offen offset:0 lds
    v_mfma_f32_16x16x32_bf16 v[96:99], v[252:255], v[232:235], v[96:99]
    ds_read_b128 v[220:223], v184 offset:0
    ds_read_b64_tr_b16 v[200:201], v188 offset:0
    buffer_load_dwordx4 v177, s[24:27], s45 offen offset:1024 lds
    v_mfma_f32_16x16x32_bf16 v[88:91], v[252:255], v[228:231], v[88:91]
    ds_read_b64_tr_b16 v[202:203], v188 offset:2048
    ds_read_b64_tr_b16 v[196:197], v187 offset:0
    buffer_load_dwordx4 v178, s[24:27], s45 offen offset:2048 lds
    v_mfma_f32_16x16x32_bf16 v[80:83], v[252:255], v[224:227], v[80:83]
    ds_read_b64_tr_b16 v[198:199], v187 offset:2048
    ds_read_b128 v[252:255], v184 offset:2048
    buffer_load_dwordx4 v179, s[24:27], s45 offen offset:3072 lds
    v_mfma_f32_16x16x32_bf16 v[84:87], v[208:211], v[224:227], v[84:87]
    ds_read_b64_tr_b16 v[192:193], v186 offset:0
    ds_read_b64_tr_b16 v[194:195], v186 offset:2048
    s_add_u32 m0, s44, 81920
    s_add_u32 s47, s45, 65536
    buffer_load_dwordx4 v176, s[24:27], s47 offen offset:0 lds
    v_mfma_f32_16x16x32_bf16 v[92:95], v[208:211], v[228:231], v[92:95]
    buffer_load_dwordx4 v177, s[24:27], s47 offen offset:1024 lds
    v_mfma_f32_16x16x32_bf16 v[100:103], v[208:211], v[232:235], v[100:103]
    buffer_load_dwordx4 v178, s[24:27], s47 offen offset:2048 lds
    v_mfma_f32_16x16x32_bf16 v[108:111], v[208:211], v[236:239], v[108:111]
    ds_read_b128 v[208:211], v184 offset:4096
    buffer_load_dwordx4 v179, s[24:27], s47 offen offset:3072 lds
    s_add_u32 s45, s45, 128
    s_and_b32 s45, s45, 1023
    v_mfma_f32_16x16x32_bf16 v[136:139], v[212:215], v[236:239], v[136:139]
    s_add_u32 m0, s44, 98304
    s_nop 0
    buffer_load_dwordx4 v180, s[28:31], s46 offen offset:0 lds
    v_mfma_f32_16x16x32_bf16 v[128:131], v[212:215], v[232:235], v[128:131]
    buffer_load_dwordx4 v181, s[28:31], s46 offen offset:1024 lds
    v_mfma_f32_16x16x32_bf16 v[120:123], v[212:215], v[228:231], v[120:123]
    buffer_load_dwordx4 v182, s[28:31], s46 offen offset:2048 lds
    v_mfma_f32_16x16x32_bf16 v[112:115], v[212:215], v[224:227], v[112:115]
    ds_read_b128 v[212:215], v184 offset:6144
    buffer_load_dwordx4 v183, s[28:31], s46 offen offset:3072 lds
    v_mfma_f32_16x16x32_bf16 v[116:119], v[216:219], v[224:227], v[116:119]
    s_add_u32 m0, s44, 114688
    s_add_u32 s47, s46, 262144
    buffer_load_dwordx4 v180, s[28:31], s47 offen offset:0 lds
    v_mfma_f32_16x16x32_bf16 v[124:127], v[216:219], v[228:231], v[124:127]
    buffer_load_dwordx4 v181, s[28:31], s47 offen offset:1024 lds
    v_mfma_f32_16x16x32_bf16 v[132:135], v[216:219], v[232:235], v[132:135]
    buffer_load_dwordx4 v182, s[28:31], s47 offen offset:2048 lds
    v_mfma_f32_16x16x32_bf16 v[140:143], v[216:219], v[236:239], v[140:143]
    ds_read_b128 v[216:219], v184 offset:8192
    buffer_load_dwordx4 v183, s[28:31], s47 offen offset:3072 lds
    s_add_u32 s46, s46, 524288
    s_and_b32 s46, s46, 0x3fffff
    s_waitcnt lgkmcnt(3)
    v_mfma_f32_16x16x32_bf16 v[40:43], v[220:223], v[204:207], v[40:43]
    ds_read_b64_tr_b16 v[236:237], v189 offset:16384
    v_mfma_f32_16x16x32_bf16 v[32:35], v[220:223], v[200:203], v[32:35]
    ds_read_b64_tr_b16 v[238:239], v189 offset:18432
    v_mfma_f32_16x16x32_bf16 v[24:27], v[220:223], v[196:199], v[24:27]
    ds_read_b64_tr_b16 v[232:233], v188 offset:16384
    v_mfma_f32_16x16x32_bf16 v[16:19], v[220:223], v[192:195], v[16:19]
    ds_read_b128 v[220:223], v184 offset:10240
    v_mfma_f32_16x16x32_bf16 v[20:23], v[252:255], v[192:195], v[20:23]
    ds_read_b64_tr_b16 v[234:235], v188 offset:18432
    v_mfma_f32_16x16x32_bf16 v[28:31], v[252:255], v[196:199], v[28:31]
    ds_read_b64_tr_b16 v[228:229], v187 offset:16384
    v_mfma_f32_16x16x32_bf16 v[36:39], v[252:255], v[200:203], v[36:39]
    ds_read_b64_tr_b16 v[230:231], v187 offset:18432
    v_mfma_f32_16x16x32_bf16 v[44:47], v[252:255], v[204:207], v[44:47]
    ds_read_b128 v[252:255], v184 offset:12288
    s_waitcnt lgkmcnt(10)
    v_mfma_f32_16x16x32_bf16 v[72:75], v[208:211], v[204:207], v[72:75]
    ds_read_b64_tr_b16 v[224:225], v186 offset:16384
    v_mfma_f32_16x16x32_bf16 v[64:67], v[208:211], v[200:203], v[64:67]
    ds_read_b64_tr_b16 v[226:227], v186 offset:18432
    v_mfma_f32_16x16x32_bf16 v[56:59], v[208:211], v[196:199], v[56:59]
    v_mfma_f32_16x16x32_bf16 v[48:51], v[208:211], v[192:195], v[48:51]
    ds_read_b128 v[208:211], v184 offset:14336
    s_waitcnt lgkmcnt(12)
    v_mfma_f32_16x16x32_bf16 v[52:55], v[212:215], v[192:195], v[52:55]
    v_mfma_f32_16x16x32_bf16 v[60:63], v[212:215], v[196:199], v[60:63]
    v_mfma_f32_16x16x32_bf16 v[68:71], v[212:215], v[200:203], v[68:71]
    v_mfma_f32_16x16x32_bf16 v[76:79], v[212:215], v[204:207], v[76:79]
    ds_read_b128 v[212:215], v185 offset:0
    s_waitcnt lgkmcnt(12)
    v_mfma_f32_16x16x32_bf16 v[104:107], v[216:219], v[204:207], v[104:107]
    v_mfma_f32_16x16x32_bf16 v[96:99], v[216:219], v[200:203], v[96:99]
    v_mfma_f32_16x16x32_bf16 v[88:91], v[216:219], v[196:199], v[88:91]
    v_mfma_f32_16x16x32_bf16 v[80:83], v[216:219], v[192:195], v[80:83]
    ds_read_b128 v[216:219], v185 offset:2048
    s_waitcnt lgkmcnt(9)
    v_mfma_f32_16x16x32_bf16 v[84:87], v[220:223], v[192:195], v[84:87]
    v_mfma_f32_16x16x32_bf16 v[92:95], v[220:223], v[196:199], v[92:95]
    v_mfma_f32_16x16x32_bf16 v[100:103], v[220:223], v[200:203], v[100:103]
    v_mfma_f32_16x16x32_bf16 v[108:111], v[220:223], v[204:207], v[108:111]
    ds_read_b128 v[220:223], v185 offset:4096
    s_waitcnt lgkmcnt(6)
    v_mfma_f32_16x16x32_bf16 v[136:139], v[252:255], v[204:207], v[136:139]
    v_mfma_f32_16x16x32_bf16 v[128:131], v[252:255], v[200:203], v[128:131]
    v_mfma_f32_16x16x32_bf16 v[120:123], v[252:255], v[196:199], v[120:123]
    v_mfma_f32_16x16x32_bf16 v[112:115], v[252:255], v[192:195], v[112:115]
    ds_read_b128 v[252:255], v185 offset:6144
    s_waitcnt lgkmcnt(4)
    v_mfma_f32_16x16x32_bf16 v[116:119], v[208:211], v[192:195], v[116:119]
    v_mfma_f32_16x16x32_bf16 v[124:127], v[208:211], v[196:199], v[124:127]
    v_mfma_f32_16x16x32_bf16 v[132:135], v[208:211], v[200:203], v[132:135]
    v_mfma_f32_16x16x32_bf16 v[140:143], v[208:211], v[204:207], v[140:143]
    ds_read_b128 v[208:211], v185 offset:8192
    s_waitcnt lgkmcnt(4)
    v_mfma_f32_16x16x32_bf16 v[40:43], v[212:215], v[236:239], v[40:43]
    v_mfma_f32_16x16x32_bf16 v[32:35], v[212:215], v[232:235], v[32:35]
    v_mfma_f32_16x16x32_bf16 v[24:27], v[212:215], v[228:231], v[24:27]
    v_mfma_f32_16x16x32_bf16 v[16:19], v[212:215], v[224:227], v[16:19]
    ds_read_b128 v[212:215], v185 offset:10240
    s_waitcnt lgkmcnt(4)
    v_mfma_f32_16x16x32_bf16 v[20:23], v[216:219], v[224:227], v[20:23]
    v_mfma_f32_16x16x32_bf16 v[28:31], v[216:219], v[228:231], v[28:31]
    v_mfma_f32_16x16x32_bf16 v[36:39], v[216:219], v[232:235], v[36:39]
    v_mfma_f32_16x16x32_bf16 v[44:47], v[216:219], v[236:239], v[44:47]
    ds_read_b128 v[216:219], v185 offset:12288
    s_waitcnt lgkmcnt(4)
    v_mfma_f32_16x16x32_bf16 v[72:75], v[220:223], v[236:239], v[72:75]
    v_mfma_f32_16x16x32_bf16 v[64:67], v[220:223], v[232:235], v[64:67]
    v_mfma_f32_16x16x32_bf16 v[56:59], v[220:223], v[228:231], v[56:59]
    v_mfma_f32_16x16x32_bf16 v[48:51], v[220:223], v[224:227], v[48:51]
    ds_read_b128 v[220:223], v185 offset:14336
    s_waitcnt lgkmcnt(4)
    v_mfma_f32_16x16x32_bf16 v[52:55], v[252:255], v[224:227], v[52:55]
    v_mfma_f32_16x16x32_bf16 v[60:63], v[252:255], v[228:231], v[60:63]
    v_mfma_f32_16x16x32_bf16 v[68:71], v[252:255], v[232:235], v[68:71]
    v_mfma_f32_16x16x32_bf16 v[76:79], v[252:255], v[236:239], v[76:79]
    s_waitcnt vmcnt(0)
    s_waitcnt lgkmcnt(0)
    v_xor_b32 v184, 65536, v184
    v_xor_b32 v185, 65536, v185
    v_xor_b32 v186, 0x10000, v186
    v_xor_b32 v187, 0x10000, v187
    v_xor_b32 v188, 0x10000, v188
    v_xor_b32 v189, 0x10000, v189
    s_barrier
    v_mfma_f32_16x16x32_bf16 v[104:107], v[208:211], v[236:239], v[104:107]
    ds_read_b64_tr_b16 v[204:205], v189 offset:0
    ds_read_b64_tr_b16 v[206:207], v189 offset:2048
    s_add_u32 m0, s44, 0
    s_nop 0
    buffer_load_dwordx4 v243, s[16:19], s55 offen offset:0 sc1 lds
    v_mfma_f32_16x16x32_bf16 v[96:99], v[208:211], v[232:235], v[96:99]
    ds_read_b128 v[252:255], v184 offset:0
    ds_read_b64_tr_b16 v[200:201], v188 offset:0
    buffer_load_dwordx4 v243, s[16:19], s55 offen offset:1024 sc1 lds
    v_mfma_f32_16x16x32_bf16 v[88:91], v[208:211], v[228:231], v[88:91]
    ds_read_b64_tr_b16 v[202:203], v188 offset:2048
    ds_read_b64_tr_b16 v[196:197], v187 offset:0
    s_add_u32 m0, s44, 2048
    s_nop 0
    buffer_load_dwordx4 v240, s[32:35], s54 offen offset:0 lds
    v_mfma_f32_16x16x32_bf16 v[80:83], v[208:211], v[224:227], v[80:83]
    ds_read_b64_tr_b16 v[198:199], v187 offset:2048
    ds_read_b128 v[208:211], v184 offset:2048
    buffer_load_dwordx4 v241, s[32:35], s54 offen offset:1024 lds
    v_mfma_f32_16x16x32_bf16 v[84:87], v[212:215], v[224:227], v[84:87]
    ds_read_b64_tr_b16 v[192:193], v186 offset:0
    ds_read_b64_tr_b16 v[194:195], v186 offset:2048
    s_add_u32 m0, s44, 16384
    s_add_u32 s47, s55, 8192
    buffer_load_dwordx4 v243, s[16:19], s47 offen offset:0 sc1 lds
    v_mfma_f32_16x16x32_bf16 v[92:95], v[212:215], v[228:231], v[92:95]
    buffer_load_dwordx4 v243, s[16:19], s47 offen offset:1024 sc1 lds
    v_mfma_f32_16x16x32_bf16 v[100:103], v[212:215], v[232:235], v[100:103]
    s_add_u32 m0, s44, 18432
    s_add_u32 s47, s54, 81920
    buffer_load_dwordx4 v240, s[32:35], s47 offen offset:0 lds
    v_mfma_f32_16x16x32_bf16 v[108:111], v[212:215], v[236:239], v[108:111]
    ds_read_b128 v[212:215], v184 offset:4096
    buffer_load_dwordx4 v241, s[32:35], s47 offen offset:1024 lds
    s_add_u32 s54, s54, 128
    s_cmp_eq_u32 s54, 1280
    s_cselect_b32 s54, 0, s54
    s_lshl_b32 s55, s54, 7
    v_mfma_f32_16x16x32_bf16 v[136:139], v[216:219], v[236:239], v[136:139]
    s_add_u32 m0, s44, 32768
    s_nop 0
    buffer_load_dwordx4 v243, s[16:19], s55 offen offset:0 sc1 lds
    v_mfma_f32_16x16x32_bf16 v[128:131], v[216:219], v[232:235], v[128:131]
    buffer_load_dwordx4 v243, s[16:19], s55 offen offset:1024 sc1 lds
    v_mfma_f32_16x16x32_bf16 v[120:123], v[216:219], v[228:231], v[120:123]
    s_add_u32 m0, s44, 34816
    s_nop 0
    buffer_load_dwordx4 v240, s[32:35], s54 offen offset:0 lds
    v_mfma_f32_16x16x32_bf16 v[112:115], v[216:219], v[224:227], v[112:115]
    ds_read_b128 v[216:219], v184 offset:6144
    buffer_load_dwordx4 v241, s[32:35], s54 offen offset:1024 lds
    v_mfma_f32_16x16x32_bf16 v[116:119], v[220:223], v[224:227], v[116:119]
    s_add_u32 m0, s44, 49152
    s_add_u32 s47, s55, 8192
    buffer_load_dwordx4 v243, s[16:19], s47 offen offset:0 sc1 lds
    v_mfma_f32_16x16x32_bf16 v[124:127], v[220:223], v[228:231], v[124:127]
    buffer_load_dwordx4 v243, s[16:19], s47 offen offset:1024 sc1 lds
    v_mfma_f32_16x16x32_bf16 v[132:135], v[220:223], v[232:235], v[132:135]
    s_add_u32 m0, s44, 51200
    s_add_u32 s47, s54, 81920
    buffer_load_dwordx4 v240, s[32:35], s47 offen offset:0 lds
    v_mfma_f32_16x16x32_bf16 v[140:143], v[220:223], v[236:239], v[140:143]
    ds_read_b128 v[220:223], v184 offset:8192
    buffer_load_dwordx4 v241, s[32:35], s47 offen offset:1024 lds
    s_add_u32 s54, s54, 128
    s_cmp_eq_u32 s54, 1280
    s_cselect_b32 s54, 0, s54
    s_lshl_b32 s55, s54, 7
    s_waitcnt lgkmcnt(3)
    v_mfma_f32_16x16x32_bf16 v[40:43], v[252:255], v[204:207], v[40:43]
    ds_read_b64_tr_b16 v[236:237], v189 offset:16384
    v_mfma_f32_16x16x32_bf16 v[32:35], v[252:255], v[200:203], v[32:35]
    ds_read_b64_tr_b16 v[238:239], v189 offset:18432
    v_mfma_f32_16x16x32_bf16 v[24:27], v[252:255], v[196:199], v[24:27]
    ds_read_b64_tr_b16 v[232:233], v188 offset:16384
    v_mfma_f32_16x16x32_bf16 v[16:19], v[252:255], v[192:195], v[16:19]
    ds_read_b128 v[252:255], v184 offset:10240
    v_mfma_f32_16x16x32_bf16 v[20:23], v[208:211], v[192:195], v[20:23]
    ds_read_b64_tr_b16 v[234:235], v188 offset:18432
    v_mfma_f32_16x16x32_bf16 v[28:31], v[208:211], v[196:199], v[28:31]
    ds_read_b64_tr_b16 v[228:229], v187 offset:16384
    v_mfma_f32_16x16x32_bf16 v[36:39], v[208:211], v[200:203], v[36:39]
    ds_read_b64_tr_b16 v[230:231], v187 offset:18432
    v_mfma_f32_16x16x32_bf16 v[44:47], v[208:211], v[204:207], v[44:47]
    ds_read_b128 v[208:211], v184 offset:12288
    s_waitcnt lgkmcnt(10)
    v_mfma_f32_16x16x32_bf16 v[72:75], v[212:215], v[204:207], v[72:75]
    ds_read_b64_tr_b16 v[224:225], v186 offset:16384
    v_mfma_f32_16x16x32_bf16 v[64:67], v[212:215], v[200:203], v[64:67]
    ds_read_b64_tr_b16 v[226:227], v186 offset:18432
    v_mfma_f32_16x16x32_bf16 v[56:59], v[212:215], v[196:199], v[56:59]
    v_mfma_f32_16x16x32_bf16 v[48:51], v[212:215], v[192:195], v[48:51]
    ds_read_b128 v[212:215], v184 offset:14336
    s_waitcnt lgkmcnt(12)
    v_mfma_f32_16x16x32_bf16 v[52:55], v[216:219], v[192:195], v[52:55]
    v_mfma_f32_16x16x32_bf16 v[60:63], v[216:219], v[196:199], v[60:63]
    v_mfma_f32_16x16x32_bf16 v[68:71], v[216:219], v[200:203], v[68:71]
    v_mfma_f32_16x16x32_bf16 v[76:79], v[216:219], v[204:207], v[76:79]
    ds_read_b128 v[216:219], v185 offset:0
    s_waitcnt lgkmcnt(12)
    v_mfma_f32_16x16x32_bf16 v[104:107], v[220:223], v[204:207], v[104:107]
    v_mfma_f32_16x16x32_bf16 v[96:99], v[220:223], v[200:203], v[96:99]
    v_mfma_f32_16x16x32_bf16 v[88:91], v[220:223], v[196:199], v[88:91]
    v_mfma_f32_16x16x32_bf16 v[80:83], v[220:223], v[192:195], v[80:83]
    ds_read_b128 v[220:223], v185 offset:2048
    s_waitcnt lgkmcnt(9)
    v_mfma_f32_16x16x32_bf16 v[84:87], v[252:255], v[192:195], v[84:87]
    v_mfma_f32_16x16x32_bf16 v[92:95], v[252:255], v[196:199], v[92:95]
    v_mfma_f32_16x16x32_bf16 v[100:103], v[252:255], v[200:203], v[100:103]
    v_mfma_f32_16x16x32_bf16 v[108:111], v[252:255], v[204:207], v[108:111]
    ds_read_b128 v[252:255], v185 offset:4096
    s_waitcnt lgkmcnt(6)
    v_mfma_f32_16x16x32_bf16 v[136:139], v[208:211], v[204:207], v[136:139]
    v_mfma_f32_16x16x32_bf16 v[128:131], v[208:211], v[200:203], v[128:131]
    v_mfma_f32_16x16x32_bf16 v[120:123], v[208:211], v[196:199], v[120:123]
    v_mfma_f32_16x16x32_bf16 v[112:115], v[208:211], v[192:195], v[112:115]
    ds_read_b128 v[208:211], v185 offset:6144
    s_waitcnt lgkmcnt(4)
    v_mfma_f32_16x16x32_bf16 v[116:119], v[212:215], v[192:195], v[116:119]
    v_mfma_f32_16x16x32_bf16 v[124:127], v[212:215], v[196:199], v[124:127]
    v_mfma_f32_16x16x32_bf16 v[132:135], v[212:215], v[200:203], v[132:135]
    v_mfma_f32_16x16x32_bf16 v[140:143], v[212:215], v[204:207], v[140:143]
    ds_read_b128 v[212:215], v185 offset:8192
    s_waitcnt lgkmcnt(4)
    v_mfma_f32_16x16x32_bf16 v[40:43], v[216:219], v[236:239], v[40:43]
    v_mfma_f32_16x16x32_bf16 v[32:35], v[216:219], v[232:235], v[32:35]
    v_mfma_f32_16x16x32_bf16 v[24:27], v[216:219], v[228:231], v[24:27]
    v_mfma_f32_16x16x32_bf16 v[16:19], v[216:219], v[224:227], v[16:19]
    ds_read_b128 v[216:219], v185 offset:10240
    s_waitcnt lgkmcnt(4)
    v_mfma_f32_16x16x32_bf16 v[20:23], v[220:223], v[224:227], v[20:23]
    v_mfma_f32_16x16x32_bf16 v[28:31], v[220:223], v[228:231], v[28:31]
    v_mfma_f32_16x16x32_bf16 v[36:39], v[220:223], v[232:235], v[36:39]
    v_mfma_f32_16x16x32_bf16 v[44:47], v[220:223], v[236:239], v[44:47]
    ds_read_b128 v[220:223], v185 offset:12288
    s_waitcnt lgkmcnt(4)
    v_mfma_f32_16x16x32_bf16 v[72:75], v[252:255], v[236:239], v[72:75]
    v_cvt_pk_bf16_f32 v16, v16, v17
    v_cvt_pk_bf16_f32 v17, v18, v19
    v_cvt_pk_bf16_f32 v18, v20, v21
    v_cvt_pk_bf16_f32 v19, v22, v23
    v_mfma_f32_16x16x32_bf16 v[64:67], v[252:255], v[232:235], v[64:67]
    v_cvt_pk_bf16_f32 v20, v24, v25
    v_cvt_pk_bf16_f32 v21, v26, v27
    v_cvt_pk_bf16_f32 v22, v28, v29
    v_cvt_pk_bf16_f32 v23, v30, v31
    v_mfma_f32_16x16x32_bf16 v[56:59], v[252:255], v[228:231], v[56:59]
    v_cvt_pk_bf16_f32 v24, v32, v33
    v_cvt_pk_bf16_f32 v25, v34, v35
    v_cvt_pk_bf16_f32 v26, v36, v37
    v_cvt_pk_bf16_f32 v27, v38, v39
    v_mfma_f32_16x16x32_bf16 v[48:51], v[252:255], v[224:227], v[48:51]
    ds_read_b128 v[252:255], v185 offset:14336
    v_cvt_pk_bf16_f32 v28, v40, v41
    v_cvt_pk_bf16_f32 v29, v42, v43
    v_cvt_pk_bf16_f32 v30, v44, v45
    v_cvt_pk_bf16_f32 v31, v46, v47
    s_waitcnt lgkmcnt(4)
    v_mfma_f32_16x16x32_bf16 v[52:55], v[208:211], v[224:227], v[52:55]
    v_mfma_f32_16x16x32_bf16 v[60:63], v[208:211], v[228:231], v[60:63]
    v_mfma_f32_16x16x32_bf16 v[68:71], v[208:211], v[232:235], v[68:71]
    v_mfma_f32_16x16x32_bf16 v[76:79], v[208:211], v[236:239], v[76:79]
    s_waitcnt vmcnt(8)
    s_waitcnt lgkmcnt(0)
    s_barrier
    v_mfma_f32_16x16x32_bf16 v[104:107], v[212:215], v[236:239], v[104:107]
    ds_read_b128 v[192:195], v244 offset:0
    ds_read_b64_tr_b16 v[196:197], v248 offset:0
    ds_read_b64_tr_b16 v[198:199], v248 offset:1024
    s_add_u32 m0, s44, 65536
    s_nop 0
    buffer_load_dwordx4 v243, s[16:19], s55 offen offset:0 sc1 lds
    v_cvt_pk_bf16_f32 v32, v48, v49
    v_cvt_pk_bf16_f32 v33, v50, v51
    v_cvt_pk_bf16_f32 v34, v52, v53
    v_cvt_pk_bf16_f32 v35, v54, v55
    v_mfma_f32_16x16x32_bf16 v[96:99], v[212:215], v[232:235], v[96:99]
    ds_read_b64_tr_b16 v[200:201], v249 offset:0
    ds_read_b64_tr_b16 v[202:203], v249 offset:1024
    buffer_load_dwordx4 v243, s[16:19], s55 offen offset:1024 sc1 lds
    v_cvt_pk_bf16_f32 v36, v56, v57
    v_cvt_pk_bf16_f32 v37, v58, v59
    v_cvt_pk_bf16_f32 v38, v60, v61
    v_cvt_pk_bf16_f32 v39, v62, v63
    v_mfma_f32_16x16x32_bf16 v[88:91], v[212:215], v[228:231], v[88:91]
    s_add_u32 m0, s44, 67584
    s_nop 0
    buffer_load_dwordx4 v240, s[32:35], s54 offen offset:0 lds
    v_cvt_pk_bf16_f32 v40, v64, v65
    v_cvt_pk_bf16_f32 v41, v66, v67
    v_cvt_pk_bf16_f32 v42, v68, v69
    v_cvt_pk_bf16_f32 v43, v70, v71
    v_mfma_f32_16x16x32_bf16 v[80:83], v[212:215], v[224:227], v[80:83]
    buffer_load_dwordx4 v241, s[32:35], s54 offen offset:1024 lds
    v_cvt_pk_bf16_f32 v44, v72, v73
    v_cvt_pk_bf16_f32 v45, v74, v75
    v_cvt_pk_bf16_f32 v46, v76, v77
    v_cvt_pk_bf16_f32 v47, v78, v79
    v_mfma_f32_16x16x32_bf16 v[84:87], v[216:219], v[224:227], v[84:87]
    ds_read_b128 v[204:207], v245 offset:0
    ds_read_b64_tr_b16 v[208:209], v248 offset:8192
    ds_read_b64_tr_b16 v[210:211], v248 offset:9216
    s_add_u32 m0, s44, 81920
    s_add_u32 s47, s55, 8192
    buffer_load_dwordx4 v243, s[16:19], s47 offen offset:0 sc1 lds
    v_mfma_f32_16x16x32_bf16 v[92:95], v[216:219], v[228:231], v[92:95]
    ds_read_b64_tr_b16 v[212:213], v249 offset:8192
    ds_read_b64_tr_b16 v[214:215], v249 offset:9216
    buffer_load_dwordx4 v243, s[16:19], s47 offen offset:1024 sc1 lds
    v_mfma_f32_16x16x32_bf16 v[100:103], v[216:219], v[232:235], v[100:103]
    s_add_u32 m0, s44, 83968
    s_add_u32 s47, s54, 81920
    buffer_load_dwordx4 v240, s[32:35], s47 offen offset:0 lds
    v_mfma_f32_16x16x32_bf16 v[108:111], v[216:219], v[236:239], v[108:111]
    buffer_load_dwordx4 v241, s[32:35], s47 offen offset:1024 lds
    s_add_u32 s54, s54, 128
    s_cmp_eq_u32 s54, 1280
    s_cselect_b32 s54, 0, s54
    s_lshl_b32 s55, s54, 7
    v_mfma_f32_16x16x32_bf16 v[136:139], v[220:223], v[236:239], v[136:139]
    ds_read_b128 v[216:219], v246 offset:0
    s_add_u32 m0, s44, 98304
    s_nop 0
    buffer_load_dwordx4 v243, s[16:19], s55 offen offset:0 sc1 lds
    v_cvt_pk_bf16_f32 v48, v80, v81
    v_cvt_pk_bf16_f32 v49, v82, v83
    v_cvt_pk_bf16_f32 v50, v84, v85
    v_cvt_pk_bf16_f32 v51, v86, v87
    v_mfma_f32_16x16x32_bf16 v[128:131], v[220:223], v[232:235], v[128:131]
    buffer_load_dwordx4 v243, s[16:19], s55 offen offset:1024 sc1 lds
    v_cvt_pk_bf16_f32 v52, v88, v89
    v_cvt_pk_bf16_f32 v53, v90, v91
    v_cvt_pk_bf16_f32 v54, v92, v93
    v_cvt_pk_bf16_f32 v55, v94, v95
    v_mfma_f32_16x16x32_bf16 v[120:123], v[220:223], v[228:231], v[120:123]
    s_add_u32 m0, s44, 100352
    s_nop 0
    buffer_load_dwordx4 v240, s[32:35], s54 offen offset:0 lds
    v_cvt_pk_bf16_f32 v56, v96, v97
    v_cvt_pk_bf16_f32 v57, v98, v99
    v_cvt_pk_bf16_f32 v58, v100, v101
    v_cvt_pk_bf16_f32 v59, v102, v103
    v_mfma_f32_16x16x32_bf16 v[112:115], v[220:223], v[224:227], v[112:115]
    buffer_load_dwordx4 v241, s[32:35], s54 offen offset:1024 lds
    v_cvt_pk_bf16_f32 v60, v104, v105
    v_cvt_pk_bf16_f32 v61, v106, v107
    v_cvt_pk_bf16_f32 v62, v108, v109
    v_cvt_pk_bf16_f32 v63, v110, v111
    v_mfma_f32_16x16x32_bf16 v[116:119], v[252:255], v[224:227], v[116:119]
    ds_read_b64_tr_b16 v[220:221], v248 offset:16384
    ds_read_b64_tr_b16 v[222:223], v248 offset:17408
    s_add_u32 m0, s44, 114688
    s_add_u32 s47, s55, 8192
    buffer_load_dwordx4 v243, s[16:19], s47 offen offset:0 sc1 lds
    v_mfma_f32_16x16x32_bf16 v[124:127], v[252:255], v[228:231], v[124:127]
    buffer_load_dwordx4 v243, s[16:19], s47 offen offset:1024 sc1 lds
    v_mfma_f32_16x16x32_bf16 v[132:135], v[252:255], v[232:235], v[132:135]
    s_add_u32 m0, s44, 116736
    s_add_u32 s47, s54, 81920
    buffer_load_dwordx4 v240, s[32:35], s47 offen offset:0 lds
    v_mfma_f32_16x16x32_bf16 v[140:143], v[252:255], v[236:239], v[140:143]
    ds_read_b64_tr_b16 v[224:225], v249 offset:16384
    ds_read_b64_tr_b16 v[226:227], v249 offset:17408
    ds_read_b128 v[228:231], v247 offset:0
    ds_read_b64_tr_b16 v[232:233], v248 offset:24576
    ds_read_b64_tr_b16 v[234:235], v248 offset:25600
    ds_read_b64_tr_b16 v[236:237], v249 offset:24576
    ds_read_b64_tr_b16 v[238:239], v249 offset:25600
    buffer_load_dwordx4 v241, s[32:35], s47 offen offset:1024 lds
    s_add_u32 s54, s54, 128
    s_cmp_eq_u32 s54, 1280
    s_cselect_b32 s54, 0, s54
    s_lshl_b32 s55, s54, 7
    v_cvt_pk_bf16_f32 v64, v112, v113
    v_cvt_pk_bf16_f32 v65, v114, v115
    v_cvt_pk_bf16_f32 v66, v116, v117
    v_cvt_pk_bf16_f32 v67, v118, v119
    v_cvt_pk_bf16_f32 v68, v120, v121
    v_cvt_pk_bf16_f32 v69, v122, v123
    v_cvt_pk_bf16_f32 v70, v124, v125
    v_cvt_pk_bf16_f32 v71, v126, v127
    v_cvt_pk_bf16_f32 v72, v128, v129
    v_cvt_pk_bf16_f32 v73, v130, v131
    v_cvt_pk_bf16_f32 v74, v132, v133
    v_cvt_pk_bf16_f32 v75, v134, v135
    v_cvt_pk_bf16_f32 v76, v136, v137
    v_cvt_pk_bf16_f32 v77, v138, v139
    v_cvt_pk_bf16_f32 v78, v140, v141
    v_cvt_pk_bf16_f32 v79, v142, v143
mg_a1_r0:
    s_waitcnt vmcnt(16)
    s_barrier
    s_waitcnt lgkmcnt(15)
    v_mfma_f32_32x32x16_bf16 v[144:159], v[196:199], v[192:195], 0
    ds_read_b128 v[80:83], v244 offset:32768
    ds_read_b64_tr_b16 v[84:85], v248 offset:32768
    ds_read_b64_tr_b16 v[86:87], v248 offset:33792
    v_bfe_u32 v8, v0, 2, 2
    v_lshl_add_u32 v9, v10, 3, v8
    v_lshlrev_b32 v9, 7, v9
    v_mfma_f32_32x32x16_bf16 v[160:175], v[200:203], v[192:195], 0
    ds_read_b64_tr_b16 v[88:89], v249 offset:32768
    ds_read_b64_tr_b16 v[90:91], v249 offset:33792
    ds_read_b128 v[92:95], v245 offset:32768
    s_and_b32 s14, s61, 1
    s_lshl_b32 s13, s14, 14
    s_add_u32 s13, s13, 131072
    s_waitcnt lgkmcnt(15)
    v_mfma_f32_32x32x16_bf16 v[144:159], v[208:211], v[204:207], v[144:159]
    ds_read_b64_tr_b16 v[96:97], v248 offset:40960
    ds_read_b64_tr_b16 v[98:99], v248 offset:41984
    ds_read_b64_tr_b16 v[100:101], v249 offset:40960
    v_add_u32 v9, s13, v9
    v_bfe_u32 v11, v0, 3, 1
    v_bfe_u32 v12, v0, 2, 1
    v_mfma_f32_32x32x16_bf16 v[160:175], v[212:215], v[204:207], v[160:175]
    ds_read_b64_tr_b16 v[102:103], v249 offset:41984
    ds_read_b128 v[104:107], v246 offset:32768
    ds_read_b64_tr_b16 v[108:109], v248 offset:49152
    v_lshl_add_u32 v11, v11, 2, v12
    v_lshl_add_u32 v9, v11, 4, v9
    v_bfe_u32 v11, v0, 4, 1
    s_waitcnt lgkmcnt(15)
    v_mfma_f32_32x32x16_bf16 v[144:159], v[220:223], v[216:219], v[144:159]
    ds_read_b64_tr_b16 v[110:111], v248 offset:50176
    ds_read_b64_tr_b16 v[112:113], v249 offset:49152
    ds_read_b64_tr_b16 v[114:115], v249 offset:50176
    v_and_b32 v12, 3, v0
    v_lshl_add_u32 v11, v11, 2, v12
    v_add_u32 v12, 10, v11
    v_mfma_f32_32x32x16_bf16 v[160:175], v[224:227], v[216:219], v[160:175]
    ds_read_b128 v[116:119], v247 offset:32768
    ds_read_b64_tr_b16 v[120:121], v248 offset:57344
    ds_read_b64_tr_b16 v[122:123], v248 offset:58368
    v_min_u32 v12, 15, v12
    v_lshlrev_b32 v12, 3, v12
    s_lshl_b32 s13, s60, 3
    s_waitcnt lgkmcnt(15)
    v_mfma_f32_32x32x16_bf16 v[144:159], v[232:235], v[228:231], v[144:159]
    ds_read_b64_tr_b16 v[124:125], v249 offset:57344
    ds_read_b64_tr_b16 v[126:127], v249 offset:58368
    v_add_u32 v11, s13, v11
    v_lshlrev_b32 v11, 3, v11
    v_xor_b32 v252, v11, v9
    v_mfma_f32_32x32x16_bf16 v[160:175], v[236:239], v[228:231], v[160:175]
    buffer_store_dwordx4 v[16:19], v1, s[16:19], s74 offen offset:0 sc1
    v_xor_b32 v253, v12, v9
    v_xor_b32 v254, 32, v252
    v_xor_b32 v255, 32, v253
    s_waitcnt vmcnt(9)
    v_xor_b32 v244, 0x10000, v244
    v_xor_b32 v245, 0x10000, v245
    v_xor_b32 v246, 0x10000, v246
    v_xor_b32 v247, 0x10000, v247
    v_xor_b32 v248, 0x10000, v248
    v_xor_b32 v249, 0x10000, v249
    s_barrier
    s_waitcnt lgkmcnt(15)
    v_mfma_f32_32x32x16_bf16 v[144:159], v[84:87], v[80:83], v[144:159]
    s_add_u32 m0, s44, 0
    s_nop 0
    buffer_load_dwordx4 v243, s[16:19], s55 offen offset:0 sc1 lds
    ds_read_b128 v[192:195], v244 offset:0
    ds_read_b64_tr_b16 v[196:197], v248 offset:0
    ds_read_b64_tr_b16 v[198:199], v248 offset:1024
    s_and_b32 s13, s2, 7
    s_lshr_b32 s14, s2, 3
    s_lshl_b32 s45, s13, 2
    v_mfma_f32_32x32x16_bf16 v[160:175], v[88:91], v[80:83], v[160:175]
    buffer_load_dwordx4 v243, s[16:19], s55 offen offset:1024 sc1 lds
    ds_read_b64_tr_b16 v[200:201], v249 offset:0
    ds_read_b64_tr_b16 v[202:203], v249 offset:1024
    ds_read_b128 v[204:207], v245 offset:0
    s_and_b32 s13, s14, 3
    s_add_u32 s45, s45, s13
    s_mov_b32 s24, s4
    s_and_b32 s25, s5, 0xffff
    s_mov_b32 s26, 2621440
    s_mov_b32 s27, 0x20000
    s_waitcnt lgkmcnt(15)
    v_mfma_f32_32x32x16_bf16 v[144:159], v[96:99], v[92:95], v[144:159]
    s_add_u32 m0, s44, 2048
    s_nop 0
    buffer_load_dwordx4 v240, s[32:35], s54 offen offset:0 lds
    ds_read_b64_tr_b16 v[208:209], v248 offset:8192
    ds_read_b64_tr_b16 v[210:211], v248 offset:9216
    ds_read_b64_tr_b16 v[212:213], v249 offset:8192
    s_mov_b32 s28, s72
    s_and_b32 s29, s73, 0xffff
    s_mov_b32 s30, 5242880
    s_mov_b32 s31, 0x20000
    s_andn2_b32 s13, s14, 3
    s_and_b32 s46, s12, 3
    v_mfma_f32_32x32x16_bf16 v[160:175], v[100:103], v[92:95], v[160:175]
    buffer_load_dwordx4 v241, s[32:35], s54 offen offset:1024 lds
    ds_read_b64_tr_b16 v[214:215], v249 offset:9216
    ds_read_b128 v[216:219], v246 offset:0
    ds_read_b64_tr_b16 v[220:221], v248 offset:16384
    s_sub_u32 s13, s13, s46
    s_add_u32 s5, s13, 3
    s_mul_i32 s5, s5, 40960
    s_waitcnt lgkmcnt(15)
    v_mfma_f32_32x32x16_bf16 v[144:159], v[108:111], v[104:107], v[144:159]
    s_add_u32 m0, s44, 16384
    s_add_u32 s47, s55, 8192
    buffer_load_dwordx4 v243, s[16:19], s47 offen offset:0 sc1 lds
    ds_read_b64_tr_b16 v[222:223], v248 offset:17408
    ds_read_b64_tr_b16 v[224:225], v249 offset:16384
    ds_read_b64_tr_b16 v[226:227], v249 offset:17408
    s_sub_u32 s64, 60, s13
    s_mul_i32 s64, s64, 40960
    v_lshrrev_b32 v8, 3, v0
    v_mfma_f32_32x32x16_bf16 v[160:175], v[112:115], v[104:107], v[160:175]
    buffer_load_dwordx4 v243, s[16:19], s47 offen offset:1024 sc1 lds
    ds_read_b128 v[228:231], v247 offset:0
    ds_read_b64_tr_b16 v[232:233], v248 offset:24576
    ds_read_b64_tr_b16 v[234:235], v248 offset:25600
    v_mul_u32_u24 v8, 1280, v8
    v_and_b32 v9, 7, v0
    v_lshrrev_b32 v12, 4, v0
    s_waitcnt lgkmcnt(15)
    v_mfma_f32_32x32x16_bf16 v[144:159], v[120:123], v[116:119], v[144:159]
    s_add_u32 m0, s44, 18432
    s_add_u32 s47, s54, 81920
    buffer_load_dwordx4 v240, s[32:35], s47 offen offset:0 lds
    ds_read_b64_tr_b16 v[236:237], v249 offset:24576
    ds_read_b64_tr_b16 v[238:239], v249 offset:25600
    v_xor_b32 v9, v9, v12
    v_lshlrev_b32 v9, 4, v9
    v_xor_b32 v11, 64, v9
    v_mfma_f32_32x32x16_bf16 v[160:175], v[124:127], v[116:119], v[160:175]
    buffer_load_dwordx4 v241, s[32:35], s47 offen offset:1024 lds
    s_add_u32 s54, s54, 128
    s_cmp_eq_u32 s54, 1280
    s_cselect_b32 s54, 0, s54
    s_lshl_b32 s55, s54, 7
    v_add_u32 v184, v8, v9
    v_add_u32 v185, v8, v11
    v_add_u32 v185, 9216, v185
    s_waitcnt vmcnt(9)
    s_barrier
    s_waitcnt lgkmcnt(15)
    v_mfma_f32_32x32x16_bf16 v[144:159], v[196:199], v[192:195], v[144:159]
    s_add_u32 m0, s44, 32768
    s_nop 0
    buffer_load_dwordx4 v243, s[16:19], s55 offen offset:0 sc1 lds
    ds_read_b128 v[80:83], v244 offset:32768
    ds_read_b64_tr_b16 v[84:85], v248 offset:32768
    ds_read_b64_tr_b16 v[86:87], v248 offset:33792
    v_add_u32 v186, v8, v9
    v_add_u32 v186, 18432, v186
    v_add_u32 v187, v8, v11
    v_mfma_f32_32x32x16_bf16 v[160:175], v[200:203], v[192:195], v[160:175]
    buffer_load_dwordx4 v243, s[16:19], s55 offen offset:1024 sc1 lds
    ds_read_b64_tr_b16 v[88:89], v249 offset:32768
    ds_read_b64_tr_b16 v[90:91], v249 offset:33792
    ds_read_b128 v[92:95], v245 offset:32768
    v_add_u32 v187, 27648, v187
    s_lshl_b32 s13, s46, 16
    s_lshl_b32 s14, s45, 8
    s_waitcnt lgkmcnt(15)
    v_mfma_f32_32x32x16_bf16 v[144:159], v[208:211], v[204:207], v[144:159]
    s_add_u32 m0, s44, 34816
    s_nop 0
    buffer_load_dwordx4 v240, s[32:35], s54 offen offset:0 lds
    ds_read_b64_tr_b16 v[96:97], v248 offset:40960
    ds_read_b64_tr_b16 v[98:99], v248 offset:41984
    ds_read_b64_tr_b16 v[100:101], v249 offset:40960
    s_add_u32 s13, s13, s14
    v_bfe_u32 v8, v0, 3, 2
    v_lshlrev_b32 v8, 13, v8
    v_mfma_f32_32x32x16_bf16 v[160:175], v[212:215], v[204:207], v[160:175]
    buffer_load_dwordx4 v241, s[32:35], s54 offen offset:1024 lds
    ds_read_b64_tr_b16 v[102:103], v249 offset:41984
    ds_read_b128 v[104:107], v246 offset:32768
    ds_read_b64_tr_b16 v[108:109], v248 offset:49152
    v_lshl_add_u32 v8, v10, 7, v8
    v_add_u32 v8, s13, v8
    s_lshl_b32 s14, s60, 1
    s_waitcnt lgkmcnt(15)
    v_mfma_f32_32x32x16_bf16 v[144:159], v[220:223], v[216:219], v[144:159]
    s_add_u32 m0, s44, 49152
    s_add_u32 s47, s55, 8192
    buffer_load_dwordx4 v243, s[16:19], s47 offen offset:0 sc1 lds
    ds_read_b64_tr_b16 v[110:111], v248 offset:50176
    ds_read_b64_tr_b16 v[112:113], v249 offset:49152
    ds_read_b64_tr_b16 v[114:115], v249 offset:50176
    v_and_b32 v9, 7, v0
    v_and_b32 v12, 1, v12
    v_lshl_or_b32 v12, v12, 2, s14
    v_mfma_f32_32x32x16_bf16 v[160:175], v[224:227], v[216:219], v[160:175]
    buffer_load_dwordx4 v243, s[16:19], s47 offen offset:1024 sc1 lds
    ds_read_b128 v[116:119], v247 offset:32768
    ds_read_b64_tr_b16 v[120:121], v248 offset:57344
    ds_read_b64_tr_b16 v[122:123], v248 offset:58368
    v_xor_b32 v9, v9, v12
    v_lshl_add_u32 v188, v9, 4, v8
    v_add_u32 v189, 31744, v188
    s_waitcnt lgkmcnt(15)
    v_mfma_f32_32x32x16_bf16 v[144:159], v[232:235], v[228:231], v[144:159]
    s_add_u32 m0, s44, 51200
    s_add_u32 s47, s54, 81920
    buffer_load_dwordx4 v240, s[32:35], s47 offen offset:0 lds
    ds_read_b64_tr_b16 v[124:125], v249 offset:57344
    ds_read_b64_tr_b16 v[126:127], v249 offset:58368
    s_add_u32 s67, s44, 65536
    s_add_u32 s68, s44, 0
    s_add_u32 s69, s44, 32768
    v_mfma_f32_32x32x16_bf16 v[160:175], v[236:239], v[228:231], v[160:175]
    buffer_load_dwordx4 v241, s[32:35], s47 offen offset:1024 lds
    s_add_u32 s54, s54, 128
    s_cmp_eq_u32 s54, 1280
    s_cselect_b32 s54, 0, s54
    s_lshl_b32 s55, s54, 7
    buffer_store_dwordx4 v[20:23], v1, s[16:19], s74 offen offset:1024 sc1
    s_lshl_b32 s66, s46, 11
    s_mov_b32 s65, 0
    s_waitcnt vmcnt(9)
    v_xor_b32 v244, 0x10000, v244
    v_xor_b32 v245, 0x10000, v245
    v_xor_b32 v246, 0x10000, v246
    v_xor_b32 v247, 0x10000, v247
    v_xor_b32 v248, 0x10000, v248
    v_xor_b32 v249, 0x10000, v249
    s_barrier
    s_waitcnt lgkmcnt(15)
    v_mfma_f32_32x32x16_bf16 v[144:159], v[84:87], v[80:83], v[144:159]
    s_add_u32 m0, s44, 65536
    s_nop 0
    buffer_load_dwordx4 v243, s[16:19], s55 offen offset:0 sc1 lds
    ds_read_b128 v[192:195], v244 offset:0
    ds_read_b64_tr_b16 v[196:197], v248 offset:0
    ds_read_b64_tr_b16 v[198:199], v248 offset:1024
    v_and_b32 v8, 15, v0
    v_lshlrev_b32 v8, 7, v8
    s_add_u32 s13, s44, 65536
    v_mfma_f32_32x32x16_bf16 v[160:175], v[88:91], v[80:83], v[160:175]
    buffer_load_dwordx4 v243, s[16:19], s55 offen offset:1024 sc1 lds
    ds_read_b64_tr_b16 v[200:201], v249 offset:0
    ds_read_b64_tr_b16 v[202:203], v249 offset:1024
    ds_read_b128 v[204:207], v245 offset:0
    v_add_u32 v8, s13, v8
    v_bfe_u32 v9, v0, 1, 3
    v_lshrrev_b32 v12, 4, v0
    s_waitcnt lgkmcnt(15)
    v_mfma_f32_32x32x16_bf16 v[144:159], v[96:99], v[92:95], v[144:159]
    s_add_u32 m0, s44, 67584
    s_nop 0
    buffer_load_dwordx4 v240, s[32:35], s54 offen offset:0 lds
    ds_read_b64_tr_b16 v[208:209], v248 offset:8192
    ds_read_b64_tr_b16 v[210:211], v248 offset:9216
    ds_read_b64_tr_b16 v[212:213], v249 offset:8192
    v_xor_b32 v9, v9, v12
    v_lshl_add_u32 v178, v9, 4, v8
    v_xor_b32 v179, 64, v178
    v_mfma_f32_32x32x16_bf16 v[160:175], v[100:103], v[92:95], v[160:175]
    buffer_load_dwordx4 v241, s[32:35], s54 offen offset:1024 lds
    ds_read_b64_tr_b16 v[214:215], v249 offset:9216
    ds_read_b128 v[216:219], v246 offset:0
    ds_read_b64_tr_b16 v[220:221], v248 offset:16384
    v_bfe_u32 v8, v0, 2, 2
    v_lshlrev_b32 v9, 11, v12
    v_lshl_add_u32 v9, v8, 7, v9
    s_waitcnt lgkmcnt(15)
    v_mfma_f32_32x32x16_bf16 v[144:159], v[108:111], v[104:107], v[144:159]
    s_add_u32 m0, s44, 81920
    s_add_u32 s47, s55, 8192
    buffer_load_dwordx4 v243, s[16:19], s47 offen offset:0 sc1 lds
    ds_read_b64_tr_b16 v[222:223], v248 offset:17408
    ds_read_b64_tr_b16 v[224:225], v249 offset:16384
    ds_read_b64_tr_b16 v[226:227], v249 offset:17408
    v_and_b32 v11, 3, v0
    v_lshl_add_u32 v9, v11, 3, v9
    v_add_u32 v9, 98304, v9
    v_mfma_f32_32x32x16_bf16 v[160:175], v[112:115], v[104:107], v[160:175]
    buffer_load_dwordx4 v243, s[16:19], s47 offen offset:1024 sc1 lds
    ds_read_b128 v[228:231], v247 offset:0
    ds_read_b64_tr_b16 v[232:233], v248 offset:24576
    ds_read_b64_tr_b16 v[234:235], v248 offset:25600
    v_and_b32 v8, 2, v8
    v_and_or_b32 v8, v12, 1, v8
    v_lshl_add_u32 v180, v8, 5, v9
    s_waitcnt lgkmcnt(15)
    v_mfma_f32_32x32x16_bf16 v[144:159], v[120:123], v[116:119], v[144:159]
    s_add_u32 m0, s44, 83968
    s_add_u32 s47, s54, 81920
    buffer_load_dwordx4 v240, s[32:35], s47 offen offset:0 lds
    ds_read_b64_tr_b16 v[236:237], v249 offset:24576
    ds_read_b64_tr_b16 v[238:239], v249 offset:25600
    v_xor_b32 v181, 32, v180
    v_xor_b32 v182, 64, v180
    v_xor_b32 v183, 96, v180
    v_mfma_f32_32x32x16_bf16 v[160:175], v[124:127], v[116:119], v[160:175]
    buffer_load_dwordx4 v241, s[32:35], s47 offen offset:1024 lds
    s_add_u32 s54, s54, 128
    s_cmp_eq_u32 s54, 1280
    s_cselect_b32 s54, 0, s54
    s_lshl_b32 s55, s54, 7
    s_waitcnt vmcnt(9)
    s_barrier
    s_waitcnt lgkmcnt(15)
    v_mfma_f32_32x32x16_bf16 v[144:159], v[196:199], v[192:195], v[144:159]
    s_add_u32 m0, s44, 98304
    s_nop 0
    buffer_load_dwordx4 v243, s[16:19], s55 offen offset:0 sc1 lds
    ds_read_b128 v[80:83], v244 offset:32768
    ds_read_b64_tr_b16 v[84:85], v248 offset:32768
    ds_read_b64_tr_b16 v[86:87], v248 offset:33792
    v_bfe_u32 v8, v0, 2, 2
    v_mul_u32_u24 v8, 40, v8
    v_mfma_f32_32x32x16_bf16 v[160:175], v[200:203], v[192:195], v[160:175]
    buffer_load_dwordx4 v243, s[16:19], s55 offen offset:1024 sc1 lds
    ds_read_b64_tr_b16 v[88:89], v249 offset:32768
    ds_read_b64_tr_b16 v[90:91], v249 offset:33792
    ds_read_b128 v[92:95], v245 offset:32768
    v_bfe_u32 v9, v0, 4, 1
    v_bfe_u32 v11, v0, 1, 1
    s_waitcnt lgkmcnt(15)
    v_mfma_f32_32x32x16_bf16 v[144:159], v[208:211], v[204:207], v[144:159]
    s_add_u32 m0, s44, 100352
    s_nop 0
    buffer_load_dwordx4 v240, s[32:35], s54 offen offset:0 lds
    ds_read_b64_tr_b16 v[96:97], v248 offset:40960
    ds_read_b64_tr_b16 v[98:99], v248 offset:41984
    ds_read_b64_tr_b16 v[100:101], v249 offset:40960
    v_lshl_add_u32 v9, v9, 1, v11
    v_lshl_add_u32 v8, v9, 3, v8
    v_mfma_f32_32x32x16_bf16 v[160:175], v[212:215], v[204:207], v[160:175]
    buffer_load_dwordx4 v241, s[32:35], s54 offen offset:1024 lds
    ds_read_b64_tr_b16 v[102:103], v249 offset:41984
    ds_read_b128 v[104:107], v246 offset:32768
    ds_read_b64_tr_b16 v[108:109], v248 offset:49152
    s_mul_i32 s13, s15, 800
    s_add_u32 s13, s13, 159744
    s_waitcnt lgkmcnt(15)
    v_mfma_f32_32x32x16_bf16 v[144:159], v[220:223], v[216:219], v[144:159]
    s_add_u32 m0, s44, 114688
    s_add_u32 s47, s55, 8192
    buffer_load_dwordx4 v243, s[16:19], s47 offen offset:0 sc1 lds
    ds_read_b64_tr_b16 v[110:111], v248 offset:50176
    ds_read_b64_tr_b16 v[112:113], v249 offset:49152
    ds_read_b64_tr_b16 v[114:115], v249 offset:50176
    v_add_u32 v15, s13, v8
    v_mfma_f32_32x32x16_bf16 v[160:175], v[224:227], v[216:219], v[160:175]
    buffer_load_dwordx4 v243, s[16:19], s47 offen offset:1024 sc1 lds
    ds_read_b128 v[116:119], v247 offset:32768
    ds_read_b64_tr_b16 v[120:121], v248 offset:57344
    ds_read_b64_tr_b16 v[122:123], v248 offset:58368
    s_waitcnt lgkmcnt(15)
    v_mfma_f32_32x32x16_bf16 v[144:159], v[232:235], v[228:231], v[144:159]
    s_add_u32 m0, s44, 116736
    s_add_u32 s47, s54, 81920
    buffer_load_dwordx4 v240, s[32:35], s47 offen offset:0 lds
    ds_read_b64_tr_b16 v[124:125], v249 offset:57344
    ds_read_b64_tr_b16 v[126:127], v249 offset:58368
    v_mfma_f32_32x32x16_bf16 v[160:175], v[236:239], v[228:231], v[160:175]
    buffer_load_dwordx4 v241, s[32:35], s47 offen offset:1024 lds
    s_add_u32 s54, s54, 128
    s_cmp_eq_u32 s54, 1280
    s_cselect_b32 s54, 0, s54
    s_lshl_b32 s55, s54, 7
    buffer_store_dwordx4 v[24:27], v1, s[16:19], s75 offen offset:0 sc1
    s_waitcnt vmcnt(9)
    v_xor_b32 v244, 0x10000, v244
    v_xor_b32 v245, 0x10000, v245
    v_xor_b32 v246, 0x10000, v246
    v_xor_b32 v247, 0x10000, v247
    v_xor_b32 v248, 0x10000, v248
    v_xor_b32 v249, 0x10000, v249
    s_barrier
    s_waitcnt lgkmcnt(15)
    v_mfma_f32_32x32x16_bf16 v[144:159], v[84:87], v[80:83], v[144:159]
    s_add_u32 m0, s44, 0
    s_nop 0
    buffer_load_dwordx4 v243, s[16:19], s55 offen offset:0 sc1 lds
    ds_read_b128 v[192:195], v244 offset:0
    ds_read_b64_tr_b16 v[196:197], v248 offset:0
    ds_read_b64_tr_b16 v[198:199], v248 offset:1024
    ds_read_b64_tr_b16 v[128:129], v15 offset:0
    v_mfma_f32_32x32x16_bf16 v[160:175], v[88:91], v[80:83], v[160:175]
    buffer_load_dwordx4 v243, s[16:19], s55 offen offset:1024 sc1 lds
    ds_read_b64_tr_b16 v[200:201], v249 offset:0
    ds_read_b64_tr_b16 v[202:203], v249 offset:1024
    ds_read_b128 v[204:207], v245 offset:0
    ds_read_b64_tr_b16 v[130:131], v15 offset:160
    s_waitcnt lgkmcnt(15)
    v_mfma_f32_32x32x16_bf16 v[144:159], v[96:99], v[92:95], v[144:159]
    s_add_u32 m0, s44, 2048
    s_nop 0
    buffer_load_dwordx4 v240, s[32:35], s54 offen offset:0 lds
    ds_read_b64_tr_b16 v[208:209], v248 offset:8192
    ds_read_b64_tr_b16 v[210:211], v248 offset:9216
    ds_read_b64_tr_b16 v[212:213], v249 offset:8192
    ds_read_b64_tr_b16 v[132:133], v15 offset:320
    v_mfma_f32_32x32x16_bf16 v[160:175], v[100:103], v[92:95], v[160:175]
    buffer_load_dwordx4 v241, s[32:35], s54 offen offset:1024 lds
    ds_read_b64_tr_b16 v[214:215], v249 offset:9216
    ds_read_b128 v[216:219], v246 offset:0
    ds_read_b64_tr_b16 v[220:221], v248 offset:16384
    ds_read_b64_tr_b16 v[134:135], v15 offset:480
    s_waitcnt lgkmcnt(15)
    v_mfma_f32_32x32x16_bf16 v[144:159], v[108:111], v[104:107], v[144:159]
    s_add_u32 m0, s44, 16384
    s_add_u32 s47, s55, 8192
    buffer_load_dwordx4 v243, s[16:19], s47 offen offset:0 sc1 lds
    ds_read_b64_tr_b16 v[222:223], v248 offset:17408
    ds_read_b64_tr_b16 v[224:225], v249 offset:16384
    ds_read_b64_tr_b16 v[226:227], v249 offset:17408
    ds_read_b64_tr_b16 v[136:137], v15 offset:640
    v_mfma_f32_32x32x16_bf16 v[160:175], v[112:115], v[104:107], v[160:175]
    buffer_load_dwordx4 v243, s[16:19], s47 offen offset:1024 sc1 lds
    ds_read_b128 v[228:231], v247 offset:0
    ds_read_b64_tr_b16 v[232:233], v248 offset:24576
    ds_read_b64_tr_b16 v[234:235], v248 offset:25600
    v_mfma_f32_32x32x16_bf16 v[144:159], v[120:123], v[116:119], v[144:159]
    s_add_u32 m0, s44, 18432
    s_add_u32 s47, s54, 81920
    buffer_load_dwordx4 v240, s[32:35], s47 offen offset:0 lds
    ds_read_b64_tr_b16 v[236:237], v249 offset:24576
    ds_read_b64_tr_b16 v[238:239], v249 offset:25600
    v_mfma_f32_32x32x16_bf16 v[160:175], v[124:127], v[116:119], v[160:175]
    buffer_load_dwordx4 v241, s[32:35], s47 offen offset:1024 lds
    s_add_u32 s54, s54, 128
    s_cmp_eq_u32 s54, 1280
    s_cselect_b32 s54, 0, s54
    s_lshl_b32 s55, s54, 7
    s_waitcnt vmcnt(9)
    s_barrier
    s_waitcnt lgkmcnt(5)
    v_mfma_f32_32x32x16_bf16 v[144:159], v[196:199], v[192:195], v[144:159]
    s_add_u32 m0, s44, 32768
    s_nop 0
    buffer_load_dwordx4 v243, s[16:19], s55 offen offset:0 sc1 lds
    ds_read_b128 v[80:83], v244 offset:32768
    ds_read_b64_tr_b16 v[84:85], v248 offset:32768
    ds_read_b64_tr_b16 v[86:87], v248 offset:33792
    v_bfe_u32 v8, v0, 2, 1
    v_cmp_eq_u32 vcc, v8, v10
    v_mfma_f32_32x32x16_bf16 v[160:175], v[200:203], v[192:195], v[160:175]
    buffer_load_dwordx4 v243, s[16:19], s55 offen offset:1024 sc1 lds
    ds_read_b64_tr_b16 v[88:89], v249 offset:32768
    ds_read_b64_tr_b16 v[90:91], v249 offset:33792
    ds_read_b128 v[92:95], v245 offset:32768
    s_nop 0
    v_cndmask_b32 v128, 0, v128, vcc
    v_mfma_f32_32x32x16_bf16 v[144:159], v[208:211], v[204:207], v[144:159]
    s_add_u32 m0, s44, 34816
    s_nop 0
    buffer_load_dwordx4 v240, s[32:35], s54 offen offset:0 lds
    ds_read_b64_tr_b16 v[96:97], v248 offset:40960
    ds_read_b64_tr_b16 v[98:99], v248 offset:41984
    ds_read_b64_tr_b16 v[100:101], v249 offset:40960
    v_cndmask_b32 v129, 0, v129, vcc
    v_cndmask_b32 v130, 0, v130, vcc
    v_mfma_f32_32x32x16_bf16 v[160:175], v[212:215], v[204:207], v[160:175]
    buffer_load_dwordx4 v241, s[32:35], s54 offen offset:1024 lds
    ds_read_b64_tr_b16 v[102:103], v249 offset:41984
    ds_read_b128 v[104:107], v246 offset:32768
    ds_read_b64_tr_b16 v[108:109], v248 offset:49152
    v_cndmask_b32 v131, 0, v131, vcc
    v_cndmask_b32 v132, 0, v132, vcc
    v_mfma_f32_32x32x16_bf16 v[144:159], v[220:223], v[216:219], v[144:159]
    s_add_u32 m0, s44, 49152
    s_add_u32 s47, s55, 8192
    buffer_load_dwordx4 v243, s[16:19], s47 offen offset:0 sc1 lds
    ds_read_b64_tr_b16 v[110:111], v248 offset:50176
    ds_read_b64_tr_b16 v[112:113], v249 offset:49152
    ds_read_b64_tr_b16 v[114:115], v249 offset:50176
    v_cndmask_b32 v133, 0, v133, vcc
    v_cndmask_b32 v134, 0, v134, vcc
    v_mfma_f32_32x32x16_bf16 v[160:175], v[224:227], v[216:219], v[160:175]
    buffer_load_dwordx4 v243, s[16:19], s47 offen offset:1024 sc1 lds
    ds_read_b128 v[116:119], v247 offset:32768
    ds_read_b64_tr_b16 v[120:121], v248 offset:57344
    ds_read_b64_tr_b16 v[122:123], v248 offset:58368
    v_cndmask_b32 v135, 0, v135, vcc
    v_cndmask_b32 v136, 0, v136, vcc
    s_waitcnt lgkmcnt(15)
    v_mfma_f32_32x32x16_bf16 v[144:159], v[232:235], v[228:231], v[144:159]
    s_add_u32 m0, s44, 51200
    s_add_u32 s47, s54, 81920
    buffer_load_dwordx4 v240, s[32:35], s47 offen offset:0 lds
    ds_read_b64_tr_b16 v[124:125], v249 offset:57344
    ds_read_b64_tr_b16 v[126:127], v249 offset:58368
    v_cndmask_b32 v137, 0, v137, vcc
    v_mov_b32 v138, 0
    v_mfma_f32_32x32x16_bf16 v[160:175], v[236:239], v[228:231], v[160:175]
    buffer_load_dwordx4 v241, s[32:35], s47 offen offset:1024 lds
    s_add_u32 s54, s54, 128
    s_cmp_eq_u32 s54, 1280
    s_cselect_b32 s54, 0, s54
    s_lshl_b32 s55, s54, 7
    buffer_store_dwordx4 v[28:31], v1, s[16:19], s75 offen offset:1024 sc1
    v_mov_b32 v139, 0
    s_waitcnt vmcnt(9)
    v_xor_b32 v244, 0x10000, v244
    v_xor_b32 v245, 0x10000, v245
    v_xor_b32 v246, 0x10000, v246
    v_xor_b32 v247, 0x10000, v247
    v_xor_b32 v248, 0x10000, v248
    v_xor_b32 v249, 0x10000, v249
    s_barrier
    s_waitcnt lgkmcnt(15)
    v_mfma_f32_32x32x16_bf16 v[144:159], v[84:87], v[80:83], v[144:159]
    s_add_u32 m0, s67, 0
    s_nop 0
    buffer_load_dwordx4 v184, s[24:27], s64 offen offset:0 lds
    ds_read_b128 v[192:195], v244 offset:0
    ds_read_b64_tr_b16 v[196:197], v248 offset:0
    ds_read_b64_tr_b16 v[198:199], v248 offset:1024
    s_lshl_b32 s70, s63, 4
    s_add_u32 s70, s70, s62
    s_lshl_b32 s70, s70, 12
    v_mfma_f32_32x32x16_bf16 v[160:175], v[88:91], v[80:83], v[160:175]
    buffer_load_dwordx4 v185, s[24:27], s64 offen offset:1024 lds
    ds_read_b64_tr_b16 v[200:201], v249 offset:0
    ds_read_b64_tr_b16 v[202:203], v249 offset:1024
    ds_read_b128 v[204:207], v245 offset:0
    s_and_b32 s14, s61, 1
    s_mul_i32 s14, s14, 2016
    s_add_u32 s70, s70, s14
    s_waitcnt lgkmcnt(15)
    v_mfma_f32_32x32x16_bf16 v[144:159], v[96:99], v[92:95], v[144:159]
    buffer_load_dwordx4 v186, s[24:27], s64 offen offset:2048 lds
    ds_read_b64_tr_b16 v[208:209], v248 offset:8192
    ds_read_b64_tr_b16 v[210:211], v248 offset:9216
    ds_read_b64_tr_b16 v[212:213], v249 offset:8192
    s_mul_i32 s14, s60, 1344
    s_add_u32 s70, s70, s14
    s_add_u32 s70, s70, 58720256
    v_mfma_f32_32x32x16_bf16 v[160:175], v[100:103], v[92:95], v[160:175]
    buffer_load_dwordx4 v187, s[24:27], s64 offen offset:3072 lds
    ds_read_b64_tr_b16 v[214:215], v249 offset:9216
    ds_read_b128 v[216:219], v246 offset:0
    ds_read_b64_tr_b16 v[220:221], v248 offset:16384
    s_cmp_eq_u32 s60, 1
    s_cselect_b32 s4, 2147418112, s70
    v_mul_u32_u24 v8, 21, v10
    v_and_b32 v9, 31, v0
    s_waitcnt lgkmcnt(15)
    v_mfma_f32_32x32x16_bf16 v[144:159], v[108:111], v[104:107], v[144:159]
    s_add_u32 s64, s64, 128
    s_add_u32 m0, s67, 16384
    s_nop 0
    buffer_load_dwordx4 v184, s[24:27], s5 offen offset:0 lds
    ds_read_b64_tr_b16 v[222:223], v248 offset:17408
    ds_read_b64_tr_b16 v[224:225], v249 offset:16384
    ds_read_b64_tr_b16 v[226:227], v249 offset:17408
    v_add_u32 v8, v8, v9
    v_lshlrev_b32 v8, 4, v8
    v_add_u32 v9, 1003, v9
    v_mfma_f32_32x32x16_bf16 v[160:175], v[112:115], v[104:107], v[160:175]
    buffer_load_dwordx4 v185, s[24:27], s5 offen offset:1024 lds
    ds_read_b128 v[228:231], v247 offset:0
    ds_read_b64_tr_b16 v[232:233], v248 offset:24576
    ds_read_b64_tr_b16 v[234:235], v248 offset:25600
    v_lshrrev_b32 v9, 10, v9
    v_lshl_add_u32 v191, v9, 30, v8
    s_waitcnt lgkmcnt(15)
    v_mfma_f32_32x32x16_bf16 v[144:159], v[120:123], v[116:119], v[144:159]
    buffer_load_dwordx4 v186, s[24:27], s5 offen offset:2048 lds
    ds_read_b64_tr_b16 v[236:237], v249 offset:24576
    ds_read_b64_tr_b16 v[238:239], v249 offset:25600
    v_mfma_f32_32x32x16_bf16 v[160:175], v[124:127], v[116:119], v[160:175]
    buffer_load_dwordx4 v187, s[24:27], s5 offen offset:3072 lds
    s_add_u32 s5, s5, 128
    s_waitcnt vmcnt(9)
    s_barrier
    s_waitcnt lgkmcnt(15)
    v_mfma_f32_32x32x16_bf16 v[144:159], v[196:199], v[192:195], v[144:159]
    s_add_u32 m0, s66, 98304
    s_nop 0
    buffer_load_dwordx4 v188, s[28:31], s65 offen offset:0 lds
    ds_read_b128 v[80:83], v244 offset:32768
    ds_read_b64_tr_b16 v[84:85], v248 offset:32768
    ds_read_b64_tr_b16 v[86:87], v248 offset:33792
    v_mfma_f32_32x32x16_bf16 v[160:175], v[200:203], v[192:195], v[160:175]
    buffer_load_dwordx4 v189, s[28:31], s65 offen offset:1024 lds
    ds_read_b64_tr_b16 v[88:89], v249 offset:32768
    ds_read_b64_tr_b16 v[90:91], v249 offset:33792
    ds_read_b128 v[92:95], v245 offset:32768
    s_waitcnt lgkmcnt(15)
    v_mfma_f32_32x32x16_bf16 v[144:159], v[208:211], v[204:207], v[144:159]
    s_add_u32 s65, s65, 262144
    s_add_u32 m0, s66, 106496
    s_nop 0
    buffer_load_dwordx4 v188, s[28:31], s65 offen offset:0 lds
    ds_read_b64_tr_b16 v[96:97], v248 offset:40960
    ds_read_b64_tr_b16 v[98:99], v248 offset:41984
    ds_read_b64_tr_b16 v[100:101], v249 offset:40960
    v_mfma_f32_32x32x16_bf16 v[160:175], v[212:215], v[204:207], v[160:175]
    buffer_load_dwordx4 v189, s[28:31], s65 offen offset:1024 lds
    ds_read_b64_tr_b16 v[102:103], v249 offset:41984
    ds_read_b128 v[104:107], v246 offset:32768
    ds_read_b64_tr_b16 v[108:109], v248 offset:49152
    ds_read_b64_tr_b16 v[192:193], v15 offset:32
    s_waitcnt lgkmcnt(15)
    v_mfma_f32_32x32x16_bf16 v[144:159], v[220:223], v[216:219], v[144:159]
    s_add_u32 s65, s65, 262144
    s_add_u32 m0, s66, 114688
    s_nop 0
    buffer_load_dwordx4 v188, s[28:31], s65 offen offset:0 lds
    ds_read_b64_tr_b16 v[110:111], v248 offset:50176
    ds_read_b64_tr_b16 v[112:113], v249 offset:49152
    ds_read_b64_tr_b16 v[114:115], v249 offset:50176
    ds_read_b64_tr_b16 v[194:195], v15 offset:192
    v_mfma_f32_32x32x16_bf16 v[160:175], v[224:227], v[216:219], v[160:175]
    buffer_load_dwordx4 v189, s[28:31], s65 offen offset:1024 lds
    ds_read_b128 v[116:119], v247 offset:32768
    ds_read_b64_tr_b16 v[120:121], v248 offset:57344
    ds_read_b64_tr_b16 v[122:123], v248 offset:58368
    ds_read_b64_tr_b16 v[196:197], v15 offset:352
    s_waitcnt lgkmcnt(15)
    v_mfma_f32_32x32x16_bf16 v[144:159], v[232:235], v[228:231], v[144:159]
    s_add_u32 s65, s65, 262144
    s_add_u32 m0, s66, 122880
    s_nop 0
    buffer_load_dwordx4 v188, s[28:31], s65 offen offset:0 lds
    ds_read_b64_tr_b16 v[124:125], v249 offset:57344
    ds_read_b64_tr_b16 v[126:127], v249 offset:58368
    ds_read_b64_tr_b16 v[198:199], v15 offset:512
    v_mfma_f32_32x32x16_bf16 v[160:175], v[236:239], v[228:231], v[160:175]
    buffer_load_dwordx4 v189, s[28:31], s65 offen offset:1024 lds
    s_add_u32 s65, s65, 262144
    buffer_store_dwordx4 v[32:35], v1, s[16:19], s76 offen offset:0 sc1
    ds_read_b64_tr_b16 v[200:201], v15 offset:672
    s_waitcnt lgkmcnt(0)
    s_barrier
    v_mfma_f32_32x32x16_bf16 v[144:159], v[84:87], v[80:83], v[144:159]
    s_add_u32 m0, s68, 0
    s_nop 0
    buffer_load_dwordx4 v184, s[24:27], s64 offen offset:0 lds
    v_cndmask_b32 v192, 0, v192, vcc
    v_cndmask_b32 v193, 0, v193, vcc
    v_mfma_f32_32x32x16_bf16 v[160:175], v[88:91], v[80:83], v[160:175]
    buffer_load_dwordx4 v185, s[24:27], s64 offen offset:1024 lds
    v_cndmask_b32 v194, 0, v194, vcc
    v_cndmask_b32 v195, 0, v195, vcc
    v_mfma_f32_32x32x16_bf16 v[144:159], v[96:99], v[92:95], v[144:159]
    buffer_load_dwordx4 v186, s[24:27], s64 offen offset:2048 lds
    v_cndmask_b32 v196, 0, v196, vcc
    v_cndmask_b32 v197, 0, v197, vcc
    v_mfma_f32_32x32x16_bf16 v[160:175], v[100:103], v[92:95], v[160:175]
    buffer_load_dwordx4 v187, s[24:27], s64 offen offset:3072 lds
    v_cndmask_b32 v198, 0, v198, vcc
    v_cndmask_b32 v199, 0, v199, vcc
    v_mfma_f32_32x32x16_bf16 v[144:159], v[108:111], v[104:107], v[144:159]
    s_add_u32 s64, s64, 128
    s_add_u32 m0, s68, 16384
    s_nop 0
    buffer_load_dwordx4 v184, s[24:27], s5 offen offset:0 lds
    v_cndmask_b32 v200, 0, v200, vcc
    v_cndmask_b32 v201, 0, v201, vcc
    v_mfma_f32_32x32x16_bf16 v[160:175], v[112:115], v[104:107], v[160:175]
    buffer_load_dwordx4 v185, s[24:27], s5 offen offset:1024 lds
    v_mov_b32 v202, 0
    v_mov_b32 v203, 0
    v_mfma_f32_32x32x16_bf16 v[144:159], v[120:123], v[116:119], v[144:159]
    buffer_load_dwordx4 v186, s[24:27], s5 offen offset:2048 lds
    v_mfma_f32_32x32x16_bf16 v[160:175], v[124:127], v[116:119], v[160:175]
    buffer_load_dwordx4 v187, s[24:27], s5 offen offset:3072 lds
    s_add_u32 s5, s5, 128
    s_and_b32 s13, s12, 3
    s_lshl_b32 s13, s13, 12
    s_lshl_b32 s14, s15, 14
    s_add_u32 s13, s13, s14
    s_add_u32 s13, s13, 131072
    v_and_b32 v8, 31, v0
    v_lshlrev_b32 v8, 7, v8
    v_add_u32 v8, s13, v8
    v_bfe_u32 v9, v0, 1, 1
    v_and_b32 v11, 1, v0
    v_lshl_add_u32 v9, v9, 2, v11
    v_bfe_u32 v11, v0, 2, 1
    v_lshl_add_u32 v9, v11, 1, v9
    v_lshl_add_u32 v15, v9, 4, v8
    v_cvt_pk_bf16_f32 v224, v144, v145
    v_cvt_pk_bf16_f32 v225, v146, v147
    v_cvt_pk_bf16_f32 v226, v148, v149
    v_cvt_pk_bf16_f32 v227, v150, v151
    v_cvt_pk_bf16_f32 v228, v152, v153
    v_cvt_pk_bf16_f32 v229, v154, v155
    v_cvt_pk_bf16_f32 v230, v156, v157
    v_cvt_pk_bf16_f32 v231, v158, v159
    v_cvt_pk_bf16_f32 v232, v160, v161
    v_cvt_pk_bf16_f32 v233, v162, v163
    v_cvt_pk_bf16_f32 v234, v164, v165
    v_cvt_pk_bf16_f32 v235, v166, v167
    v_cvt_pk_bf16_f32 v236, v168, v169
    v_cvt_pk_bf16_f32 v237, v170, v171
    v_cvt_pk_bf16_f32 v238, v172, v173
    v_cvt_pk_bf16_f32 v239, v174, v175
    v_mfma_f32_32x32x16_bf16 v[80:95], v[128:131], v[224:227], 0
    v_mfma_f32_32x32x16_bf16 v[96:111], v[192:195], v[224:227], 0
    v_mfma_f32_32x32x16_bf16 v[80:95], v[132:135], v[228:231], v[80:95]
    v_mfma_f32_32x32x16_bf16 v[96:111], v[196:199], v[228:231], v[96:111]
    v_mfma_f32_32x32x16_bf16 v[80:95], v[136:139], v[232:235], v[80:95]
    v_mfma_f32_32x32x16_bf16 v[96:111], v[200:203], v[232:235], v[96:111]
    buffer_store_dwordx4 v[36:39], v1, s[16:19], s76 offen offset:1024 sc1
    buffer_store_dwordx4 v[40:43], v1, s[16:19], s77 offen offset:0 sc1
    buffer_store_dwordx4 v[44:47], v1, s[16:19], s77 offen offset:1024 sc1
    v_mov_b32 v11, 0x3f80
    v_cmp_eq_u32 vcc, 0, v10
    s_nop 0
    s_nop 0
    v_cndmask_b32 v238, v11, v238, vcc
    v_cndmask_b32 v239, 0, v239, vcc
    v_mul_u32_u24 v11, 56, v10
    v_xor_b32 v11, 80, v11
    v_xor_b32 v12, v11, v15
    ds_write_b64 v12, v[234:235]
    v_mul_u32_u24 v11, 40, v10
    v_xor_b32 v11, 88, v11
    v_xor_b32 v13, v11, v15
    ds_write_b64 v13, v[236:237]
    v_mul_u32_u24 v11, 24, v10
    v_xor_b32 v11, 96, v11
    v_xor_b32 v14, v11, v15
    ds_write_b64 v14, v[238:239]
    v_max3_f32 v8, v80, v81, v82
    v_min3_f32 v9, v80, v81, v82
    v_max3_f32 v8, v8, v83, v84
    v_min3_f32 v9, v9, v83, v84
    v_max3_f32 v8, v8, v85, v86
    v_min3_f32 v9, v9, v85, v86
    v_max3_f32 v8, v8, v87, v88
    v_min3_f32 v9, v9, v87, v88
    v_max3_f32 v8, v8, v89, v90
    v_min3_f32 v9, v9, v89, v90
    v_max3_f32 v8, v8, v91, v92
    v_min3_f32 v9, v9, v91, v92
    v_max3_f32 v8, v8, v93, v94
    v_min3_f32 v9, v9, v93, v94
    v_max3_f32 v8, v8, v95, v96
    v_min3_f32 v9, v9, v95, v96
    v_max3_f32 v8, v8, v97, v98
    v_min3_f32 v9, v9, v97, v98
    v_max_f32 v8, v8, v99
    v_min_f32 v9, v9, v99
    s_mov_b32 s56, 0x3fb8aa3b
    s_mov_b32 s57, 0x3fb8aa3b
    s_mov_b32 s58, 0xbfb8aa3b
    s_mov_b32 s59, 0xbfb8aa3b
    v_mul_f32 v152, s58, v8
    v_mul_f32 v153, s58, v8
    v_mul_f32 v154, s56, v9
    v_mul_f32 v155, s56, v9
    v_pk_fma_f32 v[112:113], v[80:81], s[56:57], v[152:153]
    v_pk_fma_f32 v[132:133], v[80:81], s[58:59], v[154:155]
    v_pk_fma_f32 v[114:115], v[82:83], s[56:57], v[152:153]
    v_pk_fma_f32 v[134:135], v[82:83], s[58:59], v[154:155]
    v_pk_fma_f32 v[116:117], v[84:85], s[56:57], v[152:153]
    v_pk_fma_f32 v[136:137], v[84:85], s[58:59], v[154:155]
    v_pk_fma_f32 v[118:119], v[86:87], s[56:57], v[152:153]
    v_pk_fma_f32 v[138:139], v[86:87], s[58:59], v[154:155]
    v_pk_fma_f32 v[120:121], v[88:89], s[56:57], v[152:153]
    v_pk_fma_f32 v[140:141], v[88:89], s[58:59], v[154:155]
    v_pk_fma_f32 v[122:123], v[90:91], s[56:57], v[152:153]
    v_pk_fma_f32 v[142:143], v[90:91], s[58:59], v[154:155]
    v_pk_fma_f32 v[124:125], v[92:93], s[56:57], v[152:153]
    v_pk_fma_f32 v[144:145], v[92:93], s[58:59], v[154:155]
    v_pk_fma_f32 v[126:127], v[94:95], s[56:57], v[152:153]
    v_pk_fma_f32 v[146:147], v[94:95], s[58:59], v[154:155]
    v_pk_fma_f32 v[128:129], v[96:97], s[56:57], v[152:153]
    v_pk_fma_f32 v[148:149], v[96:97], s[58:59], v[154:155]
    v_pk_fma_f32 v[130:131], v[98:99], s[56:57], v[152:153]
    v_pk_fma_f32 v[150:151], v[98:99], s[58:59], v[154:155]
    v_exp_f32 v112, v112
    v_exp_f32 v113, v113
    v_exp_f32 v114, v114
    v_exp_f32 v115, v115
    v_exp_f32 v116, v116
    v_exp_f32 v117, v117
    v_exp_f32 v118, v118
    v_exp_f32 v119, v119
    v_exp_f32 v120, v120
    v_exp_f32 v121, v121
    v_exp_f32 v122, v122
    v_exp_f32 v123, v123
    v_exp_f32 v124, v124
    v_exp_f32 v125, v125
    v_exp_f32 v126, v126
    v_exp_f32 v127, v127
    v_exp_f32 v128, v128
    v_exp_f32 v129, v129
    v_exp_f32 v130, v130
    v_exp_f32 v131, v131
    v_exp_f32 v132, v132
    v_exp_f32 v133, v133
    v_exp_f32 v134, v134
    v_exp_f32 v135, v135
    v_exp_f32 v136, v136
    v_exp_f32 v137, v137
    v_exp_f32 v138, v138
    v_exp_f32 v139, v139
    v_exp_f32 v140, v140
    v_exp_f32 v141, v141
    v_exp_f32 v142, v142
    v_exp_f32 v143, v143
    v_exp_f32 v144, v144
    v_exp_f32 v145, v145
    v_exp_f32 v146, v146
    v_exp_f32 v147, v147
    v_exp_f32 v148, v148
    v_exp_f32 v149, v149
    v_exp_f32 v150, v150
    v_exp_f32 v151, v151
    v_pk_add_f32 v[152:153], v[112:113], v[114:115]
    v_pk_add_f32 v[154:155], v[132:133], v[134:135]
    v_pk_add_f32 v[152:153], v[152:153], v[116:117]
    v_pk_add_f32 v[154:155], v[154:155], v[136:137]
    v_pk_add_f32 v[152:153], v[152:153], v[118:119]
    v_pk_add_f32 v[154:155], v[154:155], v[138:139]
    v_pk_add_f32 v[152:153], v[152:153], v[120:121]
    v_pk_add_f32 v[154:155], v[154:155], v[140:141]
    v_pk_add_f32 v[152:153], v[152:153], v[122:123]
    v_pk_add_f32 v[154:155], v[154:155], v[142:143]
    v_pk_add_f32 v[152:153], v[152:153], v[124:125]
    v_pk_add_f32 v[154:155], v[154:155], v[144:145]
    v_pk_add_f32 v[152:153], v[152:153], v[126:127]
    v_pk_add_f32 v[154:155], v[154:155], v[146:147]
    v_pk_add_f32 v[152:153], v[152:153], v[128:129]
    v_pk_add_f32 v[154:155], v[154:155], v[148:149]
    v_pk_add_f32 v[152:153], v[152:153], v[130:131]
    v_pk_add_f32 v[154:155], v[154:155], v[150:151]
    v_add_f32 v152, v152, v153
    v_add_f32 v154, v154, v155
    v_rcp_f32 v152, v152
    v_rcp_f32 v154, v154
    s_nop 0
    v_mov_b32 v153, v152
    v_mov_b32 v155, v154
    v_pk_mul_f32 v[112:113], v[112:113], v[152:153]
    v_pk_mul_f32 v[132:133], v[132:133], v[154:155]
    v_pk_mul_f32 v[114:115], v[114:115], v[152:153]
    v_pk_mul_f32 v[134:135], v[134:135], v[154:155]
    v_pk_mul_f32 v[116:117], v[116:117], v[152:153]
    v_pk_mul_f32 v[136:137], v[136:137], v[154:155]
    v_pk_mul_f32 v[118:119], v[118:119], v[152:153]
    v_pk_mul_f32 v[138:139], v[138:139], v[154:155]
    v_pk_mul_f32 v[120:121], v[120:121], v[152:153]
    v_pk_mul_f32 v[140:141], v[140:141], v[154:155]
    v_pk_mul_f32 v[122:123], v[122:123], v[152:153]
    v_pk_mul_f32 v[142:143], v[142:143], v[154:155]
    v_pk_mul_f32 v[124:125], v[124:125], v[152:153]
    v_pk_mul_f32 v[144:145], v[144:145], v[154:155]
    v_pk_mul_f32 v[126:127], v[126:127], v[152:153]
    v_pk_mul_f32 v[146:147], v[146:147], v[154:155]
    v_pk_mul_f32 v[128:129], v[128:129], v[152:153]
    v_pk_mul_f32 v[148:149], v[148:149], v[154:155]
    v_pk_mul_f32 v[130:131], v[130:131], v[152:153]
    v_pk_mul_f32 v[150:151], v[150:151], v[154:155]
    s_waitcnt lgkmcnt(0)
    v_cvt_pk_bf16_f32 v232, v112, v113
    v_cvt_pk_bf16_f32 v233, v114, v115
    v_cvt_pk_bf16_f32 v234, v116, v117
    v_cvt_pk_bf16_f32 v235, v118, v119
    v_cvt_pk_bf16_f32 v236, v120, v121
    v_cvt_pk_bf16_f32 v237, v122, v123
    v_cvt_pk_bf16_f32 v238, v124, v125
    v_cvt_pk_bf16_f32 v239, v126, v127
    v_cvt_pk_bf16_f32 v240, v128, v129
    v_cvt_pk_bf16_f32 v241, v130, v131
    v_cvt_pk_bf16_f32 v242, v132, v133
    v_cvt_pk_bf16_f32 v243, v134, v135
    v_cvt_pk_bf16_f32 v244, v136, v137
    v_cvt_pk_bf16_f32 v245, v138, v139
    v_cvt_pk_bf16_f32 v246, v140, v141
    v_cvt_pk_bf16_f32 v247, v142, v143
    v_cvt_pk_bf16_f32 v248, v144, v145
    v_cvt_pk_bf16_f32 v249, v146, v147
    v_cvt_pk_bf16_f32 v250, v148, v149
    v_cvt_pk_bf16_f32 v251, v150, v151
    v_xor_b32 v11, 16, v15
    v_xor_b32 v12, 32, v15
    v_xor_b32 v13, 48, v15
    v_xor_b32 v14, 64, v15
    s_mov_b32 exec_lo, 0
    ds_write_b128 v15, v[232:235]
    ds_write_b128 v11, v[236:239]
    ds_write_b128 v12, v[240:243]
    ds_write_b128 v13, v[244:247]
    ds_write_b128 v14, v[248:251]
    s_mov_b32 exec_lo, -1
    s_waitcnt vmcnt(16)
    s_waitcnt lgkmcnt(0)
    s_barrier
    ds_read_b128 v[192:195], v178 offset:0
    ds_read_b64_tr_b16 v[208:209], v180 offset:0
    ds_read_b64_tr_b16 v[210:211], v180 offset:1024
    ds_read_b128 v[196:199], v178 offset:2048
    ds_read_b64_tr_b16 v[212:213], v181 offset:0
    ds_read_b64_tr_b16 v[214:215], v181 offset:1024
    ds_read_b64_tr_b16 v[216:217], v182 offset:0
    ds_read_b64_tr_b16 v[218:219], v182 offset:1024
    ds_read_b64_tr_b16 v[220:221], v183 offset:0
    ds_read_b64_tr_b16 v[222:223], v183 offset:1024
    ds_read_b64_tr_b16 v[224:225], v180 offset:512
    ds_read_b64_tr_b16 v[226:227], v180 offset:1536
    ds_read_b64_tr_b16 v[228:229], v181 offset:512
    ds_read_b64_tr_b16 v[230:231], v181 offset:1536
    s_add_u32 m0, s69, 0
    s_nop 0
    buffer_load_dwordx4 v184, s[24:27], s64 offen offset:0 lds
    buffer_load_dwordx4 v185, s[24:27], s64 offen offset:1024 lds
    buffer_load_dwordx4 v186, s[24:27], s64 offen offset:2048 lds
    buffer_load_dwordx4 v187, s[24:27], s64 offen offset:3072 lds
    s_add_u32 s64, s64, 128
    s_add_u32 m0, s69, 16384
    s_nop 0
    buffer_load_dwordx4 v184, s[24:27], s5 offen offset:0 lds
    buffer_load_dwordx4 v185, s[24:27], s5 offen offset:1024 lds
    buffer_load_dwordx4 v186, s[24:27], s5 offen offset:2048 lds
    buffer_load_dwordx4 v187, s[24:27], s5 offen offset:3072 lds
    s_add_u32 s5, s5, 128
    s_waitcnt lgkmcnt(10)
    v_mfma_f32_16x16x32_bf16 v[80:83], v[208:211], v[192:195], 0
    ds_read_b128 v[200:203], v179 offset:0
    s_and_b32 s13, s2, 7
    s_lshr_b32 s14, s2, 3
    v_mfma_f32_16x16x32_bf16 v[88:91], v[208:211], v[196:199], 0
    ds_read_b64_tr_b16 v[208:209], v182 offset:512
    ds_read_b64_tr_b16 v[210:211], v182 offset:1536
    s_lshl_b32 s61, s13, 2
    s_and_b32 s13, s14, 3
    ds_read_b64_tr_b16 v[16:17], v252 offset:0
    ds_read_b64_tr_b16 v[18:19], v254 offset:512
    ds_read_b64_tr_b16 v[20:21], v253 offset:0
    ds_read_b64_tr_b16 v[22:23], v255 offset:512
    s_waitcnt lgkmcnt(15)
    v_mfma_f32_16x16x32_bf16 v[92:95], v[212:215], v[196:199], 0
    ds_read_b128 v[204:207], v179 offset:2048
    s_add_u32 s61, s61, s13
    s_andn2_b32 s13, s14, 3
    v_mfma_f32_16x16x32_bf16 v[84:87], v[212:215], v[192:195], 0
    ds_read_b64_tr_b16 v[212:213], v183 offset:512
    ds_read_b64_tr_b16 v[214:215], v183 offset:1536
    s_sub_u32 s14, s12, s13
    s_add_u32 s14, s14, 60
    ds_read_b64_tr_b16 v[24:25], v252 offset:2048
    ds_read_b64_tr_b16 v[26:27], v254 offset:2560
    ds_read_b64_tr_b16 v[28:29], v253 offset:2048
    ds_read_b64_tr_b16 v[30:31], v255 offset:2560
    s_waitcnt lgkmcnt(15)
    v_mfma_f32_16x16x32_bf16 v[96:99], v[216:219], v[192:195], 0
    s_sub_u32 s13, s13, s12
    s_add_u32 s13, s13, 7
    v_mfma_f32_16x16x32_bf16 v[104:107], v[216:219], v[196:199], 0
    ds_read_b64_tr_b16 v[216:217], v180 offset:8192
    ds_read_b64_tr_b16 v[218:219], v180 offset:9216
    s_cmp_eq_u32 s15, 0
    s_cselect_b32 s44, s14, s13
    s_lshr_b32 s46, s44, 1
    ds_read_b64_tr_b16 v[32:33], v252 offset:4096
    ds_read_b64_tr_b16 v[34:35], v254 offset:4608
    ds_read_b64_tr_b16 v[36:37], v253 offset:4096
    ds_read_b64_tr_b16 v[38:39], v255 offset:4608
    v_mfma_f32_16x16x32_bf16 v[108:111], v[220:223], v[196:199], 0
    s_waitcnt lgkmcnt(13)
    v_mfma_f32_32x32x16_bf16 v[144:159], v[16:19], v[20:23], 0
    v_mfma_f32_16x16x32_bf16 v[100:103], v[220:223], v[192:195], 0
    ds_read_b64_tr_b16 v[220:221], v181 offset:8192
    ds_read_b64_tr_b16 v[222:223], v181 offset:9216
    ds_read_b64_tr_b16 v[40:41], v252 offset:6144
    ds_read_b64_tr_b16 v[42:43], v254 offset:6656
    ds_read_b64_tr_b16 v[44:45], v253 offset:6144
    ds_read_b64_tr_b16 v[46:47], v255 offset:6656
    ds_read_b64_tr_b16 v[16:17], v252 offset:8192
    ds_read_b64_tr_b16 v[18:19], v254 offset:8704
    ds_read_b64_tr_b16 v[20:21], v253 offset:8192
    ds_read_b64_tr_b16 v[22:23], v255 offset:8704
    v_mfma_f32_16x16x32_bf16 v[112:115], v[224:227], v[192:195], 0
    s_add_u32 s46, s46, 1
    s_lshr_b32 s45, s2, 5
    s_waitcnt lgkmcnt(15)
    v_mfma_f32_32x32x16_bf16 v[144:159], v[24:27], v[28:31], v[144:159]
    v_mfma_f32_16x16x32_bf16 v[120:123], v[224:227], v[196:199], 0
    ds_read_b64_tr_b16 v[224:225], v182 offset:8192
    ds_read_b64_tr_b16 v[226:227], v182 offset:9216
    s_lshl_b32 s45, s45, 1
    s_sub_u32 s45, 32, s45
    ds_read_b64_tr_b16 v[24:25], v252 offset:10240
    ds_read_b64_tr_b16 v[26:27], v254 offset:10752
    ds_read_b64_tr_b16 v[28:29], v253 offset:10240
    ds_read_b64_tr_b16 v[30:31], v255 offset:10752
    v_mfma_f32_16x16x32_bf16 v[124:127], v[228:231], v[196:199], 0
    s_and_b32 s13, s12, 3
    s_lshl_b32 s13, s13, 12
    s_waitcnt lgkmcnt(15)
    v_mfma_f32_32x32x16_bf16 v[144:159], v[32:35], v[36:39], v[144:159]
    v_mfma_f32_16x16x32_bf16 v[116:119], v[228:231], v[192:195], 0
    ds_read_b64_tr_b16 v[228:229], v183 offset:8192
    ds_read_b64_tr_b16 v[230:231], v183 offset:9216
    s_mov_b32 s50, s13
    s_add_u32 s51, s13, 114688
    ds_read_b64_tr_b16 v[32:33], v252 offset:12288
    ds_read_b64_tr_b16 v[34:35], v254 offset:12800
    ds_read_b64_tr_b16 v[36:37], v253 offset:12288
    ds_read_b64_tr_b16 v[38:39], v255 offset:12800
    v_mfma_f32_16x16x32_bf16 v[128:131], v[208:211], v[192:195], 0
    s_lshl_b32 s14, s61, 19
    s_add_u32 s52, s13, s14
    s_waitcnt lgkmcnt(15)
    v_mfma_f32_32x32x16_bf16 v[144:159], v[40:43], v[44:47], v[144:159]
    v_mfma_f32_16x16x32_bf16 v[136:139], v[208:211], v[196:199], 0
    ds_read_b64_tr_b16 v[208:209], v180 offset:8704
    ds_read_b64_tr_b16 v[210:211], v180 offset:9728
    s_add_u32 s53, s52, 16777216
    s_lshl_b32 s13, s61, 19
    ds_read_b64_tr_b16 v[40:41], v252 offset:14336
    ds_read_b64_tr_b16 v[42:43], v254 offset:14848
    ds_read_b64_tr_b16 v[44:45], v253 offset:14336
    ds_read_b64_tr_b16 v[46:47], v255 offset:14848
    v_mfma_f32_16x16x32_bf16 v[140:143], v[212:215], v[196:199], 0
    s_waitcnt lgkmcnt(15)
    v_mfma_f32_32x32x16_bf16 v[144:159], v[16:19], v[20:23], v[144:159]
    v_mfma_f32_16x16x32_bf16 v[132:135], v[212:215], v[192:195], 0
    ds_read_b64_tr_b16 v[212:213], v181 offset:8704
    ds_read_b64_tr_b16 v[214:215], v181 offset:9728
    v_mfma_f32_16x16x32_bf16 v[80:83], v[216:219], v[200:203], v[80:83]
    s_lshl_b32 s14, s45, 14
    s_add_u32 s32, s6, s13
    s_addc_u32 s33, s7, 0
    s_and_b32 s33, s33, 0xffff
    s_mov_b32 s34, s14
    s_mov_b32 s35, 0x20000
    s_waitcnt lgkmcnt(14)
    v_mfma_f32_32x32x16_bf16 v[144:159], v[24:27], v[28:31], v[144:159]
    v_mfma_f32_16x16x32_bf16 v[88:91], v[216:219], v[204:207], v[88:91]
    ds_read_b64_tr_b16 v[216:217], v182 offset:8704
    ds_read_b64_tr_b16 v[218:219], v182 offset:9728
    s_add_u32 s13, s13, 16777216
    s_add_u32 s36, s6, s13
    s_addc_u32 s37, s7, 0
    s_and_b32 s37, s37, 0xffff
    s_mov_b32 s38, s14
    s_mov_b32 s39, 0x20000
    v_mfma_f32_16x16x32_bf16 v[92:95], v[220:223], v[204:207], v[92:95]
    s_mov_b32 s54, 0
    s_mov_b32 s55, 0x2f800000
    s_waitcnt lgkmcnt(10)
    v_mfma_f32_32x32x16_bf16 v[144:159], v[32:35], v[36:39], v[144:159]
    v_mfma_f32_16x16x32_bf16 v[84:87], v[220:223], v[200:203], v[84:87]
    ds_read_b64_tr_b16 v[220:221], v183 offset:8704
    ds_read_b64_tr_b16 v[222:223], v183 offset:9728
    s_mov_b32 s47, s46
    s_lshl_b32 s56, s46, 15
    v_mfma_f32_16x16x32_bf16 v[96:99], v[224:227], v[200:203], v[96:99]
    s_and_b32 s56, s56, 32768
    s_or_b32 s56, s56, 16384
    s_waitcnt lgkmcnt(6)
    v_mfma_f32_32x32x16_bf16 v[144:159], v[40:43], v[44:47], v[144:159]
    v_mfma_f32_16x16x32_bf16 v[104:107], v[224:227], v[204:207], v[104:107]
    s_xor_b32 s57, s56, 32768
    s_lshr_b32 s58, s46, 1
    v_mfma_f32_16x16x32_bf16 v[108:111], v[228:231], v[204:207], v[108:111]
    s_sub_u32 s58, s58, 1
    s_and_b32 s60, s44, 1
    v_mfma_f32_16x16x32_bf16 v[100:103], v[228:231], v[200:203], v[100:103]
    s_mov_b32 s48, 16384
    s_mov_b32 s49, 2576980380
    s_waitcnt lgkmcnt(4)
    v_mfma_f32_16x16x32_bf16 v[112:115], v[208:211], v[200:203], v[112:115]
    buffer_store_dwordx4 v[48:51], v3, s[16:19], s74 offen offset:0 sc1
    v_add_u32 v178, 4294901760, v178
    v_add_u32 v179, 4294901760, v179
    v_add_u32 v180, 16384, v180
    v_add_u32 v181, 16384, v181
    v_add_u32 v182, 16384, v182
    v_add_u32 v183, 16384, v183
    s_waitcnt vmcnt(12)
    s_waitcnt lgkmcnt(0)
    s_barrier
    s_add_u32 m0, s66, 131072
    s_nop 0
    buffer_load_dwordx4 v188, s[28:31], s65 offen offset:0 lds
    buffer_load_dwordx4 v189, s[28:31], s65 offen offset:1024 lds
    s_add_u32 s65, s65, 262144
    s_add_u32 m0, s66, 139264
    s_nop 0
    buffer_load_dwordx4 v188, s[28:31], s65 offen offset:0 lds
    buffer_load_dwordx4 v189, s[28:31], s65 offen offset:1024 lds
    s_add_u32 s65, s65, 262144
    v_mfma_f32_16x16x32_bf16 v[120:123], v[208:211], v[204:207], v[120:123]
    v_cvt_pk_bf16_f32 v144, v144, v145
    v_cvt_pk_bf16_f32 v145, v146, v147
    ds_read_b128 v[192:195], v178 offset:0
    ds_read_b64_tr_b16 v[224:225], v180 offset:0
    ds_read_b64_tr_b16 v[226:227], v180 offset:1024
    s_add_u32 m0, s67, 0
    s_nop 0
    buffer_load_dwordx4 v184, s[24:27], s64 offen offset:0 lds
    v_mfma_f32_16x16x32_bf16 v[124:127], v[212:215], v[204:207], v[124:127]
    v_cvt_pk_bf16_f32 v146, v148, v149
    v_cvt_pk_bf16_f32 v147, v150, v151
    buffer_store_dwordx4 v[144:147], v191, s[16:19], s70 offen sc1
    ds_read_b128 v[196:199], v178 offset:2048
    ds_read_b64_tr_b16 v[228:229], v181 offset:0
    ds_read_b64_tr_b16 v[230:231], v181 offset:1024
    v_mfma_f32_16x16x32_bf16 v[116:119], v[212:215], v[200:203], v[116:119]
    v_cvt_pk_bf16_f32 v148, v152, v153
    v_cvt_pk_bf16_f32 v149, v154, v155
    ds_read_b64_tr_b16 v[208:209], v182 offset:0
    ds_read_b64_tr_b16 v[210:211], v182 offset:1024
    buffer_load_dwordx4 v185, s[24:27], s64 offen offset:1024 lds
    v_mfma_f32_16x16x32_bf16 v[128:131], v[216:219], v[200:203], v[128:131]
    v_cvt_pk_bf16_f32 v150, v156, v157
    v_cvt_pk_bf16_f32 v151, v158, v159
    buffer_store_dwordx4 v[148:151], v191, s[16:19], s4 offen offset:672 sc1
    ds_read_b64_tr_b16 v[212:213], v183 offset:0
    ds_read_b64_tr_b16 v[214:215], v183 offset:1024
    v_mfma_f32_16x16x32_bf16 v[136:139], v[216:219], v[204:207], v[136:139]
    ds_read_b64_tr_b16 v[216:217], v180 offset:512
    ds_read_b64_tr_b16 v[218:219], v180 offset:1536
    buffer_load_dwordx4 v186, s[24:27], s64 offen offset:2048 lds
    v_mfma_f32_16x16x32_bf16 v[140:143], v[220:223], v[204:207], v[140:143]
    v_mfma_f32_16x16x32_bf16 v[132:135], v[220:223], v[200:203], v[132:135]
    ds_read_b64_tr_b16 v[220:221], v181 offset:512
    ds_read_b64_tr_b16 v[222:223], v181 offset:1536
    buffer_load_dwordx4 v187, s[24:27], s64 offen offset:3072 lds
    s_waitcnt lgkmcnt(10)
    v_mfma_f32_16x16x32_bf16 v[80:83], v[224:227], v[192:195], v[80:83]
    ds_read_b128 v[200:203], v179 offset:0
    s_lshl_b32 s13, s12, 5
    s_mov_b32 s14, 147456
    v_and_b32 v8, 31, v0
    v_mfma_f32_16x16x32_bf16 v[88:91], v[224:227], v[196:199], v[88:91]
    ds_read_b64_tr_b16 v[224:225], v182 offset:512
    ds_read_b64_tr_b16 v[226:227], v182 offset:1536
    s_add_u32 s64, s64, 128
    s_add_u32 m0, s67, 16384
    s_nop 0
    buffer_load_dwordx4 v184, s[24:27], s5 offen offset:0 lds
    v_add_u32 v8, s13, v8
    v_min_u32 v8, 251, v8
    v_lshlrev_b32 v8, 4, v8
    s_waitcnt lgkmcnt(11)
    v_mfma_f32_16x16x32_bf16 v[92:95], v[228:231], v[196:199], v[92:95]
    ds_read_b128 v[204:207], v179 offset:2048
    v_lshl_add_u32 v8, v10, 12, v8
    v_and_b32 v11, 15, v0
    v_lshl_add_u32 v11, v10, 4, v11
    v_mfma_f32_16x16x32_bf16 v[84:87], v[228:231], v[192:195], v[84:87]
    ds_read_b64_tr_b16 v[228:229], v183 offset:512
    ds_read_b64_tr_b16 v[230:231], v183 offset:1536
    buffer_load_dwordx4 v185, s[24:27], s5 offen offset:1024 lds
    v_add_u32 v11, s13, v11
    v_min_u32 v11, 251, v11
    v_mul_u32_u24 v9, 3121, v11
    s_waitcnt lgkmcnt(10)
    v_mfma_f32_16x16x32_bf16 v[96:99], v[208:211], v[192:195], v[96:99]
    v_lshrrev_b32 v9, 16, v9
    v_and_b32 v9, 1, v9
    v_mul_u32_u24 v9, 328, v9
    v_mfma_f32_16x16x32_bf16 v[104:107], v[208:211], v[196:199], v[104:107]
    ds_read_b64_tr_b16 v[208:209], v180 offset:8192
    ds_read_b64_tr_b16 v[210:211], v180 offset:9216
    buffer_load_dwordx4 v186, s[24:27], s5 offen offset:2048 lds
    v_lshlrev_b32 v11, 4, v11
    v_sub_u32 v11, v11, v9
    v_bfe_u32 v9, v0, 4, 1
    v_mfma_f32_16x16x32_bf16 v[108:111], v[212:215], v[196:199], v[108:111]
    v_mul_u32_u24 v9, 336, v9
    v_add3_u32 v11, v11, v9, s14
    s_mul_i32 s13, s15, 2016
    v_mfma_f32_16x16x32_bf16 v[100:103], v[212:215], v[192:195], v[100:103]
    ds_read_b64_tr_b16 v[212:213], v181 offset:8192
    ds_read_b64_tr_b16 v[214:215], v181 offset:9216
    buffer_load_dwordx4 v187, s[24:27], s5 offen offset:3072 lds
    s_add_u32 s5, s5, 128
    s_waitcnt lgkmcnt(10)
    v_mfma_f32_16x16x32_bf16 v[112:115], v[216:219], v[192:195], v[112:115]
    s_add_u32 s13, s13, 147456
    v_and_b32 v12, 31, v0
    v_mfma_f32_16x16x32_bf16 v[120:123], v[216:219], v[196:199], v[120:123]
    ds_read_b64_tr_b16 v[216:217], v182 offset:8192
    ds_read_b64_tr_b16 v[218:219], v182 offset:9216
    s_add_u32 m0, s66, 98304
    s_nop 0
    buffer_load_dwordx4 v188, s[28:31], s65 offen offset:0 lds
    v_min_u32 v13, 20, v12
    v_lshlrev_b32 v13, 4, v13
    v_mfma_f32_16x16x32_bf16 v[124:127], v[220:223], v[196:199], v[124:127]
    v_lshl_add_u32 v13, v10, 12, v13
    v_add_u32 v13, s13, v13
    v_mfma_f32_16x16x32_bf16 v[116:119], v[220:223], v[192:195], v[116:119]
    ds_read_b64_tr_b16 v[220:221], v183 offset:8192
    ds_read_b64_tr_b16 v[222:223], v183 offset:9216
    buffer_load_dwordx4 v189, s[28:31], s65 offen offset:1024 lds
    s_lshl_b32 s13, s62, 2
    s_and_b32 s14, s12, 3
    s_waitcnt lgkmcnt(8)
    v_mfma_f32_16x16x32_bf16 v[128:131], v[224:227], v[192:195], v[128:131]
    s_add_u32 s13, s13, s14
    s_mul_i32 s13, s13, 40960
    v_mfma_f32_16x16x32_bf16 v[136:139], v[224:227], v[196:199], v[136:139]
    ds_read_b64_tr_b16 v[224:225], v180 offset:8704
    ds_read_b64_tr_b16 v[226:227], v180 offset:9728
    s_add_u32 s65, s65, 262144
    s_add_u32 m0, s66, 106496
    s_nop 0
    buffer_load_dwordx4 v188, s[28:31], s65 offen offset:0 lds
    s_mul_i32 s14, s63, 1280
    s_add_u32 s13, s13, s14
    v_mfma_f32_16x16x32_bf16 v[140:143], v[228:231], v[196:199], v[140:143]
    s_add_u32 s71, s13, 62914560
    s_mul_i32 s14, s15, 5
    v_mfma_f32_16x16x32_bf16 v[132:135], v[228:231], v[192:195], v[132:135]
    ds_read_b64_tr_b16 v[228:229], v181 offset:8704
    ds_read_b64_tr_b16 v[230:231], v181 offset:9728
    buffer_load_dwordx4 v189, s[28:31], s65 offen offset:1024 lds
    s_add_u32 s65, s65, 262144
    s_waitcnt lgkmcnt(8)
    v_mfma_f32_16x16x32_bf16 v[80:83], v[208:211], v[200:203], v[80:83]
    v_add_u32 v14, s14, v10
    v_bfe_u32 v12, v0, 4, 1
    v_mfma_f32_16x16x32_bf16 v[88:91], v[208:211], v[204:207], v[88:91]
    ds_read_b64_tr_b16 v[208:209], v182 offset:8704
    ds_read_b64_tr_b16 v[210:211], v182 offset:9728
    v_mul_u32_u24 v12, 20480, v12
    v_and_b32 v15, 15, v0
    v_mfma_f32_16x16x32_bf16 v[92:95], v[212:215], v[204:207], v[92:95]
    v_lshl_add_u32 v12, v15, 4, v12
    v_lshrrev_b32 v15, 1, v14
    v_mfma_f32_16x16x32_bf16 v[84:87], v[212:215], v[200:203], v[84:87]
    ds_read_b64_tr_b16 v[212:213], v183 offset:8704
    ds_read_b64_tr_b16 v[214:215], v183 offset:9728
    v_lshl_add_u32 v12, v15, 8, v12
    v_and_b32 v15, 1, v14
    s_waitcnt lgkmcnt(8)
    v_mfma_f32_16x16x32_bf16 v[96:99], v[216:219], v[200:203], v[96:99]
    v_lshl_add_u32 v12, v15, 3, v12
    v_lshl_add_u32 v14, v10, 30, v12
    v_mfma_f32_16x16x32_bf16 v[104:107], v[216:219], v[204:207], v[104:107]
    s_and_b32 s13, s2, 7
    s_lshl_b32 s13, s13, 1
    v_mfma_f32_16x16x32_bf16 v[108:111], v[220:223], v[204:207], v[108:111]
    s_lshr_b32 s14, s2, 6
    s_lshr_b32 s14, 9, s14
    s_and_b32 s14, s14, 1
    s_add_u32 s13, s13, s14
    v_mfma_f32_16x16x32_bf16 v[100:103], v[220:223], v[200:203], v[100:103]
    v_lshlrev_b32 v4, 2, s13
    v_mov_b32 v5, 1
    s_waitcnt lgkmcnt(4)
    v_mfma_f32_16x16x32_bf16 v[112:115], v[224:227], v[200:203], v[112:115]
    buffer_store_dwordx4 v[52:55], v3, s[16:19], s74 offen offset:1024 sc1
    v_add_u32 v178, 32768, v178
    v_add_u32 v179, 32768, v179
    v_add_u32 v180, 16384, v180
    v_add_u32 v181, 16384, v181
    v_add_u32 v182, 16384, v182
    v_add_u32 v183, 16384, v183
    s_waitcnt vmcnt(15)
    s_waitcnt lgkmcnt(0)
    s_barrier
    v_mfma_f32_16x16x32_bf16 v[120:123], v[224:227], v[204:207], v[120:123]
    ds_read_b128 v[192:195], v178 offset:0
    ds_read_b64_tr_b16 v[216:217], v180 offset:0
    ds_read_b64_tr_b16 v[218:219], v180 offset:1024
    s_add_u32 m0, s68, 0
    s_nop 0
    buffer_load_dwordx4 v184, s[24:27], s64 offen offset:0 lds
    v_mfma_f32_16x16x32_bf16 v[124:127], v[228:231], v[204:207], v[124:127]
    ds_read_b128 v[196:199], v178 offset:2048
    ds_read_b64_tr_b16 v[220:221], v181 offset:0
    ds_read_b64_tr_b16 v[222:223], v181 offset:1024
    v_mfma_f32_16x16x32_bf16 v[116:119], v[228:231], v[200:203], v[116:119]
    ds_read_b64_tr_b16 v[224:225], v182 offset:0
    ds_read_b64_tr_b16 v[226:227], v182 offset:1024
    buffer_load_dwordx4 v185, s[24:27], s64 offen offset:1024 lds
    v_mfma_f32_16x16x32_bf16 v[128:131], v[208:211], v[200:203], v[128:131]
    ds_read_b64_tr_b16 v[228:229], v183 offset:0
    ds_read_b64_tr_b16 v[230:231], v183 offset:1024
    v_mfma_f32_16x16x32_bf16 v[136:139], v[208:211], v[204:207], v[136:139]
    ds_read_b64_tr_b16 v[208:209], v180 offset:512
    ds_read_b64_tr_b16 v[210:211], v180 offset:1536
    buffer_load_dwordx4 v186, s[24:27], s64 offen offset:2048 lds
    v_mfma_f32_16x16x32_bf16 v[140:143], v[212:215], v[204:207], v[140:143]
    v_mfma_f32_16x16x32_bf16 v[132:135], v[212:215], v[200:203], v[132:135]
    ds_read_b64_tr_b16 v[212:213], v181 offset:512
    ds_read_b64_tr_b16 v[214:215], v181 offset:1536
    buffer_load_dwordx4 v187, s[24:27], s64 offen offset:3072 lds
    s_cmp_eq_u32 s12, 3
    s_cbranch_scc0 mg_w3a1_r0
    s_mov_b64 exec, 1
    buffer_atomic_add v5, v4, s[20:23], 0 offen sc0 sc1
    s_mov_b64 exec, -1
mg_w3a1_r0:
    s_waitcnt lgkmcnt(10)
    v_mfma_f32_16x16x32_bf16 v[80:83], v[216:219], v[192:195], v[80:83]
    ds_read_b128 v[200:203], v179 offset:0
    s_load_dwordx2 s[40:41], s[0:1], 80
    s_lshl_b32 s13, s44, 5
    v_mfma_f32_16x16x32_bf16 v[88:91], v[216:219], v[196:199], v[88:91]
    ds_read_b64_tr_b16 v[216:217], v182 offset:512
    ds_read_b64_tr_b16 v[218:219], v182 offset:1536
    s_add_u32 s64, s64, 128
    s_add_u32 m0, s68, 16384
    s_nop 0
    buffer_load_dwordx4 v184, s[24:27], s5 offen offset:0 lds
    s_add_u32 s13, s13, s61
    s_lshl_b32 s13, s13, 4
    s_waitcnt lgkmcnt(11)
    v_mfma_f32_16x16x32_bf16 v[92:95], v[220:223], v[196:199], v[92:95]
    ds_read_b128 v[204:207], v179 offset:2048
    s_add_u32 s9, s13, 75497472
    v_mov_b32 v190, 0
    v_mfma_f32_16x16x32_bf16 v[84:87], v[220:223], v[192:195], v[84:87]
    ds_read_b64_tr_b16 v[220:221], v183 offset:512
    ds_read_b64_tr_b16 v[222:223], v183 offset:1536
    buffer_load_dwordx4 v185, s[24:27], s5 offen offset:1024 lds
    s_mov_b64 exec, 1
    buffer_store_dword v190, off, s[16:19], s9 sc1
    s_mov_b64 exec, -1
    s_bfe_u32 s13, s2, 262146
    s_waitcnt lgkmcnt(10)
    v_mfma_f32_16x16x32_bf16 v[96:99], v[224:227], v[192:195], v[96:99]
    s_lshl_b32 s13, s13, 8
    s_add_u32 s13, s13, 75563008
    v_mfma_f32_16x16x32_bf16 v[104:107], v[224:227], v[196:199], v[104:107]
    ds_read_b64_tr_b16 v[224:225], v180 offset:8192
    ds_read_b64_tr_b16 v[226:227], v180 offset:9216
    buffer_load_dwordx4 v186, s[24:27], s5 offen offset:2048 lds
    s_and_b32 s14, s2, 195
    s_or_b32 s14, s14, s12
    s_cselect_b64 exec, 0, 1
    buffer_store_dword v190, off, s[16:19], s13 sc1
    s_mov_b64 exec, -1
    v_mfma_f32_16x16x32_bf16 v[108:111], v[228:231], v[196:199], v[108:111]
    v_mfma_f32_16x16x32_bf16 v[100:103], v[228:231], v[192:195], v[100:103]
    ds_read_b64_tr_b16 v[228:229], v181 offset:8192
    ds_read_b64_tr_b16 v[230:231], v181 offset:9216
    buffer_load_dwordx4 v187, s[24:27], s5 offen offset:3072 lds
    s_add_u32 s5, s5, 128
    s_waitcnt lgkmcnt(10)
    v_mfma_f32_16x16x32_bf16 v[112:115], v[208:211], v[192:195], v[112:115]
    v_mfma_f32_16x16x32_bf16 v[120:123], v[208:211], v[196:199], v[120:123]
    ds_read_b64_tr_b16 v[208:209], v182 offset:8192
    ds_read_b64_tr_b16 v[210:211], v182 offset:9216
    s_add_u32 m0, s66, 114688
    s_nop 0
    buffer_load_dwordx4 v188, s[28:31], s65 offen offset:0 lds
    v_mfma_f32_16x16x32_bf16 v[124:127], v[212:215], v[196:199], v[124:127]
    v_mfma_f32_16x16x32_bf16 v[116:119], v[212:215], v[192:195], v[116:119]
    ds_read_b64_tr_b16 v[212:213], v183 offset:8192
    ds_read_b64_tr_b16 v[214:215], v183 offset:9216
    buffer_load_dwordx4 v189, s[28:31], s65 offen offset:1024 lds
    s_waitcnt lgkmcnt(8)
    v_mfma_f32_16x16x32_bf16 v[128:131], v[216:219], v[192:195], v[128:131]
    v_mfma_f32_16x16x32_bf16 v[136:139], v[216:219], v[196:199], v[136:139]
    ds_read_b64_tr_b16 v[216:217], v180 offset:8704
    ds_read_b64_tr_b16 v[218:219], v180 offset:9728
    s_add_u32 s65, s65, 262144
    s_add_u32 m0, s66, 122880
    s_nop 0
    buffer_load_dwordx4 v188, s[28:31], s65 offen offset:0 lds
    v_mfma_f32_16x16x32_bf16 v[140:143], v[220:223], v[196:199], v[140:143]
    v_mfma_f32_16x16x32_bf16 v[132:135], v[220:223], v[192:195], v[132:135]
    ds_read_b64_tr_b16 v[220:221], v181 offset:8704
    ds_read_b64_tr_b16 v[222:223], v181 offset:9728
    buffer_load_dwordx4 v189, s[28:31], s65 offen offset:1024 lds
    s_add_u32 s65, s65, 262144
    s_waitcnt lgkmcnt(8)
    v_mfma_f32_16x16x32_bf16 v[80:83], v[224:227], v[200:203], v[80:83]
    v_mfma_f32_16x16x32_bf16 v[88:91], v[224:227], v[204:207], v[88:91]
    ds_read_b64_tr_b16 v[224:225], v182 offset:8704
    ds_read_b64_tr_b16 v[226:227], v182 offset:9728
    v_mfma_f32_16x16x32_bf16 v[92:95], v[228:231], v[204:207], v[92:95]
    v_mfma_f32_16x16x32_bf16 v[84:87], v[228:231], v[200:203], v[84:87]
    ds_read_b64_tr_b16 v[228:229], v183 offset:8704
    ds_read_b64_tr_b16 v[230:231], v183 offset:9728
    s_waitcnt lgkmcnt(8)
    v_mfma_f32_16x16x32_bf16 v[96:99], v[208:211], v[200:203], v[96:99]
    v_mfma_f32_16x16x32_bf16 v[104:107], v[208:211], v[204:207], v[104:107]
    v_mfma_f32_16x16x32_bf16 v[108:111], v[212:215], v[204:207], v[108:111]
    v_mfma_f32_16x16x32_bf16 v[100:103], v[212:215], v[200:203], v[100:103]
    s_waitcnt lgkmcnt(4)
    v_mfma_f32_16x16x32_bf16 v[112:115], v[216:219], v[200:203], v[112:115]
    buffer_store_dwordx4 v[56:59], v3, s[16:19], s75 offen offset:0 sc1
    v_add_u32 v178, 32768, v178
    v_add_u32 v179, 32768, v179
    v_add_u32 v180, 4294934528, v180
    v_add_u32 v181, 4294934528, v181
    v_add_u32 v182, 4294934528, v182
    v_add_u32 v183, 4294934528, v183
    s_waitcnt vmcnt(16)
    s_waitcnt lgkmcnt(0)
    s_barrier
    v_mfma_f32_16x16x32_bf16 v[120:123], v[216:219], v[204:207], v[120:123]
    ds_read_b128 v[192:195], v178 offset:0
    ds_read_b64_tr_b16 v[208:209], v180 offset:0
    ds_read_b64_tr_b16 v[210:211], v180 offset:1024
    s_add_u32 m0, s69, 0
    s_nop 0
    buffer_load_dwordx4 v184, s[24:27], s64 offen offset:0 lds
    v_mfma_f32_16x16x32_bf16 v[124:127], v[220:223], v[204:207], v[124:127]
    ds_read_b128 v[196:199], v178 offset:2048
    ds_read_b64_tr_b16 v[212:213], v181 offset:0
    ds_read_b64_tr_b16 v[214:215], v181 offset:1024
    v_mfma_f32_16x16x32_bf16 v[116:119], v[220:223], v[200:203], v[116:119]
    ds_read_b64_tr_b16 v[216:217], v182 offset:0
    ds_read_b64_tr_b16 v[218:219], v182 offset:1024
    buffer_load_dwordx4 v185, s[24:27], s64 offen offset:1024 lds
    v_mfma_f32_16x16x32_bf16 v[128:131], v[224:227], v[200:203], v[128:131]
    ds_read_b64_tr_b16 v[220:221], v183 offset:0
    ds_read_b64_tr_b16 v[222:223], v183 offset:1024
    v_mfma_f32_16x16x32_bf16 v[136:139], v[224:227], v[204:207], v[136:139]
    ds_read_b64_tr_b16 v[224:225], v180 offset:512
    ds_read_b64_tr_b16 v[226:227], v180 offset:1536
    buffer_load_dwordx4 v186, s[24:27], s64 offen offset:2048 lds
    v_mfma_f32_16x16x32_bf16 v[140:143], v[228:231], v[204:207], v[140:143]
    v_mfma_f32_16x16x32_bf16 v[132:135], v[228:231], v[200:203], v[132:135]
    ds_read_b64_tr_b16 v[228:229], v181 offset:512
    ds_read_b64_tr_b16 v[230:231], v181 offset:1536
    buffer_load_dwordx4 v187, s[24:27], s64 offen offset:3072 lds
    s_waitcnt lgkmcnt(10)
    v_mfma_f32_16x16x32_bf16 v[80:83], v[208:211], v[192:195], v[80:83]
    ds_read_b128 v[200:203], v179 offset:0
    v_bfe_u32 v144, v0, 4, 1
    v_and_b32 v145, 15, v0
    v_lshlrev_b32 v144, 3, v144
    v_mfma_f32_16x16x32_bf16 v[88:91], v[208:211], v[196:199], v[88:91]
    ds_read_b64_tr_b16 v[208:209], v182 offset:512
    ds_read_b64_tr_b16 v[210:211], v182 offset:1536
    s_add_u32 s64, s64, 128
    s_add_u32 m0, s69, 16384
    s_nop 0
    buffer_load_dwordx4 v184, s[24:27], s5 offen offset:0 lds
    v_sub_u32 v144, v145, v144
    v_and_b32 v145, 1, v0
    v_lshlrev_b32 v145, 4, v145
    s_waitcnt lgkmcnt(11)
    v_mfma_f32_16x16x32_bf16 v[92:95], v[212:215], v[196:199], v[92:95]
    ds_read_b128 v[204:207], v179 offset:2048
    v_mov_b32 v146, 0x3f80
    v_lshlrev_b32 v145, v145, v146
    v_lshrrev_b32 v144, 1, v144
    v_mfma_f32_16x16x32_bf16 v[84:87], v[212:215], v[192:195], v[84:87]
    ds_read_b64_tr_b16 v[212:213], v183 offset:512
    ds_read_b64_tr_b16 v[214:215], v183 offset:1536
    buffer_load_dwordx4 v185, s[24:27], s5 offen offset:1024 lds
    v_cmp_eq_u32 vcc, 0, v144
    s_nop 1
    v_cndmask_b32 v148, 0, v145, vcc
    v_cmp_eq_u32 vcc, 1, v144
    s_nop 1
    v_cndmask_b32 v149, 0, v145, vcc
    v_cmp_eq_u32 vcc, 2, v144
    s_nop 1
    v_cndmask_b32 v150, 0, v145, vcc
    s_waitcnt lgkmcnt(10)
    v_mfma_f32_16x16x32_bf16 v[96:99], v[216:219], v[192:195], v[96:99]
    v_cmp_eq_u32 vcc, 3, v144
    s_nop 1
    v_cndmask_b32 v151, 0, v145, vcc
    s_lshl_b32 s13, s12, 9
    s_add_u32 s13, s13, 151552
    v_mfma_f32_16x16x32_bf16 v[104:107], v[216:219], v[196:199], v[104:107]
    ds_read_b64_tr_b16 v[216:217], v180 offset:8192
    ds_read_b64_tr_b16 v[218:219], v180 offset:9216
    buffer_load_dwordx4 v186, s[24:27], s5 offen offset:2048 lds
    v_lshl_add_u32 v144, v0, 3, s13
    v_mov_b32 v146, 0
    v_mov_b32 v147, 0
    v_mfma_f32_16x16x32_bf16 v[108:111], v[220:223], v[196:199], v[108:111]
    ds_write_b64 v144, v[146:147]
    s_lshl_b32 s70, s63, 16
    s_add_u32 s70, s70, 58720256
    v_mfma_f32_16x16x32_bf16 v[100:103], v[220:223], v[192:195], v[100:103]
    ds_read_b64_tr_b16 v[220:221], v181 offset:8192
    ds_read_b64_tr_b16 v[222:223], v181 offset:9216
    buffer_load_dwordx4 v187, s[24:27], s5 offen offset:3072 lds
    s_add_u32 s5, s5, 128
    s_waitcnt lgkmcnt(11)
    v_mfma_f32_16x16x32_bf16 v[112:115], v[224:227], v[192:195], v[112:115]
    v_mfma_f32_16x16x32_bf16 v[120:123], v[224:227], v[196:199], v[120:123]
    ds_read_b64_tr_b16 v[224:225], v182 offset:8192
    ds_read_b64_tr_b16 v[226:227], v182 offset:9216
    s_add_u32 m0, s66, 131072
    s_nop 0
    buffer_load_dwordx4 v188, s[28:31], s65 offen offset:0 lds
    v_mfma_f32_16x16x32_bf16 v[124:127], v[228:231], v[196:199], v[124:127]
    v_mfma_f32_16x16x32_bf16 v[116:119], v[228:231], v[192:195], v[116:119]
    ds_read_b64_tr_b16 v[228:229], v183 offset:8192
    ds_read_b64_tr_b16 v[230:231], v183 offset:9216
    buffer_load_dwordx4 v189, s[28:31], s65 offen offset:1024 lds
    s_waitcnt lgkmcnt(9)
    v_mfma_f32_16x16x32_bf16 v[128:131], v[208:211], v[192:195], v[128:131]
    v_mfma_f32_16x16x32_bf16 v[136:139], v[208:211], v[196:199], v[136:139]
    ds_read_b64_tr_b16 v[208:209], v180 offset:8704
    ds_read_b64_tr_b16 v[210:211], v180 offset:9728
    s_add_u32 s65, s65, 262144
    s_add_u32 m0, s66, 139264
    s_nop 0
    buffer_load_dwordx4 v188, s[28:31], s65 offen offset:0 lds
    v_mfma_f32_16x16x32_bf16 v[140:143], v[212:215], v[196:199], v[140:143]
    v_mfma_f32_16x16x32_bf16 v[132:135], v[212:215], v[192:195], v[132:135]
    ds_read_b64_tr_b16 v[212:213], v181 offset:8704
    ds_read_b64_tr_b16 v[214:215], v181 offset:9728
    buffer_load_dwordx4 v189, s[28:31], s65 offen offset:1024 lds
    s_add_u32 s65, s65, 262144
    s_waitcnt lgkmcnt(8)
    v_mfma_f32_16x16x32_bf16 v[80:83], v[216:219], v[200:203], v[80:83]
    v_mfma_f32_16x16x32_bf16 v[88:91], v[216:219], v[204:207], v[88:91]
    ds_read_b64_tr_b16 v[216:217], v182 offset:8704
    ds_read_b64_tr_b16 v[218:219], v182 offset:9728
    v_mfma_f32_16x16x32_bf16 v[92:95], v[220:223], v[204:207], v[92:95]
    v_mfma_f32_16x16x32_bf16 v[84:87], v[220:223], v[200:203], v[84:87]
    ds_read_b64_tr_b16 v[220:221], v183 offset:8704
    ds_read_b64_tr_b16 v[222:223], v183 offset:9728
    s_waitcnt lgkmcnt(8)
    v_mfma_f32_16x16x32_bf16 v[96:99], v[224:227], v[200:203], v[96:99]
    v_mfma_f32_16x16x32_bf16 v[104:107], v[224:227], v[204:207], v[104:107]
    v_mfma_f32_16x16x32_bf16 v[108:111], v[228:231], v[204:207], v[108:111]
    v_mfma_f32_16x16x32_bf16 v[100:103], v[228:231], v[200:203], v[100:103]
    s_waitcnt lgkmcnt(4)
    v_mfma_f32_16x16x32_bf16 v[112:115], v[208:211], v[200:203], v[112:115]
    buffer_store_dwordx4 v[60:63], v3, s[16:19], s75 offen offset:1024 sc1
    v_add_u32 v178, 4294901760, v178
    v_add_u32 v179, 4294901760, v179
    v_add_u32 v180, 16384, v180
    v_add_u32 v181, 16384, v181
    v_add_u32 v182, 16384, v182
    v_add_u32 v183, 16384, v183
    s_waitcnt vmcnt(14)
    s_waitcnt lgkmcnt(0)
    s_barrier
    v_mfma_f32_16x16x32_bf16 v[120:123], v[208:211], v[204:207], v[120:123]
    ds_read_b128 v[192:195], v178 offset:0
    ds_read_b64_tr_b16 v[224:225], v180 offset:0
    ds_read_b64_tr_b16 v[226:227], v180 offset:1024
    s_add_u32 m0, s67, 0
    s_nop 0
    buffer_load_dwordx4 v184, s[24:27], s64 offen offset:0 lds
    v_mfma_f32_16x16x32_bf16 v[124:127], v[212:215], v[204:207], v[124:127]
    ds_read_b128 v[196:199], v178 offset:2048
    ds_read_b64_tr_b16 v[228:229], v181 offset:0
    ds_read_b64_tr_b16 v[230:231], v181 offset:1024
    v_mfma_f32_16x16x32_bf16 v[116:119], v[212:215], v[200:203], v[116:119]
    ds_read_b64_tr_b16 v[208:209], v182 offset:0
    ds_read_b64_tr_b16 v[210:211], v182 offset:1024
    buffer_load_dwordx4 v185, s[24:27], s64 offen offset:1024 lds
    v_mfma_f32_16x16x32_bf16 v[128:131], v[216:219], v[200:203], v[128:131]
    ds_read_b64_tr_b16 v[212:213], v183 offset:0
    ds_read_b64_tr_b16 v[214:215], v183 offset:1024
    v_mfma_f32_16x16x32_bf16 v[136:139], v[216:219], v[204:207], v[136:139]
    ds_read_b64_tr_b16 v[216:217], v180 offset:512
    ds_read_b64_tr_b16 v[218:219], v180 offset:1536
    buffer_load_dwordx4 v186, s[24:27], s64 offen offset:2048 lds
    v_mfma_f32_16x16x32_bf16 v[140:143], v[220:223], v[204:207], v[140:143]
    v_mfma_f32_16x16x32_bf16 v[132:135], v[220:223], v[200:203], v[132:135]
    ds_read_b64_tr_b16 v[220:221], v181 offset:512
    ds_read_b64_tr_b16 v[222:223], v181 offset:1536
    buffer_load_dwordx4 v187, s[24:27], s64 offen offset:3072 lds
    s_waitcnt lgkmcnt(10)
    v_mfma_f32_16x16x32_bf16 v[80:83], v[224:227], v[192:195], v[80:83]
    ds_read_b128 v[200:203], v179 offset:0
    s_cmp_eq_u32 s12, 3
    s_cbranch_scc0 mg_w3g1_r0
    v_and_b32 v5, 0xffff, v5
    v_cmp_eq_u32 vcc, 15, v5
    s_nop 1
    s_and_b64 exec, vcc, 1
    buffer_store_dword v5, v4, s[20:23], 0 offen offset:128 sc1
    s_mov_b64 exec, -1
mg_w3g1_r0:
    v_mfma_f32_16x16x32_bf16 v[88:91], v[224:227], v[196:199], v[88:91]
    ds_read_b64_tr_b16 v[224:225], v182 offset:512
    ds_read_b64_tr_b16 v[226:227], v182 offset:1536
    s_add_u32 s64, s64, 128
    s_add_u32 m0, s67, 16384
    s_nop 0
    buffer_load_dwordx4 v184, s[24:27], s5 offen offset:0 lds
    s_waitcnt lgkmcnt(11)
    v_mfma_f32_16x16x32_bf16 v[92:95], v[228:231], v[196:199], v[92:95]
    ds_read_b128 v[204:207], v179 offset:2048
    v_mfma_f32_16x16x32_bf16 v[84:87], v[228:231], v[192:195], v[84:87]
    ds_read_b64_tr_b16 v[228:229], v183 offset:512
    ds_read_b64_tr_b16 v[230:231], v183 offset:1536
    buffer_load_dwordx4 v185, s[24:27], s5 offen offset:1024 lds
    s_waitcnt lgkmcnt(10)
    v_mfma_f32_16x16x32_bf16 v[96:99], v[208:211], v[192:195], v[96:99]
    v_mfma_f32_16x16x32_bf16 v[104:107], v[208:211], v[196:199], v[104:107]
    ds_read_b64_tr_b16 v[208:209], v180 offset:8192
    ds_read_b64_tr_b16 v[210:211], v180 offset:9216
    buffer_load_dwordx4 v186, s[24:27], s5 offen offset:2048 lds
    v_mfma_f32_16x16x32_bf16 v[108:111], v[212:215], v[196:199], v[108:111]
    v_mfma_f32_16x16x32_bf16 v[100:103], v[212:215], v[192:195], v[100:103]
    ds_read_b64_tr_b16 v[212:213], v181 offset:8192
    ds_read_b64_tr_b16 v[214:215], v181 offset:9216
    buffer_load_dwordx4 v187, s[24:27], s5 offen offset:3072 lds
    s_add_u32 s5, s5, 128
    s_waitcnt lgkmcnt(10)
    v_mfma_f32_16x16x32_bf16 v[112:115], v[216:219], v[192:195], v[112:115]
    v_mfma_f32_16x16x32_bf16 v[120:123], v[216:219], v[196:199], v[120:123]
    ds_read_b64_tr_b16 v[216:217], v182 offset:8192
    ds_read_b64_tr_b16 v[218:219], v182 offset:9216
    s_add_u32 m0, s66, 98304
    s_nop 0
    buffer_load_dwordx4 v188, s[28:31], s65 offen offset:0 lds
    v_mfma_f32_16x16x32_bf16 v[124:127], v[220:223], v[196:199], v[124:127]
    v_mfma_f32_16x16x32_bf16 v[116:119], v[220:223], v[192:195], v[116:119]
    ds_read_b64_tr_b16 v[220:221], v183 offset:8192
    ds_read_b64_tr_b16 v[222:223], v183 offset:9216
    buffer_load_dwordx4 v189, s[28:31], s65 offen offset:1024 lds
    s_waitcnt lgkmcnt(8)
    v_mfma_f32_16x16x32_bf16 v[128:131], v[224:227], v[192:195], v[128:131]
    v_mfma_f32_16x16x32_bf16 v[136:139], v[224:227], v[196:199], v[136:139]
    ds_read_b64_tr_b16 v[224:225], v180 offset:8704
    ds_read_b64_tr_b16 v[226:227], v180 offset:9728
    s_add_u32 s65, s65, 262144
    s_add_u32 m0, s66, 106496
    s_nop 0
    buffer_load_dwordx4 v188, s[28:31], s65 offen offset:0 lds
    v_mfma_f32_16x16x32_bf16 v[140:143], v[228:231], v[196:199], v[140:143]
    v_mfma_f32_16x16x32_bf16 v[132:135], v[228:231], v[192:195], v[132:135]
    ds_read_b64_tr_b16 v[228:229], v181 offset:8704
    ds_read_b64_tr_b16 v[230:231], v181 offset:9728
    buffer_load_dwordx4 v189, s[28:31], s65 offen offset:1024 lds
    s_add_u32 s65, s65, 262144
    s_waitcnt lgkmcnt(8)
    v_mfma_f32_16x16x32_bf16 v[80:83], v[208:211], v[200:203], v[80:83]
    v_mfma_f32_16x16x32_bf16 v[88:91], v[208:211], v[204:207], v[88:91]
    ds_read_b64_tr_b16 v[208:209], v182 offset:8704
    ds_read_b64_tr_b16 v[210:211], v182 offset:9728
    v_mfma_f32_16x16x32_bf16 v[92:95], v[212:215], v[204:207], v[92:95]
    v_mfma_f32_16x16x32_bf16 v[84:87], v[212:215], v[200:203], v[84:87]
    ds_read_b64_tr_b16 v[212:213], v183 offset:8704
    ds_read_b64_tr_b16 v[214:215], v183 offset:9728
    s_waitcnt lgkmcnt(8)
    v_mfma_f32_16x16x32_bf16 v[96:99], v[216:219], v[200:203], v[96:99]
    v_mfma_f32_16x16x32_bf16 v[104:107], v[216:219], v[204:207], v[104:107]
    v_mfma_f32_16x16x32_bf16 v[108:111], v[220:223], v[204:207], v[108:111]
    v_mfma_f32_16x16x32_bf16 v[100:103], v[220:223], v[200:203], v[100:103]
    s_waitcnt lgkmcnt(4)
    v_mfma_f32_16x16x32_bf16 v[112:115], v[224:227], v[200:203], v[112:115]
    buffer_store_dwordx4 v[64:67], v3, s[16:19], s76 offen offset:0 sc1
    v_add_u32 v178, 32768, v178
    v_add_u32 v179, 32768, v179
    v_add_u32 v180, 16384, v180
    v_add_u32 v181, 16384, v181
    v_add_u32 v182, 16384, v182
    v_add_u32 v183, 16384, v183
    s_waitcnt vmcnt(14)
    s_waitcnt lgkmcnt(0)
    s_barrier
    v_mfma_f32_16x16x32_bf16 v[120:123], v[224:227], v[204:207], v[120:123]
    ds_read_b128 v[192:195], v178 offset:0
    ds_read_b64_tr_b16 v[216:217], v180 offset:0
    ds_read_b64_tr_b16 v[218:219], v180 offset:1024
    s_add_u32 m0, s68, 0
    s_nop 0
    buffer_load_dwordx4 v184, s[24:27], s64 offen offset:0 lds
    v_mfma_f32_16x16x32_bf16 v[124:127], v[228:231], v[204:207], v[124:127]
    ds_read_b128 v[196:199], v178 offset:2048
    ds_read_b64_tr_b16 v[220:221], v181 offset:0
    ds_read_b64_tr_b16 v[222:223], v181 offset:1024
    v_mfma_f32_16x16x32_bf16 v[116:119], v[228:231], v[200:203], v[116:119]
    ds_read_b64_tr_b16 v[224:225], v182 offset:0
    ds_read_b64_tr_b16 v[226:227], v182 offset:1024
    buffer_load_dwordx4 v185, s[24:27], s64 offen offset:1024 lds
    v_mfma_f32_16x16x32_bf16 v[128:131], v[208:211], v[200:203], v[128:131]
    ds_read_b64_tr_b16 v[228:229], v183 offset:0
    ds_read_b64_tr_b16 v[230:231], v183 offset:1024
    v_mfma_f32_16x16x32_bf16 v[136:139], v[208:211], v[204:207], v[136:139]
    ds_read_b64_tr_b16 v[208:209], v180 offset:512
    ds_read_b64_tr_b16 v[210:211], v180 offset:1536
    buffer_load_dwordx4 v186, s[24:27], s64 offen offset:2048 lds
    v_mfma_f32_16x16x32_bf16 v[140:143], v[212:215], v[204:207], v[140:143]
    v_mfma_f32_16x16x32_bf16 v[132:135], v[212:215], v[200:203], v[132:135]
    ds_read_b64_tr_b16 v[212:213], v181 offset:512
    ds_read_b64_tr_b16 v[214:215], v181 offset:1536
    buffer_load_dwordx4 v187, s[24:27], s64 offen offset:3072 lds
    s_waitcnt lgkmcnt(10)
    v_mfma_f32_16x16x32_bf16 v[80:83], v[216:219], v[192:195], v[80:83]
    ds_read_b128 v[200:203], v179 offset:0
    buffer_load_dwordx4 v[16:19], v8, s[16:19], s70 offen sc1
    v_mfma_f32_16x16x32_bf16 v[88:91], v[216:219], v[196:199], v[88:91]
    ds_read_b64_tr_b16 v[216:217], v182 offset:512
    ds_read_b64_tr_b16 v[218:219], v182 offset:1536
    s_add_u32 s64, s64, 128
    s_add_u32 m0, s68, 16384
    s_nop 0
    buffer_load_dwordx4 v184, s[24:27], s5 offen offset:0 lds
    s_waitcnt lgkmcnt(11)
    v_mfma_f32_16x16x32_bf16 v[92:95], v[220:223], v[196:199], v[92:95]
    ds_read_b128 v[204:207], v179 offset:2048
    s_add_u32 s70, s70, 8192
    buffer_load_dwordx4 v[20:23], v8, s[16:19], s70 offen sc1
    v_mfma_f32_16x16x32_bf16 v[84:87], v[220:223], v[192:195], v[84:87]
    ds_read_b64_tr_b16 v[220:221], v183 offset:512
    ds_read_b64_tr_b16 v[222:223], v183 offset:1536
    buffer_load_dwordx4 v185, s[24:27], s5 offen offset:1024 lds
    s_waitcnt lgkmcnt(10)
    v_mfma_f32_16x16x32_bf16 v[96:99], v[224:227], v[192:195], v[96:99]
    s_add_u32 s70, s70, 8192
    buffer_load_dwordx4 v[24:27], v8, s[16:19], s70 offen sc1
    v_mfma_f32_16x16x32_bf16 v[104:107], v[224:227], v[196:199], v[104:107]
    ds_read_b64_tr_b16 v[224:225], v180 offset:8192
    ds_read_b64_tr_b16 v[226:227], v180 offset:9216
    buffer_load_dwordx4 v186, s[24:27], s5 offen offset:2048 lds
    v_mfma_f32_16x16x32_bf16 v[108:111], v[228:231], v[196:199], v[108:111]
    s_add_u32 s70, s70, 8192
    buffer_load_dwordx4 v[28:31], v8, s[16:19], s70 offen sc1
    v_mfma_f32_16x16x32_bf16 v[100:103], v[228:231], v[192:195], v[100:103]
    ds_read_b64_tr_b16 v[228:229], v181 offset:8192
    ds_read_b64_tr_b16 v[230:231], v181 offset:9216
    buffer_load_dwordx4 v187, s[24:27], s5 offen offset:3072 lds
    s_add_u32 s5, s5, 128
    s_waitcnt lgkmcnt(10)
    v_mfma_f32_16x16x32_bf16 v[112:115], v[208:211], v[192:195], v[112:115]
    s_add_u32 s70, s70, 8192
    buffer_load_dwordx4 v[32:35], v8, s[16:19], s70 offen sc1
    v_mfma_f32_16x16x32_bf16 v[120:123], v[208:211], v[196:199], v[120:123]
    ds_read_b64_tr_b16 v[208:209], v182 offset:8192
    ds_read_b64_tr_b16 v[210:211], v182 offset:9216
    s_add_u32 m0, s66, 114688
    s_nop 0
    buffer_load_dwordx4 v188, s[28:31], s65 offen offset:0 lds
    v_mfma_f32_16x16x32_bf16 v[124:127], v[212:215], v[196:199], v[124:127]
    s_add_u32 s70, s70, 8192
    buffer_load_dwordx4 v[36:39], v8, s[16:19], s70 offen sc1
    v_mfma_f32_16x16x32_bf16 v[116:119], v[212:215], v[192:195], v[116:119]
    ds_read_b64_tr_b16 v[212:213], v183 offset:8192
    ds_read_b64_tr_b16 v[214:215], v183 offset:9216
    buffer_load_dwordx4 v189, s[28:31], s65 offen offset:1024 lds
    s_waitcnt lgkmcnt(8)
    v_mfma_f32_16x16x32_bf16 v[128:131], v[216:219], v[192:195], v[128:131]
    s_add_u32 s70, s70, 8192
    buffer_load_dwordx4 v[40:43], v8, s[16:19], s70 offen sc1
    v_mfma_f32_16x16x32_bf16 v[136:139], v[216:219], v[196:199], v[136:139]
    ds_read_b64_tr_b16 v[216:217], v180 offset:8704
    ds_read_b64_tr_b16 v[218:219], v180 offset:9728
    s_add_u32 s65, s65, 262144
    s_add_u32 m0, s66, 122880
    s_nop 0
    buffer_load_dwordx4 v188, s[28:31], s65 offen offset:0 lds
    v_mfma_f32_16x16x32_bf16 v[140:143], v[220:223], v[196:199], v[140:143]
    s_add_u32 s70, s70, 8192
    buffer_load_dwordx4 v[44:47], v8, s[16:19], s70 offen sc1
    s_add_u32 s70, s70, 8192
    v_mfma_f32_16x16x32_bf16 v[132:135], v[220:223], v[192:195], v[132:135]
    ds_read_b64_tr_b16 v[220:221], v181 offset:8704
    ds_read_b64_tr_b16 v[222:223], v181 offset:9728
    buffer_load_dwordx4 v189, s[28:31], s65 offen offset:1024 lds
    s_add_u32 s65, s65, 262144
    s_waitcnt lgkmcnt(8)
    v_mfma_f32_16x16x32_bf16 v[80:83], v[224:227], v[200:203], v[80:83]
    v_mfma_f32_16x16x32_bf16 v[88:91], v[224:227], v[204:207], v[88:91]
    ds_read_b64_tr_b16 v[224:225], v182 offset:8704
    ds_read_b64_tr_b16 v[226:227], v182 offset:9728
    v_mfma_f32_16x16x32_bf16 v[92:95], v[228:231], v[204:207], v[92:95]
    v_mfma_f32_16x16x32_bf16 v[84:87], v[228:231], v[200:203], v[84:87]
    ds_read_b64_tr_b16 v[228:229], v183 offset:8704
    ds_read_b64_tr_b16 v[230:231], v183 offset:9728
    s_waitcnt lgkmcnt(8)
    v_mfma_f32_16x16x32_bf16 v[96:99], v[208:211], v[200:203], v[96:99]
    v_mfma_f32_16x16x32_bf16 v[104:107], v[208:211], v[204:207], v[104:107]
    v_mfma_f32_16x16x32_bf16 v[108:111], v[212:215], v[204:207], v[108:111]
    v_mfma_f32_16x16x32_bf16 v[100:103], v[212:215], v[200:203], v[100:103]
    s_waitcnt lgkmcnt(4)
    v_mfma_f32_16x16x32_bf16 v[112:115], v[216:219], v[200:203], v[112:115]
    buffer_store_dwordx4 v[68:71], v3, s[16:19], s76 offen offset:1024 sc1
    v_add_u32 v178, 32768, v178
    v_add_u32 v179, 32768, v179
    v_add_u32 v180, 4294934528, v180
    v_add_u32 v181, 4294934528, v181
    v_add_u32 v182, 4294934528, v182
    v_add_u32 v183, 4294934528, v183
    s_waitcnt vmcnt(22)
    s_waitcnt lgkmcnt(0)
    s_barrier
    v_mfma_f32_16x16x32_bf16 v[120:123], v[216:219], v[204:207], v[120:123]
    ds_read_b128 v[192:195], v178 offset:0
    ds_read_b64_tr_b16 v[208:209], v180 offset:0
    ds_read_b64_tr_b16 v[210:211], v180 offset:1024
    s_add_u32 m0, s69, 0
    s_nop 0
    buffer_load_dwordx4 v184, s[24:27], s64 offen offset:0 lds
    v_mfma_f32_16x16x32_bf16 v[124:127], v[220:223], v[204:207], v[124:127]
    ds_read_b128 v[196:199], v178 offset:2048
    ds_read_b64_tr_b16 v[212:213], v181 offset:0
    ds_read_b64_tr_b16 v[214:215], v181 offset:1024
    v_mfma_f32_16x16x32_bf16 v[116:119], v[220:223], v[200:203], v[116:119]
    ds_read_b64_tr_b16 v[216:217], v182 offset:0
    ds_read_b64_tr_b16 v[218:219], v182 offset:1024
    buffer_load_dwordx4 v185, s[24:27], s64 offen offset:1024 lds
    v_mfma_f32_16x16x32_bf16 v[128:131], v[224:227], v[200:203], v[128:131]
    ds_read_b64_tr_b16 v[220:221], v183 offset:0
    ds_read_b64_tr_b16 v[222:223], v183 offset:1024
    v_mfma_f32_16x16x32_bf16 v[136:139], v[224:227], v[204:207], v[136:139]
    ds_read_b64_tr_b16 v[224:225], v180 offset:512
    ds_read_b64_tr_b16 v[226:227], v180 offset:1536
    buffer_load_dwordx4 v186, s[24:27], s64 offen offset:2048 lds
    v_mfma_f32_16x16x32_bf16 v[140:143], v[228:231], v[204:207], v[140:143]
    v_mfma_f32_16x16x32_bf16 v[132:135], v[228:231], v[200:203], v[132:135]
    ds_read_b64_tr_b16 v[228:229], v181 offset:512
    ds_read_b64_tr_b16 v[230:231], v181 offset:1536
    buffer_load_dwordx4 v187, s[24:27], s64 offen offset:3072 lds
    s_waitcnt lgkmcnt(10)
    v_mfma_f32_16x16x32_bf16 v[80:83], v[208:211], v[192:195], v[80:83]
    ds_read_b128 v[200:203], v179 offset:0
    v_mfma_f32_16x16x32_bf16 v[88:91], v[208:211], v[196:199], v[88:91]
    ds_read_b64_tr_b16 v[208:209], v182 offset:512
    ds_read_b64_tr_b16 v[210:211], v182 offset:1536
    s_add_u32 s64, s64, 128
    s_add_u32 m0, s69, 16384
    s_nop 0
    buffer_load_dwordx4 v184, s[24:27], s5 offen offset:0 lds
    s_waitcnt lgkmcnt(11)
    v_mfma_f32_16x16x32_bf16 v[92:95], v[212:215], v[196:199], v[92:95]
    ds_read_b128 v[204:207], v179 offset:2048
    v_mfma_f32_16x16x32_bf16 v[84:87], v[212:215], v[192:195], v[84:87]
    ds_read_b64_tr_b16 v[212:213], v183 offset:512
    ds_read_b64_tr_b16 v[214:215], v183 offset:1536
    buffer_load_dwordx4 v185, s[24:27], s5 offen offset:1024 lds
    s_waitcnt lgkmcnt(10)
    v_mfma_f32_16x16x32_bf16 v[96:99], v[216:219], v[192:195], v[96:99]
    v_mfma_f32_16x16x32_bf16 v[104:107], v[216:219], v[196:199], v[104:107]
    ds_read_b64_tr_b16 v[216:217], v180 offset:8192
    ds_read_b64_tr_b16 v[218:219], v180 offset:9216
    buffer_load_dwordx4 v186, s[24:27], s5 offen offset:2048 lds
    v_mfma_f32_16x16x32_bf16 v[108:111], v[220:223], v[196:199], v[108:111]
    v_mfma_f32_16x16x32_bf16 v[100:103], v[220:223], v[192:195], v[100:103]
    ds_read_b64_tr_b16 v[220:221], v181 offset:8192
    ds_read_b64_tr_b16 v[222:223], v181 offset:9216
    buffer_load_dwordx4 v187, s[24:27], s5 offen offset:3072 lds
    s_add_u32 s5, s5, 128
    s_waitcnt lgkmcnt(10)
    v_mfma_f32_16x16x32_bf16 v[112:115], v[224:227], v[192:195], v[112:115]
    s_waitcnt vmcnt(10)
    v_mfma_f32_16x16x32_bf16 v[144:147], v[148:151], v[16:19], 0
    v_mfma_f32_16x16x32_bf16 v[120:123], v[224:227], v[196:199], v[120:123]
    ds_read_b64_tr_b16 v[224:225], v182 offset:8192
    ds_read_b64_tr_b16 v[226:227], v182 offset:9216
    s_add_u32 m0, s66, 131072
    s_nop 0
    buffer_load_dwordx4 v188, s[28:31], s65 offen offset:0 lds
    v_mfma_f32_16x16x32_bf16 v[144:147], v[148:151], v[20:23], v[144:147]
    v_mfma_f32_16x16x32_bf16 v[124:127], v[228:231], v[196:199], v[124:127]
    v_mfma_f32_16x16x32_bf16 v[144:147], v[148:151], v[24:27], v[144:147]
    v_mfma_f32_16x16x32_bf16 v[116:119], v[228:231], v[192:195], v[116:119]
    ds_read_b64_tr_b16 v[228:229], v183 offset:8192
    ds_read_b64_tr_b16 v[230:231], v183 offset:9216
    buffer_load_dwordx4 v189, s[28:31], s65 offen offset:1024 lds
    v_mfma_f32_16x16x32_bf16 v[144:147], v[148:151], v[28:31], v[144:147]
    s_waitcnt lgkmcnt(8)
    v_mfma_f32_16x16x32_bf16 v[128:131], v[208:211], v[192:195], v[128:131]
    v_mfma_f32_16x16x32_bf16 v[144:147], v[148:151], v[32:35], v[144:147]
    v_mfma_f32_16x16x32_bf16 v[136:139], v[208:211], v[196:199], v[136:139]
    ds_read_b64_tr_b16 v[208:209], v180 offset:8704
    ds_read_b64_tr_b16 v[210:211], v180 offset:9728
    s_add_u32 s65, s65, 262144
    s_add_u32 m0, s66, 139264
    s_nop 0
    buffer_load_dwordx4 v188, s[28:31], s65 offen offset:0 lds
    v_mfma_f32_16x16x32_bf16 v[144:147], v[148:151], v[36:39], v[144:147]
    v_mfma_f32_16x16x32_bf16 v[140:143], v[212:215], v[196:199], v[140:143]
    v_mfma_f32_16x16x32_bf16 v[144:147], v[148:151], v[40:43], v[144:147]
    v_mfma_f32_16x16x32_bf16 v[132:135], v[212:215], v[192:195], v[132:135]
    ds_read_b64_tr_b16 v[212:213], v181 offset:8704
    ds_read_b64_tr_b16 v[214:215], v181 offset:9728
    buffer_load_dwordx4 v189, s[28:31], s65 offen offset:1024 lds
    s_add_u32 s65, s65, 262144
    v_mfma_f32_16x16x32_bf16 v[144:147], v[148:151], v[44:47], v[144:147]
    s_waitcnt lgkmcnt(8)
    v_mfma_f32_16x16x32_bf16 v[80:83], v[216:219], v[200:203], v[80:83]
    v_mfma_f32_16x16x32_bf16 v[88:91], v[216:219], v[204:207], v[88:91]
    ds_read_b64_tr_b16 v[216:217], v182 offset:8704
    ds_read_b64_tr_b16 v[218:219], v182 offset:9728
    v_mfma_f32_16x16x32_bf16 v[92:95], v[220:223], v[204:207], v[92:95]
    v_cmp_u_f32 vcc, v144, v145
    v_mfma_f32_16x16x32_bf16 v[84:87], v[220:223], v[200:203], v[84:87]
    ds_read_b64_tr_b16 v[220:221], v183 offset:8704
    ds_read_b64_tr_b16 v[222:223], v183 offset:9728
    s_waitcnt lgkmcnt(8)
    v_mfma_f32_16x16x32_bf16 v[96:99], v[224:227], v[200:203], v[96:99]
    s_cbranch_vccnz mg_kpw_r0
mg_kpr_r0:
    v_cvt_pk_bf16_f32 v144, v144, v145
    v_cvt_pk_bf16_f32 v145, v146, v147
    v_mfma_f32_16x16x32_bf16 v[104:107], v[224:227], v[204:207], v[104:107]
    ds_write_b64 v11, v[144:145]
    v_mfma_f32_16x16x32_bf16 v[108:111], v[228:231], v[204:207], v[108:111]
    v_mfma_f32_16x16x32_bf16 v[100:103], v[228:231], v[200:203], v[100:103]
    s_waitcnt lgkmcnt(5)
    v_mfma_f32_16x16x32_bf16 v[112:115], v[208:211], v[200:203], v[112:115]
    buffer_store_dwordx4 v[72:75], v3, s[16:19], s77 offen offset:0 sc1
    v_add_u32 v178, 4294901760, v178
    v_add_u32 v179, 4294901760, v179
    v_add_u32 v180, 16384, v180
    v_add_u32 v181, 16384, v181
    v_add_u32 v182, 16384, v182
    v_add_u32 v183, 16384, v183
    s_waitcnt vmcnt(14)
    s_waitcnt lgkmcnt(0)
    s_barrier
    v_mfma_f32_16x16x32_bf16 v[120:123], v[208:211], v[204:207], v[120:123]
    ds_read_b128 v[192:195], v178 offset:0
    ds_read_b64_tr_b16 v[224:225], v180 offset:0
    ds_read_b64_tr_b16 v[226:227], v180 offset:1024
    s_add_u32 m0, s67, 0
    s_nop 0
    buffer_load_dwordx4 v184, s[24:27], s64 offen offset:0 lds
    v_mfma_f32_16x16x32_bf16 v[124:127], v[212:215], v[204:207], v[124:127]
    ds_read_b128 v[196:199], v178 offset:2048
    ds_read_b64_tr_b16 v[228:229], v181 offset:0
    ds_read_b64_tr_b16 v[230:231], v181 offset:1024
    v_mfma_f32_16x16x32_bf16 v[116:119], v[212:215], v[200:203], v[116:119]
    ds_read_b64_tr_b16 v[208:209], v182 offset:0
    ds_read_b64_tr_b16 v[210:211], v182 offset:1024
    buffer_load_dwordx4 v185, s[24:27], s64 offen offset:1024 lds
    v_mfma_f32_16x16x32_bf16 v[128:131], v[216:219], v[200:203], v[128:131]
    ds_read_b64_tr_b16 v[212:213], v183 offset:0
    ds_read_b64_tr_b16 v[214:215], v183 offset:1024
    v_mfma_f32_16x16x32_bf16 v[136:139], v[216:219], v[204:207], v[136:139]
    ds_read_b64_tr_b16 v[216:217], v180 offset:512
    ds_read_b64_tr_b16 v[218:219], v180 offset:1536
    buffer_load_dwordx4 v186, s[24:27], s64 offen offset:2048 lds
    v_mfma_f32_16x16x32_bf16 v[140:143], v[220:223], v[204:207], v[140:143]
    v_mfma_f32_16x16x32_bf16 v[132:135], v[220:223], v[200:203], v[132:135]
    ds_read_b64_tr_b16 v[220:221], v181 offset:512
    ds_read_b64_tr_b16 v[222:223], v181 offset:1536
    buffer_load_dwordx4 v187, s[24:27], s64 offen offset:3072 lds
    s_waitcnt lgkmcnt(10)
    v_mfma_f32_16x16x32_bf16 v[80:83], v[224:227], v[192:195], v[80:83]
    ds_read_b128 v[200:203], v179 offset:0
    s_lshr_b32 s72, s61, 1
    s_lshl_b32 s72, s72, 2
    v_mfma_f32_16x16x32_bf16 v[88:91], v[224:227], v[196:199], v[88:91]
    ds_read_b64_tr_b16 v[224:225], v182 offset:512
    ds_read_b64_tr_b16 v[226:227], v182 offset:1536
    s_add_u32 s64, s64, 128
    s_add_u32 m0, s67, 16384
    s_nop 0
    buffer_load_dwordx4 v184, s[24:27], s5 offen offset:0 lds
    s_cmp_eq_u32 s12, 3
    s_cbranch_scc0 mg_w3pb_r0
    buffer_load_dword v5, off, s[20:23], s72 offset:128 sc1
mg_w3pb_r0:
    s_waitcnt lgkmcnt(11)
    v_mfma_f32_16x16x32_bf16 v[92:95], v[228:231], v[196:199], v[92:95]
    ds_read_b128 v[204:207], v179 offset:2048
    ds_read_b128 v[20:23], v13 offset:0
    ds_read_b128 v[24:27], v13 offset:336
    v_mfma_f32_16x16x32_bf16 v[84:87], v[228:231], v[192:195], v[84:87]
    ds_read_b64_tr_b16 v[228:229], v183 offset:512
    ds_read_b64_tr_b16 v[230:231], v183 offset:1536
    buffer_load_dwordx4 v185, s[24:27], s5 offen offset:1024 lds
    ds_read_b128 v[28:31], v13 offset:672
    ds_read_b128 v[32:35], v13 offset:1008
    s_waitcnt lgkmcnt(14)
    v_mfma_f32_16x16x32_bf16 v[96:99], v[208:211], v[192:195], v[96:99]
    ds_read_b128 v[36:39], v13 offset:1344
    v_mfma_f32_16x16x32_bf16 v[104:107], v[208:211], v[196:199], v[104:107]
    ds_read_b64_tr_b16 v[208:209], v180 offset:8192
    ds_read_b64_tr_b16 v[210:211], v180 offset:9216
    buffer_load_dwordx4 v186, s[24:27], s5 offen offset:2048 lds
    v_mfma_f32_16x16x32_bf16 v[108:111], v[212:215], v[196:199], v[108:111]
    v_mfma_f32_16x16x32_bf16 v[100:103], v[212:215], v[192:195], v[100:103]
    ds_read_b64_tr_b16 v[212:213], v181 offset:8192
    ds_read_b64_tr_b16 v[214:215], v181 offset:9216
    buffer_load_dwordx4 v187, s[24:27], s5 offen offset:3072 lds
    s_add_u32 s5, s5, 128
    s_waitcnt lgkmcnt(15)
    v_mfma_f32_16x16x32_bf16 v[112:115], v[216:219], v[192:195], v[112:115]
    s_waitcnt lgkmcnt(4)
    v_mfma_f32_16x16x32_bf16 v[120:123], v[216:219], v[196:199], v[120:123]
    ds_read_b64_tr_b16 v[216:217], v182 offset:8192
    ds_read_b64_tr_b16 v[218:219], v182 offset:9216
    s_add_u32 m0, s66, 98304
    s_nop 0
    buffer_load_dwordx4 v188, s[28:31], s65 offen offset:0 lds
    v_mfma_f32_32x32x16_bf16 v[144:159], v[20:23], v[232:235], 0
    v_mfma_f32_16x16x32_bf16 v[124:127], v[220:223], v[196:199], v[124:127]
    v_mfma_f32_32x32x16_bf16 v[144:159], v[24:27], v[236:239], v[144:159]
    v_mfma_f32_16x16x32_bf16 v[116:119], v[220:223], v[192:195], v[116:119]
    ds_read_b64_tr_b16 v[220:221], v183 offset:8192
    ds_read_b64_tr_b16 v[222:223], v183 offset:9216
    buffer_load_dwordx4 v189, s[28:31], s65 offen offset:1024 lds
    v_mfma_f32_32x32x16_bf16 v[144:159], v[28:31], v[240:243], v[144:159]
    v_mfma_f32_16x16x32_bf16 v[128:131], v[224:227], v[192:195], v[128:131]
    v_mfma_f32_32x32x16_bf16 v[144:159], v[32:35], v[244:247], v[144:159]
    v_mfma_f32_16x16x32_bf16 v[136:139], v[224:227], v[196:199], v[136:139]
    ds_read_b64_tr_b16 v[224:225], v180 offset:8704
    ds_read_b64_tr_b16 v[226:227], v180 offset:9728
    s_add_u32 s65, s65, 262144
    s_add_u32 m0, s66, 106496
    s_nop 0
    buffer_load_dwordx4 v188, s[28:31], s65 offen offset:0 lds
    v_mfma_f32_32x32x16_bf16 v[144:159], v[36:39], v[248:251], v[144:159]
    v_mfma_f32_16x16x32_bf16 v[140:143], v[228:231], v[196:199], v[140:143]
    v_mfma_f32_16x16x32_bf16 v[132:135], v[228:231], v[192:195], v[132:135]
    ds_read_b64_tr_b16 v[228:229], v181 offset:8704
    ds_read_b64_tr_b16 v[230:231], v181 offset:9728
    buffer_load_dwordx4 v189, s[28:31], s65 offen offset:1024 lds
    s_add_u32 s65, s65, 262144
    s_waitcnt lgkmcnt(8)
    v_mfma_f32_16x16x32_bf16 v[80:83], v[208:211], v[200:203], v[80:83]
    v_add_f32 v8, 0x358637bd, v156
    v_rcp_f32 v8, v8
    s_nop 0
    v_mfma_f32_16x16x32_bf16 v[88:91], v[208:211], v[204:207], v[88:91]
    ds_read_b64_tr_b16 v[208:209], v182 offset:8704
    ds_read_b64_tr_b16 v[210:211], v182 offset:9728
    v_mul_f32 v144, v144, v8
    v_mul_f32 v145, v145, v8
    v_mul_f32 v146, v146, v8
    v_mfma_f32_16x16x32_bf16 v[92:95], v[212:215], v[204:207], v[92:95]
    v_mul_f32 v147, v147, v8
    v_mul_f32 v148, v148, v8
    v_mul_f32 v149, v149, v8
    v_mfma_f32_16x16x32_bf16 v[84:87], v[212:215], v[200:203], v[84:87]
    ds_read_b64_tr_b16 v[212:213], v183 offset:8704
    ds_read_b64_tr_b16 v[214:215], v183 offset:9728
    v_mul_f32 v150, v150, v8
    v_mul_f32 v151, v151, v8
    v_mul_f32 v152, v152, v8
    s_waitcnt lgkmcnt(8)
    v_mfma_f32_16x16x32_bf16 v[96:99], v[216:219], v[200:203], v[96:99]
    v_mul_f32 v153, v153, v8
    v_mul_f32 v154, v154, v8
    v_mul_f32 v155, v155, v8
    v_mfma_f32_16x16x32_bf16 v[104:107], v[216:219], v[204:207], v[104:107]
    v_cvt_pk_bf16_f32 v160, v144, v145
    v_cvt_pk_bf16_f32 v161, v146, v147
    v_cvt_pk_bf16_f32 v162, v148, v149
    v_mfma_f32_16x16x32_bf16 v[108:111], v[220:223], v[204:207], v[108:111]
    v_cvt_pk_bf16_f32 v163, v150, v151
    v_cvt_pk_bf16_f32 v164, v152, v153
    v_cvt_pk_bf16_f32 v165, v154, v155
    v_mfma_f32_16x16x32_bf16 v[100:103], v[220:223], v[200:203], v[100:103]
    buffer_store_dwordx2 v[160:161], v12, s[16:19], s71 offen offset:0 sc1
    buffer_store_dwordx2 v[162:163], v12, s[16:19], s71 offen offset:256 sc1
    buffer_store_dwordx2 v[164:165], v14, s[16:19], s71 offen offset:512 sc1
    s_waitcnt lgkmcnt(4)
    v_mfma_f32_16x16x32_bf16 v[112:115], v[224:227], v[200:203], v[112:115]
    buffer_store_dwordx4 v[76:79], v3, s[16:19], s77 offen offset:1024 sc1
    v_add_u32 v178, 32768, v178
    v_add_u32 v179, 32768, v179
    v_add_u32 v180, 16384, v180
    v_add_u32 v181, 16384, v181
    v_add_u32 v182, 16384, v182
    v_add_u32 v183, 16384, v183
    s_waitcnt vmcnt(17)
    s_waitcnt lgkmcnt(0)
    s_cmp_eq_u32 s12, 3
    s_cbranch_scc0 mg_w3qb_r0
    s_waitcnt vmcnt(11)
    v_readfirstlane_b32 s13, v5
    s_mov_b32 s14, 0
    s_cmp_eq_u32 s13, 0
    s_cbranch_scc1 mg_pwb_r0
mg_w3qb_r0:
    s_barrier
    v_mfma_f32_16x16x32_bf16 v[120:123], v[224:227], v[204:207], v[120:123]
    ds_read_b128 v[192:195], v178 offset:0
    ds_read_b64_tr_b16 v[216:217], v180 offset:0
    ds_read_b64_tr_b16 v[218:219], v180 offset:1024
    v_mfma_f32_16x16x32_bf16 v[124:127], v[228:231], v[204:207], v[124:127]
    ds_read_b128 v[196:199], v178 offset:2048
    ds_read_b64_tr_b16 v[220:221], v181 offset:0
    ds_read_b64_tr_b16 v[222:223], v181 offset:1024
    v_mfma_f32_16x16x32_bf16 v[116:119], v[228:231], v[200:203], v[116:119]
    ds_read_b64_tr_b16 v[224:225], v182 offset:0
    ds_read_b64_tr_b16 v[226:227], v182 offset:1024
    v_mfma_f32_16x16x32_bf16 v[128:131], v[208:211], v[200:203], v[128:131]
    ds_read_b64_tr_b16 v[228:229], v183 offset:0
    ds_read_b64_tr_b16 v[230:231], v183 offset:1024
    v_mfma_f32_16x16x32_bf16 v[136:139], v[208:211], v[204:207], v[136:139]
    ds_read_b64_tr_b16 v[208:209], v180 offset:512
    ds_read_b64_tr_b16 v[210:211], v180 offset:1536
    v_mfma_f32_16x16x32_bf16 v[140:143], v[212:215], v[204:207], v[140:143]
    v_mfma_f32_16x16x32_bf16 v[132:135], v[212:215], v[200:203], v[132:135]
    ds_read_b64_tr_b16 v[212:213], v181 offset:512
    ds_read_b64_tr_b16 v[214:215], v181 offset:1536
    s_waitcnt lgkmcnt(10)
    v_mfma_f32_16x16x32_bf16 v[80:83], v[216:219], v[192:195], v[80:83]
    ds_read_b128 v[200:203], v179 offset:0
    v_mov_b32 v16, 0
    v_mov_b32 v17, 0
    v_mfma_f32_16x16x32_bf16 v[88:91], v[216:219], v[196:199], v[88:91]
    ds_read_b64_tr_b16 v[216:217], v182 offset:512
    ds_read_b64_tr_b16 v[218:219], v182 offset:1536
    v_mov_b32 v18, 0
    v_mov_b32 v19, 0
    s_waitcnt lgkmcnt(11)
    v_mfma_f32_16x16x32_bf16 v[92:95], v[220:223], v[196:199], v[92:95]
    ds_read_b128 v[204:207], v179 offset:2048
    v_mov_b32 v20, 0
    v_mov_b32 v21, 0
    v_mfma_f32_16x16x32_bf16 v[84:87], v[220:223], v[192:195], v[84:87]
    ds_read_b64_tr_b16 v[220:221], v183 offset:512
    ds_read_b64_tr_b16 v[222:223], v183 offset:1536
    v_mov_b32 v22, 0
    v_mov_b32 v23, 0
    s_waitcnt lgkmcnt(10)
    v_mfma_f32_16x16x32_bf16 v[96:99], v[224:227], v[192:195], v[96:99]
    v_mov_b32 v24, 0
    v_mov_b32 v25, 0
    v_mfma_f32_16x16x32_bf16 v[104:107], v[224:227], v[196:199], v[104:107]
    ds_read_b64_tr_b16 v[224:225], v180 offset:8192
    ds_read_b64_tr_b16 v[226:227], v180 offset:9216
    v_mov_b32 v26, 0
    v_mov_b32 v27, 0
    v_mfma_f32_16x16x32_bf16 v[108:111], v[228:231], v[196:199], v[108:111]
    v_mov_b32 v28, 0
    v_mov_b32 v29, 0
    v_mfma_f32_16x16x32_bf16 v[100:103], v[228:231], v[192:195], v[100:103]
    ds_read_b64_tr_b16 v[228:229], v181 offset:8192
    ds_read_b64_tr_b16 v[230:231], v181 offset:9216
    v_mov_b32 v30, 0
    v_mov_b32 v31, 0
    s_waitcnt lgkmcnt(10)
    v_mfma_f32_16x16x32_bf16 v[112:115], v[208:211], v[192:195], v[112:115]
    v_mov_b32 v32, 0
    v_mov_b32 v33, 0
    v_mfma_f32_16x16x32_bf16 v[120:123], v[208:211], v[196:199], v[120:123]
    ds_read_b64_tr_b16 v[208:209], v182 offset:8192
    ds_read_b64_tr_b16 v[210:211], v182 offset:9216
    v_mov_b32 v34, 0
    v_mov_b32 v35, 0
    v_mfma_f32_16x16x32_bf16 v[124:127], v[212:215], v[196:199], v[124:127]
    v_mov_b32 v36, 0
    v_mov_b32 v37, 0
    v_mfma_f32_16x16x32_bf16 v[116:119], v[212:215], v[192:195], v[116:119]
    ds_read_b64_tr_b16 v[212:213], v183 offset:8192
    ds_read_b64_tr_b16 v[214:215], v183 offset:9216
    v_mov_b32 v38, 0
    v_mov_b32 v39, 0
    s_waitcnt lgkmcnt(8)
    v_mfma_f32_16x16x32_bf16 v[128:131], v[216:219], v[192:195], v[128:131]
    v_mov_b32 v40, 0
    v_mov_b32 v41, 0
    v_mfma_f32_16x16x32_bf16 v[136:139], v[216:219], v[196:199], v[136:139]
    ds_read_b64_tr_b16 v[216:217], v180 offset:8704
    ds_read_b64_tr_b16 v[218:219], v180 offset:9728
    v_mov_b32 v42, 0
    v_mov_b32 v43, 0
    v_mfma_f32_16x16x32_bf16 v[140:143], v[220:223], v[196:199], v[140:143]
    v_mov_b32 v44, 0
    v_mov_b32 v45, 0
    v_mfma_f32_16x16x32_bf16 v[132:135], v[220:223], v[192:195], v[132:135]
    ds_read_b64_tr_b16 v[220:221], v181 offset:8704
    ds_read_b64_tr_b16 v[222:223], v181 offset:9728
    v_mov_b32 v46, 0
    v_mov_b32 v47, 0
    s_waitcnt lgkmcnt(8)
    v_mfma_f32_16x16x32_bf16 v[80:83], v[224:227], v[200:203], v[80:83]
    v_mov_b32 v48, 0
    v_mov_b32 v49, 0
    v_mfma_f32_16x16x32_bf16 v[88:91], v[224:227], v[204:207], v[88:91]
    ds_read_b64_tr_b16 v[224:225], v182 offset:8704
    ds_read_b64_tr_b16 v[226:227], v182 offset:9728
    v_mov_b32 v50, 0
    v_mov_b32 v51, 0
    v_mfma_f32_16x16x32_bf16 v[92:95], v[228:231], v[204:207], v[92:95]
    v_mov_b32 v52, 0
    v_mov_b32 v53, 0
    v_mfma_f32_16x16x32_bf16 v[84:87], v[228:231], v[200:203], v[84:87]
    ds_read_b64_tr_b16 v[228:229], v183 offset:8704
    ds_read_b64_tr_b16 v[230:231], v183 offset:9728
    v_mov_b32 v54, 0
    v_mov_b32 v55, 0
    s_waitcnt lgkmcnt(8)
    v_mfma_f32_16x16x32_bf16 v[96:99], v[208:211], v[200:203], v[96:99]
    v_mov_b32 v56, 0
    v_mov_b32 v57, 0
    v_mfma_f32_16x16x32_bf16 v[104:107], v[208:211], v[204:207], v[104:107]
    v_mov_b32 v58, 0
    v_mov_b32 v59, 0
    v_mfma_f32_16x16x32_bf16 v[108:111], v[212:215], v[204:207], v[108:111]
    v_mov_b32 v60, 0
    v_mov_b32 v61, 0
    v_mfma_f32_16x16x32_bf16 v[100:103], v[212:215], v[200:203], v[100:103]
    v_mov_b32 v62, 0
    v_mov_b32 v63, 0
    s_waitcnt lgkmcnt(4)
    v_mfma_f32_16x16x32_bf16 v[112:115], v[216:219], v[200:203], v[112:115]
    v_add_u32 v178, 32768, v178
    v_add_u32 v179, 32768, v179
    v_add_u32 v180, 4294934528, v180
    v_add_u32 v181, 4294934528, v181
    v_add_u32 v182, 4294934528, v182
    v_add_u32 v183, 4294934528, v183
    s_waitcnt vmcnt(4)
    s_waitcnt lgkmcnt(0)
    s_barrier
    v_mfma_f32_16x16x32_bf16 v[120:123], v[216:219], v[204:207], v[120:123]
    ds_read_b128 v[192:195], v178 offset:0
    ds_read_b64_tr_b16 v[208:209], v180 offset:0
    ds_read_b64_tr_b16 v[210:211], v180 offset:1024
    v_mfma_f32_16x16x32_bf16 v[124:127], v[220:223], v[204:207], v[124:127]
    ds_read_b128 v[196:199], v178 offset:2048
    ds_read_b64_tr_b16 v[212:213], v181 offset:0
    ds_read_b64_tr_b16 v[214:215], v181 offset:1024
    v_mfma_f32_16x16x32_bf16 v[116:119], v[220:223], v[200:203], v[116:119]
    ds_read_b64_tr_b16 v[216:217], v182 offset:0
    ds_read_b64_tr_b16 v[218:219], v182 offset:1024
    v_mfma_f32_16x16x32_bf16 v[128:131], v[224:227], v[200:203], v[128:131]
    ds_read_b64_tr_b16 v[220:221], v183 offset:0
    ds_read_b64_tr_b16 v[222:223], v183 offset:1024
    v_mfma_f32_16x16x32_bf16 v[136:139], v[224:227], v[204:207], v[136:139]
    ds_read_b64_tr_b16 v[224:225], v180 offset:512
    ds_read_b64_tr_b16 v[226:227], v180 offset:1536
    v_mfma_f32_16x16x32_bf16 v[140:143], v[228:231], v[204:207], v[140:143]
    v_mfma_f32_16x16x32_bf16 v[132:135], v[228:231], v[200:203], v[132:135]
    ds_read_b64_tr_b16 v[228:229], v181 offset:512
    ds_read_b64_tr_b16 v[230:231], v181 offset:1536
    s_waitcnt lgkmcnt(10)
    v_mfma_f32_16x16x32_bf16 v[80:83], v[208:211], v[192:195], v[80:83]
    ds_read_b128 v[200:203], v179 offset:0
    v_mov_b32 v64, 0
    v_mov_b32 v65, 0
    v_mfma_f32_16x16x32_bf16 v[88:91], v[208:211], v[196:199], v[88:91]
    ds_read_b64_tr_b16 v[208:209], v182 offset:512
    ds_read_b64_tr_b16 v[210:211], v182 offset:1536
    v_mov_b32 v66, 0
    v_mov_b32 v67, 0
    s_waitcnt lgkmcnt(11)
    v_mfma_f32_16x16x32_bf16 v[92:95], v[212:215], v[196:199], v[92:95]
    ds_read_b128 v[204:207], v179 offset:2048
    v_mov_b32 v68, 0
    v_mov_b32 v69, 0
    v_mfma_f32_16x16x32_bf16 v[84:87], v[212:215], v[192:195], v[84:87]
    ds_read_b64_tr_b16 v[212:213], v183 offset:512
    ds_read_b64_tr_b16 v[214:215], v183 offset:1536
    v_mov_b32 v70, 0
    v_mov_b32 v71, 0
    s_waitcnt lgkmcnt(10)
    v_mfma_f32_16x16x32_bf16 v[96:99], v[216:219], v[192:195], v[96:99]
    v_mov_b32 v72, 0
    v_mov_b32 v73, 0
    v_mfma_f32_16x16x32_bf16 v[104:107], v[216:219], v[196:199], v[104:107]
    ds_read_b64_tr_b16 v[216:217], v180 offset:8192
    ds_read_b64_tr_b16 v[218:219], v180 offset:9216
    v_mov_b32 v74, 0
    v_mov_b32 v75, 0
    v_mfma_f32_16x16x32_bf16 v[108:111], v[220:223], v[196:199], v[108:111]
    v_mov_b32 v76, 0
    v_mov_b32 v77, 0
    v_mfma_f32_16x16x32_bf16 v[100:103], v[220:223], v[192:195], v[100:103]
    ds_read_b64_tr_b16 v[220:221], v181 offset:8192
    ds_read_b64_tr_b16 v[222:223], v181 offset:9216
    v_mov_b32 v78, 0
    v_mov_b32 v79, 0
    s_waitcnt lgkmcnt(10)
    v_mfma_f32_16x16x32_bf16 v[112:115], v[224:227], v[192:195], v[112:115]
    v_and_b32 v12, 3, v0
    v_mfma_f32_16x16x32_bf16 v[120:123], v[224:227], v[196:199], v[120:123]
    ds_read_b64_tr_b16 v[224:225], v182 offset:8192
    ds_read_b64_tr_b16 v[226:227], v182 offset:9216
    v_cmp_eq_u32 vcc, 0, v12
    v_mfma_f32_16x16x32_bf16 v[124:127], v[228:231], v[196:199], v[124:127]
    v_mov_b32 v12, 0x3f803f80
    v_mfma_f32_16x16x32_bf16 v[116:119], v[228:231], v[192:195], v[116:119]
    ds_read_b64_tr_b16 v[228:229], v183 offset:8192
    ds_read_b64_tr_b16 v[230:231], v183 offset:9216
    v_mov_b32 v10, 0xff800000
    s_waitcnt lgkmcnt(8)
    v_mfma_f32_16x16x32_bf16 v[128:131], v[208:211], v[192:195], v[128:131]
    v_cndmask_b32 v6, 0, v12, vcc
    v_mfma_f32_16x16x32_bf16 v[136:139], v[208:211], v[196:199], v[136:139]
    ds_read_b64_tr_b16 v[208:209], v180 offset:8704
    ds_read_b64_tr_b16 v[210:211], v180 offset:9728
    v_cndmask_b32 v7, 0, v12, vcc
    v_mfma_f32_16x16x32_bf16 v[140:143], v[212:215], v[196:199], v[140:143]
    v_mfma_f32_16x16x32_bf16 v[132:135], v[212:215], v[192:195], v[132:135]
    ds_read_b64_tr_b16 v[212:213], v181 offset:8704
    ds_read_b64_tr_b16 v[214:215], v181 offset:9728
    s_waitcnt lgkmcnt(8)
    v_mfma_f32_16x16x32_bf16 v[80:83], v[216:219], v[200:203], v[80:83]
    s_lshr_b32 s13, s2, 5
    s_lshl_b32 s13, s13, 1
    s_and_b32 s14, s2, 1
    s_add_u32 s13, s13, s14
    s_mul_i32 s63, s13, 327680
    s_and_b32 s13, s12, 3
    v_mfma_f32_16x16x32_bf16 v[88:91], v[216:219], v[204:207], v[88:91]
    ds_read_b64_tr_b16 v[216:217], v182 offset:8704
    ds_read_b64_tr_b16 v[218:219], v182 offset:9728
    s_lshl_b32 s13, s13, 12
    s_add_u32 s63, s63, s13
    s_lshl_b32 s65, s61, 19
    s_add_u32 s65, s65, s13
    s_lshl_b32 s13, s45, 14
    s_add_u32 s65, s65, s13
    v_mfma_f32_16x16x32_bf16 v[92:95], v[220:223], v[204:207], v[92:95]
    s_add_u32 s66, s65, 16777216
    s_mul_i32 s62, s15, 163840
    s_add_u32 s62, s62, s63
    s_add_u32 s62, s62, 50331648
    s_add_u32 s64, s63, 50429952
    s_add_u32 s63, s63, 50364416
    v_mfma_f32_16x16x32_bf16 v[84:87], v[220:223], v[200:203], v[84:87]
    ds_read_b64_tr_b16 v[220:221], v183 offset:8704
    ds_read_b64_tr_b16 v[222:223], v183 offset:9728
    s_bfe_u32 s13, s2, 0x20001
    s_lshl_b32 s13, s13, 2
    s_bfe_u32 s67, s2, 0x20003
    s_add_u32 s13, s13, s67
    s_lshl_b32 s13, s13, 1
    s_add_u32 s13, s13, s14
    s_waitcnt lgkmcnt(8)
    v_mfma_f32_16x16x32_bf16 v[96:99], v[224:227], v[200:203], v[96:99]
    s_lshl_b32 s68, s13, 3
    s_add_u32 s68, s68, s12
    s_lshl_b32 s68, s68, 5
    s_add_u32 s68, s68, 75497472
    s_lshl_b32 s67, s13, 17
    s_lshl_b32 s13, s14, 3
    v_mfma_f32_16x16x32_bf16 v[104:107], v[224:227], v[204:207], v[104:107]
    s_add_u32 s13, s13, s12
    s_lshl_b32 s13, s13, 13
    s_add_u32 s67, s67, s13
    s_add_u32 s67, s67, 33554432
    s_mov_b32 s24, s40
    s_and_b32 s25, s41, 0xffff
    s_mov_b32 s26, 5242880
    s_mov_b32 s27, 0x20000
    s_sub_u32 s30, s45, 10
    v_mfma_f32_16x16x32_bf16 v[108:111], v[228:231], v[204:207], v[108:111]
    s_max_u32 s30, s30, 15
    s_lshl_b32 s11, 6, s30
    s_or_b32 s11, s11, 0x80
    s_cmp_eq_u32 s12, 4
    s_cselect_b32 s11, s11, 0
    s_cmp_lt_u32 s2, 96
    s_cselect_b32 s7, 0, 0
    s_cmp_ge_u32 s46, s30
    s_cselect_b32 s31, 1, 0
    v_mfma_f32_16x16x32_bf16 v[100:103], v[228:231], v[200:203], v[100:103]
    s_cmp_ge_u32 s2, 224
    s_cselect_b32 s30, 1, 0
    s_waitcnt lgkmcnt(4)
    v_mfma_f32_16x16x32_bf16 v[112:115], v[208:211], v[200:203], v[112:115]
    s_waitcnt vmcnt(0) lgkmcnt(0)
    v_mov_b32 v2, v1
    s_barrier
    v_mfma_f32_16x16x32_bf16 v[120:123], v[208:211], v[204:207], v[120:123]
    ds_read_b128 v[192:195], v2 offset:0
    ds_read_b128 v[196:199], v2 offset:1024
    ds_read_b128 v[208:211], v2 offset:4096
    v_mfma_f32_16x16x32_bf16 v[124:127], v[212:215], v[204:207], v[124:127]
    ds_read_b128 v[224:227], v2 offset:8192
    ds_read_b128 v[228:231], v2 offset:9216
    ds_read_b128 v[232:235], v2 offset:10240
    v_mfma_f32_16x16x32_bf16 v[116:119], v[212:215], v[200:203], v[116:119]
    ds_read_b128 v[236:239], v2 offset:11264
    ds_read_b128 v[240:243], v2 offset:12288
    ds_read_b128 v[244:247], v2 offset:13312
    v_mfma_f32_16x16x32_bf16 v[128:131], v[216:219], v[200:203], v[128:131]
    ds_read_b128 v[248:251], v2 offset:14336
    ds_read_b128 v[252:255], v2 offset:15360
    ds_read_b128 v[212:215], v2 offset:5120
    v_mfma_f32_16x16x32_bf16 v[136:139], v[216:219], v[204:207], v[136:139]
    ds_read_b128 v[216:219], v2 offset:6144
    v_mfma_f32_16x16x32_bf16 v[140:143], v[220:223], v[204:207], v[140:143]
    v_mfma_f32_16x16x32_bf16 v[132:135], v[220:223], v[200:203], v[132:135]
    ds_read_b128 v[200:203], v2 offset:2048
    ds_read_b128 v[204:207], v2 offset:3072
    ds_read_b128 v[220:223], v2 offset:7168
mg_att:
    v_mov_b32 v4, v6
    v_mov_b32 v5, v6
    s_mov_b32 s70, 0x3e0293ee
    s_mov_b32 s71, 0x3e0293ee
    v_pk_mul_f32 v[80:81], v[80:81], s[70:71]
    v_pk_mul_f32 v[82:83], v[82:83], s[70:71]
    v_pk_mul_f32 v[84:85], v[84:85], s[70:71]
    v_pk_mul_f32 v[86:87], v[86:87], s[70:71]
    v_cvt_pk_bf16_f32 v144, v80, v81
    v_cvt_pk_bf16_f32 v145, v82, v83
    v_cvt_pk_bf16_f32 v146, v84, v85
    v_cvt_pk_bf16_f32 v147, v86, v87
    v_pk_mul_f32 v[88:89], v[88:89], s[70:71]
    v_pk_mul_f32 v[90:91], v[90:91], s[70:71]
    v_pk_mul_f32 v[92:93], v[92:93], s[70:71]
    v_pk_mul_f32 v[94:95], v[94:95], s[70:71]
    v_cvt_pk_bf16_f32 v148, v88, v89
    v_cvt_pk_bf16_f32 v149, v90, v91
    v_cvt_pk_bf16_f32 v150, v92, v93
    v_cvt_pk_bf16_f32 v151, v94, v95
    v_pk_mul_f32 v[96:97], v[96:97], s[70:71]
    v_pk_mul_f32 v[98:99], v[98:99], s[70:71]
    v_pk_mul_f32 v[100:101], v[100:101], s[70:71]
    v_pk_mul_f32 v[102:103], v[102:103], s[70:71]
    v_cvt_pk_bf16_f32 v152, v96, v97
    v_cvt_pk_bf16_f32 v153, v98, v99
    v_cvt_pk_bf16_f32 v154, v100, v101
    v_cvt_pk_bf16_f32 v155, v102, v103
    v_pk_mul_f32 v[104:105], v[104:105], s[70:71]
    v_pk_mul_f32 v[106:107], v[106:107], s[70:71]
    v_pk_mul_f32 v[108:109], v[108:109], s[70:71]
    v_pk_mul_f32 v[110:111], v[110:111], s[70:71]
    v_cvt_pk_bf16_f32 v156, v104, v105
    v_cvt_pk_bf16_f32 v157, v106, v107
    v_cvt_pk_bf16_f32 v158, v108, v109
    v_cvt_pk_bf16_f32 v159, v110, v111
    v_pk_mul_f32 v[112:113], v[112:113], s[70:71]
    v_pk_mul_f32 v[114:115], v[114:115], s[70:71]
    v_pk_mul_f32 v[116:117], v[116:117], s[70:71]
    v_pk_mul_f32 v[118:119], v[118:119], s[70:71]
    v_cvt_pk_bf16_f32 v160, v112, v113
    v_cvt_pk_bf16_f32 v161, v114, v115
    v_cvt_pk_bf16_f32 v162, v116, v117
    v_cvt_pk_bf16_f32 v163, v118, v119
    v_pk_mul_f32 v[120:121], v[120:121], s[70:71]
    v_pk_mul_f32 v[122:123], v[122:123], s[70:71]
    v_pk_mul_f32 v[124:125], v[124:125], s[70:71]
    v_pk_mul_f32 v[126:127], v[126:127], s[70:71]
    v_cvt_pk_bf16_f32 v164, v120, v121
    v_cvt_pk_bf16_f32 v165, v122, v123
    v_cvt_pk_bf16_f32 v166, v124, v125
    v_cvt_pk_bf16_f32 v167, v126, v127
    v_pk_mul_f32 v[128:129], v[128:129], s[70:71]
    v_pk_mul_f32 v[130:131], v[130:131], s[70:71]
    v_pk_mul_f32 v[132:133], v[132:133], s[70:71]
    v_pk_mul_f32 v[134:135], v[134:135], s[70:71]
    v_cvt_pk_bf16_f32 v168, v128, v129
    v_cvt_pk_bf16_f32 v169, v130, v131
    v_cvt_pk_bf16_f32 v170, v132, v133
    v_cvt_pk_bf16_f32 v171, v134, v135
    v_pk_mul_f32 v[136:137], v[136:137], s[70:71]
    v_pk_mul_f32 v[138:139], v[138:139], s[70:71]
    v_pk_mul_f32 v[140:141], v[140:141], s[70:71]
    v_pk_mul_f32 v[142:143], v[142:143], s[70:71]
    v_cvt_pk_bf16_f32 v172, v136, v137
    v_cvt_pk_bf16_f32 v173, v138, v139
    v_cvt_pk_bf16_f32 v174, v140, v141
    v_cvt_pk_bf16_f32 v175, v142, v143
    s_nop 1
    s_waitcnt lgkmcnt(0)
    v_mfma_f32_16x16x32_bf16 v[80:83], v[192:195], v[144:147], 0
    v_mfma_f32_16x16x32_bf16 v[88:91], v[192:195], v[148:151], 0
    v_mov_b32 v184, 0
    v_mfma_f32_16x16x32_bf16 v[88:91], v[196:199], v[156:159], v[88:91]
    v_mfma_f32_16x16x32_bf16 v[80:83], v[196:199], v[152:155], v[80:83]
    v_mov_b32 v185, 0
    v_mfma_f32_16x16x32_bf16 v[80:83], v[200:203], v[160:163], v[80:83]
    v_mfma_f32_16x16x32_bf16 v[88:91], v[200:203], v[164:167], v[88:91]
    v_mov_b32 v186, 0
    v_mfma_f32_16x16x32_bf16 v[88:91], v[204:207], v[172:175], v[88:91]
    v_mfma_f32_16x16x32_bf16 v[80:83], v[204:207], v[168:171], v[80:83]
    v_mov_b32 v187, 0
    v_mfma_f32_16x16x32_bf16 v[84:87], v[208:211], v[144:147], 0
    v_mfma_f32_16x16x32_bf16 v[92:95], v[208:211], v[148:151], 0
    v_mov_b32 v188, 0
    v_mfma_f32_16x16x32_bf16 v[92:95], v[212:215], v[156:159], v[92:95]
    v_mfma_f32_16x16x32_bf16 v[84:87], v[212:215], v[152:155], v[84:87]
    v_mov_b32 v189, 0
    v_mfma_f32_16x16x32_bf16 v[84:87], v[216:219], v[160:163], v[84:87]
    v_mfma_f32_16x16x32_bf16 v[92:95], v[216:219], v[164:167], v[92:95]
    v_mov_b32 v190, 0
    v_mfma_f32_16x16x32_bf16 v[92:95], v[220:223], v[172:175], v[92:95]
    v_mfma_f32_16x16x32_bf16 v[84:87], v[220:223], v[168:171], v[84:87]
    v_mov_b32 v191, 0
    v_mfma_f32_16x16x32_bf16 v[96:99], v[224:227], v[144:147], 0
    v_mfma_f32_16x16x32_bf16 v[104:107], v[224:227], v[148:151], 0
    s_mov_b32 s70, 0xfff0ffff
    v_mfma_f32_16x16x32_bf16 v[104:107], v[228:231], v[156:159], v[104:107]
    v_mfma_f32_16x16x32_bf16 v[96:99], v[228:231], v[152:155], v[96:99]
    s_mov_b32 s71, 0xf000ff00
    v_mfma_f32_16x16x32_bf16 v[96:99], v[232:235], v[160:163], v[96:99]
    v_mfma_f32_16x16x32_bf16 v[104:107], v[232:235], v[164:167], v[104:107]
    s_mov_b32 s72, 0xffe0fffe
    v_mfma_f32_16x16x32_bf16 v[104:107], v[236:239], v[172:175], v[104:107]
    v_mfma_f32_16x16x32_bf16 v[96:99], v[236:239], v[168:171], v[96:99]
    s_mov_b32 s73, 0xe000fe00
    v_mfma_f32_16x16x32_bf16 v[100:103], v[240:243], v[144:147], 0
    v_mfma_f32_16x16x32_bf16 v[108:111], v[240:243], v[148:151], 0
    s_mov_b32 s74, 0xffc0fffc
    v_mfma_f32_16x16x32_bf16 v[108:111], v[244:247], v[156:159], v[108:111]
    v_mfma_f32_16x16x32_bf16 v[100:103], v[244:247], v[152:155], v[100:103]
    s_mov_b32 s75, 0xc000fc00
    v_mfma_f32_16x16x32_bf16 v[100:103], v[248:251], v[160:163], v[100:103]
    v_mfma_f32_16x16x32_bf16 v[108:111], v[248:251], v[164:167], v[108:111]
    s_mov_b32 s76, 0xff80fff8
    v_mfma_f32_16x16x32_bf16 v[108:111], v[252:255], v[172:175], v[108:111]
    v_mfma_f32_16x16x32_bf16 v[100:103], v[252:255], v[168:171], v[100:103]
    s_mov_b32 s77, 0x8000f800
    s_cmp_eq_u32 s15, 0
    s_cbranch_scc1 mg_rb0a
    s_waitcnt vmcnt(16)
mg_rb0a:
    s_barrier
    v_add_u32 v2, 16384, v1
    v_add_u32 v3, 114688, v1
    s_cmp_eq_u32 s15, 0
    s_cbranch_scc1 mg_rb0da
    s_mov_b32 m0, s50
    s_add_u32 s50, s50, 16384
    buffer_load_dwordx4 v1, s[16:19], s52 offen offset:0 sc1 lds
    buffer_load_dwordx4 v1, s[16:19], s52 offen offset:1024 sc1 lds
    buffer_load_dwordx4 v1, s[16:19], s52 offen offset:2048 sc1 lds
    buffer_load_dwordx4 v1, s[16:19], s52 offen offset:3072 sc1 lds
    s_and_b32 s50, s50, 65535
    s_add_u32 s52, s52, 16384
    s_mov_b32 m0, s51
    s_add_u32 s51, s51, 16384
    buffer_load_dwordx4 v1, s[16:19], s53 offen offset:0 sc1 lds
    buffer_load_dwordx4 v1, s[16:19], s53 offen offset:1024 sc1 lds
    buffer_load_dwordx4 v1, s[16:19], s53 offen offset:2048 sc1 lds
    buffer_load_dwordx4 v1, s[16:19], s53 offen offset:3072 sc1 lds
    s_sub_u32 s14, s51, 81920
    s_cmp_ge_u32 s51, 147456
    s_cselect_b32 s51, s14, s51
    s_add_u32 s53, s53, 16384
    s_lshl_b32 s13, s2, 2
    s_add_u32 s13, s13, s12
    s_mul_i32 s13, s13, 5120
    s_add_u32 s13, s13, 67088384
    s_add_u32 s14, s13, 4096
    v_mov_b32 v112, -1
    v_mov_b32 v113, -1
    v_mov_b32 v114, -1
    v_mov_b32 v115, -1
    buffer_store_dwordx4 v[112:115], v1, s[16:19], s13 offen offset:0 sc1
    buffer_store_dwordx4 v[112:115], v1, s[16:19], s13 offen offset:1024 sc1
    buffer_store_dwordx4 v[112:115], v1, s[16:19], s13 offen offset:2048 sc1
    buffer_store_dwordx4 v[112:115], v1, s[16:19], s13 offen offset:3072 sc1
    buffer_store_dwordx4 v[112:115], v1, s[16:19], s14 offen offset:0 sc1
    s_and_b32 s41, s41, 0xffff
    s_mov_b32 s43, 0x20000
    v_lshlrev_b32 v116, 7, v0
    buffer_load_dword v15, v116, s[40:43], s8 offen
mg_rb0da:
    s_cmp_eq_u32 s46, 1
    s_cbranch_scc0 mg_nomask0
    s_cmp_eq_u32 s60, 0
    s_cbranch_scc1 mg_one_even
    ds_read_b128 v[192:195], v3 offset:0
    ds_read_b128 v[196:199], v3 offset:1024
    ds_read_b128 v[200:203], v3 offset:2048
    ds_read_b128 v[204:207], v3 offset:3072
    ds_read_b128 v[208:211], v3 offset:4096
    ds_read_b128 v[212:215], v3 offset:5120
    ds_read_b128 v[216:219], v3 offset:6144
    ds_read_b128 v[220:223], v3 offset:7168
    ds_read_b128 v[224:227], v3 offset:8192
    ds_read_b128 v[228:231], v3 offset:9216
    ds_read_b128 v[232:235], v3 offset:10240
    ds_read_b128 v[236:239], v3 offset:11264
    s_branch mg_one_m
mg_one_even:
    ds_read_b128 v[240:243], v3 offset:0
    ds_read_b128 v[244:247], v3 offset:1024
    ds_read_b128 v[248:251], v3 offset:2048
    ds_read_b128 v[252:255], v3 offset:3072
    ds_read_b128 v[192:195], v3 offset:4096
    ds_read_b128 v[196:199], v3 offset:5120
    ds_read_b128 v[200:203], v3 offset:6144
    ds_read_b128 v[204:207], v3 offset:7168
mg_one_m:
    s_cmp_eq_u32 s60, 0
    s_cbranch_scc1 mg_mkae
    v_cndmask_b32_e64 v96, v10, v96, s[70:71]
    v_cndmask_b32_e64 v97, v10, v97, s[72:73]
    v_cndmask_b32_e64 v98, v10, v98, s[74:75]
    v_cndmask_b32_e64 v99, v10, v99, s[76:77]
    v_mov_b32 v100, v10
    v_mov_b32 v101, v10
    v_mov_b32 v102, v10
    v_mov_b32 v103, v10
    v_cndmask_b32_e64 v108, v10, v108, s[70:71]
    v_cndmask_b32_e64 v109, v10, v109, s[72:73]
    v_cndmask_b32_e64 v110, v10, v110, s[74:75]
    v_cndmask_b32_e64 v111, v10, v111, s[76:77]
    s_branch mg_mkad
mg_mkae:
    v_cndmask_b32_e64 v80, v10, v80, s[70:71]
    v_cndmask_b32_e64 v81, v10, v81, s[72:73]
    v_cndmask_b32_e64 v82, v10, v82, s[74:75]
    v_cndmask_b32_e64 v83, v10, v83, s[76:77]
    v_mov_b32 v84, v10
    v_mov_b32 v85, v10
    v_mov_b32 v86, v10
    v_mov_b32 v87, v10
    v_cndmask_b32_e64 v92, v10, v92, s[70:71]
    v_cndmask_b32_e64 v93, v10, v93, s[72:73]
    v_cndmask_b32_e64 v94, v10, v94, s[74:75]
    v_cndmask_b32_e64 v95, v10, v95, s[76:77]
    v_mov_b32 v96, v10
    v_mov_b32 v97, v10
    v_mov_b32 v98, v10
    v_mov_b32 v99, v10
    v_mov_b32 v104, v10
    v_mov_b32 v105, v10
    v_mov_b32 v106, v10
    v_mov_b32 v107, v10
    v_mov_b32 v100, v10
    v_mov_b32 v101, v10
    v_mov_b32 v102, v10
    v_mov_b32 v103, v10
    v_mov_b32 v108, v10
    v_mov_b32 v109, v10
    v_mov_b32 v110, v10
    v_mov_b32 v111, v10
mg_mkad:
    s_branch mg_max0
mg_nomask0:
    ds_read_b128 v[192:195], v2 offset:0
    ds_read_b128 v[196:199], v2 offset:1024
    ds_read_b128 v[200:203], v2 offset:2048
    ds_read_b128 v[204:207], v2 offset:3072
    ds_read_b128 v[208:211], v2 offset:4096
    ds_read_b128 v[212:215], v2 offset:5120
    ds_read_b128 v[216:219], v2 offset:6144
    ds_read_b128 v[220:223], v2 offset:7168
    ds_read_b128 v[224:227], v2 offset:8192
    ds_read_b128 v[228:231], v2 offset:9216
    ds_read_b128 v[232:235], v2 offset:10240
    ds_read_b128 v[236:239], v2 offset:11264
mg_max0:
    v_max_f32 v11, v80, v81
    v_max3_f32 v11, v11, v82, v83
    v_max3_f32 v11, v11, v84, v85
    v_max3_f32 v11, v11, v86, v87
    v_max3_f32 v11, v11, v96, v97
    v_max3_f32 v11, v11, v98, v99
    v_max3_f32 v11, v11, v100, v101
    v_max3_f32 v11, v11, v102, v103
    v_max_f32 v12, v88, v89
    v_max3_f32 v12, v12, v90, v91
    v_max3_f32 v12, v12, v92, v93
    v_max3_f32 v12, v12, v94, v95
    v_max3_f32 v12, v12, v104, v105
    v_max3_f32 v12, v12, v106, v107
    v_max3_f32 v12, v12, v108, v109
    v_max3_f32 v12, v12, v110, v111
    v_mov_b32 v13, v11
    v_mov_b32 v14, v12
    s_nop 0
    v_permlane32_swap_b32 v11, v13
    v_permlane32_swap_b32 v12, v14
    s_nop 0
    v_max_f32 v11, v11, v13
    v_max_f32 v12, v12, v14
    v_mov_b32 v13, v11
    v_mov_b32 v14, v12
    s_nop 0
    v_permlane16_swap_b32 v11, v13
    v_permlane16_swap_b32 v12, v14
    s_nop 0
    v_max_f32 v11, v11, v13
    v_max_f32 v12, v12, v14
    s_mov_b64 vcc, 0
    v_sub_f32 v176, 0xc2c00000, v11
    v_sub_f32 v177, 0xc2c00000, v11
    v_sub_f32 v178, 0xc2c00000, v11
    v_sub_f32 v179, 0xc2c00000, v11
    v_sub_f32 v180, 0xc2c00000, v12
    v_sub_f32 v181, 0xc2c00000, v12
    v_sub_f32 v182, 0xc2c00000, v12
    v_sub_f32 v183, 0xc2c00000, v12
    s_bitcmp1_b32 s46, 0
    s_cbranch_scc1 mg_start0
    v_pk_add_f32 v[112:113], v[80:81], v[176:177]
    v_pk_add_f32 v[114:115], v[82:83], v[176:177]
    v_pk_add_f32 v[116:117], v[84:85], v[176:177]
    v_pk_add_f32 v[118:119], v[86:87], v[176:177]
    v_pk_add_f32 v[120:121], v[88:89], v[180:181]
    v_pk_add_f32 v[122:123], v[90:91], v[180:181]
    v_pk_add_f32 v[124:125], v[92:93], v[180:181]
    v_pk_add_f32 v[126:127], v[94:95], v[180:181]
    v_pk_add_f32 v[128:129], v[96:97], v[176:177]
    v_pk_add_f32 v[130:131], v[98:99], v[176:177]
    v_pk_add_f32 v[132:133], v[100:101], v[176:177]
    v_pk_add_f32 v[134:135], v[102:103], v[176:177]
    v_pk_add_f32 v[136:137], v[104:105], v[180:181]
    v_pk_add_f32 v[138:139], v[106:107], v[180:181]
    v_pk_add_f32 v[140:141], v[108:109], v[180:181]
    v_pk_add_f32 v[142:143], v[110:111], v[180:181]
    v_exp_f32 v112, v112
    v_exp_f32 v113, v113
    v_exp_f32 v114, v114
    v_exp_f32 v115, v115
    v_exp_f32 v116, v116
    v_exp_f32 v117, v117
    v_exp_f32 v118, v118
    v_exp_f32 v119, v119
    v_exp_f32 v120, v120
    v_exp_f32 v121, v121
    v_exp_f32 v122, v122
    v_exp_f32 v123, v123
    v_exp_f32 v124, v124
    v_exp_f32 v125, v125
    v_cvt_pk_bf16_f32 v112, v112, v113
    v_cvt_pk_bf16_f32 v113, v114, v115
    v_cvt_pk_bf16_f32 v114, v116, v117
    v_cvt_pk_bf16_f32 v115, v118, v119
    v_cvt_pk_bf16_f32 v120, v120, v121
    v_cvt_pk_bf16_f32 v121, v122, v123
    s_cmp_eq_u32 s15, 0
    s_cbranch_scc1 mg_P1N
    s_branch mg_P1L
mg_start0:
    v_pk_add_f32 v[80:81], v[80:81], v[176:177]
    v_pk_add_f32 v[82:83], v[82:83], v[176:177]
    v_pk_add_f32 v[84:85], v[84:85], v[176:177]
    v_pk_add_f32 v[86:87], v[86:87], v[176:177]
    v_pk_add_f32 v[88:89], v[88:89], v[180:181]
    v_pk_add_f32 v[90:91], v[90:91], v[180:181]
    v_pk_add_f32 v[92:93], v[92:93], v[180:181]
    v_pk_add_f32 v[94:95], v[94:95], v[180:181]
    v_pk_add_f32 v[96:97], v[96:97], v[176:177]
    v_pk_add_f32 v[98:99], v[98:99], v[176:177]
    v_pk_add_f32 v[100:101], v[100:101], v[176:177]
    v_pk_add_f32 v[102:103], v[102:103], v[176:177]
    v_pk_add_f32 v[104:105], v[104:105], v[180:181]
    v_pk_add_f32 v[106:107], v[106:107], v[180:181]
    v_pk_add_f32 v[108:109], v[108:109], v[180:181]
    v_pk_add_f32 v[110:111], v[110:111], v[180:181]
    v_exp_f32 v80, v80
    v_exp_f32 v81, v81
    v_exp_f32 v82, v82
    v_exp_f32 v83, v83
    v_exp_f32 v84, v84
    v_exp_f32 v85, v85
    v_exp_f32 v86, v86
    v_exp_f32 v87, v87
    v_exp_f32 v88, v88
    v_exp_f32 v89, v89
    v_exp_f32 v90, v90
    v_exp_f32 v91, v91
    v_exp_f32 v92, v92
    v_exp_f32 v93, v93
    v_cvt_pk_bf16_f32 v80, v80, v81
    v_cvt_pk_bf16_f32 v81, v82, v83
    v_cvt_pk_bf16_f32 v82, v84, v85
    v_cvt_pk_bf16_f32 v83, v86, v87
    v_cvt_pk_bf16_f32 v88, v88, v89
    v_cvt_pk_bf16_f32 v89, v90, v91
    s_cmp_eq_u32 s46, 1
    s_cbranch_scc1 mg_final
    s_cmp_eq_u32 s15, 0
    s_cbranch_scc0 mg_L0L
mg_L0N:
    s_waitcnt lgkmcnt(8)
    v_mfma_f32_16x16x32_bf16 v[112:115], v[192:195], v[144:147], v[176:179]
    v_exp_f32 v94, v94
    v_mfma_f32_16x16x32_bf16 v[120:123], v[192:195], v[148:151], v[180:183]
    ds_read_b128 v[240:243], v2 offset:12288
    s_add_u32 s49, s49, 858993460
    v_mfma_f32_16x16x32_bf16 v[120:123], v[196:199], v[156:159], v[120:123]
    v_exp_f32 v95, v95
    v_mfma_f32_16x16x32_bf16 v[112:115], v[196:199], v[152:155], v[112:115]
    ds_read_b128 v[244:247], v2 offset:13312
    s_cselect_b32 s10, 4294901760, s48
    v_mfma_f32_16x16x32_bf16 v[112:115], v[200:203], v[160:163], v[112:115]
    v_exp_f32 v96, v96
    v_mfma_f32_16x16x32_bf16 v[120:123], v[200:203], v[164:167], v[120:123]
    v_cvt_pk_bf16_f32 v90, v92, v93
    v_cvt_pk_bf16_f32 v91, v94, v95
    v_mfma_f32_16x16x32_bf16 v[120:123], v[204:207], v[172:175], v[120:123]
    v_exp_f32 v97, v97
    v_mfma_f32_16x16x32_bf16 v[112:115], v[204:207], v[168:171], v[112:115]
    v_cvt_pk_bf16_f32 v96, v96, v97
    s_waitcnt lgkmcnt(6)
    v_mfma_f32_16x16x32_bf16 v[116:119], v[208:211], v[144:147], v[176:179]
    v_exp_f32 v98, v98
    v_mfma_f32_16x16x32_bf16 v[124:127], v[208:211], v[148:151], v[180:183]
    ds_read_b128 v[248:251], v2 offset:14336
    ds_read_b128 v[252:255], v2 offset:15360
    v_mfma_f32_16x16x32_bf16 v[124:127], v[212:215], v[156:159], v[124:127]
    v_exp_f32 v99, v99
    v_mfma_f32_16x16x32_bf16 v[116:119], v[212:215], v[152:155], v[116:119]
    v_cvt_pk_bf16_f32 v97, v98, v99
    v_xor_b32 v2, s56, v2
    v_mfma_f32_16x16x32_bf16 v[116:119], v[216:219], v[160:163], v[116:119]
    v_exp_f32 v100, v100
    v_mfma_f32_16x16x32_bf16 v[124:127], v[216:219], v[164:167], v[124:127]
    ds_read_b128 v[192:195], v3 offset:0
    ds_read_b128 v[196:199], v3 offset:1024
    v_mfma_f32_16x16x32_bf16 v[124:127], v[220:223], v[172:175], v[124:127]
    v_exp_f32 v101, v101
    v_mfma_f32_16x16x32_bf16 v[116:119], v[220:223], v[168:171], v[116:119]
    v_cvt_pk_bf16_f32 v98, v100, v101
    s_waitcnt lgkmcnt(6)
    v_mfma_f32_16x16x32_bf16 v[128:131], v[224:227], v[144:147], v[176:179]
    v_exp_f32 v102, v102
    v_mfma_f32_16x16x32_bf16 v[136:139], v[224:227], v[148:151], v[180:183]
    ds_read_b128 v[200:203], v3 offset:2048
    ds_read_b128 v[204:207], v3 offset:3072
    v_mfma_f32_16x16x32_bf16 v[136:139], v[228:231], v[156:159], v[136:139]
    v_exp_f32 v103, v103
    v_mfma_f32_16x16x32_bf16 v[128:131], v[228:231], v[152:155], v[128:131]
    v_cvt_pk_bf16_f32 v99, v102, v103
    v_mfma_f32_16x16x32_bf16 v[128:131], v[232:235], v[160:163], v[128:131]
    v_exp_f32 v104, v104
    v_mfma_f32_16x16x32_bf16 v[136:139], v[232:235], v[164:167], v[136:139]
    ds_read_b128 v[208:211], v3 offset:4096
    ds_read_b128 v[212:215], v3 offset:5120
    v_mfma_f32_16x16x32_bf16 v[136:139], v[236:239], v[172:175], v[136:139]
    v_exp_f32 v105, v105
    v_mfma_f32_16x16x32_bf16 v[128:131], v[236:239], v[168:171], v[128:131]
    v_cvt_pk_bf16_f32 v104, v104, v105
    s_waitcnt lgkmcnt(6)
    v_mfma_f32_16x16x32_bf16 v[132:135], v[240:243], v[144:147], v[176:179]
    v_exp_f32 v106, v106
    v_mfma_f32_16x16x32_bf16 v[140:143], v[240:243], v[148:151], v[180:183]
    ds_read_b128 v[216:219], v3 offset:6144
    ds_read_b128 v[220:223], v3 offset:7168
    v_mfma_f32_16x16x32_bf16 v[140:143], v[244:247], v[156:159], v[140:143]
    v_exp_f32 v107, v107
    v_mfma_f32_16x16x32_bf16 v[132:135], v[244:247], v[152:155], v[132:135]
    v_cvt_pk_bf16_f32 v105, v106, v107
    v_mfma_f32_16x16x32_bf16 v[132:135], v[248:251], v[160:163], v[132:135]
    v_exp_f32 v108, v108
    v_mfma_f32_16x16x32_bf16 v[140:143], v[248:251], v[164:167], v[140:143]
    ds_read_b128 v[224:227], v3 offset:8192
    ds_read_b128 v[228:231], v3 offset:9216
    v_mfma_f32_16x16x32_bf16 v[140:143], v[252:255], v[172:175], v[140:143]
    v_exp_f32 v109, v109
    v_mfma_f32_16x16x32_bf16 v[132:135], v[252:255], v[168:171], v[132:135]
    v_cvt_pk_bf16_f32 v106, v108, v109
    s_waitcnt lgkmcnt(7)
    v_mfma_f32_16x16x32_bf16 v[16:19], v[192:195], v[80:83], v[16:19]
    v_exp_f32 v110, v110
    v_mfma_f32_16x16x32_bf16 v[24:27], v[192:195], v[88:91], v[24:27]
    ds_read_b128 v[232:235], v3 offset:10240
    ds_read_b128 v[236:239], v3 offset:11264
    v_mfma_f32_16x16x32_bf16 v[188:191], v[4:7], v[88:91], v[188:191]
    v_exp_f32 v111, v111
    v_mfma_f32_16x16x32_bf16 v[184:187], v[4:7], v[80:83], v[184:187]
    v_cvt_pk_bf16_f32 v107, v110, v111
    v_mfma_f32_16x16x32_bf16 v[20:23], v[196:199], v[80:83], v[20:23]
    v_exp_f32 v112, v112
    v_mfma_f32_16x16x32_bf16 v[28:31], v[196:199], v[88:91], v[28:31]
    ds_read_b128 v[240:243], v3 offset:12288
    ds_read_b128 v[244:247], v3 offset:13312
    v_mfma_f32_16x16x32_bf16 v[40:43], v[200:203], v[88:91], v[40:43]
    v_exp_f32 v113, v113
    v_mfma_f32_16x16x32_bf16 v[32:35], v[200:203], v[80:83], v[32:35]
    v_cvt_pk_bf16_f32 v112, v112, v113
    s_waitcnt lgkmcnt(7)
    v_mfma_f32_16x16x32_bf16 v[36:39], v[204:207], v[80:83], v[36:39]
    v_exp_f32 v114, v114
    v_mfma_f32_16x16x32_bf16 v[44:47], v[204:207], v[88:91], v[44:47]
    ds_read_b128 v[248:251], v3 offset:14336
    ds_read_b128 v[252:255], v3 offset:15360
    v_mfma_f32_16x16x32_bf16 v[56:59], v[208:211], v[88:91], v[56:59]
    s_barrier
    ds_read_b128 v[192:195], v2 offset:0
    v_mfma_f32_16x16x32_bf16 v[48:51], v[208:211], v[80:83], v[48:51]
    v_exp_f32 v115, v115
    v_mfma_f32_16x16x32_bf16 v[52:55], v[212:215], v[80:83], v[52:55]
    v_cvt_pk_bf16_f32 v113, v114, v115
    v_add_u32 v3, s10, v3
    v_mfma_f32_16x16x32_bf16 v[60:63], v[212:215], v[88:91], v[60:63]
    v_exp_f32 v116, v116
    v_mfma_f32_16x16x32_bf16 v[72:75], v[216:219], v[88:91], v[72:75]
    ds_read_b128 v[196:199], v2 offset:1024
    ds_read_b128 v[200:203], v2 offset:2048
    v_mfma_f32_16x16x32_bf16 v[64:67], v[216:219], v[80:83], v[64:67]
    s_waitcnt lgkmcnt(9)
    v_mfma_f32_16x16x32_bf16 v[68:71], v[220:223], v[80:83], v[68:71]
    v_exp_f32 v117, v117
    v_mfma_f32_16x16x32_bf16 v[76:79], v[220:223], v[88:91], v[76:79]
    v_cvt_pk_bf16_f32 v114, v116, v117
    v_mfma_f32_16x16x32_bf16 v[24:27], v[224:227], v[104:107], v[24:27]
    v_exp_f32 v118, v118
    v_mfma_f32_16x16x32_bf16 v[16:19], v[224:227], v[96:99], v[16:19]
    ds_read_b128 v[204:207], v2 offset:3072
    ds_read_b128 v[208:211], v2 offset:4096
    v_mfma_f32_16x16x32_bf16 v[184:187], v[4:7], v[96:99], v[184:187]
    v_exp_f32 v119, v119
    v_mfma_f32_16x16x32_bf16 v[188:191], v[4:7], v[104:107], v[188:191]
    v_cvt_pk_bf16_f32 v115, v118, v119
    v_mfma_f32_16x16x32_bf16 v[28:31], v[228:231], v[104:107], v[28:31]
    v_exp_f32 v120, v120
    v_mfma_f32_16x16x32_bf16 v[20:23], v[228:231], v[96:99], v[20:23]
    ds_read_b128 v[212:215], v2 offset:5120
    s_waitcnt lgkmcnt(8)
    v_mfma_f32_16x16x32_bf16 v[32:35], v[232:235], v[96:99], v[32:35]
    v_exp_f32 v121, v121
    v_mfma_f32_16x16x32_bf16 v[40:43], v[232:235], v[104:107], v[40:43]
    v_cvt_pk_bf16_f32 v120, v120, v121
    v_max_f32 v11, v184, v188
    v_mfma_f32_16x16x32_bf16 v[44:47], v[236:239], v[104:107], v[44:47]
    v_exp_f32 v122, v122
    v_mfma_f32_16x16x32_bf16 v[36:39], v[236:239], v[96:99], v[36:39]
    ds_read_b128 v[216:219], v2 offset:6144
    ds_read_b128 v[220:223], v2 offset:7168
    v_mfma_f32_16x16x32_bf16 v[48:51], v[240:243], v[96:99], v[48:51]
    v_exp_f32 v123, v123
    v_mfma_f32_16x16x32_bf16 v[56:59], v[240:243], v[104:107], v[56:59]
    v_cvt_pk_bf16_f32 v121, v122, v123
    v_cmp_lt_f32 vcc, s55, v11
    v_mfma_f32_16x16x32_bf16 v[60:63], v[244:247], v[104:107], v[60:63]
    v_exp_f32 v124, v124
    v_mfma_f32_16x16x32_bf16 v[52:55], v[244:247], v[96:99], v[52:55]
    ds_read_b128 v[224:227], v2 offset:8192
    s_waitcnt lgkmcnt(9)
    v_mfma_f32_16x16x32_bf16 v[64:67], v[248:251], v[96:99], v[64:67]
    v_exp_f32 v125, v125
    v_mfma_f32_16x16x32_bf16 v[72:75], v[248:251], v[104:107], v[72:75]
    ds_read_b128 v[228:231], v2 offset:9216
    ds_read_b128 v[232:235], v2 offset:10240
    v_mfma_f32_16x16x32_bf16 v[76:79], v[252:255], v[104:107], v[76:79]
    ds_read_b128 v[236:239], v2 offset:11264
    v_mfma_f32_16x16x32_bf16 v[68:71], v[252:255], v[96:99], v[68:71]
    s_cbranch_vccnz mg_decN
mg_P1N:
    s_sub_u32 s58, s58, 1
    s_cbranch_scc1 mg_pen
    s_waitcnt lgkmcnt(8)
    v_mfma_f32_16x16x32_bf16 v[80:83], v[192:195], v[144:147], v[176:179]
    v_exp_f32 v126, v126
    v_mfma_f32_16x16x32_bf16 v[88:91], v[192:195], v[148:151], v[180:183]
    ds_read_b128 v[240:243], v2 offset:12288
    s_add_u32 s49, s49, 858993460
    v_mfma_f32_16x16x32_bf16 v[88:91], v[196:199], v[156:159], v[88:91]
    v_exp_f32 v127, v127
    v_mfma_f32_16x16x32_bf16 v[80:83], v[196:199], v[152:155], v[80:83]
    ds_read_b128 v[244:247], v2 offset:13312
    s_cselect_b32 s10, 4294901760, s48
    v_mfma_f32_16x16x32_bf16 v[80:83], v[200:203], v[160:163], v[80:83]
    v_exp_f32 v128, v128
    v_mfma_f32_16x16x32_bf16 v[88:91], v[200:203], v[164:167], v[88:91]
    v_cvt_pk_bf16_f32 v122, v124, v125
    v_cvt_pk_bf16_f32 v123, v126, v127
    v_mfma_f32_16x16x32_bf16 v[88:91], v[204:207], v[172:175], v[88:91]
    v_exp_f32 v129, v129
    v_mfma_f32_16x16x32_bf16 v[80:83], v[204:207], v[168:171], v[80:83]
    v_cvt_pk_bf16_f32 v128, v128, v129
    s_waitcnt lgkmcnt(6)
    v_mfma_f32_16x16x32_bf16 v[84:87], v[208:211], v[144:147], v[176:179]
    v_exp_f32 v130, v130
    v_mfma_f32_16x16x32_bf16 v[92:95], v[208:211], v[148:151], v[180:183]
    ds_read_b128 v[248:251], v2 offset:14336
    ds_read_b128 v[252:255], v2 offset:15360
    v_mfma_f32_16x16x32_bf16 v[92:95], v[212:215], v[156:159], v[92:95]
    v_exp_f32 v131, v131
    v_mfma_f32_16x16x32_bf16 v[84:87], v[212:215], v[152:155], v[84:87]
    v_cvt_pk_bf16_f32 v129, v130, v131
    v_xor_b32 v2, s57, v2
    v_mfma_f32_16x16x32_bf16 v[84:87], v[216:219], v[160:163], v[84:87]
    v_exp_f32 v132, v132
    v_mfma_f32_16x16x32_bf16 v[92:95], v[216:219], v[164:167], v[92:95]
    ds_read_b128 v[192:195], v3 offset:0
    ds_read_b128 v[196:199], v3 offset:1024
    v_mfma_f32_16x16x32_bf16 v[92:95], v[220:223], v[172:175], v[92:95]
    v_exp_f32 v133, v133
    v_mfma_f32_16x16x32_bf16 v[84:87], v[220:223], v[168:171], v[84:87]
    v_cvt_pk_bf16_f32 v130, v132, v133
    s_waitcnt lgkmcnt(6)
    v_mfma_f32_16x16x32_bf16 v[96:99], v[224:227], v[144:147], v[176:179]
    v_exp_f32 v134, v134
    v_mfma_f32_16x16x32_bf16 v[104:107], v[224:227], v[148:151], v[180:183]
    ds_read_b128 v[200:203], v3 offset:2048
    ds_read_b128 v[204:207], v3 offset:3072
    v_mfma_f32_16x16x32_bf16 v[104:107], v[228:231], v[156:159], v[104:107]
    v_exp_f32 v135, v135
    v_mfma_f32_16x16x32_bf16 v[96:99], v[228:231], v[152:155], v[96:99]
    v_cvt_pk_bf16_f32 v131, v134, v135
    v_mfma_f32_16x16x32_bf16 v[96:99], v[232:235], v[160:163], v[96:99]
    v_exp_f32 v136, v136
    v_mfma_f32_16x16x32_bf16 v[104:107], v[232:235], v[164:167], v[104:107]
    ds_read_b128 v[208:211], v3 offset:4096
    ds_read_b128 v[212:215], v3 offset:5120
    v_mfma_f32_16x16x32_bf16 v[104:107], v[236:239], v[172:175], v[104:107]
    v_exp_f32 v137, v137
    v_mfma_f32_16x16x32_bf16 v[96:99], v[236:239], v[168:171], v[96:99]
    v_cvt_pk_bf16_f32 v136, v136, v137
    s_waitcnt lgkmcnt(6)
    v_mfma_f32_16x16x32_bf16 v[100:103], v[240:243], v[144:147], v[176:179]
    v_exp_f32 v138, v138
    v_mfma_f32_16x16x32_bf16 v[108:111], v[240:243], v[148:151], v[180:183]
    ds_read_b128 v[216:219], v3 offset:6144
    ds_read_b128 v[220:223], v3 offset:7168
    v_mfma_f32_16x16x32_bf16 v[108:111], v[244:247], v[156:159], v[108:111]
    v_exp_f32 v139, v139
    v_mfma_f32_16x16x32_bf16 v[100:103], v[244:247], v[152:155], v[100:103]
    v_cvt_pk_bf16_f32 v137, v138, v139
    v_mfma_f32_16x16x32_bf16 v[100:103], v[248:251], v[160:163], v[100:103]
    v_exp_f32 v140, v140
    v_mfma_f32_16x16x32_bf16 v[108:111], v[248:251], v[164:167], v[108:111]
    ds_read_b128 v[224:227], v3 offset:8192
    ds_read_b128 v[228:231], v3 offset:9216
    v_mfma_f32_16x16x32_bf16 v[108:111], v[252:255], v[172:175], v[108:111]
    v_exp_f32 v141, v141
    v_mfma_f32_16x16x32_bf16 v[100:103], v[252:255], v[168:171], v[100:103]
    v_cvt_pk_bf16_f32 v138, v140, v141
    s_waitcnt lgkmcnt(7)
    v_mfma_f32_16x16x32_bf16 v[16:19], v[192:195], v[112:115], v[16:19]
    v_exp_f32 v142, v142
    v_mfma_f32_16x16x32_bf16 v[24:27], v[192:195], v[120:123], v[24:27]
    ds_read_b128 v[232:235], v3 offset:10240
    ds_read_b128 v[236:239], v3 offset:11264
    v_mfma_f32_16x16x32_bf16 v[188:191], v[4:7], v[120:123], v[188:191]
    v_exp_f32 v143, v143
    v_mfma_f32_16x16x32_bf16 v[184:187], v[4:7], v[112:115], v[184:187]
    v_cvt_pk_bf16_f32 v139, v142, v143
    v_mfma_f32_16x16x32_bf16 v[20:23], v[196:199], v[112:115], v[20:23]
    v_exp_f32 v80, v80
    v_mfma_f32_16x16x32_bf16 v[28:31], v[196:199], v[120:123], v[28:31]
    ds_read_b128 v[240:243], v3 offset:12288
    ds_read_b128 v[244:247], v3 offset:13312
    v_mfma_f32_16x16x32_bf16 v[40:43], v[200:203], v[120:123], v[40:43]
    v_exp_f32 v81, v81
    v_mfma_f32_16x16x32_bf16 v[32:35], v[200:203], v[112:115], v[32:35]
    v_cvt_pk_bf16_f32 v80, v80, v81
    s_waitcnt lgkmcnt(7)
    v_mfma_f32_16x16x32_bf16 v[36:39], v[204:207], v[112:115], v[36:39]
    v_exp_f32 v82, v82
    v_mfma_f32_16x16x32_bf16 v[44:47], v[204:207], v[120:123], v[44:47]
    ds_read_b128 v[248:251], v3 offset:14336
    ds_read_b128 v[252:255], v3 offset:15360
    v_mfma_f32_16x16x32_bf16 v[56:59], v[208:211], v[120:123], v[56:59]
    s_barrier
    ds_read_b128 v[192:195], v2 offset:0
    v_mfma_f32_16x16x32_bf16 v[48:51], v[208:211], v[112:115], v[48:51]
    v_exp_f32 v83, v83
    v_mfma_f32_16x16x32_bf16 v[52:55], v[212:215], v[112:115], v[52:55]
    v_cvt_pk_bf16_f32 v81, v82, v83
    v_add_u32 v3, s10, v3
    v_mfma_f32_16x16x32_bf16 v[60:63], v[212:215], v[120:123], v[60:63]
    v_exp_f32 v84, v84
    v_mfma_f32_16x16x32_bf16 v[72:75], v[216:219], v[120:123], v[72:75]
    ds_read_b128 v[196:199], v2 offset:1024
    ds_read_b128 v[200:203], v2 offset:2048
    v_mfma_f32_16x16x32_bf16 v[64:67], v[216:219], v[112:115], v[64:67]
    s_waitcnt lgkmcnt(9)
    v_mfma_f32_16x16x32_bf16 v[68:71], v[220:223], v[112:115], v[68:71]
    v_exp_f32 v85, v85
    v_mfma_f32_16x16x32_bf16 v[76:79], v[220:223], v[120:123], v[76:79]
    v_cvt_pk_bf16_f32 v82, v84, v85
    v_mfma_f32_16x16x32_bf16 v[24:27], v[224:227], v[136:139], v[24:27]
    v_exp_f32 v86, v86
    v_mfma_f32_16x16x32_bf16 v[16:19], v[224:227], v[128:131], v[16:19]
    ds_read_b128 v[204:207], v2 offset:3072
    ds_read_b128 v[208:211], v2 offset:4096
    v_mfma_f32_16x16x32_bf16 v[184:187], v[4:7], v[128:131], v[184:187]
    v_exp_f32 v87, v87
    v_mfma_f32_16x16x32_bf16 v[188:191], v[4:7], v[136:139], v[188:191]
    v_cvt_pk_bf16_f32 v83, v86, v87
    v_mfma_f32_16x16x32_bf16 v[28:31], v[228:231], v[136:139], v[28:31]
    v_exp_f32 v88, v88
    v_mfma_f32_16x16x32_bf16 v[20:23], v[228:231], v[128:131], v[20:23]
    ds_read_b128 v[212:215], v2 offset:5120
    s_waitcnt lgkmcnt(8)
    v_mfma_f32_16x16x32_bf16 v[32:35], v[232:235], v[128:131], v[32:35]
    v_exp_f32 v89, v89
    v_mfma_f32_16x16x32_bf16 v[40:43], v[232:235], v[136:139], v[40:43]
    v_cvt_pk_bf16_f32 v88, v88, v89
    v_mfma_f32_16x16x32_bf16 v[44:47], v[236:239], v[136:139], v[44:47]
    v_exp_f32 v90, v90
    v_mfma_f32_16x16x32_bf16 v[36:39], v[236:239], v[128:131], v[36:39]
    ds_read_b128 v[216:219], v2 offset:6144
    ds_read_b128 v[220:223], v2 offset:7168
    v_mfma_f32_16x16x32_bf16 v[48:51], v[240:243], v[128:131], v[48:51]
    v_exp_f32 v91, v91
    v_mfma_f32_16x16x32_bf16 v[56:59], v[240:243], v[136:139], v[56:59]
    v_cvt_pk_bf16_f32 v89, v90, v91
    v_mfma_f32_16x16x32_bf16 v[60:63], v[244:247], v[136:139], v[60:63]
    v_exp_f32 v92, v92
    v_mfma_f32_16x16x32_bf16 v[52:55], v[244:247], v[128:131], v[52:55]
    ds_read_b128 v[224:227], v2 offset:8192
    s_waitcnt lgkmcnt(9)
    v_mfma_f32_16x16x32_bf16 v[64:67], v[248:251], v[128:131], v[64:67]
    v_exp_f32 v93, v93
    v_mfma_f32_16x16x32_bf16 v[72:75], v[248:251], v[136:139], v[72:75]
    ds_read_b128 v[228:231], v2 offset:9216
    ds_read_b128 v[232:235], v2 offset:10240
    v_mfma_f32_16x16x32_bf16 v[76:79], v[252:255], v[136:139], v[76:79]
    ds_read_b128 v[236:239], v2 offset:11264
    v_mfma_f32_16x16x32_bf16 v[68:71], v[252:255], v[128:131], v[68:71]
    s_cbranch_vccz mg_L0N
    s_nop 7
    s_mov_b32 s13, 0x44800000
    v_cmp_nge_f32 vcc, 0x44800000, v184
    v_cmp_nge_f32_e64 s[4:5], s13, v188
    s_nop 1
    s_or_b64 vcc, vcc, s[4:5]
    s_cselect_b32 s13, 1, 0
    s_or_b32 s54, s54, s13
    v_ldexp_f32 v16, v16, v8
    v_ldexp_f32 v17, v17, v8
    v_ldexp_f32 v18, v18, v8
    v_ldexp_f32 v19, v19, v8
    v_ldexp_f32 v20, v20, v8
    v_ldexp_f32 v21, v21, v8
    v_ldexp_f32 v22, v22, v8
    v_ldexp_f32 v23, v23, v8
    v_ldexp_f32 v24, v24, v9
    v_ldexp_f32 v25, v25, v9
    v_ldexp_f32 v26, v26, v9
    v_ldexp_f32 v27, v27, v9
    v_ldexp_f32 v28, v28, v9
    v_ldexp_f32 v29, v29, v9
    v_ldexp_f32 v30, v30, v9
    v_ldexp_f32 v31, v31, v9
    v_ldexp_f32 v32, v32, v8
    v_ldexp_f32 v33, v33, v8
    v_ldexp_f32 v34, v34, v8
    v_ldexp_f32 v35, v35, v8
    v_ldexp_f32 v36, v36, v8
    v_ldexp_f32 v37, v37, v8
    v_ldexp_f32 v38, v38, v8
    v_ldexp_f32 v39, v39, v8
    v_ldexp_f32 v40, v40, v9
    v_ldexp_f32 v41, v41, v9
    v_ldexp_f32 v42, v42, v9
    v_ldexp_f32 v43, v43, v9
    v_ldexp_f32 v44, v44, v9
    v_ldexp_f32 v45, v45, v9
    v_ldexp_f32 v46, v46, v9
    v_ldexp_f32 v47, v47, v9
    v_ldexp_f32 v48, v48, v8
    v_ldexp_f32 v49, v49, v8
    v_ldexp_f32 v50, v50, v8
    v_ldexp_f32 v51, v51, v8
    v_ldexp_f32 v52, v52, v8
    v_ldexp_f32 v53, v53, v8
    v_ldexp_f32 v54, v54, v8
    v_ldexp_f32 v55, v55, v8
    v_ldexp_f32 v56, v56, v9
    v_ldexp_f32 v57, v57, v9
    v_ldexp_f32 v58, v58, v9
    v_ldexp_f32 v59, v59, v9
    v_ldexp_f32 v60, v60, v9
    v_ldexp_f32 v61, v61, v9
    v_ldexp_f32 v62, v62, v9
    v_ldexp_f32 v63, v63, v9
    v_ldexp_f32 v64, v64, v8
    v_ldexp_f32 v65, v65, v8
    v_ldexp_f32 v66, v66, v8
    v_ldexp_f32 v67, v67, v8
    v_ldexp_f32 v68, v68, v8
    v_ldexp_f32 v69, v69, v8
    v_ldexp_f32 v70, v70, v8
    v_ldexp_f32 v71, v71, v8
    v_ldexp_f32 v72, v72, v9
    v_ldexp_f32 v73, v73, v9
    v_ldexp_f32 v74, v74, v9
    v_ldexp_f32 v75, v75, v9
    v_ldexp_f32 v76, v76, v9
    v_ldexp_f32 v77, v77, v9
    v_ldexp_f32 v78, v78, v9
    v_ldexp_f32 v79, v79, v9
    v_ldexp_f32 v184, v184, v8
    v_ldexp_f32 v188, v188, v9
    s_branch mg_L0N
mg_L0L:
    s_waitcnt lgkmcnt(8)
    v_mfma_f32_16x16x32_bf16 v[112:115], v[192:195], v[144:147], v[176:179]
    v_exp_f32 v94, v94
    v_mfma_f32_16x16x32_bf16 v[120:123], v[192:195], v[148:151], v[180:183]
    ds_read_b128 v[240:243], v2 offset:12288
    s_add_u32 s49, s49, 858993460
    v_mfma_f32_16x16x32_bf16 v[120:123], v[196:199], v[156:159], v[120:123]
    v_exp_f32 v95, v95
    v_mfma_f32_16x16x32_bf16 v[112:115], v[196:199], v[152:155], v[112:115]
    ds_read_b128 v[244:247], v2 offset:13312
    s_cselect_b32 s10, 4294901760, s48
    v_mfma_f32_16x16x32_bf16 v[112:115], v[200:203], v[160:163], v[112:115]
    v_exp_f32 v96, v96
    v_mfma_f32_16x16x32_bf16 v[120:123], v[200:203], v[164:167], v[120:123]
    v_cvt_pk_bf16_f32 v90, v92, v93
    v_cvt_pk_bf16_f32 v91, v94, v95
    v_mfma_f32_16x16x32_bf16 v[120:123], v[204:207], v[172:175], v[120:123]
    v_exp_f32 v97, v97
    v_mfma_f32_16x16x32_bf16 v[112:115], v[204:207], v[168:171], v[112:115]
    v_cvt_pk_bf16_f32 v96, v96, v97
    s_waitcnt lgkmcnt(6)
    v_mfma_f32_16x16x32_bf16 v[116:119], v[208:211], v[144:147], v[176:179]
    v_exp_f32 v98, v98
    v_mfma_f32_16x16x32_bf16 v[124:127], v[208:211], v[148:151], v[180:183]
    ds_read_b128 v[248:251], v2 offset:14336
    ds_read_b128 v[252:255], v2 offset:15360
    v_mfma_f32_16x16x32_bf16 v[124:127], v[212:215], v[156:159], v[124:127]
    v_exp_f32 v99, v99
    v_mfma_f32_16x16x32_bf16 v[116:119], v[212:215], v[152:155], v[116:119]
    v_cvt_pk_bf16_f32 v97, v98, v99
    v_xor_b32 v2, s56, v2
    v_mfma_f32_16x16x32_bf16 v[116:119], v[216:219], v[160:163], v[116:119]
    v_exp_f32 v100, v100
    v_mfma_f32_16x16x32_bf16 v[124:127], v[216:219], v[164:167], v[124:127]
    ds_read_b128 v[192:195], v3 offset:0
    ds_read_b128 v[196:199], v3 offset:1024
    v_mfma_f32_16x16x32_bf16 v[124:127], v[220:223], v[172:175], v[124:127]
    v_exp_f32 v101, v101
    v_mfma_f32_16x16x32_bf16 v[116:119], v[220:223], v[168:171], v[116:119]
    v_cvt_pk_bf16_f32 v98, v100, v101
    s_waitcnt lgkmcnt(6)
    v_mfma_f32_16x16x32_bf16 v[128:131], v[224:227], v[144:147], v[176:179]
    v_exp_f32 v102, v102
    v_mfma_f32_16x16x32_bf16 v[136:139], v[224:227], v[148:151], v[180:183]
    ds_read_b128 v[200:203], v3 offset:2048
    ds_read_b128 v[204:207], v3 offset:3072
    v_mfma_f32_16x16x32_bf16 v[136:139], v[228:231], v[156:159], v[136:139]
    v_exp_f32 v103, v103
    v_mfma_f32_16x16x32_bf16 v[128:131], v[228:231], v[152:155], v[128:131]
    v_cvt_pk_bf16_f32 v99, v102, v103
    v_mfma_f32_16x16x32_bf16 v[128:131], v[232:235], v[160:163], v[128:131]
    v_exp_f32 v104, v104
    v_mfma_f32_16x16x32_bf16 v[136:139], v[232:235], v[164:167], v[136:139]
    ds_read_b128 v[208:211], v3 offset:4096
    ds_read_b128 v[212:215], v3 offset:5120
    v_mfma_f32_16x16x32_bf16 v[136:139], v[236:239], v[172:175], v[136:139]
    v_exp_f32 v105, v105
    v_mfma_f32_16x16x32_bf16 v[128:131], v[236:239], v[168:171], v[128:131]
    v_cvt_pk_bf16_f32 v104, v104, v105
    s_waitcnt lgkmcnt(6)
    v_mfma_f32_16x16x32_bf16 v[132:135], v[240:243], v[144:147], v[176:179]
    v_exp_f32 v106, v106
    v_mfma_f32_16x16x32_bf16 v[140:143], v[240:243], v[148:151], v[180:183]
    ds_read_b128 v[216:219], v3 offset:6144
    ds_read_b128 v[220:223], v3 offset:7168
    v_mfma_f32_16x16x32_bf16 v[140:143], v[244:247], v[156:159], v[140:143]
    v_exp_f32 v107, v107
    v_mfma_f32_16x16x32_bf16 v[132:135], v[244:247], v[152:155], v[132:135]
    v_cvt_pk_bf16_f32 v105, v106, v107
    v_mfma_f32_16x16x32_bf16 v[132:135], v[248:251], v[160:163], v[132:135]
    v_exp_f32 v108, v108
    v_mfma_f32_16x16x32_bf16 v[140:143], v[248:251], v[164:167], v[140:143]
    ds_read_b128 v[224:227], v3 offset:8192
    ds_read_b128 v[228:231], v3 offset:9216
    v_mfma_f32_16x16x32_bf16 v[140:143], v[252:255], v[172:175], v[140:143]
    v_exp_f32 v109, v109
    v_mfma_f32_16x16x32_bf16 v[132:135], v[252:255], v[168:171], v[132:135]
    v_cvt_pk_bf16_f32 v106, v108, v109
    s_waitcnt lgkmcnt(7)
    v_mfma_f32_16x16x32_bf16 v[16:19], v[192:195], v[80:83], v[16:19]
    v_exp_f32 v110, v110
    v_mfma_f32_16x16x32_bf16 v[24:27], v[192:195], v[88:91], v[24:27]
    ds_read_b128 v[232:235], v3 offset:10240
    ds_read_b128 v[236:239], v3 offset:11264
    v_mfma_f32_16x16x32_bf16 v[188:191], v[4:7], v[88:91], v[188:191]
    v_exp_f32 v111, v111
    v_mfma_f32_16x16x32_bf16 v[184:187], v[4:7], v[80:83], v[184:187]
    v_cvt_pk_bf16_f32 v107, v110, v111
    v_mfma_f32_16x16x32_bf16 v[20:23], v[196:199], v[80:83], v[20:23]
    v_exp_f32 v112, v112
    v_mfma_f32_16x16x32_bf16 v[28:31], v[196:199], v[88:91], v[28:31]
    ds_read_b128 v[240:243], v3 offset:12288
    ds_read_b128 v[244:247], v3 offset:13312
    v_mfma_f32_16x16x32_bf16 v[40:43], v[200:203], v[88:91], v[40:43]
    v_exp_f32 v113, v113
    v_mfma_f32_16x16x32_bf16 v[32:35], v[200:203], v[80:83], v[32:35]
    v_cvt_pk_bf16_f32 v112, v112, v113
    s_waitcnt lgkmcnt(7)
    v_mfma_f32_16x16x32_bf16 v[36:39], v[204:207], v[80:83], v[36:39]
    v_exp_f32 v114, v114
    v_mfma_f32_16x16x32_bf16 v[44:47], v[204:207], v[88:91], v[44:47]
    ds_read_b128 v[248:251], v3 offset:14336
    ds_read_b128 v[252:255], v3 offset:15360
    v_mfma_f32_16x16x32_bf16 v[56:59], v[208:211], v[88:91], v[56:59]
    s_waitcnt vmcnt(16)
    s_barrier
    s_bfe_u32 s3, s52, 0x5000e
    s_bitcmp1_b32 s11, s3
    s_cbranch_scc1 mg_ck_9
mg_ck_9r:
    s_mov_b32 m0, s50
    s_add_u32 s50, s50, 16384
    buffer_load_dwordx4 v1, s[16:19], s52 offen offset:0 sc1 lds
    buffer_load_dwordx4 v1, s[16:19], s52 offen offset:1024 sc1 lds
    buffer_load_dwordx4 v1, s[16:19], s52 offen offset:2048 sc1 lds
    buffer_load_dwordx4 v1, s[16:19], s52 offen offset:3072 sc1 lds
    s_and_b32 s50, s50, 65535
    s_add_u32 s52, s52, 16384
    s_cmp_eq_u32 s52, s65
    s_cselect_b32 s52, s63, s52
    s_mov_b32 m0, s51
    s_add_u32 s51, s51, 16384
    buffer_load_dwordx4 v1, s[16:19], s53 offen offset:0 sc1 lds
    buffer_load_dwordx4 v1, s[16:19], s53 offen offset:1024 sc1 lds
    buffer_load_dwordx4 v1, s[16:19], s53 offen offset:2048 sc1 lds
    buffer_load_dwordx4 v1, s[16:19], s53 offen offset:3072 sc1 lds
    s_sub_u32 s14, s51, 81920
    s_cmp_ge_u32 s51, 147456
    s_cselect_b32 s51, s14, s51
    s_add_u32 s53, s53, 16384
    s_cmp_eq_u32 s53, s66
    s_cselect_b32 s53, s64, s53
    ds_read_b128 v[192:195], v2 offset:0
    v_mfma_f32_16x16x32_bf16 v[48:51], v[208:211], v[80:83], v[48:51]
    v_exp_f32 v115, v115
    v_mfma_f32_16x16x32_bf16 v[52:55], v[212:215], v[80:83], v[52:55]
    v_cvt_pk_bf16_f32 v113, v114, v115
    v_add_u32 v3, s10, v3
    v_mfma_f32_16x16x32_bf16 v[60:63], v[212:215], v[88:91], v[60:63]
    v_exp_f32 v116, v116
    v_mfma_f32_16x16x32_bf16 v[72:75], v[216:219], v[88:91], v[72:75]
    ds_read_b128 v[196:199], v2 offset:1024
    ds_read_b128 v[200:203], v2 offset:2048
    v_mfma_f32_16x16x32_bf16 v[64:67], v[216:219], v[80:83], v[64:67]
    s_waitcnt lgkmcnt(9)
    v_mfma_f32_16x16x32_bf16 v[68:71], v[220:223], v[80:83], v[68:71]
    v_exp_f32 v117, v117
    v_mfma_f32_16x16x32_bf16 v[76:79], v[220:223], v[88:91], v[76:79]
    v_cvt_pk_bf16_f32 v114, v116, v117
    v_mfma_f32_16x16x32_bf16 v[24:27], v[224:227], v[104:107], v[24:27]
    v_exp_f32 v118, v118
    v_mfma_f32_16x16x32_bf16 v[16:19], v[224:227], v[96:99], v[16:19]
    ds_read_b128 v[204:207], v2 offset:3072
    ds_read_b128 v[208:211], v2 offset:4096
    v_mfma_f32_16x16x32_bf16 v[184:187], v[4:7], v[96:99], v[184:187]
    v_exp_f32 v119, v119
    v_mfma_f32_16x16x32_bf16 v[188:191], v[4:7], v[104:107], v[188:191]
    v_cvt_pk_bf16_f32 v115, v118, v119
    v_mfma_f32_16x16x32_bf16 v[28:31], v[228:231], v[104:107], v[28:31]
    v_exp_f32 v120, v120
    v_mfma_f32_16x16x32_bf16 v[20:23], v[228:231], v[96:99], v[20:23]
    ds_read_b128 v[212:215], v2 offset:5120
    s_waitcnt lgkmcnt(8)
    v_mfma_f32_16x16x32_bf16 v[32:35], v[232:235], v[96:99], v[32:35]
    v_exp_f32 v121, v121
    v_mfma_f32_16x16x32_bf16 v[40:43], v[232:235], v[104:107], v[40:43]
    v_cvt_pk_bf16_f32 v120, v120, v121
    v_max_f32 v11, v184, v188
    v_mfma_f32_16x16x32_bf16 v[44:47], v[236:239], v[104:107], v[44:47]
    v_exp_f32 v122, v122
    v_mfma_f32_16x16x32_bf16 v[36:39], v[236:239], v[96:99], v[36:39]
    ds_read_b128 v[216:219], v2 offset:6144
    ds_read_b128 v[220:223], v2 offset:7168
    v_mfma_f32_16x16x32_bf16 v[48:51], v[240:243], v[96:99], v[48:51]
    v_exp_f32 v123, v123
    v_mfma_f32_16x16x32_bf16 v[56:59], v[240:243], v[104:107], v[56:59]
    v_cvt_pk_bf16_f32 v121, v122, v123
    v_cmp_lt_f32 vcc, s55, v11
    v_mfma_f32_16x16x32_bf16 v[60:63], v[244:247], v[104:107], v[60:63]
    v_exp_f32 v124, v124
    v_mfma_f32_16x16x32_bf16 v[52:55], v[244:247], v[96:99], v[52:55]
    ds_read_b128 v[224:227], v2 offset:8192
    s_waitcnt lgkmcnt(9)
    v_mfma_f32_16x16x32_bf16 v[64:67], v[248:251], v[96:99], v[64:67]
    v_exp_f32 v125, v125
    v_mfma_f32_16x16x32_bf16 v[72:75], v[248:251], v[104:107], v[72:75]
    ds_read_b128 v[228:231], v2 offset:9216
    ds_read_b128 v[232:235], v2 offset:10240
    v_mfma_f32_16x16x32_bf16 v[76:79], v[252:255], v[104:107], v[76:79]
    ds_read_b128 v[236:239], v2 offset:11264
    v_mfma_f32_16x16x32_bf16 v[68:71], v[252:255], v[96:99], v[68:71]
    s_cbranch_vccnz mg_decL
mg_P1L:
    s_sub_u32 s58, s58, 1
    s_cbranch_scc1 mg_pen
    s_waitcnt lgkmcnt(8)
    v_mfma_f32_16x16x32_bf16 v[80:83], v[192:195], v[144:147], v[176:179]
    v_exp_f32 v126, v126
    v_mfma_f32_16x16x32_bf16 v[88:91], v[192:195], v[148:151], v[180:183]
    ds_read_b128 v[240:243], v2 offset:12288
    s_add_u32 s49, s49, 858993460
    v_mfma_f32_16x16x32_bf16 v[88:91], v[196:199], v[156:159], v[88:91]
    v_exp_f32 v127, v127
    v_mfma_f32_16x16x32_bf16 v[80:83], v[196:199], v[152:155], v[80:83]
    ds_read_b128 v[244:247], v2 offset:13312
    s_cselect_b32 s10, 4294901760, s48
    v_mfma_f32_16x16x32_bf16 v[80:83], v[200:203], v[160:163], v[80:83]
    v_exp_f32 v128, v128
    v_mfma_f32_16x16x32_bf16 v[88:91], v[200:203], v[164:167], v[88:91]
    v_cvt_pk_bf16_f32 v122, v124, v125
    v_cvt_pk_bf16_f32 v123, v126, v127
    v_mfma_f32_16x16x32_bf16 v[88:91], v[204:207], v[172:175], v[88:91]
    v_exp_f32 v129, v129
    v_mfma_f32_16x16x32_bf16 v[80:83], v[204:207], v[168:171], v[80:83]
    v_cvt_pk_bf16_f32 v128, v128, v129
    s_waitcnt lgkmcnt(6)
    v_mfma_f32_16x16x32_bf16 v[84:87], v[208:211], v[144:147], v[176:179]
    v_exp_f32 v130, v130
    v_mfma_f32_16x16x32_bf16 v[92:95], v[208:211], v[148:151], v[180:183]
    ds_read_b128 v[248:251], v2 offset:14336
    ds_read_b128 v[252:255], v2 offset:15360
    v_mfma_f32_16x16x32_bf16 v[92:95], v[212:215], v[156:159], v[92:95]
    v_exp_f32 v131, v131
    v_mfma_f32_16x16x32_bf16 v[84:87], v[212:215], v[152:155], v[84:87]
    v_cvt_pk_bf16_f32 v129, v130, v131
    v_xor_b32 v2, s57, v2
    v_mfma_f32_16x16x32_bf16 v[84:87], v[216:219], v[160:163], v[84:87]
    v_exp_f32 v132, v132
    v_mfma_f32_16x16x32_bf16 v[92:95], v[216:219], v[164:167], v[92:95]
    ds_read_b128 v[192:195], v3 offset:0
    ds_read_b128 v[196:199], v3 offset:1024
    v_mfma_f32_16x16x32_bf16 v[92:95], v[220:223], v[172:175], v[92:95]
    v_exp_f32 v133, v133
    v_mfma_f32_16x16x32_bf16 v[84:87], v[220:223], v[168:171], v[84:87]
    v_cvt_pk_bf16_f32 v130, v132, v133
    s_waitcnt lgkmcnt(6)
    v_mfma_f32_16x16x32_bf16 v[96:99], v[224:227], v[144:147], v[176:179]
    v_exp_f32 v134, v134
    v_mfma_f32_16x16x32_bf16 v[104:107], v[224:227], v[148:151], v[180:183]
    ds_read_b128 v[200:203], v3 offset:2048
    ds_read_b128 v[204:207], v3 offset:3072
    v_mfma_f32_16x16x32_bf16 v[104:107], v[228:231], v[156:159], v[104:107]
    v_exp_f32 v135, v135
    v_mfma_f32_16x16x32_bf16 v[96:99], v[228:231], v[152:155], v[96:99]
    v_cvt_pk_bf16_f32 v131, v134, v135
    v_mfma_f32_16x16x32_bf16 v[96:99], v[232:235], v[160:163], v[96:99]
    v_exp_f32 v136, v136
    v_mfma_f32_16x16x32_bf16 v[104:107], v[232:235], v[164:167], v[104:107]
    ds_read_b128 v[208:211], v3 offset:4096
    ds_read_b128 v[212:215], v3 offset:5120
    v_mfma_f32_16x16x32_bf16 v[104:107], v[236:239], v[172:175], v[104:107]
    v_exp_f32 v137, v137
    v_mfma_f32_16x16x32_bf16 v[96:99], v[236:239], v[168:171], v[96:99]
    v_cvt_pk_bf16_f32 v136, v136, v137
    s_waitcnt lgkmcnt(6)
    v_mfma_f32_16x16x32_bf16 v[100:103], v[240:243], v[144:147], v[176:179]
    v_exp_f32 v138, v138
    v_mfma_f32_16x16x32_bf16 v[108:111], v[240:243], v[148:151], v[180:183]
    ds_read_b128 v[216:219], v3 offset:6144
    ds_read_b128 v[220:223], v3 offset:7168
    v_mfma_f32_16x16x32_bf16 v[108:111], v[244:247], v[156:159], v[108:111]
    v_exp_f32 v139, v139
    v_mfma_f32_16x16x32_bf16 v[100:103], v[244:247], v[152:155], v[100:103]
    v_cvt_pk_bf16_f32 v137, v138, v139
    v_mfma_f32_16x16x32_bf16 v[100:103], v[248:251], v[160:163], v[100:103]
    v_exp_f32 v140, v140
    v_mfma_f32_16x16x32_bf16 v[108:111], v[248:251], v[164:167], v[108:111]
    ds_read_b128 v[224:227], v3 offset:8192
    ds_read_b128 v[228:231], v3 offset:9216
    v_mfma_f32_16x16x32_bf16 v[108:111], v[252:255], v[172:175], v[108:111]
    v_exp_f32 v141, v141
    v_mfma_f32_16x16x32_bf16 v[100:103], v[252:255], v[168:171], v[100:103]
    v_cvt_pk_bf16_f32 v138, v140, v141
    s_waitcnt lgkmcnt(7)
    v_mfma_f32_16x16x32_bf16 v[16:19], v[192:195], v[112:115], v[16:19]
    v_exp_f32 v142, v142
    v_mfma_f32_16x16x32_bf16 v[24:27], v[192:195], v[120:123], v[24:27]
    ds_read_b128 v[232:235], v3 offset:10240
    ds_read_b128 v[236:239], v3 offset:11264
    v_mfma_f32_16x16x32_bf16 v[188:191], v[4:7], v[120:123], v[188:191]
    v_exp_f32 v143, v143
    v_mfma_f32_16x16x32_bf16 v[184:187], v[4:7], v[112:115], v[184:187]
    v_cvt_pk_bf16_f32 v139, v142, v143
    v_mfma_f32_16x16x32_bf16 v[20:23], v[196:199], v[112:115], v[20:23]
    v_exp_f32 v80, v80
    v_mfma_f32_16x16x32_bf16 v[28:31], v[196:199], v[120:123], v[28:31]
    ds_read_b128 v[240:243], v3 offset:12288
    ds_read_b128 v[244:247], v3 offset:13312
    v_mfma_f32_16x16x32_bf16 v[40:43], v[200:203], v[120:123], v[40:43]
    v_exp_f32 v81, v81
    v_mfma_f32_16x16x32_bf16 v[32:35], v[200:203], v[112:115], v[32:35]
    v_cvt_pk_bf16_f32 v80, v80, v81
    s_waitcnt lgkmcnt(7)
    v_mfma_f32_16x16x32_bf16 v[36:39], v[204:207], v[112:115], v[36:39]
    v_exp_f32 v82, v82
    v_mfma_f32_16x16x32_bf16 v[44:47], v[204:207], v[120:123], v[44:47]
    ds_read_b128 v[248:251], v3 offset:14336
    ds_read_b128 v[252:255], v3 offset:15360
    v_mfma_f32_16x16x32_bf16 v[56:59], v[208:211], v[120:123], v[56:59]
    s_waitcnt vmcnt(16)
    s_barrier
    s_bfe_u32 s3, s52, 0x5000e
    s_bitcmp1_b32 s11, s3
    s_cbranch_scc1 mg_ck_10
mg_ck_10r:
    s_mov_b32 m0, s50
    s_add_u32 s50, s50, 16384
    buffer_load_dwordx4 v1, s[16:19], s52 offen offset:0 sc1 lds
    buffer_load_dwordx4 v1, s[16:19], s52 offen offset:1024 sc1 lds
    buffer_load_dwordx4 v1, s[16:19], s52 offen offset:2048 sc1 lds
    buffer_load_dwordx4 v1, s[16:19], s52 offen offset:3072 sc1 lds
    s_and_b32 s50, s50, 65535
    s_add_u32 s52, s52, 16384
    s_cmp_eq_u32 s52, s65
    s_cselect_b32 s52, s63, s52
    s_mov_b32 m0, s51
    s_add_u32 s51, s51, 16384
    buffer_load_dwordx4 v1, s[16:19], s53 offen offset:0 sc1 lds
    buffer_load_dwordx4 v1, s[16:19], s53 offen offset:1024 sc1 lds
    buffer_load_dwordx4 v1, s[16:19], s53 offen offset:2048 sc1 lds
    buffer_load_dwordx4 v1, s[16:19], s53 offen offset:3072 sc1 lds
    s_sub_u32 s14, s51, 81920
    s_cmp_ge_u32 s51, 147456
    s_cselect_b32 s51, s14, s51
    s_add_u32 s53, s53, 16384
    s_cmp_eq_u32 s53, s66
    s_cselect_b32 s53, s64, s53
    ds_read_b128 v[192:195], v2 offset:0
    v_mfma_f32_16x16x32_bf16 v[48:51], v[208:211], v[112:115], v[48:51]
    v_exp_f32 v83, v83
    v_mfma_f32_16x16x32_bf16 v[52:55], v[212:215], v[112:115], v[52:55]
    v_cvt_pk_bf16_f32 v81, v82, v83
    v_add_u32 v3, s10, v3
    v_mfma_f32_16x16x32_bf16 v[60:63], v[212:215], v[120:123], v[60:63]
    v_exp_f32 v84, v84
    v_mfma_f32_16x16x32_bf16 v[72:75], v[216:219], v[120:123], v[72:75]
    ds_read_b128 v[196:199], v2 offset:1024
    ds_read_b128 v[200:203], v2 offset:2048
    v_mfma_f32_16x16x32_bf16 v[64:67], v[216:219], v[112:115], v[64:67]
    s_waitcnt lgkmcnt(9)
    v_mfma_f32_16x16x32_bf16 v[68:71], v[220:223], v[112:115], v[68:71]
    v_exp_f32 v85, v85
    v_mfma_f32_16x16x32_bf16 v[76:79], v[220:223], v[120:123], v[76:79]
    v_cvt_pk_bf16_f32 v82, v84, v85
    v_mfma_f32_16x16x32_bf16 v[24:27], v[224:227], v[136:139], v[24:27]
    v_exp_f32 v86, v86
    v_mfma_f32_16x16x32_bf16 v[16:19], v[224:227], v[128:131], v[16:19]
    ds_read_b128 v[204:207], v2 offset:3072
    ds_read_b128 v[208:211], v2 offset:4096
    v_mfma_f32_16x16x32_bf16 v[184:187], v[4:7], v[128:131], v[184:187]
    v_exp_f32 v87, v87
    v_mfma_f32_16x16x32_bf16 v[188:191], v[4:7], v[136:139], v[188:191]
    v_cvt_pk_bf16_f32 v83, v86, v87
    v_mfma_f32_16x16x32_bf16 v[28:31], v[228:231], v[136:139], v[28:31]
    v_exp_f32 v88, v88
    v_mfma_f32_16x16x32_bf16 v[20:23], v[228:231], v[128:131], v[20:23]
    ds_read_b128 v[212:215], v2 offset:5120
    s_waitcnt lgkmcnt(8)
    v_mfma_f32_16x16x32_bf16 v[32:35], v[232:235], v[128:131], v[32:35]
    v_exp_f32 v89, v89
    v_mfma_f32_16x16x32_bf16 v[40:43], v[232:235], v[136:139], v[40:43]
    v_cvt_pk_bf16_f32 v88, v88, v89
    v_mfma_f32_16x16x32_bf16 v[44:47], v[236:239], v[136:139], v[44:47]
    v_exp_f32 v90, v90
    v_mfma_f32_16x16x32_bf16 v[36:39], v[236:239], v[128:131], v[36:39]
    ds_read_b128 v[216:219], v2 offset:6144
    ds_read_b128 v[220:223], v2 offset:7168
    v_mfma_f32_16x16x32_bf16 v[48:51], v[240:243], v[128:131], v[48:51]
    v_exp_f32 v91, v91
    v_mfma_f32_16x16x32_bf16 v[56:59], v[240:243], v[136:139], v[56:59]
    v_cvt_pk_bf16_f32 v89, v90, v91
    v_mfma_f32_16x16x32_bf16 v[60:63], v[244:247], v[136:139], v[60:63]
    v_exp_f32 v92, v92
    v_mfma_f32_16x16x32_bf16 v[52:55], v[244:247], v[128:131], v[52:55]
    ds_read_b128 v[224:227], v2 offset:8192
    s_waitcnt lgkmcnt(9)
    v_mfma_f32_16x16x32_bf16 v[64:67], v[248:251], v[128:131], v[64:67]
    v_exp_f32 v93, v93
    v_mfma_f32_16x16x32_bf16 v[72:75], v[248:251], v[136:139], v[72:75]
    ds_read_b128 v[228:231], v2 offset:9216
    ds_read_b128 v[232:235], v2 offset:10240
    v_mfma_f32_16x16x32_bf16 v[76:79], v[252:255], v[136:139], v[76:79]
    ds_read_b128 v[236:239], v2 offset:11264
    v_mfma_f32_16x16x32_bf16 v[68:71], v[252:255], v[128:131], v[68:71]
    s_cbranch_vccz mg_L0L
    s_nop 7
    s_mov_b32 s13, 0x44800000
    v_cmp_nge_f32 vcc, 0x44800000, v184
    v_cmp_nge_f32_e64 s[4:5], s13, v188
    s_nop 1
    s_or_b64 vcc, vcc, s[4:5]
    s_cselect_b32 s13, 1, 0
    s_or_b32 s54, s54, s13
    v_ldexp_f32 v16, v16, v8
    v_ldexp_f32 v17, v17, v8
    v_ldexp_f32 v18, v18, v8
    v_ldexp_f32 v19, v19, v8
    v_ldexp_f32 v20, v20, v8
    v_ldexp_f32 v21, v21, v8
    v_ldexp_f32 v22, v22, v8
    v_ldexp_f32 v23, v23, v8
    v_ldexp_f32 v24, v24, v9
    v_ldexp_f32 v25, v25, v9
    v_ldexp_f32 v26, v26, v9
    v_ldexp_f32 v27, v27, v9
    v_ldexp_f32 v28, v28, v9
    v_ldexp_f32 v29, v29, v9
    v_ldexp_f32 v30, v30, v9
    v_ldexp_f32 v31, v31, v9
    v_ldexp_f32 v32, v32, v8
    v_ldexp_f32 v33, v33, v8
    v_ldexp_f32 v34, v34, v8
    v_ldexp_f32 v35, v35, v8
    v_ldexp_f32 v36, v36, v8
    v_ldexp_f32 v37, v37, v8
    v_ldexp_f32 v38, v38, v8
    v_ldexp_f32 v39, v39, v8
    v_ldexp_f32 v40, v40, v9
    v_ldexp_f32 v41, v41, v9
    v_ldexp_f32 v42, v42, v9
    v_ldexp_f32 v43, v43, v9
    v_ldexp_f32 v44, v44, v9
    v_ldexp_f32 v45, v45, v9
    v_ldexp_f32 v46, v46, v9
    v_ldexp_f32 v47, v47, v9
    v_ldexp_f32 v48, v48, v8
    v_ldexp_f32 v49, v49, v8
    v_ldexp_f32 v50, v50, v8
    v_ldexp_f32 v51, v51, v8
    v_ldexp_f32 v52, v52, v8
    v_ldexp_f32 v53, v53, v8
    v_ldexp_f32 v54, v54, v8
    v_ldexp_f32 v55, v55, v8
    v_ldexp_f32 v56, v56, v9
    v_ldexp_f32 v57, v57, v9
    v_ldexp_f32 v58, v58, v9
    v_ldexp_f32 v59, v59, v9
    v_ldexp_f32 v60, v60, v9
    v_ldexp_f32 v61, v61, v9
    v_ldexp_f32 v62, v62, v9
    v_ldexp_f32 v63, v63, v9
    v_ldexp_f32 v64, v64, v8
    v_ldexp_f32 v65, v65, v8
    v_ldexp_f32 v66, v66, v8
    v_ldexp_f32 v67, v67, v8
    v_ldexp_f32 v68, v68, v8
    v_ldexp_f32 v69, v69, v8
    v_ldexp_f32 v70, v70, v8
    v_ldexp_f32 v71, v71, v8
    v_ldexp_f32 v72, v72, v9
    v_ldexp_f32 v73, v73, v9
    v_ldexp_f32 v74, v74, v9
    v_ldexp_f32 v75, v75, v9
    v_ldexp_f32 v76, v76, v9
    v_ldexp_f32 v77, v77, v9
    v_ldexp_f32 v78, v78, v9
    v_ldexp_f32 v79, v79, v9
    v_ldexp_f32 v184, v184, v8
    v_ldexp_f32 v188, v188, v9
    s_branch mg_L0L
mg_pen:
    s_cmp_eq_u32 s60, 0
    s_cbranch_scc1 mg_pen_even
    s_waitcnt lgkmcnt(8)
    v_mfma_f32_16x16x32_bf16 v[80:83], v[192:195], v[144:147], v[176:179]
    v_exp_f32 v126, v126
    v_mfma_f32_16x16x32_bf16 v[88:91], v[192:195], v[148:151], v[180:183]
    ds_read_b128 v[240:243], v2 offset:12288
    s_add_u32 s49, s49, 858993460
    v_mfma_f32_16x16x32_bf16 v[88:91], v[196:199], v[156:159], v[88:91]
    v_exp_f32 v127, v127
    v_mfma_f32_16x16x32_bf16 v[80:83], v[196:199], v[152:155], v[80:83]
    ds_read_b128 v[244:247], v2 offset:13312
    s_cselect_b32 s10, 4294901760, s48
    v_mfma_f32_16x16x32_bf16 v[80:83], v[200:203], v[160:163], v[80:83]
    v_exp_f32 v128, v128
    v_mfma_f32_16x16x32_bf16 v[88:91], v[200:203], v[164:167], v[88:91]
    v_cvt_pk_bf16_f32 v122, v124, v125
    v_cvt_pk_bf16_f32 v123, v126, v127
    v_mfma_f32_16x16x32_bf16 v[88:91], v[204:207], v[172:175], v[88:91]
    v_exp_f32 v129, v129
    v_mfma_f32_16x16x32_bf16 v[80:83], v[204:207], v[168:171], v[80:83]
    v_cndmask_b32_e64 v96, v10, v176, s[70:71]
    s_waitcnt lgkmcnt(6)
    v_mfma_f32_16x16x32_bf16 v[84:87], v[208:211], v[144:147], v[176:179]
    v_exp_f32 v130, v130
    v_mfma_f32_16x16x32_bf16 v[92:95], v[208:211], v[148:151], v[180:183]
    v_cndmask_b32_e64 v97, v10, v177, s[72:73]
    v_cvt_pk_bf16_f32 v128, v128, v129
    v_mfma_f32_16x16x32_bf16 v[92:95], v[212:215], v[156:159], v[92:95]
    v_exp_f32 v131, v131
    v_mfma_f32_16x16x32_bf16 v[84:87], v[212:215], v[152:155], v[84:87]
    v_cndmask_b32_e64 v98, v10, v178, s[74:75]
    v_cvt_pk_bf16_f32 v129, v130, v131
    v_mfma_f32_16x16x32_bf16 v[84:87], v[216:219], v[160:163], v[84:87]
    v_exp_f32 v132, v132
    v_mfma_f32_16x16x32_bf16 v[92:95], v[216:219], v[164:167], v[92:95]
    v_cndmask_b32_e64 v99, v10, v179, s[76:77]
    v_cndmask_b32_e64 v108, v10, v180, s[70:71]
    v_mfma_f32_16x16x32_bf16 v[92:95], v[220:223], v[172:175], v[92:95]
    ds_read_b128 v[248:251], v2 offset:14336
    ds_read_b128 v[252:255], v2 offset:15360
    v_mfma_f32_16x16x32_bf16 v[84:87], v[220:223], v[168:171], v[84:87]
    ds_read_b128 v[192:195], v3 offset:0
    s_waitcnt lgkmcnt(5)
    v_mfma_f32_16x16x32_bf16 v[96:99], v[224:227], v[144:147], v[96:99]
    v_exp_f32 v133, v133
    v_mfma_f32_16x16x32_bf16 v[104:107], v[224:227], v[148:151], v[180:183]
    v_cndmask_b32_e64 v109, v10, v181, s[72:73]
    v_cvt_pk_bf16_f32 v130, v132, v133
    v_mfma_f32_16x16x32_bf16 v[104:107], v[228:231], v[156:159], v[104:107]
    v_exp_f32 v134, v134
    v_mfma_f32_16x16x32_bf16 v[96:99], v[228:231], v[152:155], v[96:99]
    v_cndmask_b32_e64 v110, v10, v182, s[74:75]
    v_cndmask_b32_e64 v111, v10, v183, s[76:77]
    v_mfma_f32_16x16x32_bf16 v[96:99], v[232:235], v[160:163], v[96:99]
    ds_read_b128 v[196:199], v3 offset:1024
    ds_read_b128 v[200:203], v3 offset:2048
    v_mfma_f32_16x16x32_bf16 v[104:107], v[232:235], v[164:167], v[104:107]
    v_exp_f32 v135, v135
    v_mfma_f32_16x16x32_bf16 v[104:107], v[236:239], v[172:175], v[104:107]
    v_exp_f32 v136, v136
    v_mfma_f32_16x16x32_bf16 v[96:99], v[236:239], v[168:171], v[96:99]
    v_mov_b32 v100, v10
    s_waitcnt lgkmcnt(4)
    v_mfma_f32_16x16x32_bf16 v[108:111], v[240:243], v[148:151], v[108:111]
    ds_read_b128 v[204:207], v3 offset:3072
    ds_read_b128 v[208:211], v3 offset:4096
    v_mfma_f32_16x16x32_bf16 v[108:111], v[244:247], v[156:159], v[108:111]
    v_mov_b32 v101, v10
    v_cvt_pk_bf16_f32 v131, v134, v135
    v_mfma_f32_16x16x32_bf16 v[108:111], v[248:251], v[164:167], v[108:111]
    ds_read_b128 v[212:215], v3 offset:5120
    s_waitcnt lgkmcnt(4)
    v_mfma_f32_16x16x32_bf16 v[108:111], v[252:255], v[172:175], v[108:111]
    v_mov_b32 v102, v10
    v_mov_b32 v103, v10
    v_mfma_f32_16x16x32_bf16 v[16:19], v[192:195], v[112:115], v[16:19]
    v_exp_f32 v137, v137
    v_mfma_f32_16x16x32_bf16 v[24:27], v[192:195], v[120:123], v[24:27]
    v_exp_f32 v138, v138
    v_mfma_f32_16x16x32_bf16 v[188:191], v[4:7], v[120:123], v[188:191]
    ds_read_b128 v[216:219], v3 offset:6144
    ds_read_b128 v[220:223], v3 offset:7168
    v_mfma_f32_16x16x32_bf16 v[184:187], v[4:7], v[112:115], v[184:187]
    v_exp_f32 v139, v139
    v_mfma_f32_16x16x32_bf16 v[20:23], v[196:199], v[112:115], v[20:23]
    v_exp_f32 v140, v140
    v_mfma_f32_16x16x32_bf16 v[28:31], v[196:199], v[120:123], v[28:31]
    ds_read_b128 v[224:227], v3 offset:8192
    s_waitcnt lgkmcnt(4)
    v_mfma_f32_16x16x32_bf16 v[40:43], v[200:203], v[120:123], v[40:43]
    v_exp_f32 v141, v141
    v_mfma_f32_16x16x32_bf16 v[32:35], v[200:203], v[112:115], v[32:35]
    v_exp_f32 v142, v142
    v_mfma_f32_16x16x32_bf16 v[36:39], v[204:207], v[112:115], v[36:39]
    v_exp_f32 v143, v143
    v_mfma_f32_16x16x32_bf16 v[44:47], v[204:207], v[120:123], v[44:47]
    ds_read_b128 v[228:231], v3 offset:9216
    ds_read_b128 v[232:235], v3 offset:10240
    v_mfma_f32_16x16x32_bf16 v[56:59], v[208:211], v[120:123], v[56:59]
    v_exp_f32 v80, v80
    v_mfma_f32_16x16x32_bf16 v[48:51], v[208:211], v[112:115], v[48:51]
    ds_read_b128 v[236:239], v3 offset:11264
    s_waitcnt lgkmcnt(4)
    v_mfma_f32_16x16x32_bf16 v[52:55], v[212:215], v[112:115], v[52:55]
    v_exp_f32 v81, v81
    v_mfma_f32_16x16x32_bf16 v[60:63], v[212:215], v[120:123], v[60:63]
    ds_read_b128 v[240:243], v3 offset:12288
    ds_read_b128 v[244:247], v3 offset:13312
    v_mfma_f32_16x16x32_bf16 v[72:75], v[216:219], v[120:123], v[72:75]
    v_exp_f32 v82, v82
    v_mfma_f32_16x16x32_bf16 v[64:67], v[216:219], v[112:115], v[64:67]
    ds_read_b128 v[248:251], v3 offset:14336
    ds_read_b128 v[252:255], v3 offset:15360
    v_mfma_f32_16x16x32_bf16 v[68:71], v[220:223], v[112:115], v[68:71]
    v_add_u32 v3, s10, v3
    v_cvt_pk_bf16_f32 v136, v136, v137
    v_cvt_pk_bf16_f32 v137, v138, v139
    v_cvt_pk_bf16_f32 v138, v140, v141
    v_cvt_pk_bf16_f32 v139, v142, v143
    v_mfma_f32_16x16x32_bf16 v[76:79], v[220:223], v[120:123], v[76:79]
    s_waitcnt vmcnt(16)
    s_barrier
    s_cmp_eq_u32 s15, 0
    s_cbranch_scc1 mg_rpoa
    s_bfe_u32 s3, s52, 0x5000e
    s_bitcmp1_b32 s11, s3
    s_cbranch_scc1 mg_ck_11
mg_ck_11r:
    s_mov_b32 m0, s50
    s_add_u32 s50, s50, 16384
    buffer_load_dwordx4 v1, s[16:19], s52 offen offset:0 sc1 lds
    buffer_load_dwordx4 v1, s[16:19], s52 offen offset:1024 sc1 lds
    buffer_load_dwordx4 v1, s[16:19], s52 offen offset:2048 sc1 lds
    buffer_load_dwordx4 v1, s[16:19], s52 offen offset:3072 sc1 lds
    s_and_b32 s50, s50, 65535
    s_add_u32 s52, s52, 16384
    s_cmp_eq_u32 s52, s65
    s_cselect_b32 s52, s63, s52
    s_mov_b32 m0, s51
    s_add_u32 s51, s51, 16384
    buffer_load_dwordx4 v1, s[16:19], s53 offen offset:0 sc1 lds
    buffer_load_dwordx4 v1, s[16:19], s53 offen offset:1024 sc1 lds
    buffer_load_dwordx4 v1, s[16:19], s53 offen offset:2048 sc1 lds
    buffer_load_dwordx4 v1, s[16:19], s53 offen offset:3072 sc1 lds
    s_sub_u32 s14, s51, 81920
    s_cmp_ge_u32 s51, 147456
    s_cselect_b32 s51, s14, s51
    s_add_u32 s53, s53, 16384
    s_cmp_eq_u32 s53, s66
    s_cselect_b32 s53, s64, s53
mg_rpoa:
    s_waitcnt lgkmcnt(5)
    v_mfma_f32_16x16x32_bf16 v[24:27], v[224:227], v[136:139], v[24:27]
    v_exp_f32 v83, v83
    v_mfma_f32_16x16x32_bf16 v[16:19], v[224:227], v[128:131], v[16:19]
    v_exp_f32 v84, v84
    v_mfma_f32_16x16x32_bf16 v[184:187], v[4:7], v[128:131], v[184:187]
    v_exp_f32 v85, v85
    v_mfma_f32_16x16x32_bf16 v[188:191], v[4:7], v[136:139], v[188:191]
    ds_read_b128 v[192:195], v3 offset:0
    ds_read_b128 v[196:199], v3 offset:1024
    v_mfma_f32_16x16x32_bf16 v[28:31], v[228:231], v[136:139], v[28:31]
    v_exp_f32 v86, v86
    v_mfma_f32_16x16x32_bf16 v[20:23], v[228:231], v[128:131], v[20:23]
    ds_read_b128 v[200:203], v3 offset:2048
    ds_read_b128 v[204:207], v3 offset:3072
    v_mfma_f32_16x16x32_bf16 v[32:35], v[232:235], v[128:131], v[32:35]
    v_exp_f32 v87, v87
    v_mfma_f32_16x16x32_bf16 v[40:43], v[232:235], v[136:139], v[40:43]
    v_cvt_pk_bf16_f32 v80, v80, v81
    s_waitcnt lgkmcnt(5)
    v_mfma_f32_16x16x32_bf16 v[44:47], v[236:239], v[136:139], v[44:47]
    v_exp_f32 v88, v88
    v_mfma_f32_16x16x32_bf16 v[36:39], v[236:239], v[128:131], v[36:39]
    ds_read_b128 v[208:211], v3 offset:4096
    ds_read_b128 v[212:215], v3 offset:5120
    v_mfma_f32_16x16x32_bf16 v[48:51], v[240:243], v[128:131], v[48:51]
    v_exp_f32 v89, v89
    v_mfma_f32_16x16x32_bf16 v[56:59], v[240:243], v[136:139], v[56:59]
    v_cvt_pk_bf16_f32 v81, v82, v83
    v_cvt_pk_bf16_f32 v82, v84, v85
    v_mfma_f32_16x16x32_bf16 v[60:63], v[244:247], v[136:139], v[60:63]
    v_exp_f32 v90, v90
    v_mfma_f32_16x16x32_bf16 v[52:55], v[244:247], v[128:131], v[52:55]
    ds_read_b128 v[216:219], v3 offset:6144
    ds_read_b128 v[220:223], v3 offset:7168
    v_mfma_f32_16x16x32_bf16 v[64:67], v[248:251], v[128:131], v[64:67]
    v_exp_f32 v91, v91
    v_mfma_f32_16x16x32_bf16 v[72:75], v[248:251], v[136:139], v[72:75]
    v_cvt_pk_bf16_f32 v83, v86, v87
    s_waitcnt lgkmcnt(8)
    v_mfma_f32_16x16x32_bf16 v[76:79], v[252:255], v[136:139], v[76:79]
    v_exp_f32 v92, v92
    v_mfma_f32_16x16x32_bf16 v[68:71], v[252:255], v[128:131], v[68:71]
    v_cvt_pk_bf16_f32 v88, v88, v89
    v_cvt_pk_bf16_f32 v89, v90, v91
    ds_read_b128 v[224:227], v3 offset:8192
    ds_read_b128 v[228:231], v3 offset:9216
    ds_read_b128 v[232:235], v3 offset:10240
    ds_read_b128 v[236:239], v3 offset:11264
    v_exp_f32 v93, v93
    s_branch mg_pen_done
mg_pen_even:
    v_cndmask_b32_e64 v80, v10, v176, s[70:71]
    v_cndmask_b32_e64 v81, v10, v177, s[72:73]
    v_cndmask_b32_e64 v82, v10, v178, s[74:75]
    v_cndmask_b32_e64 v83, v10, v179, s[76:77]
    v_cndmask_b32_e64 v92, v10, v180, s[70:71]
    s_waitcnt lgkmcnt(8)
    v_mfma_f32_16x16x32_bf16 v[80:83], v[192:195], v[144:147], v[80:83]
    ds_read_b128 v[240:243], v3 offset:0
    ds_read_b128 v[244:247], v3 offset:1024
    v_mfma_f32_16x16x32_bf16 v[88:91], v[192:195], v[148:151], v[180:183]
    s_add_u32 s49, s49, 858993460
    s_cselect_b32 s10, 4294901760, s48
    v_cndmask_b32_e64 v93, v10, v181, s[72:73]
    v_mfma_f32_16x16x32_bf16 v[88:91], v[196:199], v[156:159], v[88:91]
    v_exp_f32 v126, v126
    v_mfma_f32_16x16x32_bf16 v[80:83], v[196:199], v[152:155], v[80:83]
    v_cndmask_b32_e64 v94, v10, v182, s[74:75]
    v_cvt_pk_bf16_f32 v122, v124, v125
    v_mfma_f32_16x16x32_bf16 v[80:83], v[200:203], v[160:163], v[80:83]
    v_exp_f32 v127, v127
    v_mfma_f32_16x16x32_bf16 v[88:91], v[200:203], v[164:167], v[88:91]
    v_cndmask_b32_e64 v95, v10, v183, s[76:77]
    v_cvt_pk_bf16_f32 v123, v126, v127
    v_mfma_f32_16x16x32_bf16 v[88:91], v[204:207], v[172:175], v[88:91]
    ds_read_b128 v[248:251], v3 offset:2048
    ds_read_b128 v[252:255], v3 offset:3072
    v_mfma_f32_16x16x32_bf16 v[80:83], v[204:207], v[168:171], v[80:83]
    v_mov_b32 v84, v10
    s_waitcnt lgkmcnt(8)
    v_mfma_f32_16x16x32_bf16 v[92:95], v[208:211], v[148:151], v[92:95]
    v_exp_f32 v128, v128
    v_mfma_f32_16x16x32_bf16 v[92:95], v[212:215], v[156:159], v[92:95]
    v_mov_b32 v85, v10
    v_mov_b32 v86, v10
    v_mfma_f32_16x16x32_bf16 v[92:95], v[216:219], v[164:167], v[92:95]
    ds_read_b128 v[192:195], v3 offset:4096
    ds_read_b128 v[196:199], v3 offset:5120
    v_mfma_f32_16x16x32_bf16 v[92:95], v[220:223], v[172:175], v[92:95]
    ds_read_b128 v[200:203], v3 offset:6144
    s_waitcnt lgkmcnt(4)
    v_mfma_f32_16x16x32_bf16 v[16:19], v[240:243], v[112:115], v[16:19]
    v_exp_f32 v129, v129
    v_mfma_f32_16x16x32_bf16 v[24:27], v[240:243], v[120:123], v[24:27]
    v_mov_b32 v87, v10
    v_cvt_pk_bf16_f32 v128, v128, v129
    v_mfma_f32_16x16x32_bf16 v[188:191], v[4:7], v[120:123], v[188:191]
    v_exp_f32 v130, v130
    v_mfma_f32_16x16x32_bf16 v[184:187], v[4:7], v[112:115], v[184:187]
    v_exp_f32 v131, v131
    v_mfma_f32_16x16x32_bf16 v[20:23], v[244:247], v[112:115], v[20:23]
    ds_read_b128 v[204:207], v3 offset:7168
    ds_read_b128 v[208:211], v3 offset:8192
    v_mfma_f32_16x16x32_bf16 v[28:31], v[244:247], v[120:123], v[28:31]
    v_exp_f32 v132, v132
    v_mfma_f32_16x16x32_bf16 v[40:43], v[248:251], v[120:123], v[40:43]
    v_exp_f32 v133, v133
    v_mfma_f32_16x16x32_bf16 v[32:35], v[248:251], v[112:115], v[32:35]
    ds_read_b128 v[212:215], v3 offset:9216
    s_waitcnt lgkmcnt(4)
    v_mfma_f32_16x16x32_bf16 v[36:39], v[252:255], v[112:115], v[36:39]
    v_exp_f32 v134, v134
    v_mfma_f32_16x16x32_bf16 v[44:47], v[252:255], v[120:123], v[44:47]
    v_exp_f32 v135, v135
    v_mfma_f32_16x16x32_bf16 v[56:59], v[192:195], v[120:123], v[56:59]
    v_exp_f32 v136, v136
    v_mfma_f32_16x16x32_bf16 v[48:51], v[192:195], v[112:115], v[48:51]
    v_exp_f32 v137, v137
    v_mfma_f32_16x16x32_bf16 v[52:55], v[196:199], v[112:115], v[52:55]
    ds_read_b128 v[216:219], v3 offset:10240
    ds_read_b128 v[220:223], v3 offset:11264
    v_mfma_f32_16x16x32_bf16 v[60:63], v[196:199], v[120:123], v[60:63]
    ds_read_b128 v[224:227], v3 offset:12288
    s_waitcnt lgkmcnt(4)
    v_mfma_f32_16x16x32_bf16 v[72:75], v[200:203], v[120:123], v[72:75]
    v_exp_f32 v138, v138
    v_mfma_f32_16x16x32_bf16 v[64:67], v[200:203], v[112:115], v[64:67]
    v_exp_f32 v139, v139
    v_mfma_f32_16x16x32_bf16 v[68:71], v[204:207], v[112:115], v[68:71]
    v_cvt_pk_bf16_f32 v136, v136, v137
    v_cvt_pk_bf16_f32 v137, v138, v139
    v_exp_f32 v140, v140
    v_exp_f32 v141, v141
    s_nop 0
    v_cvt_pk_bf16_f32 v138, v140, v141
    v_exp_f32 v142, v142
    v_exp_f32 v143, v143
    s_nop 0
    v_cvt_pk_bf16_f32 v139, v142, v143
    v_mfma_f32_16x16x32_bf16 v[76:79], v[204:207], v[120:123], v[76:79]
    v_cvt_pk_bf16_f32 v129, v130, v131
    v_cvt_pk_bf16_f32 v130, v132, v133
    v_cvt_pk_bf16_f32 v131, v134, v135
    v_mfma_f32_16x16x32_bf16 v[24:27], v[208:211], v[136:139], v[24:27]
    ds_read_b128 v[228:231], v3 offset:13312
    ds_read_b128 v[232:235], v3 offset:14336
    v_mfma_f32_16x16x32_bf16 v[16:19], v[208:211], v[128:131], v[16:19]
    v_exp_f32 v80, v80
    v_mfma_f32_16x16x32_bf16 v[184:187], v[4:7], v[128:131], v[184:187]
    v_exp_f32 v81, v81
    v_mfma_f32_16x16x32_bf16 v[188:191], v[4:7], v[136:139], v[188:191]
    ds_read_b128 v[236:239], v3 offset:15360
    s_waitcnt lgkmcnt(4)
    v_mfma_f32_16x16x32_bf16 v[28:31], v[212:215], v[136:139], v[28:31]
    v_add_u32 v3, s10, v3
    v_cvt_pk_bf16_f32 v80, v80, v81
    v_mfma_f32_16x16x32_bf16 v[20:23], v[212:215], v[128:131], v[20:23]
    s_waitcnt vmcnt(16)
    s_barrier
    s_cmp_eq_u32 s15, 0
    s_cbranch_scc1 mg_rpea
    s_bfe_u32 s3, s52, 0x5000e
    s_bitcmp1_b32 s11, s3
    s_cbranch_scc1 mg_ck_12
mg_ck_12r:
    s_mov_b32 m0, s50
    s_add_u32 s50, s50, 16384
    buffer_load_dwordx4 v1, s[16:19], s52 offen offset:0 sc1 lds
    buffer_load_dwordx4 v1, s[16:19], s52 offen offset:1024 sc1 lds
    buffer_load_dwordx4 v1, s[16:19], s52 offen offset:2048 sc1 lds
    buffer_load_dwordx4 v1, s[16:19], s52 offen offset:3072 sc1 lds
    s_and_b32 s50, s50, 65535
    s_add_u32 s52, s52, 16384
    s_cmp_eq_u32 s52, s65
    s_cselect_b32 s52, s63, s52
    s_mov_b32 m0, s51
    s_add_u32 s51, s51, 16384
    buffer_load_dwordx4 v1, s[16:19], s53 offen offset:0 sc1 lds
    buffer_load_dwordx4 v1, s[16:19], s53 offen offset:1024 sc1 lds
    buffer_load_dwordx4 v1, s[16:19], s53 offen offset:2048 sc1 lds
    buffer_load_dwordx4 v1, s[16:19], s53 offen offset:3072 sc1 lds
    s_sub_u32 s14, s51, 81920
    s_cmp_ge_u32 s51, 147456
    s_cselect_b32 s51, s14, s51
    s_add_u32 s53, s53, 16384
    s_cmp_eq_u32 s53, s66
    s_cselect_b32 s53, s64, s53
mg_rpea:
    ds_read_b128 v[240:243], v3 offset:0
    v_mfma_f32_16x16x32_bf16 v[32:35], v[216:219], v[128:131], v[32:35]
    v_exp_f32 v82, v82
    v_mfma_f32_16x16x32_bf16 v[40:43], v[216:219], v[136:139], v[40:43]
    v_exp_f32 v83, v83
    v_mfma_f32_16x16x32_bf16 v[44:47], v[220:223], v[136:139], v[44:47]
    ds_read_b128 v[244:247], v3 offset:1024
    ds_read_b128 v[248:251], v3 offset:2048
    v_mfma_f32_16x16x32_bf16 v[36:39], v[220:223], v[128:131], v[36:39]
    ds_read_b128 v[252:255], v3 offset:3072
    s_waitcnt lgkmcnt(4)
    v_mfma_f32_16x16x32_bf16 v[48:51], v[224:227], v[128:131], v[48:51]
    v_exp_f32 v84, v84
    v_mfma_f32_16x16x32_bf16 v[56:59], v[224:227], v[136:139], v[56:59]
    v_exp_f32 v85, v85
    v_mfma_f32_16x16x32_bf16 v[60:63], v[228:231], v[136:139], v[60:63]
    v_exp_f32 v86, v86
    v_mfma_f32_16x16x32_bf16 v[52:55], v[228:231], v[128:131], v[52:55]
    v_exp_f32 v87, v87
    v_mfma_f32_16x16x32_bf16 v[64:67], v[232:235], v[128:131], v[64:67]
    ds_read_b128 v[192:195], v3 offset:4096
    ds_read_b128 v[196:199], v3 offset:5120
    v_mfma_f32_16x16x32_bf16 v[72:75], v[232:235], v[136:139], v[72:75]
    v_exp_f32 v88, v88
    v_mfma_f32_16x16x32_bf16 v[76:79], v[236:239], v[136:139], v[76:79]
    v_exp_f32 v89, v89
    v_mfma_f32_16x16x32_bf16 v[68:71], v[236:239], v[128:131], v[68:71]
    v_cvt_pk_bf16_f32 v81, v82, v83
    v_cvt_pk_bf16_f32 v82, v84, v85
    v_cvt_pk_bf16_f32 v83, v86, v87
    v_cvt_pk_bf16_f32 v88, v88, v89
    v_exp_f32 v90, v90
    v_exp_f32 v91, v91
    s_nop 0
    v_cvt_pk_bf16_f32 v89, v90, v91
    ds_read_b128 v[200:203], v3 offset:6144
    ds_read_b128 v[204:207], v3 offset:7168
    v_exp_f32 v92, v92
    v_exp_f32 v93, v93
mg_pen_done:
    s_cbranch_vccz mg_final
    s_nop 7
    s_mov_b32 s13, 0x44800000
    v_cmp_nge_f32 vcc, 0x44800000, v184
    v_cmp_nge_f32_e64 s[4:5], s13, v188
    s_nop 1
    s_or_b64 vcc, vcc, s[4:5]
    s_cselect_b32 s13, 1, 0
    s_or_b32 s54, s54, s13
    v_ldexp_f32 v16, v16, v8
    v_ldexp_f32 v17, v17, v8
    v_ldexp_f32 v18, v18, v8
    v_ldexp_f32 v19, v19, v8
    v_ldexp_f32 v20, v20, v8
    v_ldexp_f32 v21, v21, v8
    v_ldexp_f32 v22, v22, v8
    v_ldexp_f32 v23, v23, v8
    v_ldexp_f32 v24, v24, v9
    v_ldexp_f32 v25, v25, v9
    v_ldexp_f32 v26, v26, v9
    v_ldexp_f32 v27, v27, v9
    v_ldexp_f32 v28, v28, v9
    v_ldexp_f32 v29, v29, v9
    v_ldexp_f32 v30, v30, v9
    v_ldexp_f32 v31, v31, v9
    v_ldexp_f32 v32, v32, v8
    v_ldexp_f32 v33, v33, v8
    v_ldexp_f32 v34, v34, v8
    v_ldexp_f32 v35, v35, v8
    v_ldexp_f32 v36, v36, v8
    v_ldexp_f32 v37, v37, v8
    v_ldexp_f32 v38, v38, v8
    v_ldexp_f32 v39, v39, v8
    v_ldexp_f32 v40, v40, v9
    v_ldexp_f32 v41, v41, v9
    v_ldexp_f32 v42, v42, v9
    v_ldexp_f32 v43, v43, v9
    v_ldexp_f32 v44, v44, v9
    v_ldexp_f32 v45, v45, v9
    v_ldexp_f32 v46, v46, v9
    v_ldexp_f32 v47, v47, v9
    v_ldexp_f32 v48, v48, v8
    v_ldexp_f32 v49, v49, v8
    v_ldexp_f32 v50, v50, v8
    v_ldexp_f32 v51, v51, v8
    v_ldexp_f32 v52, v52, v8
    v_ldexp_f32 v53, v53, v8
    v_ldexp_f32 v54, v54, v8
    v_ldexp_f32 v55, v55, v8
    v_ldexp_f32 v56, v56, v9
    v_ldexp_f32 v57, v57, v9
    v_ldexp_f32 v58, v58, v9
    v_ldexp_f32 v59, v59, v9
    v_ldexp_f32 v60, v60, v9
    v_ldexp_f32 v61, v61, v9
    v_ldexp_f32 v62, v62, v9
    v_ldexp_f32 v63, v63, v9
    v_ldexp_f32 v64, v64, v8
    v_ldexp_f32 v65, v65, v8
    v_ldexp_f32 v66, v66, v8
    v_ldexp_f32 v67, v67, v8
    v_ldexp_f32 v68, v68, v8
    v_ldexp_f32 v69, v69, v8
    v_ldexp_f32 v70, v70, v8
    v_ldexp_f32 v71, v71, v8
    v_ldexp_f32 v72, v72, v9
    v_ldexp_f32 v73, v73, v9
    v_ldexp_f32 v74, v74, v9
    v_ldexp_f32 v75, v75, v9
    v_ldexp_f32 v76, v76, v9
    v_ldexp_f32 v77, v77, v9
    v_ldexp_f32 v78, v78, v9
    v_ldexp_f32 v79, v79, v9
    v_ldexp_f32 v184, v184, v8
    v_ldexp_f32 v188, v188, v9
    s_nop 1
mg_final:
    s_cmp_eq_u32 s31, 0
    s_cbranch_scc1 mg_final2
    s_mov_b64 exec, 3
    buffer_load_dword v176, v1, s[16:19], s68 offen sc1
    s_mov_b64 exec, -1
    buffer_load_dwordx4 v[112:115], v1, s[16:19], s62 offen offset:0 sc1
    buffer_load_dwordx4 v[116:119], v1, s[16:19], s62 offen offset:1024 sc1
    buffer_load_dwordx4 v[120:123], v1, s[16:19], s62 offen offset:2048 sc1
    buffer_load_dwordx4 v[124:127], v1, s[16:19], s62 offen offset:3072 sc1
    s_add_u32 s62, s62, 16384
    buffer_load_dwordx4 v[128:131], v1, s[16:19], s62 offen offset:0 sc1
    buffer_load_dwordx4 v[132:135], v1, s[16:19], s62 offen offset:1024 sc1
    buffer_load_dwordx4 v[136:139], v1, s[16:19], s62 offen offset:2048 sc1
    buffer_load_dwordx4 v[140:143], v1, s[16:19], s62 offen offset:3072 sc1
    s_add_u32 s62, s62, 16384
mg_final2:
    s_cmp_eq_u32 s60, 0
    s_cbranch_scc1 mg_fin_even
    v_cvt_pk_bf16_f32 v90, v92, v93
    v_exp_f32 v94, v94
    v_exp_f32 v95, v95
    s_nop 0
    v_cvt_pk_bf16_f32 v91, v94, v95
    s_nop 0
    s_waitcnt lgkmcnt(9)
    v_mfma_f32_16x16x32_bf16 v[16:19], v[192:195], v[80:83], v[16:19]
    v_exp_f32 v96, v96
    v_mfma_f32_16x16x32_bf16 v[24:27], v[192:195], v[88:91], v[24:27]
    v_mfma_f32_16x16x32_bf16 v[188:191], v[4:7], v[88:91], v[188:191]
    v_exp_f32 v97, v97
    v_mfma_f32_16x16x32_bf16 v[184:187], v[4:7], v[80:83], v[184:187]
    v_cvt_pk_bf16_f32 v96, v96, v97
    v_mfma_f32_16x16x32_bf16 v[20:23], v[196:199], v[80:83], v[20:23]
    v_exp_f32 v98, v98
    v_mfma_f32_16x16x32_bf16 v[28:31], v[196:199], v[88:91], v[28:31]
    ds_read_b128 v[240:243], v3 offset:12288
    ds_read_b128 v[244:247], v3 offset:13312
    v_mfma_f32_16x16x32_bf16 v[40:43], v[200:203], v[88:91], v[40:43]
    v_exp_f32 v99, v99
    v_mfma_f32_16x16x32_bf16 v[32:35], v[200:203], v[80:83], v[32:35]
    v_cvt_pk_bf16_f32 v97, v98, v99
    s_waitcnt lgkmcnt(7)
    v_mfma_f32_16x16x32_bf16 v[36:39], v[204:207], v[80:83], v[36:39]
    v_exp_f32 v100, v100
    v_mfma_f32_16x16x32_bf16 v[44:47], v[204:207], v[88:91], v[44:47]
    v_exp_f32 v101, v101
    v_mfma_f32_16x16x32_bf16 v[56:59], v[208:211], v[88:91], v[56:59]
    v_exp_f32 v102, v102
    v_mfma_f32_16x16x32_bf16 v[48:51], v[208:211], v[80:83], v[48:51]
    v_exp_f32 v103, v103
    v_mfma_f32_16x16x32_bf16 v[52:55], v[212:215], v[80:83], v[52:55]
    v_exp_f32 v104, v104
    v_mfma_f32_16x16x32_bf16 v[60:63], v[212:215], v[88:91], v[60:63]
    v_exp_f32 v105, v105
    v_mfma_f32_16x16x32_bf16 v[72:75], v[216:219], v[88:91], v[72:75]
    v_exp_f32 v106, v106
    v_mfma_f32_16x16x32_bf16 v[64:67], v[216:219], v[80:83], v[64:67]
    ds_read_b128 v[248:251], v3 offset:14336
    s_waitcnt lgkmcnt(5)
    v_mfma_f32_16x16x32_bf16 v[68:71], v[220:223], v[80:83], v[68:71]
    v_cvt_pk_bf16_f32 v104, v104, v105
    v_exp_f32 v107, v107
    s_nop 0
    v_cvt_pk_bf16_f32 v105, v106, v107
    v_exp_f32 v108, v108
    v_exp_f32 v109, v109
    s_nop 0
    v_cvt_pk_bf16_f32 v106, v108, v109
    v_exp_f32 v110, v110
    v_exp_f32 v111, v111
    s_nop 0
    v_cvt_pk_bf16_f32 v107, v110, v111
    v_mfma_f32_16x16x32_bf16 v[76:79], v[220:223], v[88:91], v[76:79]
    v_cvt_pk_bf16_f32 v98, v100, v101
    v_cvt_pk_bf16_f32 v99, v102, v103
    v_mfma_f32_16x16x32_bf16 v[24:27], v[224:227], v[104:107], v[24:27]
    ds_read_b128 v[252:255], v3 offset:15360
    v_mfma_f32_16x16x32_bf16 v[16:19], v[224:227], v[96:99], v[16:19]
    v_mfma_f32_16x16x32_bf16 v[184:187], v[4:7], v[96:99], v[184:187]
    v_mfma_f32_16x16x32_bf16 v[188:191], v[4:7], v[104:107], v[188:191]
    v_mfma_f32_16x16x32_bf16 v[28:31], v[228:231], v[104:107], v[28:31]
    v_mfma_f32_16x16x32_bf16 v[20:23], v[228:231], v[96:99], v[20:23]
    s_waitcnt lgkmcnt(4)
    v_mfma_f32_16x16x32_bf16 v[32:35], v[232:235], v[96:99], v[32:35]
    v_mfma_f32_16x16x32_bf16 v[40:43], v[232:235], v[104:107], v[40:43]
    v_mfma_f32_16x16x32_bf16 v[44:47], v[236:239], v[104:107], v[44:47]
    v_mfma_f32_16x16x32_bf16 v[36:39], v[236:239], v[96:99], v[36:39]
    s_waitcnt lgkmcnt(3)
    v_mfma_f32_16x16x32_bf16 v[48:51], v[240:243], v[96:99], v[48:51]
    v_mfma_f32_16x16x32_bf16 v[56:59], v[240:243], v[104:107], v[56:59]
    s_waitcnt lgkmcnt(2)
    v_mfma_f32_16x16x32_bf16 v[60:63], v[244:247], v[104:107], v[60:63]
    v_mfma_f32_16x16x32_bf16 v[52:55], v[244:247], v[96:99], v[52:55]
    s_waitcnt lgkmcnt(1)
    v_mfma_f32_16x16x32_bf16 v[64:67], v[248:251], v[96:99], v[64:67]
    v_mfma_f32_16x16x32_bf16 v[72:75], v[248:251], v[104:107], v[72:75]
    s_waitcnt lgkmcnt(0)
    v_mfma_f32_16x16x32_bf16 v[76:79], v[252:255], v[104:107], v[76:79]
    v_mfma_f32_16x16x32_bf16 v[68:71], v[252:255], v[96:99], v[68:71]
    s_cmp_ge_u32 s47, s45
    s_cbranch_scc1 mg_fnbfo
    s_waitcnt vmcnt(16)
    s_barrier
    s_cmp_eq_u32 s15, 0
    s_cbranch_scc1 mg_rfoa
    s_bfe_u32 s3, s52, 0x5000e
    s_bitcmp1_b32 s11, s3
    s_cbranch_scc1 mg_ck_13
mg_ck_13r:
    s_mov_b32 m0, s50
    s_add_u32 s50, s50, 16384
    buffer_load_dwordx4 v1, s[16:19], s52 offen offset:0 sc1 lds
    buffer_load_dwordx4 v1, s[16:19], s52 offen offset:1024 sc1 lds
    buffer_load_dwordx4 v1, s[16:19], s52 offen offset:2048 sc1 lds
    buffer_load_dwordx4 v1, s[16:19], s52 offen offset:3072 sc1 lds
    s_and_b32 s50, s50, 65535
    s_add_u32 s52, s52, 16384
    s_cmp_eq_u32 s52, s65
    s_cselect_b32 s52, s63, s52
    s_mov_b32 m0, s51
    s_add_u32 s51, s51, 16384
    buffer_load_dwordx4 v1, s[16:19], s53 offen offset:0 sc1 lds
    buffer_load_dwordx4 v1, s[16:19], s53 offen offset:1024 sc1 lds
    buffer_load_dwordx4 v1, s[16:19], s53 offen offset:2048 sc1 lds
    buffer_load_dwordx4 v1, s[16:19], s53 offen offset:3072 sc1 lds
    s_sub_u32 s14, s51, 81920
    s_cmp_ge_u32 s51, 147456
    s_cselect_b32 s51, s14, s51
    s_add_u32 s53, s53, 16384
    s_cmp_eq_u32 s53, s66
    s_cselect_b32 s53, s64, s53
mg_rfoa:
    s_add_u32 s47, s47, 1
mg_fnbfo:
    s_branch mg_epi
mg_fin_even:
    v_cvt_pk_bf16_f32 v90, v92, v93
    v_exp_f32 v94, v94
    v_exp_f32 v95, v95
    s_nop 0
    v_cvt_pk_bf16_f32 v91, v94, v95
    s_nop 0
    s_waitcnt lgkmcnt(5)
    v_mfma_f32_16x16x32_bf16 v[16:19], v[240:243], v[80:83], v[16:19]
    v_mfma_f32_16x16x32_bf16 v[24:27], v[240:243], v[88:91], v[24:27]
    v_mfma_f32_16x16x32_bf16 v[188:191], v[4:7], v[88:91], v[188:191]
    v_mfma_f32_16x16x32_bf16 v[184:187], v[4:7], v[80:83], v[184:187]
    v_mfma_f32_16x16x32_bf16 v[20:23], v[244:247], v[80:83], v[20:23]
    v_mfma_f32_16x16x32_bf16 v[28:31], v[244:247], v[88:91], v[28:31]
    v_mfma_f32_16x16x32_bf16 v[40:43], v[248:251], v[88:91], v[40:43]
    v_mfma_f32_16x16x32_bf16 v[32:35], v[248:251], v[80:83], v[32:35]
    s_waitcnt lgkmcnt(4)
    v_mfma_f32_16x16x32_bf16 v[36:39], v[252:255], v[80:83], v[36:39]
    v_mfma_f32_16x16x32_bf16 v[44:47], v[252:255], v[88:91], v[44:47]
    s_waitcnt lgkmcnt(3)
    v_mfma_f32_16x16x32_bf16 v[56:59], v[192:195], v[88:91], v[56:59]
    v_mfma_f32_16x16x32_bf16 v[48:51], v[192:195], v[80:83], v[48:51]
    s_waitcnt lgkmcnt(2)
    v_mfma_f32_16x16x32_bf16 v[52:55], v[196:199], v[80:83], v[52:55]
    v_mfma_f32_16x16x32_bf16 v[60:63], v[196:199], v[88:91], v[60:63]
    s_waitcnt lgkmcnt(1)
    v_mfma_f32_16x16x32_bf16 v[72:75], v[200:203], v[88:91], v[72:75]
    v_mfma_f32_16x16x32_bf16 v[64:67], v[200:203], v[80:83], v[64:67]
    s_waitcnt lgkmcnt(0)
    v_mfma_f32_16x16x32_bf16 v[68:71], v[204:207], v[80:83], v[68:71]
    v_mfma_f32_16x16x32_bf16 v[76:79], v[204:207], v[88:91], v[76:79]
    s_cmp_ge_u32 s47, s45
    s_cbranch_scc1 mg_fnbfe
    s_waitcnt vmcnt(16)
    s_barrier
    s_cmp_eq_u32 s15, 0
    s_cbranch_scc1 mg_rfea
    s_bfe_u32 s3, s52, 0x5000e
    s_bitcmp1_b32 s11, s3
    s_cbranch_scc1 mg_ck_14
mg_ck_14r:
    s_mov_b32 m0, s50
    s_add_u32 s50, s50, 16384
    buffer_load_dwordx4 v1, s[16:19], s52 offen offset:0 sc1 lds
    buffer_load_dwordx4 v1, s[16:19], s52 offen offset:1024 sc1 lds
    buffer_load_dwordx4 v1, s[16:19], s52 offen offset:2048 sc1 lds
    buffer_load_dwordx4 v1, s[16:19], s52 offen offset:3072 sc1 lds
    s_and_b32 s50, s50, 65535
    s_add_u32 s52, s52, 16384
    s_cmp_eq_u32 s52, s65
    s_cselect_b32 s52, s63, s52
    s_mov_b32 m0, s51
    s_add_u32 s51, s51, 16384
    buffer_load_dwordx4 v1, s[16:19], s53 offen offset:0 sc1 lds
    buffer_load_dwordx4 v1, s[16:19], s53 offen offset:1024 sc1 lds
    buffer_load_dwordx4 v1, s[16:19], s53 offen offset:2048 sc1 lds
    buffer_load_dwordx4 v1, s[16:19], s53 offen offset:3072 sc1 lds
    s_sub_u32 s14, s51, 81920
    s_cmp_ge_u32 s51, 147456
    s_cselect_b32 s51, s14, s51
    s_add_u32 s53, s53, 16384
    s_cmp_eq_u32 s53, s66
    s_cselect_b32 s53, s64, s53
mg_rfea:
    s_add_u32 s47, s47, 1
mg_fnbfe:
mg_epi:
    s_mov_b32 s13, 0x44800000
    v_cmp_nge_f32 vcc, 0x44800000, v184
    v_cmp_nge_f32_e64 s[4:5], s13, v188
    v_rcp_f32 v12, v184
    v_rcp_f32 v13, v184
    v_rcp_f32 v8, v188
    v_rcp_f32 v9, v188
    s_or_b64 vcc, vcc, s[4:5]
    s_cselect_b32 s13, 1, 0
    s_or_b32 s54, s54, s13
    s_cbranch_scc1 mg_ldP0
mg_store:
    s_cmp_lg_u32 s15, 0
    s_cbranch_scc1 mg_store1
    s_waitcnt vmcnt(8)
    v_cmp_ne_u32 vcc, 1, v176
    s_nop 1
    s_and_b32 s13, vcc_lo, 3
    s_cbranch_scc1 mg_store3
mg_storeq:
    s_xor_b32 s69, s67, 131072
    buffer_load_dwordx4 v[144:147], v1, s[16:19], s69 offen offset:0 sc1
    buffer_load_dwordx4 v[148:151], v1, s[16:19], s69 offen offset:1024 sc1
    buffer_load_dwordx4 v[152:155], v1, s[16:19], s69 offen offset:2048 sc1
    buffer_load_dwordx4 v[156:159], v1, s[16:19], s69 offen offset:3072 sc1
    s_xor_b32 s69, s67, 135168
    buffer_load_dwordx4 v[160:163], v1, s[16:19], s69 offen offset:0 sc1
    buffer_load_dwordx4 v[164:167], v1, s[16:19], s69 offen offset:1024 sc1
    buffer_load_dwordx4 v[168:171], v1, s[16:19], s69 offen offset:2048 sc1
    buffer_load_dwordx4 v[172:175], v1, s[16:19], s69 offen offset:3072 sc1
    s_xor_b32 s69, s67, 0
    buffer_load_dwordx4 v[176:179], v1, s[16:19], s69 offen offset:0 sc1
    buffer_load_dwordx4 v[180:183], v1, s[16:19], s69 offen offset:1024 sc1
    buffer_load_dwordx4 v[184:187], v1, s[16:19], s69 offen offset:2048 sc1
    buffer_load_dwordx4 v[188:191], v1, s[16:19], s69 offen offset:3072 sc1
mg_store2:
    s_lshl_b32 s13, s44, 18
    s_lshl_b32 s14, s61, 12
    s_add_u32 s13, s13, s14
    s_add_u32 s13, s13, 33554432
    s_add_u32 s14, s13, 131072
    v_pk_mul_f32 v[16:17], v[16:17], v[12:13]
    v_pk_mul_f32 v[18:19], v[18:19], v[12:13]
    v_pk_mul_f32 v[20:21], v[20:21], v[12:13]
    v_pk_mul_f32 v[22:23], v[22:23], v[12:13]
    v_cvt_pk_bf16_f32 v80, v16, v17
    v_cvt_pk_bf16_f32 v81, v18, v19
    v_cvt_pk_bf16_f32 v82, v20, v21
    v_cvt_pk_bf16_f32 v83, v22, v23
    buffer_store_dwordx4 v[80:83], v1, s[16:19], s13 offen offset:0 sc1
    v_pk_mul_f32 v[24:25], v[24:25], v[8:9]
    v_pk_mul_f32 v[26:27], v[26:27], v[8:9]
    v_pk_mul_f32 v[28:29], v[28:29], v[8:9]
    v_pk_mul_f32 v[30:31], v[30:31], v[8:9]
    v_cvt_pk_bf16_f32 v84, v24, v25
    v_cvt_pk_bf16_f32 v85, v26, v27
    v_cvt_pk_bf16_f32 v86, v28, v29
    v_cvt_pk_bf16_f32 v87, v30, v31
    buffer_store_dwordx4 v[84:87], v1, s[16:19], s14 offen offset:0 sc1
    v_pk_mul_f32 v[32:33], v[32:33], v[12:13]
    v_pk_mul_f32 v[34:35], v[34:35], v[12:13]
    v_pk_mul_f32 v[36:37], v[36:37], v[12:13]
    v_pk_mul_f32 v[38:39], v[38:39], v[12:13]
    v_cvt_pk_bf16_f32 v88, v32, v33
    v_cvt_pk_bf16_f32 v89, v34, v35
    v_cvt_pk_bf16_f32 v90, v36, v37
    v_cvt_pk_bf16_f32 v91, v38, v39
    buffer_store_dwordx4 v[88:91], v1, s[16:19], s13 offen offset:1024 sc1
    v_pk_mul_f32 v[40:41], v[40:41], v[8:9]
    v_pk_mul_f32 v[42:43], v[42:43], v[8:9]
    v_pk_mul_f32 v[44:45], v[44:45], v[8:9]
    v_pk_mul_f32 v[46:47], v[46:47], v[8:9]
    v_cvt_pk_bf16_f32 v92, v40, v41
    v_cvt_pk_bf16_f32 v93, v42, v43
    v_cvt_pk_bf16_f32 v94, v44, v45
    v_cvt_pk_bf16_f32 v95, v46, v47
    buffer_store_dwordx4 v[92:95], v1, s[16:19], s14 offen offset:1024 sc1
    v_pk_mul_f32 v[48:49], v[48:49], v[12:13]
    v_pk_mul_f32 v[50:51], v[50:51], v[12:13]
    v_pk_mul_f32 v[52:53], v[52:53], v[12:13]
    v_pk_mul_f32 v[54:55], v[54:55], v[12:13]
    v_cvt_pk_bf16_f32 v96, v48, v49
    v_cvt_pk_bf16_f32 v97, v50, v51
    v_cvt_pk_bf16_f32 v98, v52, v53
    v_cvt_pk_bf16_f32 v99, v54, v55
    buffer_store_dwordx4 v[96:99], v1, s[16:19], s13 offen offset:2048 sc1
    v_pk_mul_f32 v[56:57], v[56:57], v[8:9]
    v_pk_mul_f32 v[58:59], v[58:59], v[8:9]
    v_pk_mul_f32 v[60:61], v[60:61], v[8:9]
    v_pk_mul_f32 v[62:63], v[62:63], v[8:9]
    v_cvt_pk_bf16_f32 v100, v56, v57
    v_cvt_pk_bf16_f32 v101, v58, v59
    v_cvt_pk_bf16_f32 v102, v60, v61
    v_cvt_pk_bf16_f32 v103, v62, v63
    buffer_store_dwordx4 v[100:103], v1, s[16:19], s14 offen offset:2048 sc1
    v_pk_mul_f32 v[64:65], v[64:65], v[12:13]
    v_pk_mul_f32 v[66:67], v[66:67], v[12:13]
    v_pk_mul_f32 v[68:69], v[68:69], v[12:13]
    v_pk_mul_f32 v[70:71], v[70:71], v[12:13]
    v_cvt_pk_bf16_f32 v104, v64, v65
    v_cvt_pk_bf16_f32 v105, v66, v67
    v_cvt_pk_bf16_f32 v106, v68, v69
    v_cvt_pk_bf16_f32 v107, v70, v71
    buffer_store_dwordx4 v[104:107], v1, s[16:19], s13 offen offset:3072 sc1
    v_pk_mul_f32 v[72:73], v[72:73], v[8:9]
    v_pk_mul_f32 v[74:75], v[74:75], v[8:9]
    v_pk_mul_f32 v[76:77], v[76:77], v[8:9]
    v_pk_mul_f32 v[78:79], v[78:79], v[8:9]
    v_cvt_pk_bf16_f32 v108, v72, v73
    v_cvt_pk_bf16_f32 v109, v74, v75
    v_cvt_pk_bf16_f32 v110, v76, v77
    v_cvt_pk_bf16_f32 v111, v78, v79
    buffer_store_dwordx4 v[108:111], v1, s[16:19], s14 offen offset:3072 sc1
    s_cmp_eq_u32 s30, 0
    s_cbranch_scc1 mg_p3
    s_or_b32 s3, s7, s31
    s_cbranch_scc1 mg_cx
    s_cmp_ge_u32 s47, s45
    s_cbranch_scc1 mg_sf0
    s_call_b64 s[28:29], mg_iter
    s_waitcnt vmcnt(8)
    s_branch mg_sf1
mg_sf0:
    s_waitcnt vmcnt(0)
mg_sf1:
    v_mov_b32 v11, 1
    s_mov_b64 exec, 1
    buffer_store_dword v11, off, s[16:19], s9 sc1
    s_mov_b64 exec, -1
mg_cpl:
mg_ld1:
    s_cmp_ge_u32 s47, s30
    s_cbranch_scc1 mg_le1
    s_call_b64 s[28:29], mg_iter
    s_branch mg_ld1
mg_le1:
    s_sub_u32 s59, s45, 3
    s_waitcnt vmcnt(8)
    s_and_b32 s13, s12, 3
    s_lshl_b32 s13, s13, 12
    s_add_u32 m0, s13, 147456
    s_add_u32 s13, s64, 49152
    buffer_load_dwordx4 v1, s[16:19], s13 offen offset:0 sc1 lds
    buffer_load_dwordx4 v1, s[16:19], s13 offen offset:1024 sc1 lds
    buffer_load_dwordx4 v1, s[16:19], s13 offen offset:2048 sc1 lds
    buffer_load_dwordx4 v1, s[16:19], s13 offen offset:3072 sc1 lds
    buffer_load_dwordx4 v[112:115], v1, s[16:19], s62 offen offset:0 sc1
    buffer_load_dwordx4 v[116:119], v1, s[16:19], s62 offen offset:1024 sc1
    buffer_load_dwordx4 v[120:123], v1, s[16:19], s62 offen offset:2048 sc1
    buffer_load_dwordx4 v[124:127], v1, s[16:19], s62 offen offset:3072 sc1
    s_add_u32 s62, s62, 16384
    buffer_load_dwordx4 v[128:131], v1, s[16:19], s62 offen offset:0 sc1
    buffer_load_dwordx4 v[132:135], v1, s[16:19], s62 offen offset:1024 sc1
    buffer_load_dwordx4 v[136:139], v1, s[16:19], s62 offen offset:2048 sc1
    buffer_load_dwordx4 v[140:143], v1, s[16:19], s62 offen offset:3072 sc1
    s_add_u32 s62, s62, 16384
    s_cmp_ge_u32 s47, s59
    s_cbranch_scc1 mg_sw0
    s_call_b64 s[28:29], mg_itn
    s_waitcnt vmcnt(20)
mg_sw0:
    buffer_load_dwordx4 v[192:195], v1, s[16:19], s62 offen offset:0 sc1
    buffer_load_dwordx4 v[196:199], v1, s[16:19], s62 offen offset:1024 sc1
    buffer_load_dwordx4 v[200:203], v1, s[16:19], s62 offen offset:2048 sc1
    buffer_load_dwordx4 v[204:207], v1, s[16:19], s62 offen offset:3072 sc1
    s_add_u32 s62, s62, 16384
    buffer_load_dwordx4 v[208:211], v1, s[16:19], s62 offen offset:0 sc1
    buffer_load_dwordx4 v[212:215], v1, s[16:19], s62 offen offset:1024 sc1
    buffer_load_dwordx4 v[216:219], v1, s[16:19], s62 offen offset:2048 sc1
    buffer_load_dwordx4 v[220:223], v1, s[16:19], s62 offen offset:3072 sc1
    s_add_u32 s62, s62, 16384
    s_cmp_ge_u32 s47, s59
    s_cbranch_scc1 mg_sw1
    s_call_b64 s[28:29], mg_itn
    s_waitcnt vmcnt(16)
mg_sw1:
    buffer_load_dwordx4 v[224:227], v1, s[16:19], s62 offen offset:0 sc1
    buffer_load_dwordx4 v[228:231], v1, s[16:19], s62 offen offset:1024 sc1
    buffer_load_dwordx4 v[232:235], v1, s[16:19], s62 offen offset:2048 sc1
    buffer_load_dwordx4 v[236:239], v1, s[16:19], s62 offen offset:3072 sc1
    s_add_u32 s62, s62, 16384
    buffer_load_dwordx4 v[240:243], v1, s[16:19], s62 offen offset:0 sc1
    buffer_load_dwordx4 v[244:247], v1, s[16:19], s62 offen offset:1024 sc1
    buffer_load_dwordx4 v[248:251], v1, s[16:19], s62 offen offset:2048 sc1
    buffer_load_dwordx4 v[252:255], v1, s[16:19], s62 offen offset:3072 sc1
    s_add_u32 s62, s62, 16384
    s_cmp_ge_u32 s47, s59
    s_cbranch_scc1 mg_sw2
    s_call_b64 s[28:29], mg_itn
    s_waitcnt vmcnt(16)
mg_sw2:
    buffer_load_dwordx4 v[16:19], v1, s[16:19], s62 offen offset:0 sc1
    buffer_load_dwordx4 v[20:23], v1, s[16:19], s62 offen offset:1024 sc1
    buffer_load_dwordx4 v[24:27], v1, s[16:19], s62 offen offset:2048 sc1
    buffer_load_dwordx4 v[28:31], v1, s[16:19], s62 offen offset:3072 sc1
    s_add_u32 s62, s62, 16384
    buffer_load_dwordx4 v[32:35], v1, s[16:19], s62 offen offset:0 sc1
    buffer_load_dwordx4 v[36:39], v1, s[16:19], s62 offen offset:1024 sc1
    buffer_load_dwordx4 v[40:43], v1, s[16:19], s62 offen offset:2048 sc1
    buffer_load_dwordx4 v[44:47], v1, s[16:19], s62 offen offset:3072 sc1
    s_add_u32 s62, s62, 16384
    s_cmp_ge_u32 s47, s59
    s_cbranch_scc1 mg_sw3
    s_call_b64 s[28:29], mg_itn
    s_waitcnt vmcnt(16)
mg_sw3:
    buffer_load_dwordx4 v[48:51], v1, s[16:19], s62 offen offset:0 sc1
    buffer_load_dwordx4 v[52:55], v1, s[16:19], s62 offen offset:1024 sc1
    buffer_load_dwordx4 v[56:59], v1, s[16:19], s62 offen offset:2048 sc1
    buffer_load_dwordx4 v[60:63], v1, s[16:19], s62 offen offset:3072 sc1
    s_add_u32 s62, s62, 16384
    buffer_load_dwordx4 v[64:67], v1, s[16:19], s62 offen offset:0 sc1
    buffer_load_dwordx4 v[68:71], v1, s[16:19], s62 offen offset:1024 sc1
    buffer_load_dwordx4 v[72:75], v1, s[16:19], s62 offen offset:2048 sc1
    buffer_load_dwordx4 v[76:79], v1, s[16:19], s62 offen offset:3072 sc1
    s_add_u32 s62, s62, 16384
    s_cmp_ge_u32 s47, s45
    s_cbranch_scc1 mg_sw4
    s_call_b64 s[28:29], mg_itn
    s_waitcnt vmcnt(16)
mg_sw4:
    s_cmp_eq_u32 s12, 4
    s_cselect_b64 exec, -1, 0
    buffer_load_dword v15, off, s[20:23], 0 offset:64 sc1
    s_mov_b64 exec, -1
    s_sub_u32 s59, s45, 4
mg_ld2:
    s_cmp_ge_u32 s47, s59
    s_cbranch_scc1 mg_le2
    s_call_b64 s[28:29], mg_iter
    s_branch mg_ld2
mg_le2:
mg_ea:
    s_cmp_ge_u32 s47, s45
    s_cbranch_scc1 mg_eb
    s_mov_b64 exec, 3
    buffer_load_dword v176, v1, s[16:19], s68 offen sc1
    s_mov_b64 exec, -1
    s_call_b64 s[28:29], mg_iter
    s_waitcnt vmcnt(8)
    v_cmp_ne_u32 vcc, 1, v176
    s_nop 1
    s_and_b32 s13, vcc_lo, 3
    s_cbranch_scc1 mg_ea
    s_xor_b32 s69, s67, 131072
    buffer_load_dwordx4 v[144:147], v1, s[16:19], s69 offen offset:0 sc1
    buffer_load_dwordx4 v[148:151], v1, s[16:19], s69 offen offset:1024 sc1
    buffer_load_dwordx4 v[152:155], v1, s[16:19], s69 offen offset:2048 sc1
    buffer_load_dwordx4 v[156:159], v1, s[16:19], s69 offen offset:3072 sc1
    s_xor_b32 s69, s67, 135168
    buffer_load_dwordx4 v[160:163], v1, s[16:19], s69 offen offset:0 sc1
    buffer_load_dwordx4 v[164:167], v1, s[16:19], s69 offen offset:1024 sc1
    buffer_load_dwordx4 v[168:171], v1, s[16:19], s69 offen offset:2048 sc1
    buffer_load_dwordx4 v[172:175], v1, s[16:19], s69 offen offset:3072 sc1
    s_xor_b32 s69, s67, 0
    buffer_load_dwordx4 v[176:179], v1, s[16:19], s69 offen offset:0 sc1
    buffer_load_dwordx4 v[180:183], v1, s[16:19], s69 offen offset:1024 sc1
    buffer_load_dwordx4 v[184:187], v1, s[16:19], s69 offen offset:2048 sc1
    buffer_load_dwordx4 v[188:191], v1, s[16:19], s69 offen offset:3072 sc1
    s_cmp_ge_u32 s47, s45
    s_waitcnt vmcnt(12)
    s_cbranch_scc1 mg_p3
mg_ld3:
    s_cmp_ge_u32 s47, s45
    s_cbranch_scc1 mg_le3
    s_call_b64 s[28:29], mg_iter
    s_branch mg_ld3
mg_le3:
    s_waitcnt vmcnt(0)
    s_branch mg_p3
mg_eb:
    s_mov_b64 exec, 3
    buffer_load_dword v176, v1, s[16:19], s68 offen sc1
    s_mov_b64 exec, -1
    s_waitcnt vmcnt(0)
    v_cmp_ne_u32 vcc, 1, v176
    s_nop 1
    s_and_b32 s13, vcc_lo, 3
    s_cbranch_scc1 mg_fwb
mg_frb:
    s_xor_b32 s69, s67, 131072
    buffer_load_dwordx4 v[144:147], v1, s[16:19], s69 offen offset:0 sc1
    buffer_load_dwordx4 v[148:151], v1, s[16:19], s69 offen offset:1024 sc1
    buffer_load_dwordx4 v[152:155], v1, s[16:19], s69 offen offset:2048 sc1
    buffer_load_dwordx4 v[156:159], v1, s[16:19], s69 offen offset:3072 sc1
    s_xor_b32 s69, s67, 135168
    buffer_load_dwordx4 v[160:163], v1, s[16:19], s69 offen offset:0 sc1
    buffer_load_dwordx4 v[164:167], v1, s[16:19], s69 offen offset:1024 sc1
    buffer_load_dwordx4 v[168:171], v1, s[16:19], s69 offen offset:2048 sc1
    buffer_load_dwordx4 v[172:175], v1, s[16:19], s69 offen offset:3072 sc1
    s_xor_b32 s69, s67, 0
    buffer_load_dwordx4 v[176:179], v1, s[16:19], s69 offen offset:0 sc1
    buffer_load_dwordx4 v[180:183], v1, s[16:19], s69 offen offset:1024 sc1
    buffer_load_dwordx4 v[184:187], v1, s[16:19], s69 offen offset:2048 sc1
    buffer_load_dwordx4 v[188:191], v1, s[16:19], s69 offen offset:3072 sc1
mg_p3:
    s_cmp_eq_u32 s12, 4
    s_cbranch_scc1 mg_ack
mg_acr:
    s_mul_i32 s13, s12, 5120
    v_add_u32 v3, s13, v1
    s_mul_i32 s13, s12, 640
    v_add_u32 v4, s13, v1
    v_add_u32 v7, 40960, v4
    v_mov_b32 v10, 0x40000000
    v_cmp_gt_u32 vcc, 40, v0
    v_bfe_u32 v11, v4, 4, 4
    v_mul_u32_u24 v11, 2560, v11
    v_lshrrev_b32 v12, 8, v4
    v_lshl_add_u32 v11, v12, 3, v11
    v_cndmask_b32 v5, v10, v4, vcc
    v_cndmask_b32 v6, v10, v11, vcc
    s_lshr_b32 s48, s2, 5
    s_mul_i32 s13, s48, 3
    s_lshr_b32 s13, 2893912, s13
    s_and_b32 s13, s13, 7
    s_and_b32 s14, s12, 3
    s_lshl_b32 s14, s14, 12
    v_add_u32 v8, s14, v1
    s_lshl_b32 s14, s13, 14
    s_add_u32 s14, s14, 65536
    v_add_u32 v10, s14, v8
    s_add_u32 s13, s13, 1
    s_cmp_eq_u32 s13, 5
    s_cselect_b32 s13, 0, s13
    s_lshl_b32 s14, s13, 14
    s_add_u32 s14, s14, 65536
    v_add_u32 v11, s14, v8
    s_add_u32 s13, s13, 1
    s_cmp_eq_u32 s13, 5
    s_cselect_b32 s13, 0, s13
    s_lshl_b32 s14, s13, 14
    s_add_u32 s14, s14, 65536
    v_add_u32 v12, s14, v8
    v_add_u32 v13, 147456, v8
    s_and_b32 s13, s45, 2
    s_lshl_b32 s13, s13, 14
    v_add_u32 v8, s13, v8
    v_xor_b32 v9, 32768, v8
    s_barrier
    s_cmp_lg_u32 s15, 0
    s_cbranch_scc1 mg_t0s
    ds_read_b128 v[192:195], v8 offset:0
    ds_read_b128 v[196:199], v8 offset:1024
    ds_read_b128 v[200:203], v8 offset:2048
    ds_read_b128 v[204:207], v8 offset:3072
    ds_read_b128 v[208:211], v8 offset:16384
    ds_read_b128 v[212:215], v8 offset:17408
    ds_read_b128 v[216:219], v8 offset:18432
    ds_read_b128 v[220:223], v8 offset:19456
    ds_read_b128 v[224:227], v9 offset:0
    ds_read_b128 v[228:231], v9 offset:1024
    ds_read_b128 v[232:235], v9 offset:2048
    ds_read_b128 v[236:239], v9 offset:3072
    s_waitcnt vmcnt(19)
    v_mfma_f32_16x16x32_bf16 v[80:83], v[112:115], v[144:147], 0
    s_mul_i32 s45, s2, 20480
    s_add_u32 s45, s45, 67108864
    s_add_i32 s68, s68, 8192
    s_mov_b64 exec, 3
    buffer_load_dword v0, v1, s[16:19], s68 offen sc1
    s_mov_b64 exec, -1
    v_mfma_f32_16x16x32_bf16 v[84:87], v[116:119], v[144:147], 0
    s_xor_b32 s13, s2, 1
    s_mul_i32 s46, s13, 20480
    v_mfma_f32_16x16x32_bf16 v[88:91], v[120:123], v[144:147], 0
    s_add_u32 s46, s46, 67108864
    s_mul_i32 s50, s48, 160
    v_mfma_f32_16x16x32_bf16 v[92:95], v[124:127], v[144:147], 0
    s_bfe_u32 s13, s67, 0x50011
    s_mul_i32 s48, s13, 40960
    v_mfma_f32_16x16x32_bf16 v[96:99], v[128:131], v[144:147], 0
    ds_read_b128 v[240:243], v9 offset:16384
    s_add_u32 s48, s48, s50
    s_bfe_u32 s52, s2, 262146
    s_waitcnt vmcnt(19)
    v_mfma_f32_16x16x32_bf16 v[80:83], v[132:135], v[148:151], v[80:83]
    ds_read_b128 v[244:247], v9 offset:17408
    s_lshl_b32 s52, s52, 8
    s_add_u32 s52, s52, 75563008
    s_xor_b32 s69, s67, 4096
    buffer_load_dwordx4 v[144:147], v1, s[16:19], s69 offen offset:0 sc1
    v_mfma_f32_16x16x32_bf16 v[84:87], v[136:139], v[148:151], v[84:87]
    ds_read_b128 v[248:251], v9 offset:18432
    s_mul_i32 s55, s12, 40960
    s_mul_i32 s54, s12, 3072
    v_mfma_f32_16x16x32_bf16 v[88:91], v[140:143], v[148:151], v[88:91]
    ds_read_b128 v[252:255], v9 offset:19456
    s_bfe_u32 s13, s2, 262146
    s_lshl_b32 s13, s13, 3
    s_waitcnt lgkmcnt(15)
    v_mfma_f32_16x16x32_bf16 v[92:95], v[192:195], v[148:151], v[92:95]
    ds_read_b128 v[16:19], v10 offset:0
    s_add_u32 s13, s13, s12
    s_mul_i32 s49, s13, 20480
    s_waitcnt lgkmcnt(15)
    v_mfma_f32_16x16x32_bf16 v[96:99], v[196:199], v[148:151], v[96:99]
    ds_read_b128 v[20:23], v10 offset:1024
    s_add_u32 s49, s49, 62914560
    s_mul_i32 s50, s13, 40960
    s_waitcnt vmcnt(19) lgkmcnt(15)
    v_mfma_f32_16x16x32_bf16 v[80:83], v[200:203], v[152:155], v[80:83]
    ds_read_b128 v[24:27], v10 offset:2048
    buffer_load_dwordx4 v[148:151], v1, s[16:19], s69 offen offset:1024 sc1
    s_waitcnt lgkmcnt(15)
    v_mfma_f32_16x16x32_bf16 v[84:87], v[204:207], v[152:155], v[84:87]
    ds_read_b128 v[28:31], v10 offset:3072
    s_waitcnt lgkmcnt(15)
    v_mfma_f32_16x16x32_bf16 v[88:91], v[208:211], v[152:155], v[88:91]
    ds_read_b128 v[32:35], v11 offset:0
    s_waitcnt lgkmcnt(15)
    v_mfma_f32_16x16x32_bf16 v[92:95], v[212:215], v[152:155], v[92:95]
    ds_read_b128 v[36:39], v11 offset:1024
    s_waitcnt lgkmcnt(15)
    v_mfma_f32_16x16x32_bf16 v[96:99], v[216:219], v[152:155], v[96:99]
    ds_read_b128 v[40:43], v11 offset:2048
    s_waitcnt vmcnt(19) lgkmcnt(15)
    v_mfma_f32_16x16x32_bf16 v[80:83], v[220:223], v[156:159], v[80:83]
    ds_read_b128 v[44:47], v11 offset:3072
    buffer_load_dwordx4 v[152:155], v1, s[16:19], s69 offen offset:2048 sc1
    s_waitcnt lgkmcnt(15)
    v_mfma_f32_16x16x32_bf16 v[84:87], v[224:227], v[156:159], v[84:87]
    ds_read_b128 v[48:51], v12 offset:0
    s_waitcnt lgkmcnt(15)
    v_mfma_f32_16x16x32_bf16 v[88:91], v[228:231], v[156:159], v[88:91]
    ds_read_b128 v[52:55], v12 offset:1024
    s_waitcnt lgkmcnt(15)
    v_mfma_f32_16x16x32_bf16 v[92:95], v[232:235], v[156:159], v[92:95]
    ds_read_b128 v[56:59], v12 offset:2048
    s_waitcnt lgkmcnt(15)
    v_mfma_f32_16x16x32_bf16 v[96:99], v[236:239], v[156:159], v[96:99]
    ds_read_b128 v[60:63], v12 offset:3072
    s_waitcnt vmcnt(19) lgkmcnt(15)
    v_mfma_f32_16x16x32_bf16 v[80:83], v[240:243], v[160:163], v[80:83]
    ds_read_b128 v[64:67], v13 offset:0
    buffer_load_dwordx4 v[156:159], v1, s[16:19], s69 offen offset:3072 sc1
    s_waitcnt lgkmcnt(15)
    v_mfma_f32_16x16x32_bf16 v[84:87], v[244:247], v[160:163], v[84:87]
    ds_read_b128 v[68:71], v13 offset:1024
    s_waitcnt lgkmcnt(15)
    v_mfma_f32_16x16x32_bf16 v[88:91], v[248:251], v[160:163], v[88:91]
    ds_read_b128 v[72:75], v13 offset:2048
    s_waitcnt lgkmcnt(15)
    v_mfma_f32_16x16x32_bf16 v[92:95], v[252:255], v[160:163], v[92:95]
    ds_read_b128 v[76:79], v13 offset:3072
    s_waitcnt lgkmcnt(15)
    v_mfma_f32_16x16x32_bf16 v[96:99], v[16:19], v[160:163], v[96:99]
    s_waitcnt vmcnt(19) lgkmcnt(14)
    v_mfma_f32_16x16x32_bf16 v[80:83], v[20:23], v[164:167], v[80:83]
    s_waitcnt vmcnt(4)
    v_cmp_ne_u32 vcc, 1, v0
    s_nop 1
    s_and_b32 s13, vcc_lo, 3
    s_cbranch_scc1 mg_fwc_16
mg_frc_16:
    s_xor_b32 s69, s67, 4325376
    buffer_load_dwordx4 v[160:163], v1, s[16:19], s69 offen offset:0 sc1
    s_waitcnt lgkmcnt(13)
    v_mfma_f32_16x16x32_bf16 v[84:87], v[24:27], v[164:167], v[84:87]
    s_waitcnt lgkmcnt(12)
    v_mfma_f32_16x16x32_bf16 v[88:91], v[28:31], v[164:167], v[88:91]
    s_waitcnt lgkmcnt(11)
    v_mfma_f32_16x16x32_bf16 v[92:95], v[32:35], v[164:167], v[92:95]
    s_waitcnt lgkmcnt(10)
    v_mfma_f32_16x16x32_bf16 v[96:99], v[36:39], v[164:167], v[96:99]
    s_waitcnt lgkmcnt(9)
    v_mfma_f32_16x16x32_bf16 v[80:83], v[40:43], v[168:171], v[80:83]
    buffer_load_dwordx4 v[164:167], v1, s[16:19], s69 offen offset:1024 sc1
    s_waitcnt lgkmcnt(8)
    v_mfma_f32_16x16x32_bf16 v[84:87], v[44:47], v[168:171], v[84:87]
    s_waitcnt lgkmcnt(7)
    v_mfma_f32_16x16x32_bf16 v[88:91], v[48:51], v[168:171], v[88:91]
    s_waitcnt lgkmcnt(4)
    v_mfma_f32_16x16x32_bf16 v[80:83], v[60:63], v[172:175], v[80:83]
    v_mfma_f32_16x16x32_bf16 v[92:95], v[52:55], v[168:171], v[92:95]
    v_mov_b32 v0, 1
    s_mov_b64 exec, 1
    buffer_store_dword v0, off, s[16:19], s9 sc1
    s_mov_b64 exec, -1
    s_waitcnt lgkmcnt(3)
    v_mfma_f32_16x16x32_bf16 v[84:87], v[64:67], v[172:175], v[84:87]
    s_waitcnt lgkmcnt(0)
    s_branch mg_t0j
mg_t0s:
    s_waitcnt vmcnt(11)
    v_mfma_f32_16x16x32_bf16 v[80:83], v[112:115], v[144:147], 0
    s_mul_i32 s45, s2, 20480
    s_add_u32 s45, s45, 67108864
    s_add_i32 s68, s68, 8192
    s_mov_b64 exec, 3
    buffer_load_dword v0, v1, s[16:19], s68 offen sc1
    s_mov_b64 exec, -1
    v_mfma_f32_16x16x32_bf16 v[84:87], v[116:119], v[144:147], 0
    s_xor_b32 s13, s2, 1
    s_mul_i32 s46, s13, 20480
    v_mfma_f32_16x16x32_bf16 v[88:91], v[120:123], v[144:147], 0
    s_add_u32 s46, s46, 67108864
    s_mul_i32 s50, s48, 160
    v_mfma_f32_16x16x32_bf16 v[92:95], v[124:127], v[144:147], 0
    s_bfe_u32 s13, s67, 0x50011
    s_mul_i32 s48, s13, 40960
    v_mfma_f32_16x16x32_bf16 v[96:99], v[128:131], v[144:147], 0
    s_add_u32 s48, s48, s50
    s_bfe_u32 s52, s2, 262146
    s_waitcnt vmcnt(11)
    v_mfma_f32_16x16x32_bf16 v[80:83], v[132:135], v[148:151], v[80:83]
    s_lshl_b32 s52, s52, 8
    s_add_u32 s52, s52, 75563008
    s_xor_b32 s69, s67, 4096
    buffer_load_dwordx4 v[144:147], v1, s[16:19], s69 offen offset:0 sc1
    v_mfma_f32_16x16x32_bf16 v[84:87], v[136:139], v[148:151], v[84:87]
    s_mul_i32 s55, s12, 40960
    s_mul_i32 s54, s12, 3072
    v_mfma_f32_16x16x32_bf16 v[88:91], v[140:143], v[148:151], v[88:91]
    s_bfe_u32 s13, s2, 262146
    s_lshl_b32 s13, s13, 3
    v_mfma_f32_16x16x32_bf16 v[92:95], v[192:195], v[148:151], v[92:95]
    s_add_u32 s13, s13, s12
    s_mul_i32 s49, s13, 20480
    v_mfma_f32_16x16x32_bf16 v[96:99], v[196:199], v[148:151], v[96:99]
    s_add_u32 s49, s49, 62914560
    s_mul_i32 s50, s13, 40960
    s_waitcnt vmcnt(11)
    v_mfma_f32_16x16x32_bf16 v[80:83], v[200:203], v[152:155], v[80:83]
    buffer_load_dwordx4 v[148:151], v1, s[16:19], s69 offen offset:1024 sc1
    v_mfma_f32_16x16x32_bf16 v[84:87], v[204:207], v[152:155], v[84:87]
    v_mfma_f32_16x16x32_bf16 v[88:91], v[208:211], v[152:155], v[88:91]
    v_mfma_f32_16x16x32_bf16 v[92:95], v[212:215], v[152:155], v[92:95]
    v_mfma_f32_16x16x32_bf16 v[96:99], v[216:219], v[152:155], v[96:99]
    s_waitcnt vmcnt(11)
    v_mfma_f32_16x16x32_bf16 v[80:83], v[220:223], v[156:159], v[80:83]
    buffer_load_dwordx4 v[152:155], v1, s[16:19], s69 offen offset:2048 sc1
    v_mfma_f32_16x16x32_bf16 v[84:87], v[224:227], v[156:159], v[84:87]
    v_mfma_f32_16x16x32_bf16 v[88:91], v[228:231], v[156:159], v[88:91]
    v_mfma_f32_16x16x32_bf16 v[92:95], v[232:235], v[156:159], v[92:95]
    v_mfma_f32_16x16x32_bf16 v[96:99], v[236:239], v[156:159], v[96:99]
    s_waitcnt vmcnt(11)
    v_mfma_f32_16x16x32_bf16 v[80:83], v[240:243], v[160:163], v[80:83]
    buffer_load_dwordx4 v[156:159], v1, s[16:19], s69 offen offset:3072 sc1
    v_mfma_f32_16x16x32_bf16 v[84:87], v[244:247], v[160:163], v[84:87]
    v_mfma_f32_16x16x32_bf16 v[88:91], v[248:251], v[160:163], v[88:91]
    v_mfma_f32_16x16x32_bf16 v[92:95], v[252:255], v[160:163], v[92:95]
    v_mfma_f32_16x16x32_bf16 v[96:99], v[16:19], v[160:163], v[96:99]
    s_waitcnt vmcnt(11)
    v_mfma_f32_16x16x32_bf16 v[80:83], v[20:23], v[164:167], v[80:83]
    s_waitcnt vmcnt(4)
    v_cmp_ne_u32 vcc, 1, v0
    s_nop 1
    s_and_b32 s13, vcc_lo, 3
    s_cbranch_scc1 mg_fwc_17
mg_frc_17:
    s_xor_b32 s69, s67, 4325376
    buffer_load_dwordx4 v[160:163], v1, s[16:19], s69 offen offset:0 sc1
    v_mfma_f32_16x16x32_bf16 v[84:87], v[24:27], v[164:167], v[84:87]
    v_mfma_f32_16x16x32_bf16 v[88:91], v[28:31], v[164:167], v[88:91]
    v_mfma_f32_16x16x32_bf16 v[92:95], v[32:35], v[164:167], v[92:95]
    v_mfma_f32_16x16x32_bf16 v[96:99], v[36:39], v[164:167], v[96:99]
    v_mfma_f32_16x16x32_bf16 v[80:83], v[40:43], v[168:171], v[80:83]
    buffer_load_dwordx4 v[164:167], v1, s[16:19], s69 offen offset:1024 sc1
    v_mfma_f32_16x16x32_bf16 v[84:87], v[44:47], v[168:171], v[84:87]
    v_mfma_f32_16x16x32_bf16 v[88:91], v[48:51], v[168:171], v[88:91]
    v_mfma_f32_16x16x32_bf16 v[80:83], v[60:63], v[172:175], v[80:83]
    v_mfma_f32_16x16x32_bf16 v[92:95], v[52:55], v[168:171], v[92:95]
    v_mov_b32 v0, 1
    s_mov_b64 exec, 1
    buffer_store_dword v0, off, s[16:19], s9 sc1
    s_mov_b64 exec, -1
    v_mfma_f32_16x16x32_bf16 v[84:87], v[64:67], v[172:175], v[84:87]
    s_waitcnt lgkmcnt(0)
mg_t0j:
    v_mfma_f32_16x16x32_bf16 v[96:99], v[56:59], v[168:171], v[96:99]
    s_waitcnt lgkmcnt(0)
    s_barrier
    ds_write_b128 v3, v[80:83] offset:0
    v_mfma_f32_16x16x32_bf16 v[88:91], v[68:71], v[172:175], v[88:91]
    buffer_load_dwordx4 v[168:171], v1, s[16:19], s69 offen offset:2048 sc1
    v_mfma_f32_16x16x32_bf16 v[80:83], v[112:115], v[176:179], 0
    ds_write_b128 v3, v[84:87] offset:1024
    v_mfma_f32_16x16x32_bf16 v[92:95], v[72:75], v[172:175], v[92:95]
    v_mfma_f32_16x16x32_bf16 v[84:87], v[116:119], v[176:179], 0
    s_lshl_b32 s13, s12, 10
    s_add_u32 s13, s13, 155648
    v_add_u32 v2, s13, v1
    ds_write_b128 v3, v[88:91] offset:2048
    v_mfma_f32_16x16x32_bf16 v[96:99], v[76:79], v[172:175], v[96:99]
    v_mfma_f32_16x16x32_bf16 v[88:91], v[120:123], v[176:179], 0
    buffer_load_dwordx4 v[172:175], v1, s[16:19], s69 offen offset:3072 sc1
    ds_write_b128 v3, v[92:95] offset:3072
    v_mfma_f32_16x16x32_bf16 v[80:83], v[132:135], v[180:183], v[80:83]
    v_mfma_f32_16x16x32_bf16 v[92:95], v[124:127], v[176:179], 0
    ds_write_b128 v3, v[96:99] offset:4096
    v_mfma_f32_16x16x32_bf16 v[84:87], v[136:139], v[180:183], v[84:87]
    v_mfma_f32_16x16x32_bf16 v[96:99], v[128:131], v[176:179], 0
    v_mfma_f32_16x16x32_bf16 v[88:91], v[140:143], v[180:183], v[88:91]
    s_xor_b32 s69, s67, 4329472
    buffer_load_dwordx4 v[176:179], v1, s[16:19], s69 offen offset:0 sc1
    v_mfma_f32_16x16x32_bf16 v[92:95], v[192:195], v[180:183], v[92:95]
    s_waitcnt lgkmcnt(0)
    v_mfma_f32_16x16x32_bf16 v[96:99], v[196:199], v[180:183], v[96:99]
    s_barrier
    v_mfma_f32_16x16x32_bf16 v[80:83], v[200:203], v[184:187], v[80:83]
    buffer_load_dwordx4 v[180:183], v1, s[16:19], s69 offen offset:1024 sc1
    ds_read_b128 v[100:103], v4 offset:0
    v_mfma_f32_16x16x32_bf16 v[84:87], v[204:207], v[184:187], v[84:87]
    ds_read_b128 v[104:107], v4 offset:5120
    v_mfma_f32_16x16x32_bf16 v[88:91], v[208:211], v[184:187], v[88:91]
    ds_read_b128 v[108:111], v4 offset:10240
    v_mfma_f32_16x16x32_bf16 v[92:95], v[212:215], v[184:187], v[92:95]
    ds_read_b128 v[8:11], v4 offset:15360
    v_mfma_f32_16x16x32_bf16 v[96:99], v[216:219], v[184:187], v[96:99]
    v_mfma_f32_16x16x32_bf16 v[80:83], v[220:223], v[188:191], v[80:83]
    buffer_load_dwordx4 v[184:187], v1, s[16:19], s69 offen offset:2048 sc1
    v_mfma_f32_16x16x32_bf16 v[84:87], v[224:227], v[188:191], v[84:87]
    v_mfma_f32_16x16x32_bf16 v[88:91], v[228:231], v[188:191], v[88:91]
    s_waitcnt lgkmcnt(2)
    v_add_f32 v100, v100, v104
    v_add_f32 v101, v101, v105
    v_mfma_f32_16x16x32_bf16 v[92:95], v[232:235], v[188:191], v[92:95]
    v_add_f32 v102, v102, v106
    v_add_f32 v103, v103, v107
    ds_read_b128 v[104:107], v4 offset:20480
    v_mfma_f32_16x16x32_bf16 v[96:99], v[236:239], v[188:191], v[96:99]
    s_waitcnt lgkmcnt(2)
    v_add_f32 v100, v100, v108
    v_add_f32 v101, v101, v109
    s_waitcnt vmcnt(11)
    v_mfma_f32_16x16x32_bf16 v[80:83], v[240:243], v[144:147], v[80:83]
    buffer_load_dwordx4 v[188:191], v1, s[16:19], s69 offen offset:3072 sc1
    v_add_f32 v102, v102, v110
    v_add_f32 v103, v103, v111
    ds_read_b128 v[108:111], v4 offset:25600
    v_mfma_f32_16x16x32_bf16 v[84:87], v[244:247], v[144:147], v[84:87]
    s_waitcnt lgkmcnt(2)
    v_add_f32 v100, v100, v8
    v_add_f32 v101, v101, v9
    v_mfma_f32_16x16x32_bf16 v[88:91], v[248:251], v[144:147], v[88:91]
    v_add_f32 v102, v102, v10
    v_add_f32 v103, v103, v11
    ds_read_b128 v[8:11], v4 offset:30720
    v_mfma_f32_16x16x32_bf16 v[92:95], v[252:255], v[144:147], v[92:95]
    s_waitcnt lgkmcnt(2)
    v_add_f32 v100, v100, v104
    v_add_f32 v101, v101, v105
    v_mfma_f32_16x16x32_bf16 v[96:99], v[16:19], v[144:147], v[96:99]
    v_add_f32 v102, v102, v106
    v_add_f32 v103, v103, v107
    ds_read_b128 v[104:107], v4 offset:35840
    s_waitcnt vmcnt(11)
    v_mfma_f32_16x16x32_bf16 v[80:83], v[20:23], v[148:151], v[80:83]
    s_xor_b32 s69, s67, 4194304
    buffer_load_dwordx4 v[144:147], v1, s[16:19], s69 offen offset:0 sc1
    s_waitcnt lgkmcnt(2)
    v_add_f32 v100, v100, v108
    v_add_f32 v101, v101, v109
    v_mfma_f32_16x16x32_bf16 v[84:87], v[24:27], v[148:151], v[84:87]
    v_add_f32 v102, v102, v110
    v_add_f32 v103, v103, v111
    v_mfma_f32_16x16x32_bf16 v[88:91], v[28:31], v[148:151], v[88:91]
    s_waitcnt lgkmcnt(1)
    v_add_f32 v100, v100, v8
    v_add_f32 v101, v101, v9
    v_mfma_f32_16x16x32_bf16 v[92:95], v[32:35], v[148:151], v[92:95]
    v_add_f32 v102, v102, v10
    v_add_f32 v103, v103, v11
    v_mfma_f32_16x16x32_bf16 v[96:99], v[36:39], v[148:151], v[96:99]
    s_waitcnt vmcnt(11)
    v_mfma_f32_16x16x32_bf16 v[80:83], v[40:43], v[152:155], v[80:83]
    buffer_load_dwordx4 v[148:151], v1, s[16:19], s69 offen offset:1024 sc1
    s_waitcnt lgkmcnt(0)
    v_add_f32 v100, v100, v104
    v_add_f32 v101, v101, v105
    v_mfma_f32_16x16x32_bf16 v[84:87], v[44:47], v[152:155], v[84:87]
    v_add_f32 v102, v102, v106
    v_add_f32 v103, v103, v107
    v_mfma_f32_16x16x32_bf16 v[88:91], v[48:51], v[152:155], v[88:91]
    s_add_u32 s13, s45, 0
    buffer_store_dwordx4 v[100:103], v5, s[16:19], s13 offen sc1
    s_waitcnt vmcnt(12)
    v_mfma_f32_16x16x32_bf16 v[80:83], v[60:63], v[156:159], v[80:83]
    v_mfma_f32_16x16x32_bf16 v[92:95], v[52:55], v[152:155], v[92:95]
    v_mfma_f32_16x16x32_bf16 v[84:87], v[64:67], v[156:159], v[84:87]
    v_mfma_f32_16x16x32_bf16 v[96:99], v[56:59], v[152:155], v[96:99]
    ds_write_b128 v3, v[80:83] offset:40960
    v_mfma_f32_16x16x32_bf16 v[88:91], v[68:71], v[156:159], v[88:91]
    s_add_i32 s68, s68, 8192
    s_mov_b64 exec, 3
    buffer_load_dword v0, v1, s[16:19], s68 offen sc1
    s_mov_b64 exec, -1
    buffer_load_dwordx4 v[152:155], v1, s[16:19], s69 offen offset:2048 sc1
    s_waitcnt vmcnt(13)
    v_mfma_f32_16x16x32_bf16 v[80:83], v[112:115], v[160:163], 0
    ds_write_b128 v3, v[84:87] offset:41984
    v_mfma_f32_16x16x32_bf16 v[92:95], v[72:75], v[156:159], v[92:95]
    v_mfma_f32_16x16x32_bf16 v[84:87], v[116:119], v[160:163], 0
    ds_write_b128 v3, v[88:91] offset:43008
    v_mfma_f32_16x16x32_bf16 v[96:99], v[76:79], v[156:159], v[96:99]
    v_mfma_f32_16x16x32_bf16 v[88:91], v[120:123], v[160:163], 0
    buffer_load_dwordx4 v[156:159], v1, s[16:19], s69 offen offset:3072 sc1
    ds_write_b128 v3, v[92:95] offset:44032
    s_waitcnt vmcnt(13)
    v_mfma_f32_16x16x32_bf16 v[80:83], v[132:135], v[164:167], v[80:83]
    v_mfma_f32_16x16x32_bf16 v[92:95], v[124:127], v[160:163], 0
    ds_write_b128 v3, v[96:99] offset:45056
    v_mfma_f32_16x16x32_bf16 v[84:87], v[136:139], v[164:167], v[84:87]
    v_mfma_f32_16x16x32_bf16 v[96:99], v[128:131], v[160:163], 0
    v_mfma_f32_16x16x32_bf16 v[88:91], v[140:143], v[164:167], v[88:91]
    s_xor_b32 s69, s67, 4198400
    buffer_load_dwordx4 v[160:163], v1, s[16:19], s69 offen offset:0 sc1
    v_mfma_f32_16x16x32_bf16 v[92:95], v[192:195], v[164:167], v[92:95]
    s_waitcnt lgkmcnt(0)
    v_mfma_f32_16x16x32_bf16 v[96:99], v[196:199], v[164:167], v[96:99]
    s_barrier
    s_waitcnt vmcnt(12)
    v_mfma_f32_16x16x32_bf16 v[80:83], v[200:203], v[168:171], v[80:83]
    buffer_load_dwordx4 v[164:167], v1, s[16:19], s69 offen offset:1024 sc1
    ds_read_b128 v[100:103], v4 offset:40960
    v_mfma_f32_16x16x32_bf16 v[84:87], v[204:207], v[168:171], v[84:87]
    ds_read_b128 v[104:107], v4 offset:46080
    v_mfma_f32_16x16x32_bf16 v[88:91], v[208:211], v[168:171], v[88:91]
    ds_read_b128 v[108:111], v4 offset:51200
    v_mfma_f32_16x16x32_bf16 v[92:95], v[212:215], v[168:171], v[92:95]
    ds_read_b128 v[8:11], v4 offset:56320
    v_mfma_f32_16x16x32_bf16 v[96:99], v[216:219], v[168:171], v[96:99]
    s_waitcnt vmcnt(12)
    v_mfma_f32_16x16x32_bf16 v[80:83], v[220:223], v[172:175], v[80:83]
    buffer_load_dwordx4 v[168:171], v1, s[16:19], s69 offen offset:2048 sc1
    v_mfma_f32_16x16x32_bf16 v[84:87], v[224:227], v[172:175], v[84:87]
    v_mfma_f32_16x16x32_bf16 v[88:91], v[228:231], v[172:175], v[88:91]
    s_waitcnt lgkmcnt(2)
    v_add_f32 v100, v100, v104
    v_add_f32 v101, v101, v105
    v_mfma_f32_16x16x32_bf16 v[92:95], v[232:235], v[172:175], v[92:95]
    v_add_f32 v102, v102, v106
    v_add_f32 v103, v103, v107
    ds_read_b128 v[104:107], v4 offset:61440
    v_mfma_f32_16x16x32_bf16 v[96:99], v[236:239], v[172:175], v[96:99]
    s_waitcnt lgkmcnt(2)
    v_add_f32 v100, v100, v108
    v_add_f32 v101, v101, v109
    s_waitcnt vmcnt(12)
    v_mfma_f32_16x16x32_bf16 v[80:83], v[240:243], v[176:179], v[80:83]
    buffer_load_dwordx4 v[172:175], v1, s[16:19], s69 offen offset:3072 sc1
    v_add_f32 v102, v102, v110
    v_add_f32 v103, v103, v111
    ds_read_b128 v[108:111], v7 offset:25600
    v_mfma_f32_16x16x32_bf16 v[84:87], v[244:247], v[176:179], v[84:87]
    s_waitcnt lgkmcnt(2)
    v_add_f32 v100, v100, v8
    v_add_f32 v101, v101, v9
    v_mfma_f32_16x16x32_bf16 v[88:91], v[248:251], v[176:179], v[88:91]
    v_add_f32 v102, v102, v10
    v_add_f32 v103, v103, v11
    ds_read_b128 v[8:11], v7 offset:30720
    v_mfma_f32_16x16x32_bf16 v[92:95], v[252:255], v[176:179], v[92:95]
    s_waitcnt lgkmcnt(2)
    v_add_f32 v100, v100, v104
    v_add_f32 v101, v101, v105
    v_mfma_f32_16x16x32_bf16 v[96:99], v[16:19], v[176:179], v[96:99]
    v_add_f32 v102, v102, v106
    v_add_f32 v103, v103, v107
    ds_read_b128 v[104:107], v7 offset:35840
    s_waitcnt vmcnt(12)
    v_mfma_f32_16x16x32_bf16 v[80:83], v[20:23], v[180:183], v[80:83]
    s_waitcnt vmcnt(6)
    v_cmp_ne_u32 vcc, 1, v0
    s_nop 1
    s_and_b32 s13, vcc_lo, 3
    s_cbranch_scc1 mg_fwc_18
mg_frc_18:
    s_xor_b32 s69, s67, 8519680
    buffer_load_dwordx4 v[176:179], v1, s[16:19], s69 offen offset:0 sc1
    s_waitcnt lgkmcnt(2)
    v_add_f32 v100, v100, v108
    v_add_f32 v101, v101, v109
    v_mfma_f32_16x16x32_bf16 v[84:87], v[24:27], v[180:183], v[84:87]
    v_add_f32 v102, v102, v110
    v_add_f32 v103, v103, v111
    v_mfma_f32_16x16x32_bf16 v[88:91], v[28:31], v[180:183], v[88:91]
    s_waitcnt lgkmcnt(1)
    v_add_f32 v100, v100, v8
    v_add_f32 v101, v101, v9
    v_mfma_f32_16x16x32_bf16 v[92:95], v[32:35], v[180:183], v[92:95]
    v_add_f32 v102, v102, v10
    v_add_f32 v103, v103, v11
    v_mfma_f32_16x16x32_bf16 v[96:99], v[36:39], v[180:183], v[96:99]
    v_mfma_f32_16x16x32_bf16 v[80:83], v[40:43], v[184:187], v[80:83]
    buffer_load_dwordx4 v[180:183], v1, s[16:19], s69 offen offset:1024 sc1
    s_waitcnt lgkmcnt(0)
    v_add_f32 v100, v100, v104
    v_add_f32 v101, v101, v105
    v_mfma_f32_16x16x32_bf16 v[84:87], v[44:47], v[184:187], v[84:87]
    v_add_f32 v102, v102, v106
    v_add_f32 v103, v103, v107
    v_mfma_f32_16x16x32_bf16 v[88:91], v[48:51], v[184:187], v[88:91]
    ds_write_b128 v2, v[100:103]
    v_mfma_f32_16x16x32_bf16 v[80:83], v[60:63], v[188:191], v[80:83]
    v_mfma_f32_16x16x32_bf16 v[92:95], v[52:55], v[184:187], v[92:95]
    v_mfma_f32_16x16x32_bf16 v[84:87], v[64:67], v[188:191], v[84:87]
    v_mfma_f32_16x16x32_bf16 v[96:99], v[56:59], v[184:187], v[96:99]
    ds_write_b128 v3, v[80:83] offset:0
    v_mfma_f32_16x16x32_bf16 v[88:91], v[68:71], v[188:191], v[88:91]
    s_add_i32 s68, s68, 8192
    s_mov_b64 exec, 3
    buffer_load_dword v0, v1, s[16:19], s68 offen sc1
    s_mov_b64 exec, -1
    buffer_load_dwordx4 v[184:187], v1, s[16:19], s69 offen offset:2048 sc1
    v_mfma_f32_16x16x32_bf16 v[80:83], v[112:115], v[144:147], 0
    ds_write_b128 v3, v[84:87] offset:1024
    s_add_u32 s47, s46, 0
    buffer_load_dwordx4 v[12:15], v5, s[16:19], s47 offen sc1
    v_mfma_f32_16x16x32_bf16 v[92:95], v[72:75], v[188:191], v[92:95]
    v_mfma_f32_16x16x32_bf16 v[84:87], v[116:119], v[144:147], 0
    ds_write_b128 v3, v[88:91] offset:2048
    v_mfma_f32_16x16x32_bf16 v[96:99], v[76:79], v[188:191], v[96:99]
    v_mfma_f32_16x16x32_bf16 v[88:91], v[120:123], v[144:147], 0
    buffer_load_dwordx4 v[188:191], v1, s[16:19], s69 offen offset:3072 sc1
    ds_write_b128 v3, v[92:95] offset:3072
    v_mfma_f32_16x16x32_bf16 v[80:83], v[132:135], v[148:151], v[80:83]
    v_mfma_f32_16x16x32_bf16 v[92:95], v[124:127], v[144:147], 0
    ds_write_b128 v3, v[96:99] offset:4096
    v_mfma_f32_16x16x32_bf16 v[84:87], v[136:139], v[148:151], v[84:87]
    v_mfma_f32_16x16x32_bf16 v[96:99], v[128:131], v[144:147], 0
    v_mfma_f32_16x16x32_bf16 v[88:91], v[140:143], v[148:151], v[88:91]
    s_xor_b32 s69, s67, 8523776
    buffer_load_dwordx4 v[144:147], v1, s[16:19], s69 offen offset:0 sc1
    v_mfma_f32_16x16x32_bf16 v[92:95], v[192:195], v[148:151], v[92:95]
    s_waitcnt lgkmcnt(0)
    v_mfma_f32_16x16x32_bf16 v[96:99], v[196:199], v[148:151], v[96:99]
    s_barrier
    s_waitcnt vmcnt(12)
    v_mfma_f32_16x16x32_bf16 v[80:83], v[200:203], v[152:155], v[80:83]
    buffer_load_dwordx4 v[148:151], v1, s[16:19], s69 offen offset:1024 sc1
    ds_read_b128 v[100:103], v4 offset:0
    v_mfma_f32_16x16x32_bf16 v[84:87], v[204:207], v[152:155], v[84:87]
    ds_read_b128 v[104:107], v4 offset:5120
    v_mfma_f32_16x16x32_bf16 v[88:91], v[208:211], v[152:155], v[88:91]
    ds_read_b128 v[108:111], v4 offset:10240
    v_mfma_f32_16x16x32_bf16 v[92:95], v[212:215], v[152:155], v[92:95]
    ds_read_b128 v[8:11], v4 offset:15360
    v_mfma_f32_16x16x32_bf16 v[96:99], v[216:219], v[152:155], v[96:99]
    s_waitcnt vmcnt(12)
    v_mfma_f32_16x16x32_bf16 v[80:83], v[220:223], v[156:159], v[80:83]
    buffer_load_dwordx4 v[152:155], v1, s[16:19], s69 offen offset:2048 sc1
    v_mfma_f32_16x16x32_bf16 v[84:87], v[224:227], v[156:159], v[84:87]
    v_mfma_f32_16x16x32_bf16 v[88:91], v[228:231], v[156:159], v[88:91]
    s_waitcnt lgkmcnt(2)
    v_add_f32 v100, v100, v104
    v_add_f32 v101, v101, v105
    v_mfma_f32_16x16x32_bf16 v[92:95], v[232:235], v[156:159], v[92:95]
    v_add_f32 v102, v102, v106
    v_add_f32 v103, v103, v107
    ds_read_b128 v[104:107], v4 offset:20480
    v_mfma_f32_16x16x32_bf16 v[96:99], v[236:239], v[156:159], v[96:99]
    s_waitcnt lgkmcnt(2)
    v_add_f32 v100, v100, v108
    v_add_f32 v101, v101, v109
    s_waitcnt vmcnt(12)
    v_mfma_f32_16x16x32_bf16 v[80:83], v[240:243], v[160:163], v[80:83]
    buffer_load_dwordx4 v[156:159], v1, s[16:19], s69 offen offset:3072 sc1
    v_add_f32 v102, v102, v110
    v_add_f32 v103, v103, v111
    ds_read_b128 v[108:111], v4 offset:25600
    v_mfma_f32_16x16x32_bf16 v[84:87], v[244:247], v[160:163], v[84:87]
    s_waitcnt lgkmcnt(2)
    v_add_f32 v100, v100, v8
    v_add_f32 v101, v101, v9
    v_mfma_f32_16x16x32_bf16 v[88:91], v[248:251], v[160:163], v[88:91]
    v_add_f32 v102, v102, v10
    v_add_f32 v103, v103, v11
    ds_read_b128 v[8:11], v4 offset:30720
    v_mfma_f32_16x16x32_bf16 v[92:95], v[252:255], v[160:163], v[92:95]
    s_waitcnt lgkmcnt(2)
    v_add_f32 v100, v100, v104
    v_add_f32 v101, v101, v105
    v_mfma_f32_16x16x32_bf16 v[96:99], v[16:19], v[160:163], v[96:99]
    v_add_f32 v102, v102, v106
    v_add_f32 v103, v103, v107
    ds_read_b128 v[104:107], v4 offset:35840
    s_waitcnt vmcnt(12)
    v_mfma_f32_16x16x32_bf16 v[80:83], v[20:23], v[164:167], v[80:83]
    s_waitcnt vmcnt(7)
    v_cmp_ne_u32 vcc, 1, v0
    s_nop 1
    s_and_b32 s13, vcc_lo, 3
    s_cbranch_scc1 mg_fwc_19
mg_frc_19:
    s_xor_b32 s69, s67, 12713984
    buffer_load_dwordx4 v[160:163], v1, s[16:19], s69 offen offset:0 sc1
    s_waitcnt lgkmcnt(2)
    v_add_f32 v100, v100, v108
    v_add_f32 v101, v101, v109
    v_mfma_f32_16x16x32_bf16 v[84:87], v[24:27], v[164:167], v[84:87]
    v_add_f32 v102, v102, v110
    v_add_f32 v103, v103, v111
    ds_read_b128 v[108:111], v2
    v_mfma_f32_16x16x32_bf16 v[88:91], v[28:31], v[164:167], v[88:91]
    s_waitcnt lgkmcnt(2)
    v_add_f32 v100, v100, v8
    v_add_f32 v101, v101, v9
    v_mfma_f32_16x16x32_bf16 v[92:95], v[32:35], v[164:167], v[92:95]
    v_add_f32 v102, v102, v10
    v_add_f32 v103, v103, v11
    v_mfma_f32_16x16x32_bf16 v[96:99], v[36:39], v[164:167], v[96:99]
    v_mfma_f32_16x16x32_bf16 v[80:83], v[40:43], v[168:171], v[80:83]
    buffer_load_dwordx4 v[164:167], v1, s[16:19], s69 offen offset:1024 sc1
    s_waitcnt lgkmcnt(1)
    v_add_f32 v100, v100, v104
    v_add_f32 v101, v101, v105
    v_mfma_f32_16x16x32_bf16 v[84:87], v[44:47], v[168:171], v[84:87]
    v_add_f32 v102, v102, v106
    v_add_f32 v103, v103, v107
    v_mfma_f32_16x16x32_bf16 v[88:91], v[48:51], v[168:171], v[88:91]
    s_add_u32 s13, s45, 5120
    buffer_store_dwordx4 v[100:103], v5, s[16:19], s13 offen sc1
    v_mfma_f32_16x16x32_bf16 v[80:83], v[60:63], v[172:175], v[80:83]
    s_waitcnt vmcnt(8)
    v_max3_u32 v8, v12, v13, v14
    v_max_u32 v8, v8, v15
    v_mfma_f32_16x16x32_bf16 v[92:95], v[52:55], v[168:171], v[92:95]
    v_cmp_eq_u32 vcc, -1, v8
    s_add_u32 s13, s48, 1280
    v_mfma_f32_16x16x32_bf16 v[84:87], v[64:67], v[172:175], v[84:87]
    s_waitcnt lgkmcnt(0)
    s_cbranch_vccnz mg_xwx_20
mg_xrx_20:
    v_add_f32 v108, v108, v12
    v_add_f32 v109, v109, v13
    v_mfma_f32_16x16x32_bf16 v[96:99], v[56:59], v[168:171], v[96:99]
    v_add_f32 v110, v110, v14
    v_add_f32 v111, v111, v15
    ds_write_b128 v3, v[80:83] offset:40960
    v_mfma_f32_16x16x32_bf16 v[88:91], v[68:71], v[172:175], v[88:91]
    buffer_load_dwordx4 v[168:171], v1, s[16:19], s69 offen offset:2048 sc1
    v_cvt_pk_bf16_f32 v108, v108, v109
    v_cvt_pk_bf16_f32 v109, v110, v111
    v_mfma_f32_16x16x32_bf16 v[80:83], v[112:115], v[176:179], 0
    buffer_store_dwordx2 v[108:109], v6, s[24:27], s13 offen
    ds_write_b128 v3, v[84:87] offset:41984
    v_mfma_f32_16x16x32_bf16 v[92:95], v[72:75], v[172:175], v[92:95]
    v_mfma_f32_16x16x32_bf16 v[84:87], v[116:119], v[176:179], 0
    ds_write_b128 v3, v[88:91] offset:43008
    v_mfma_f32_16x16x32_bf16 v[96:99], v[76:79], v[172:175], v[96:99]
    v_mfma_f32_16x16x32_bf16 v[88:91], v[120:123], v[176:179], 0
    buffer_load_dwordx4 v[172:175], v1, s[16:19], s69 offen offset:3072 sc1
    ds_write_b128 v3, v[92:95] offset:44032
    v_mfma_f32_16x16x32_bf16 v[80:83], v[132:135], v[180:183], v[80:83]
    v_mfma_f32_16x16x32_bf16 v[92:95], v[124:127], v[176:179], 0
    ds_write_b128 v3, v[96:99] offset:45056
    v_mfma_f32_16x16x32_bf16 v[84:87], v[136:139], v[180:183], v[84:87]
    v_mfma_f32_16x16x32_bf16 v[96:99], v[128:131], v[176:179], 0
    v_mfma_f32_16x16x32_bf16 v[88:91], v[140:143], v[180:183], v[88:91]
    s_xor_b32 s69, s67, 12718080
    buffer_load_dwordx4 v[176:179], v1, s[16:19], s69 offen offset:0 sc1
    v_mfma_f32_16x16x32_bf16 v[92:95], v[192:195], v[180:183], v[92:95]
    s_waitcnt lgkmcnt(0)
    v_mfma_f32_16x16x32_bf16 v[96:99], v[196:199], v[180:183], v[96:99]
    s_barrier
    v_mfma_f32_16x16x32_bf16 v[80:83], v[200:203], v[184:187], v[80:83]
    buffer_load_dwordx4 v[180:183], v1, s[16:19], s69 offen offset:1024 sc1
    ds_read_b128 v[100:103], v4 offset:40960
    v_mfma_f32_16x16x32_bf16 v[84:87], v[204:207], v[184:187], v[84:87]
    ds_read_b128 v[104:107], v4 offset:46080
    v_mfma_f32_16x16x32_bf16 v[88:91], v[208:211], v[184:187], v[88:91]
    ds_read_b128 v[108:111], v4 offset:51200
    v_mfma_f32_16x16x32_bf16 v[92:95], v[212:215], v[184:187], v[92:95]
    ds_read_b128 v[8:11], v4 offset:56320
    v_mfma_f32_16x16x32_bf16 v[96:99], v[216:219], v[184:187], v[96:99]
    s_waitcnt vmcnt(12)
    v_mfma_f32_16x16x32_bf16 v[80:83], v[220:223], v[188:191], v[80:83]
    buffer_load_dwordx4 v[184:187], v1, s[16:19], s69 offen offset:2048 sc1
    v_mfma_f32_16x16x32_bf16 v[84:87], v[224:227], v[188:191], v[84:87]
    v_mfma_f32_16x16x32_bf16 v[88:91], v[228:231], v[188:191], v[88:91]
    s_waitcnt lgkmcnt(2)
    v_add_f32 v100, v100, v104
    v_add_f32 v101, v101, v105
    v_mfma_f32_16x16x32_bf16 v[92:95], v[232:235], v[188:191], v[92:95]
    v_add_f32 v102, v102, v106
    v_add_f32 v103, v103, v107
    ds_read_b128 v[104:107], v4 offset:61440
    v_mfma_f32_16x16x32_bf16 v[96:99], v[236:239], v[188:191], v[96:99]
    s_waitcnt lgkmcnt(2)
    v_add_f32 v100, v100, v108
    v_add_f32 v101, v101, v109
    s_waitcnt vmcnt(12)
    v_mfma_f32_16x16x32_bf16 v[80:83], v[240:243], v[144:147], v[80:83]
    buffer_load_dwordx4 v[188:191], v1, s[16:19], s69 offen offset:3072 sc1
    v_add_f32 v102, v102, v110
    v_add_f32 v103, v103, v111
    ds_read_b128 v[108:111], v7 offset:25600
    v_mfma_f32_16x16x32_bf16 v[84:87], v[244:247], v[144:147], v[84:87]
    s_waitcnt lgkmcnt(2)
    v_add_f32 v100, v100, v8
    v_add_f32 v101, v101, v9
    v_mfma_f32_16x16x32_bf16 v[88:91], v[248:251], v[144:147], v[88:91]
    v_add_f32 v102, v102, v10
    v_add_f32 v103, v103, v11
    ds_read_b128 v[8:11], v7 offset:30720
    v_mfma_f32_16x16x32_bf16 v[92:95], v[252:255], v[144:147], v[92:95]
    s_waitcnt lgkmcnt(2)
    v_add_f32 v100, v100, v104
    v_add_f32 v101, v101, v105
    v_mfma_f32_16x16x32_bf16 v[96:99], v[16:19], v[144:147], v[96:99]
    v_add_f32 v102, v102, v106
    v_add_f32 v103, v103, v107
    ds_read_b128 v[104:107], v7 offset:35840
    s_waitcnt vmcnt(12)
    v_mfma_f32_16x16x32_bf16 v[80:83], v[20:23], v[148:151], v[80:83]
    s_xor_b32 s69, s67, 8388608
    buffer_load_dwordx4 v[144:147], v1, s[16:19], s69 offen offset:0 sc1
    s_waitcnt lgkmcnt(2)
    v_add_f32 v100, v100, v108
    v_add_f32 v101, v101, v109
    v_mfma_f32_16x16x32_bf16 v[84:87], v[24:27], v[148:151], v[84:87]
    v_add_f32 v102, v102, v110
    v_add_f32 v103, v103, v111
    v_mfma_f32_16x16x32_bf16 v[88:91], v[28:31], v[148:151], v[88:91]
    s_waitcnt lgkmcnt(1)
    v_add_f32 v100, v100, v8
    v_add_f32 v101, v101, v9
    v_mfma_f32_16x16x32_bf16 v[92:95], v[32:35], v[148:151], v[92:95]
    v_add_f32 v102, v102, v10
    v_add_f32 v103, v103, v11
    v_mfma_f32_16x16x32_bf16 v[96:99], v[36:39], v[148:151], v[96:99]
    s_waitcnt vmcnt(12)
    v_mfma_f32_16x16x32_bf16 v[80:83], v[40:43], v[152:155], v[80:83]
    buffer_load_dwordx4 v[148:151], v1, s[16:19], s69 offen offset:1024 sc1
    s_waitcnt lgkmcnt(0)
    v_add_f32 v100, v100, v104
    v_add_f32 v101, v101, v105
    v_mfma_f32_16x16x32_bf16 v[84:87], v[44:47], v[152:155], v[84:87]
    v_add_f32 v102, v102, v106
    v_add_f32 v103, v103, v107
    v_mfma_f32_16x16x32_bf16 v[88:91], v[48:51], v[152:155], v[88:91]
    ds_write_b128 v2, v[100:103]
    s_waitcnt vmcnt(12)
    v_mfma_f32_16x16x32_bf16 v[80:83], v[60:63], v[156:159], v[80:83]
    v_mfma_f32_16x16x32_bf16 v[92:95], v[52:55], v[152:155], v[92:95]
    v_mfma_f32_16x16x32_bf16 v[84:87], v[64:67], v[156:159], v[84:87]
    v_mov_b32 v0, 1
    s_cmp_eq_u32 s12, 0
    s_cselect_b64 exec, 1, 0
    buffer_atomic_add v0, off, s[16:19], s52 sc0 sc1
    s_mov_b64 exec, -1
    v_mfma_f32_16x16x32_bf16 v[96:99], v[56:59], v[152:155], v[96:99]
    ds_write_b128 v3, v[80:83] offset:0
    v_mfma_f32_16x16x32_bf16 v[88:91], v[68:71], v[156:159], v[88:91]
    buffer_load_dwordx4 v[152:155], v1, s[16:19], s69 offen offset:2048 sc1
    s_waitcnt vmcnt(13)
    v_mfma_f32_16x16x32_bf16 v[80:83], v[112:115], v[160:163], 0
    ds_write_b128 v3, v[84:87] offset:1024
    s_add_u32 s47, s46, 5120
    buffer_load_dwordx4 v[12:15], v5, s[16:19], s47 offen sc1
    v_mfma_f32_16x16x32_bf16 v[92:95], v[72:75], v[156:159], v[92:95]
    v_mfma_f32_16x16x32_bf16 v[84:87], v[116:119], v[160:163], 0
    ds_write_b128 v3, v[88:91] offset:2048
    v_mfma_f32_16x16x32_bf16 v[96:99], v[76:79], v[156:159], v[96:99]
    v_mfma_f32_16x16x32_bf16 v[88:91], v[120:123], v[160:163], 0
    buffer_load_dwordx4 v[156:159], v1, s[16:19], s69 offen offset:3072 sc1
    ds_write_b128 v3, v[92:95] offset:3072
    s_waitcnt vmcnt(14)
    v_mfma_f32_16x16x32_bf16 v[80:83], v[132:135], v[164:167], v[80:83]
    v_mfma_f32_16x16x32_bf16 v[92:95], v[124:127], v[160:163], 0
    ds_write_b128 v3, v[96:99] offset:4096
    v_mfma_f32_16x16x32_bf16 v[84:87], v[136:139], v[164:167], v[84:87]
    v_mfma_f32_16x16x32_bf16 v[96:99], v[128:131], v[160:163], 0
    v_mfma_f32_16x16x32_bf16 v[88:91], v[140:143], v[164:167], v[88:91]
    s_xor_b32 s69, s67, 8392704
    buffer_load_dwordx4 v[160:163], v1, s[16:19], s69 offen offset:0 sc1
    v_mfma_f32_16x16x32_bf16 v[92:95], v[192:195], v[164:167], v[92:95]
    s_waitcnt lgkmcnt(0)
    v_mfma_f32_16x16x32_bf16 v[96:99], v[196:199], v[164:167], v[96:99]
    s_barrier
    s_waitcnt vmcnt(13)
    v_mfma_f32_16x16x32_bf16 v[80:83], v[200:203], v[168:171], v[80:83]
    buffer_load_dwordx4 v[164:167], v1, s[16:19], s69 offen offset:1024 sc1
    ds_read_b128 v[100:103], v4 offset:0
    v_mfma_f32_16x16x32_bf16 v[84:87], v[204:207], v[168:171], v[84:87]
    ds_read_b128 v[104:107], v4 offset:5120
    v_mfma_f32_16x16x32_bf16 v[88:91], v[208:211], v[168:171], v[88:91]
    ds_read_b128 v[108:111], v4 offset:10240
    v_mfma_f32_16x16x32_bf16 v[92:95], v[212:215], v[168:171], v[92:95]
    ds_read_b128 v[8:11], v4 offset:15360
    v_mfma_f32_16x16x32_bf16 v[96:99], v[216:219], v[168:171], v[96:99]
    s_waitcnt vmcnt(12)
    v_mfma_f32_16x16x32_bf16 v[80:83], v[220:223], v[172:175], v[80:83]
    buffer_load_dwordx4 v[168:171], v1, s[16:19], s69 offen offset:2048 sc1
    v_mfma_f32_16x16x32_bf16 v[84:87], v[224:227], v[172:175], v[84:87]
    v_mfma_f32_16x16x32_bf16 v[88:91], v[228:231], v[172:175], v[88:91]
    s_waitcnt lgkmcnt(2)
    v_add_f32 v100, v100, v104
    v_add_f32 v101, v101, v105
    v_mfma_f32_16x16x32_bf16 v[92:95], v[232:235], v[172:175], v[92:95]
    v_add_f32 v102, v102, v106
    v_add_f32 v103, v103, v107
    ds_read_b128 v[104:107], v4 offset:20480
    v_mfma_f32_16x16x32_bf16 v[96:99], v[236:239], v[172:175], v[96:99]
    s_waitcnt lgkmcnt(2)
    v_add_f32 v100, v100, v108
    v_add_f32 v101, v101, v109
    s_waitcnt vmcnt(12)
    v_mfma_f32_16x16x32_bf16 v[80:83], v[240:243], v[176:179], v[80:83]
    buffer_load_dwordx4 v[172:175], v1, s[16:19], s69 offen offset:3072 sc1
    v_add_f32 v102, v102, v110
    v_add_f32 v103, v103, v111
    ds_read_b128 v[108:111], v4 offset:25600
    v_mfma_f32_16x16x32_bf16 v[84:87], v[244:247], v[176:179], v[84:87]
    s_waitcnt lgkmcnt(2)
    v_add_f32 v100, v100, v8
    v_add_f32 v101, v101, v9
    v_mfma_f32_16x16x32_bf16 v[88:91], v[248:251], v[176:179], v[88:91]
    v_add_f32 v102, v102, v10
    v_add_f32 v103, v103, v11
    ds_read_b128 v[8:11], v4 offset:30720
    v_mfma_f32_16x16x32_bf16 v[92:95], v[252:255], v[176:179], v[92:95]
    s_waitcnt lgkmcnt(2)
    v_add_f32 v100, v100, v104
    v_add_f32 v101, v101, v105
    v_mfma_f32_16x16x32_bf16 v[96:99], v[16:19], v[176:179], v[96:99]
    v_add_f32 v102, v102, v106
    v_add_f32 v103, v103, v107
    ds_read_b128 v[104:107], v4 offset:35840
    s_waitcnt vmcnt(12)
    v_mfma_f32_16x16x32_bf16 v[80:83], v[20:23], v[180:183], v[80:83]
    s_xor_b32 s69, s67, 12582912
    buffer_load_dwordx4 v[176:179], v1, s[16:19], s69 offen offset:0 sc1
    s_waitcnt lgkmcnt(2)
    v_add_f32 v100, v100, v108
    v_add_f32 v101, v101, v109
    v_mfma_f32_16x16x32_bf16 v[84:87], v[24:27], v[180:183], v[84:87]
    v_add_f32 v102, v102, v110
    v_add_f32 v103, v103, v111
    ds_read_b128 v[108:111], v2
    v_mfma_f32_16x16x32_bf16 v[88:91], v[28:31], v[180:183], v[88:91]
    s_waitcnt lgkmcnt(2)
    v_add_f32 v100, v100, v8
    v_add_f32 v101, v101, v9
    v_mfma_f32_16x16x32_bf16 v[92:95], v[32:35], v[180:183], v[92:95]
    v_add_f32 v102, v102, v10
    v_add_f32 v103, v103, v11
    v_mfma_f32_16x16x32_bf16 v[96:99], v[36:39], v[180:183], v[96:99]
    s_waitcnt vmcnt(12)
    v_mfma_f32_16x16x32_bf16 v[80:83], v[40:43], v[184:187], v[80:83]
    buffer_load_dwordx4 v[180:183], v1, s[16:19], s69 offen offset:1024 sc1
    s_waitcnt lgkmcnt(1)
    v_add_f32 v100, v100, v104
    v_add_f32 v101, v101, v105
    v_mfma_f32_16x16x32_bf16 v[84:87], v[44:47], v[184:187], v[84:87]
    v_add_f32 v102, v102, v106
    v_add_f32 v103, v103, v107
    v_mfma_f32_16x16x32_bf16 v[88:91], v[48:51], v[184:187], v[88:91]
    s_add_u32 s13, s45, 10240
    buffer_store_dwordx4 v[100:103], v5, s[16:19], s13 offen sc1
    s_waitcnt vmcnt(13)
    v_mfma_f32_16x16x32_bf16 v[80:83], v[60:63], v[188:191], v[80:83]
    s_waitcnt vmcnt(8)
    v_max3_u32 v8, v12, v13, v14
    v_max_u32 v8, v8, v15
    v_mfma_f32_16x16x32_bf16 v[92:95], v[52:55], v[184:187], v[92:95]
    v_cmp_eq_u32 vcc, -1, v8
    s_add_u32 s13, s48, 1312000
    v_mfma_f32_16x16x32_bf16 v[84:87], v[64:67], v[188:191], v[84:87]
    s_waitcnt lgkmcnt(0)
    s_cbranch_vccnz mg_xwx_21
mg_xrx_21:
    v_add_f32 v108, v108, v12
    v_add_f32 v109, v109, v13
    v_mfma_f32_16x16x32_bf16 v[96:99], v[56:59], v[184:187], v[96:99]
    v_add_f32 v110, v110, v14
    v_add_f32 v111, v111, v15
    ds_write_b128 v3, v[80:83] offset:40960
    v_mfma_f32_16x16x32_bf16 v[88:91], v[68:71], v[188:191], v[88:91]
    buffer_load_dwordx4 v[184:187], v1, s[16:19], s69 offen offset:2048 sc1
    v_cvt_pk_bf16_f32 v108, v108, v109
    v_cvt_pk_bf16_f32 v109, v110, v111
    v_mfma_f32_16x16x32_bf16 v[80:83], v[112:115], v[144:147], 0
    buffer_store_dwordx2 v[108:109], v6, s[24:27], s13 offen
    ds_write_b128 v3, v[84:87] offset:41984
    v_mfma_f32_16x16x32_bf16 v[92:95], v[72:75], v[188:191], v[92:95]
    v_mfma_f32_16x16x32_bf16 v[84:87], v[116:119], v[144:147], 0
    v_mov_b32 v13, 143360
    s_cmp_eq_u32 s12, 0
    s_cselect_b64 exec, 1, 0
    ds_write_b32 v13, v0
    s_mov_b64 exec, -1
    ds_write_b128 v3, v[88:91] offset:43008
    v_mfma_f32_16x16x32_bf16 v[96:99], v[76:79], v[188:191], v[96:99]
    v_mfma_f32_16x16x32_bf16 v[88:91], v[120:123], v[144:147], 0
    buffer_load_dwordx4 v[188:191], v1, s[16:19], s69 offen offset:3072 sc1
    ds_write_b128 v3, v[92:95] offset:44032
    v_mfma_f32_16x16x32_bf16 v[80:83], v[132:135], v[148:151], v[80:83]
    v_mfma_f32_16x16x32_bf16 v[92:95], v[124:127], v[144:147], 0
    ds_write_b128 v3, v[96:99] offset:45056
    v_mfma_f32_16x16x32_bf16 v[84:87], v[136:139], v[148:151], v[84:87]
    v_mfma_f32_16x16x32_bf16 v[96:99], v[128:131], v[144:147], 0
    v_mfma_f32_16x16x32_bf16 v[88:91], v[140:143], v[148:151], v[88:91]
    s_xor_b32 s69, s67, 12587008
    buffer_load_dwordx4 v[144:147], v1, s[16:19], s69 offen offset:0 sc1
    v_mfma_f32_16x16x32_bf16 v[92:95], v[192:195], v[148:151], v[92:95]
    s_waitcnt lgkmcnt(0)
    v_mfma_f32_16x16x32_bf16 v[96:99], v[196:199], v[148:151], v[96:99]
    s_barrier
    v_mfma_f32_16x16x32_bf16 v[80:83], v[200:203], v[152:155], v[80:83]
    buffer_load_dwordx4 v[148:151], v1, s[16:19], s69 offen offset:1024 sc1
    v_mov_b32 v0, 143360
    ds_read_b32 v0, v0
    ds_read_b128 v[100:103], v4 offset:40960
    v_mfma_f32_16x16x32_bf16 v[84:87], v[204:207], v[152:155], v[84:87]
    ds_read_b128 v[104:107], v4 offset:46080
    v_mfma_f32_16x16x32_bf16 v[88:91], v[208:211], v[152:155], v[88:91]
    ds_read_b128 v[108:111], v4 offset:51200
    v_mfma_f32_16x16x32_bf16 v[92:95], v[212:215], v[152:155], v[92:95]
    ds_read_b128 v[8:11], v4 offset:56320
    v_mfma_f32_16x16x32_bf16 v[96:99], v[216:219], v[152:155], v[96:99]
    s_waitcnt lgkmcnt(4)
    v_readfirstlane_b32 s52, v0
    s_waitcnt vmcnt(12)
    v_mfma_f32_16x16x32_bf16 v[80:83], v[220:223], v[156:159], v[80:83]
    buffer_load_dwordx4 v[152:155], v1, s[16:19], s69 offen offset:2048 sc1
    s_mul_i32 s14, s52, 3
    s_add_u32 s52, s52, 24
    s_cmp_lt_u32 s52, 36
    s_cselect_b32 s14, s14, s52
    s_cselect_b32 s52, 4, 0
    s_lshl_b32 s14, s14, 5
    s_add_u32 s50, s50, s14
    s_lshl_b32 s14, s14, 5
    s_add_u32 s55, s55, s14
    v_mfma_f32_16x16x32_bf16 v[84:87], v[224:227], v[156:159], v[84:87]
    s_add_u32 m0, s54, 81920
    s_add_u32 s14, s55, 56623104
    buffer_load_dwordx4 v1, s[16:19], s14 offen offset:0 sc1 lds
    v_mfma_f32_16x16x32_bf16 v[88:91], v[228:231], v[156:159], v[88:91]
    s_cmp_lg_u32 s52, 0
    s_cselect_b64 exec, -1, 0
    buffer_load_dwordx4 v1, s[16:19], s14 offen offset:1024 sc1 lds
    s_mov_b64 exec, -1
    s_waitcnt lgkmcnt(2)
    v_add_f32 v100, v100, v104
    v_add_f32 v101, v101, v105
    v_mfma_f32_16x16x32_bf16 v[92:95], v[232:235], v[156:159], v[92:95]
    s_cmp_lg_u32 s52, 0
    s_cselect_b64 exec, -1, 0
    buffer_load_dwordx4 v1, s[16:19], s14 offen offset:2048 sc1 lds
    s_mov_b64 exec, -1
    v_add_f32 v102, v102, v106
    v_add_f32 v103, v103, v107
    ds_read_b128 v[104:107], v4 offset:61440
    v_mfma_f32_16x16x32_bf16 v[96:99], v[236:239], v[156:159], v[96:99]
    s_add_u32 m0, s54, 106496
    s_add_u32 s14, s55, 56950784
    buffer_load_dwordx4 v1, s[16:19], s14 offen offset:0 sc1 lds
    s_waitcnt lgkmcnt(2)
    v_add_f32 v100, v100, v108
    v_add_f32 v101, v101, v109
    s_waitcnt vmcnt(16)
    v_mfma_f32_16x16x32_bf16 v[80:83], v[240:243], v[160:163], v[80:83]
    s_cmp_lg_u32 s52, 0
    s_cselect_b64 exec, -1, 0
    buffer_load_dwordx4 v1, s[16:19], s14 offen offset:1024 sc1 lds
    s_mov_b64 exec, -1
    buffer_load_dwordx4 v[156:159], v1, s[16:19], s69 offen offset:3072 sc1
    v_add_f32 v102, v102, v110
    v_add_f32 v103, v103, v111
    ds_read_b128 v[108:111], v7 offset:25600
    v_mfma_f32_16x16x32_bf16 v[84:87], v[244:247], v[160:163], v[84:87]
    s_cmp_lg_u32 s52, 0
    s_cselect_b64 exec, -1, 0
    buffer_load_dwordx4 v1, s[16:19], s14 offen offset:2048 sc1 lds
    s_mov_b64 exec, -1
    s_waitcnt lgkmcnt(2)
    v_add_f32 v100, v100, v8
    v_add_f32 v101, v101, v9
    v_mfma_f32_16x16x32_bf16 v[88:91], v[248:251], v[160:163], v[88:91]
    s_add_u32 m0, s54, 131072
    s_add_u32 s14, s55, 57278464
    s_cmp_lt_u32 s12, 4
    s_cselect_b64 exec, -1, 0
    buffer_load_dwordx4 v1, s[16:19], s14 offen offset:0 sc1 lds
    s_mov_b64 exec, -1
    v_add_f32 v102, v102, v10
    v_add_f32 v103, v103, v11
    ds_read_b128 v[8:11], v7 offset:30720
    v_mfma_f32_16x16x32_bf16 v[92:95], v[252:255], v[160:163], v[92:95]
    s_cmp_lt_u32 s12, s52
    s_cselect_b64 exec, -1, 0
    buffer_load_dwordx4 v1, s[16:19], s14 offen offset:1024 sc1 lds
    s_mov_b64 exec, -1
    s_waitcnt lgkmcnt(2)
    v_add_f32 v100, v100, v104
    v_add_f32 v101, v101, v105
    v_mfma_f32_16x16x32_bf16 v[96:99], v[16:19], v[160:163], v[96:99]
    s_cmp_lt_u32 s12, s52
    s_cselect_b64 exec, -1, 0
    buffer_load_dwordx4 v1, s[16:19], s14 offen offset:2048 sc1 lds
    s_mov_b64 exec, -1
    v_add_f32 v102, v102, v106
    v_add_f32 v103, v103, v107
    ds_read_b128 v[104:107], v7 offset:35840
    s_waitcnt vmcnt(21)
    v_mfma_f32_16x16x32_bf16 v[80:83], v[20:23], v[164:167], v[80:83]
    buffer_load_dwordx4 v[160:163], v1, s[16:19], s49 offen offset:0 sc1
    s_waitcnt lgkmcnt(2)
    v_add_f32 v100, v100, v108
    v_add_f32 v101, v101, v109
    v_mfma_f32_16x16x32_bf16 v[84:87], v[24:27], v[164:167], v[84:87]
    v_add_f32 v102, v102, v110
    v_add_f32 v103, v103, v111
    v_mfma_f32_16x16x32_bf16 v[88:91], v[28:31], v[164:167], v[88:91]
    s_waitcnt lgkmcnt(1)
    v_add_f32 v100, v100, v8
    v_add_f32 v101, v101, v9
    v_mfma_f32_16x16x32_bf16 v[92:95], v[32:35], v[164:167], v[92:95]
    v_add_f32 v102, v102, v10
    v_add_f32 v103, v103, v11
    v_mfma_f32_16x16x32_bf16 v[96:99], v[36:39], v[164:167], v[96:99]
    s_waitcnt vmcnt(21)
    v_mfma_f32_16x16x32_bf16 v[80:83], v[40:43], v[168:171], v[80:83]
    buffer_load_dwordx4 v[164:167], v1, s[16:19], s49 offen offset:1024 sc1
    s_waitcnt lgkmcnt(0)
    v_add_f32 v100, v100, v104
    v_add_f32 v101, v101, v105
    v_mfma_f32_16x16x32_bf16 v[84:87], v[44:47], v[168:171], v[84:87]
    v_add_f32 v102, v102, v106
    v_add_f32 v103, v103, v107
    v_mfma_f32_16x16x32_bf16 v[88:91], v[48:51], v[168:171], v[88:91]
    s_add_u32 s13, s45, 15360
    buffer_store_dwordx4 v[100:103], v5, s[16:19], s13 offen sc1
    s_waitcnt vmcnt(22)
    v_mfma_f32_16x16x32_bf16 v[80:83], v[60:63], v[172:175], v[80:83]
    v_mfma_f32_16x16x32_bf16 v[92:95], v[52:55], v[168:171], v[92:95]
    v_mfma_f32_16x16x32_bf16 v[84:87], v[64:67], v[172:175], v[84:87]
    v_mfma_f32_16x16x32_bf16 v[96:99], v[56:59], v[168:171], v[96:99]
    ds_write_b128 v3, v[80:83] offset:0
    v_mfma_f32_16x16x32_bf16 v[88:91], v[68:71], v[172:175], v[88:91]
    buffer_load_dwordx4 v[168:171], v1, s[16:19], s49 offen offset:2048 sc1
    s_waitcnt vmcnt(22)
    v_mfma_f32_16x16x32_bf16 v[80:83], v[112:115], v[176:179], 0
    ds_write_b128 v3, v[84:87] offset:1024
    s_add_u32 s47, s46, 10240
    buffer_load_dwordx4 v[12:15], v5, s[16:19], s47 offen sc1
    v_mfma_f32_16x16x32_bf16 v[92:95], v[72:75], v[172:175], v[92:95]
    v_mfma_f32_16x16x32_bf16 v[84:87], v[116:119], v[176:179], 0
    ds_write_b128 v3, v[88:91] offset:2048
    v_mfma_f32_16x16x32_bf16 v[96:99], v[76:79], v[172:175], v[96:99]
    v_mfma_f32_16x16x32_bf16 v[88:91], v[120:123], v[176:179], 0
    buffer_load_dwordx4 v[172:175], v1, s[16:19], s49 offen offset:3072 sc1
    s_add_u32 s49, s49, 4096
    ds_write_b128 v3, v[92:95] offset:3072
    s_waitcnt vmcnt(23)
    v_mfma_f32_16x16x32_bf16 v[80:83], v[132:135], v[180:183], v[80:83]
    v_mfma_f32_16x16x32_bf16 v[92:95], v[124:127], v[176:179], 0
    ds_write_b128 v3, v[96:99] offset:4096
    v_mfma_f32_16x16x32_bf16 v[84:87], v[136:139], v[180:183], v[84:87]
    v_mfma_f32_16x16x32_bf16 v[96:99], v[128:131], v[176:179], 0
    v_mfma_f32_16x16x32_bf16 v[88:91], v[140:143], v[180:183], v[88:91]
    buffer_load_dwordx4 v[176:179], v1, s[16:19], s49 offen offset:0 sc1
    v_mfma_f32_16x16x32_bf16 v[92:95], v[192:195], v[180:183], v[92:95]
    s_waitcnt vmcnt(7) lgkmcnt(0)
    v_mfma_f32_16x16x32_bf16 v[96:99], v[196:199], v[180:183], v[96:99]
    s_barrier
    v_mfma_f32_16x16x32_bf16 v[80:83], v[200:203], v[184:187], v[80:83]
    buffer_load_dwordx4 v[180:183], v1, s[16:19], s49 offen offset:1024 sc1
    ds_read_b128 v[100:103], v4 offset:0
    v_mfma_f32_16x16x32_bf16 v[84:87], v[204:207], v[184:187], v[84:87]
    ds_read_b128 v[104:107], v4 offset:5120
    v_mfma_f32_16x16x32_bf16 v[88:91], v[208:211], v[184:187], v[88:91]
    ds_read_b128 v[108:111], v4 offset:10240
    v_add_u32 v2, 81920, v1
    v_mfma_f32_16x16x32_bf16 v[92:95], v[212:215], v[184:187], v[92:95]
    ds_read_b128 v[8:11], v4 offset:15360
    v_mfma_f32_16x16x32_bf16 v[96:99], v[216:219], v[184:187], v[96:99]
    v_mfma_f32_16x16x32_bf16 v[80:83], v[220:223], v[188:191], v[80:83]
    buffer_load_dwordx4 v[184:187], v1, s[16:19], s49 offen offset:2048 sc1
    v_mfma_f32_16x16x32_bf16 v[84:87], v[224:227], v[188:191], v[84:87]
    v_mfma_f32_16x16x32_bf16 v[88:91], v[228:231], v[188:191], v[88:91]
    s_waitcnt lgkmcnt(2)
    v_add_f32 v100, v100, v104
    v_add_f32 v101, v101, v105
    v_mfma_f32_16x16x32_bf16 v[92:95], v[232:235], v[188:191], v[92:95]
    v_add_f32 v102, v102, v106
    v_add_f32 v103, v103, v107
    ds_read_b128 v[104:107], v4 offset:20480
    v_mfma_f32_16x16x32_bf16 v[96:99], v[236:239], v[188:191], v[96:99]
    s_waitcnt lgkmcnt(2)
    v_add_f32 v100, v100, v108
    v_add_f32 v101, v101, v109
    v_mfma_f32_16x16x32_bf16 v[80:83], v[240:243], v[144:147], v[80:83]
    buffer_load_dwordx4 v[188:191], v1, s[16:19], s49 offen offset:3072 sc1
    s_add_u32 s49, s49, 4096
    v_add_f32 v102, v102, v110
    v_add_f32 v103, v103, v111
    ds_read_b128 v[108:111], v4 offset:25600
    v_mfma_f32_16x16x32_bf16 v[84:87], v[244:247], v[144:147], v[84:87]
    s_waitcnt lgkmcnt(2)
    v_add_f32 v100, v100, v8
    v_add_f32 v101, v101, v9
    v_mfma_f32_16x16x32_bf16 v[88:91], v[248:251], v[144:147], v[88:91]
    v_add_f32 v102, v102, v10
    v_add_f32 v103, v103, v11
    ds_read_b128 v[8:11], v4 offset:30720
    ds_read_b128 v[132:135], v2 offset:0
    ds_read_b128 v[136:139], v2 offset:1024
    ds_read_b128 v[140:143], v2 offset:2048
    v_mfma_f32_16x16x32_bf16 v[92:95], v[252:255], v[144:147], v[92:95]
    s_waitcnt lgkmcnt(5)
    v_add_f32 v100, v100, v104
    v_add_f32 v101, v101, v105
    v_mfma_f32_16x16x32_bf16 v[96:99], v[16:19], v[144:147], v[96:99]
    v_add_f32 v102, v102, v106
    v_add_f32 v103, v103, v107
    ds_read_b128 v[104:107], v4 offset:35840
    s_add_u32 s64, s46, 15360
    buffer_load_dwordx4 v[252:255], v5, s[16:19], s64 offen sc1
    v_mfma_f32_16x16x32_bf16 v[80:83], v[20:23], v[148:151], v[80:83]
    buffer_load_dwordx4 v[220:223], v1, s[16:19], s49 offen offset:0 sc1
    s_waitcnt lgkmcnt(5)
    v_add_f32 v100, v100, v108
    v_add_f32 v101, v101, v109
    v_mfma_f32_16x16x32_bf16 v[84:87], v[24:27], v[148:151], v[84:87]
    buffer_load_dwordx4 v[224:227], v1, s[16:19], s49 offen offset:1024 sc1
    v_add_f32 v102, v102, v110
    v_add_f32 v103, v103, v111
    v_mfma_f32_16x16x32_bf16 v[88:91], v[28:31], v[148:151], v[88:91]
    buffer_load_dwordx4 v[228:231], v1, s[16:19], s49 offen offset:2048 sc1
    s_waitcnt lgkmcnt(4)
    v_add_f32 v100, v100, v8
    v_add_f32 v101, v101, v9
    v_mfma_f32_16x16x32_bf16 v[92:95], v[32:35], v[148:151], v[92:95]
    buffer_load_dwordx4 v[232:235], v1, s[16:19], s49 offen offset:3072 sc1
    s_add_u32 s49, s49, 4096
    v_add_f32 v102, v102, v10
    v_add_f32 v103, v103, v11
    v_mfma_f32_16x16x32_bf16 v[96:99], v[36:39], v[148:151], v[96:99]
    buffer_load_dwordx4 v[236:239], v1, s[16:19], s49 offen offset:0 sc1
    v_mfma_f32_16x16x32_bf16 v[80:83], v[40:43], v[152:155], v[80:83]
    buffer_load_dwordx4 v[240:243], v1, s[16:19], s49 offen offset:1024 sc1
    s_waitcnt lgkmcnt(0)
    v_add_f32 v100, v100, v104
    v_add_f32 v101, v101, v105
    v_mfma_f32_16x16x32_bf16 v[84:87], v[44:47], v[152:155], v[84:87]
    buffer_load_dwordx4 v[244:247], v1, s[16:19], s49 offen offset:2048 sc1
    v_add_f32 v102, v102, v106
    v_add_f32 v103, v103, v107
    v_mfma_f32_16x16x32_bf16 v[88:91], v[48:51], v[152:155], v[88:91]
    buffer_load_dwordx4 v[248:251], v1, s[16:19], s49 offen offset:3072 sc1
    s_add_u32 s49, s49, 4096
    s_waitcnt vmcnt(14)
    v_max3_u32 v8, v12, v13, v14
    v_max_u32 v8, v8, v15
    ds_read_b128 v[192:195], v2 offset:3072
    ds_read_b128 v[196:199], v2 offset:4096
    ds_read_b128 v[200:203], v2 offset:5120
    v_mfma_f32_16x16x32_bf16 v[92:95], v[52:55], v[152:155], v[92:95]
    buffer_load_dwordx4 v[144:147], v1, s[16:19], s49 offen offset:0 sc1
    v_cmp_eq_u32 vcc, -1, v8
    s_add_u32 s13, s48, 2622720
    v_mfma_f32_16x16x32_bf16 v[96:99], v[56:59], v[152:155], v[96:99]
    buffer_load_dwordx4 v[148:151], v1, s[16:19], s49 offen offset:1024 sc1
    s_cbranch_vccnz mg_xwx_22
mg_xrx_22:
    v_add_f32 v100, v100, v12
    v_add_f32 v101, v101, v13
    v_mfma_f32_16x16x32_bf16 v[80:83], v[60:63], v[156:159], v[80:83]
    buffer_load_dwordx4 v[152:155], v1, s[16:19], s49 offen offset:2048 sc1
    v_add_f32 v102, v102, v14
    v_add_f32 v103, v103, v15
    v_mfma_f32_16x16x32_bf16 v[84:87], v[64:67], v[156:159], v[84:87]
    v_cvt_pk_bf16_f32 v100, v100, v101
    v_cvt_pk_bf16_f32 v101, v102, v103
    v_mfma_f32_16x16x32_bf16 v[88:91], v[68:71], v[156:159], v[88:91]
    buffer_store_dwordx2 v[100:101], v6, s[24:27], s13 offen
    v_mfma_f32_16x16x32_bf16 v[92:95], v[72:75], v[156:159], v[92:95]
    ds_write_b128 v3, v[80:83] offset:40960
    v_mfma_f32_16x16x32_bf16 v[96:99], v[76:79], v[156:159], v[96:99]
    s_cmp_eq_u32 s52, 0
    s_cbranch_scc1 mg_one
    v_mfma_f32_16x16x32_bf16 v[112:115], v[132:135], v[160:163], 0
    buffer_load_dwordx4 v[156:159], v1, s[16:19], s49 offen offset:3072 sc1
    s_add_u32 s49, s49, 4096
    ds_write_b128 v3, v[84:87] offset:41984
    ds_read_b128 v[204:207], v2 offset:6144
    ds_read_b128 v[208:211], v2 offset:7168
    ds_read_b128 v[212:215], v2 offset:8192
    v_mfma_f32_16x16x32_bf16 v[116:119], v[136:139], v[160:163], 0
    v_mfma_f32_16x16x32_bf16 v[120:123], v[140:143], v[160:163], 0
    ds_write_b128 v3, v[88:91] offset:43008
    s_waitcnt lgkmcnt(6)
    v_mfma_f32_16x16x32_bf16 v[112:115], v[192:195], v[164:167], v[112:115]
    ds_read_b128 v[132:135], v2 offset:9216
    ds_read_b128 v[136:139], v2 offset:10240
    ds_read_b128 v[140:143], v2 offset:11264
    v_mfma_f32_16x16x32_bf16 v[116:119], v[196:199], v[164:167], v[116:119]
    ds_write_b128 v3, v[92:95] offset:44032
    v_mfma_f32_16x16x32_bf16 v[120:123], v[200:203], v[164:167], v[120:123]
    s_waitcnt lgkmcnt(5)
    v_mfma_f32_16x16x32_bf16 v[112:115], v[204:207], v[168:171], v[112:115]
    ds_write_b128 v3, v[96:99] offset:45056
    ds_read_b128 v[192:195], v2 offset:12288
    ds_read_b128 v[196:199], v2 offset:13312
    ds_read_b128 v[200:203], v2 offset:14336
    v_mfma_f32_16x16x32_bf16 v[116:119], v[208:211], v[168:171], v[116:119]
    v_mfma_f32_16x16x32_bf16 v[120:123], v[212:215], v[168:171], v[120:123]
    s_waitcnt vmcnt(18) lgkmcnt(5)
    v_mfma_f32_16x16x32_bf16 v[112:115], v[132:135], v[172:175], v[112:115]
    ds_read_b128 v[204:207], v2 offset:15360
    ds_read_b128 v[208:211], v2 offset:16384
    ds_read_b128 v[212:215], v2 offset:17408
    v_mfma_f32_16x16x32_bf16 v[116:119], v[136:139], v[172:175], v[116:119]
    s_waitcnt lgkmcnt(6)
    v_mfma_f32_16x16x32_bf16 v[120:123], v[140:143], v[172:175], v[120:123]
    s_barrier
    s_waitcnt vmcnt(17) lgkmcnt(3)
    v_mfma_f32_16x16x32_bf16 v[112:115], v[192:195], v[176:179], v[112:115]
    ds_read_b128 v[100:103], v4 offset:40960
    ds_read_b128 v[132:135], v2 offset:18432
    ds_read_b128 v[136:139], v2 offset:19456
    ds_read_b128 v[140:143], v2 offset:20480
    v_mfma_f32_16x16x32_bf16 v[116:119], v[196:199], v[176:179], v[116:119]
    ds_read_b128 v[104:107], v4 offset:46080
    v_mfma_f32_16x16x32_bf16 v[120:123], v[200:203], v[176:179], v[120:123]
    ds_read_b128 v[108:111], v4 offset:51200
    s_waitcnt vmcnt(16) lgkmcnt(6)
    v_mfma_f32_16x16x32_bf16 v[112:115], v[204:207], v[180:183], v[112:115]
    ds_read_b128 v[8:11], v4 offset:56320
    ds_read_b128 v[192:195], v2 offset:21504
    ds_read_b128 v[196:199], v2 offset:22528
    ds_read_b128 v[200:203], v2 offset:23552
    v_mfma_f32_16x16x32_bf16 v[116:119], v[208:211], v[180:183], v[116:119]
    v_mfma_f32_16x16x32_bf16 v[120:123], v[212:215], v[180:183], v[120:123]
    s_waitcnt vmcnt(15) lgkmcnt(6)
    v_mfma_f32_16x16x32_bf16 v[112:115], v[132:135], v[184:187], v[112:115]
    ds_read_b128 v[204:207], v2 offset:24576
    ds_read_b128 v[208:211], v2 offset:25600
    ds_read_b128 v[212:215], v2 offset:26624
    v_mfma_f32_16x16x32_bf16 v[116:119], v[136:139], v[184:187], v[116:119]
    s_waitcnt lgkmcnt(8)
    v_add_f32 v100, v100, v104
    v_add_f32 v101, v101, v105
    v_mfma_f32_16x16x32_bf16 v[120:123], v[140:143], v[184:187], v[120:123]
    v_add_f32 v102, v102, v106
    v_add_f32 v103, v103, v107
    ds_read_b128 v[104:107], v4 offset:61440
    s_waitcnt vmcnt(14) lgkmcnt(4)
    v_mfma_f32_16x16x32_bf16 v[112:115], v[192:195], v[188:191], v[112:115]
    v_add_f32 v100, v100, v108
    v_add_f32 v101, v101, v109
    ds_read_b128 v[132:135], v2 offset:27648
    ds_read_b128 v[136:139], v2 offset:28672
    ds_read_b128 v[140:143], v2 offset:29696
    v_mfma_f32_16x16x32_bf16 v[116:119], v[196:199], v[188:191], v[116:119]
    v_add_f32 v102, v102, v110
    v_add_f32 v103, v103, v111
    ds_read_b128 v[108:111], v7 offset:25600
    v_mfma_f32_16x16x32_bf16 v[120:123], v[200:203], v[188:191], v[120:123]
    v_add_f32 v100, v100, v8
    v_add_f32 v101, v101, v9
    s_waitcnt vmcnt(12) lgkmcnt(5)
    v_mfma_f32_16x16x32_bf16 v[112:115], v[204:207], v[220:223], v[112:115]
    v_add_f32 v102, v102, v10
    v_add_f32 v103, v103, v11
    ds_read_b128 v[8:11], v7 offset:30720
    ds_read_b128 v[192:195], v2 offset:30720
    ds_read_b128 v[196:199], v2 offset:31744
    ds_read_b128 v[200:203], v2 offset:32768
    v_mfma_f32_16x16x32_bf16 v[116:119], v[208:211], v[220:223], v[116:119]
    s_waitcnt lgkmcnt(8)
    v_add_f32 v100, v100, v104
    v_add_f32 v101, v101, v105
    v_mfma_f32_16x16x32_bf16 v[120:123], v[212:215], v[220:223], v[120:123]
    v_add_f32 v102, v102, v106
    v_add_f32 v103, v103, v107
    ds_read_b128 v[104:107], v7 offset:35840
    s_waitcnt vmcnt(11) lgkmcnt(6)
    v_mfma_f32_16x16x32_bf16 v[112:115], v[132:135], v[224:227], v[112:115]
    s_waitcnt lgkmcnt(5)
    v_add_f32 v100, v100, v108
    v_add_f32 v101, v101, v109
    ds_read_b128 v[204:207], v2 offset:33792
    ds_read_b128 v[208:211], v2 offset:34816
    ds_read_b128 v[212:215], v2 offset:35840
    v_mfma_f32_16x16x32_bf16 v[116:119], v[136:139], v[224:227], v[116:119]
    v_add_f32 v102, v102, v110
    v_add_f32 v103, v103, v111
    v_mfma_f32_16x16x32_bf16 v[120:123], v[140:143], v[224:227], v[120:123]
    s_waitcnt lgkmcnt(7)
    v_add_f32 v100, v100, v8
    v_add_f32 v101, v101, v9
    s_waitcnt vmcnt(10) lgkmcnt(4)
    v_mfma_f32_16x16x32_bf16 v[112:115], v[192:195], v[228:231], v[112:115]
    v_add_f32 v102, v102, v10
    v_add_f32 v103, v103, v11
    ds_read_b128 v[132:135], v2 offset:36864
    ds_read_b128 v[136:139], v2 offset:37888
    ds_read_b128 v[140:143], v2 offset:38912
    v_mfma_f32_16x16x32_bf16 v[116:119], v[196:199], v[228:231], v[116:119]
    v_mfma_f32_16x16x32_bf16 v[120:123], v[200:203], v[228:231], v[120:123]
    s_waitcnt lgkmcnt(6)
    v_add_f32 v100, v100, v104
    v_add_f32 v101, v101, v105
    s_waitcnt vmcnt(9) lgkmcnt(3)
    v_mfma_f32_16x16x32_bf16 v[112:115], v[204:207], v[232:235], v[112:115]
    v_add_f32 v102, v102, v106
    v_add_f32 v103, v103, v107
    ds_read_b128 v[192:195], v2 offset:39936
    ds_read_b128 v[196:199], v2 offset:40960
    ds_read_b128 v[200:203], v2 offset:41984
    v_mfma_f32_16x16x32_bf16 v[116:119], v[208:211], v[232:235], v[116:119]
    v_max3_u32 v8, v252, v253, v254
    v_max_u32 v8, v8, v255
    v_mfma_f32_16x16x32_bf16 v[120:123], v[212:215], v[232:235], v[120:123]
    v_cmp_eq_u32 vcc, -1, v8
    s_add_u32 s13, s48, 3933440
    s_waitcnt vmcnt(8) lgkmcnt(3)
    v_mfma_f32_16x16x32_bf16 v[112:115], v[132:135], v[236:239], v[112:115]
    s_cbranch_vccnz mg_xwx_24
mg_xrx_24:
    v_add_f32 v100, v100, v252
    v_add_f32 v101, v101, v253
    ds_read_b128 v[204:207], v2 offset:43008
    ds_read_b128 v[208:211], v2 offset:44032
    ds_read_b128 v[212:215], v2 offset:45056
    v_mfma_f32_16x16x32_bf16 v[116:119], v[136:139], v[236:239], v[116:119]
    v_add_f32 v102, v102, v254
    v_add_f32 v103, v103, v255
    v_mfma_f32_16x16x32_bf16 v[120:123], v[140:143], v[236:239], v[120:123]
    v_cvt_pk_bf16_f32 v100, v100, v101
    v_cvt_pk_bf16_f32 v101, v102, v103
    s_waitcnt vmcnt(7) lgkmcnt(3)
    v_mfma_f32_16x16x32_bf16 v[112:115], v[192:195], v[240:243], v[112:115]
    buffer_store_dwordx2 v[100:101], v6, s[24:27], s13 offen
    ds_read_b128 v[132:135], v2 offset:46080
    ds_read_b128 v[136:139], v2 offset:47104
    ds_read_b128 v[140:143], v2 offset:48128
    v_mfma_f32_16x16x32_bf16 v[116:119], v[196:199], v[240:243], v[116:119]
    v_mfma_f32_16x16x32_bf16 v[120:123], v[200:203], v[240:243], v[120:123]
    s_waitcnt vmcnt(7) lgkmcnt(3)
    v_mfma_f32_16x16x32_bf16 v[112:115], v[204:207], v[244:247], v[112:115]
    ds_read_b128 v[192:195], v2 offset:49152
    ds_read_b128 v[196:199], v2 offset:50176
    ds_read_b128 v[200:203], v2 offset:51200
    v_mfma_f32_16x16x32_bf16 v[116:119], v[208:211], v[244:247], v[116:119]
    v_mfma_f32_16x16x32_bf16 v[120:123], v[212:215], v[244:247], v[120:123]
    s_waitcnt vmcnt(6) lgkmcnt(3)
    v_mfma_f32_16x16x32_bf16 v[112:115], v[132:135], v[248:251], v[112:115]
    ds_read_b128 v[204:207], v2 offset:52224
    ds_read_b128 v[208:211], v2 offset:53248
    ds_read_b128 v[212:215], v2 offset:54272
    v_mfma_f32_16x16x32_bf16 v[116:119], v[136:139], v[248:251], v[116:119]
    v_mfma_f32_16x16x32_bf16 v[120:123], v[140:143], v[248:251], v[120:123]
    s_waitcnt vmcnt(5) lgkmcnt(3)
    v_mfma_f32_16x16x32_bf16 v[112:115], v[192:195], v[144:147], v[112:115]
    ds_read_b128 v[132:135], v2 offset:55296
    ds_read_b128 v[136:139], v2 offset:56320
    ds_read_b128 v[140:143], v2 offset:57344
    v_mfma_f32_16x16x32_bf16 v[116:119], v[196:199], v[144:147], v[116:119]
    v_mfma_f32_16x16x32_bf16 v[120:123], v[200:203], v[144:147], v[120:123]
    s_waitcnt vmcnt(4) lgkmcnt(3)
    v_mfma_f32_16x16x32_bf16 v[112:115], v[204:207], v[148:151], v[112:115]
    ds_read_b128 v[192:195], v2 offset:58368
    ds_read_b128 v[196:199], v2 offset:59392
    ds_read_b128 v[200:203], v2 offset:60416
    v_mfma_f32_16x16x32_bf16 v[116:119], v[208:211], v[148:151], v[116:119]
    v_mfma_f32_16x16x32_bf16 v[120:123], v[212:215], v[148:151], v[120:123]
    s_waitcnt vmcnt(3) lgkmcnt(3)
    v_mfma_f32_16x16x32_bf16 v[112:115], v[132:135], v[152:155], v[112:115]
    v_mfma_f32_16x16x32_bf16 v[116:119], v[136:139], v[152:155], v[116:119]
    v_mfma_f32_16x16x32_bf16 v[120:123], v[140:143], v[152:155], v[120:123]
    s_waitcnt vmcnt(1) lgkmcnt(0)
    v_mfma_f32_16x16x32_bf16 v[112:115], v[192:195], v[156:159], v[112:115]
    v_mfma_f32_16x16x32_bf16 v[116:119], v[196:199], v[156:159], v[116:119]
    v_mfma_f32_16x16x32_bf16 v[120:123], v[200:203], v[156:159], v[120:123]
    v_bfe_u32 v8, v1, 4, 4
    v_mul_u32_u24 v8, 2560, v8
    v_lshrrev_b32 v9, 8, v1
    v_lshl_add_u32 v8, v9, 3, v8
    s_add_u32 s13, s50, 40960
    s_bitcmp1_b32 s2, 0
    v_cvt_pk_bf16_f32 v112, v112, v113
    v_cvt_pk_bf16_f32 v113, v114, v115
    v_cvt_pk_bf16_f32 v116, v116, v117
    v_cvt_pk_bf16_f32 v117, v118, v119
    v_cvt_pk_bf16_f32 v120, v120, v121
    v_cvt_pk_bf16_f32 v121, v122, v123
    buffer_store_dwordx2 v[120:121], v8, s[24:27], s50 offen offset:64
    buffer_store_dwordx2 v[116:117], v8, s[24:27], s50 offen offset:32
    buffer_store_dwordx2 v[112:113], v8, s[24:27], s50 offen offset:0
mg_fin:
    s_endpgm
mg_ldP:
    s_cmp_ge_u32 s47, s45
    s_cbranch_scc1 mg_leP
    s_call_b64 s[28:29], mg_iter
    s_branch mg_ldP
mg_leP:
    s_cmp_lg_u32 s31, 0
    s_cselect_b32 s13, 32768, 0
    s_mov_b32 s31, 0
    s_max_u32 s30, s30, 1
    s_sub_u32 s62, s62, s13
    s_mov_b32 s15, 1
mg_slow:
    s_mov_b32 s54, 0
    s_mov_b32 s52, 0
    s_mov_b32 s59, 1
    v_mov_b32 v8, v10
    v_mov_b32 v9, v10
    v_mov_b32 v184, 0
    v_mov_b32 v185, 0
    v_mov_b32 v186, 0
    v_mov_b32 v187, 0
    v_mov_b32 v188, 0
    v_mov_b32 v189, 0
    v_mov_b32 v190, 0
    v_mov_b32 v191, 0
    v_add_u32 v2, 4096, v1
    v_add_u32 v3, 8192, v1
    v_add_u32 v178, 12288, v1
    v_mov_b32 v16, 0
    v_mov_b32 v17, 0
    v_mov_b32 v18, 0
    v_mov_b32 v19, 0
    v_mov_b32 v20, 0
    v_mov_b32 v21, 0
    v_mov_b32 v22, 0
    v_mov_b32 v23, 0
    v_mov_b32 v24, 0
    v_mov_b32 v25, 0
    v_mov_b32 v26, 0
    v_mov_b32 v27, 0
    v_mov_b32 v28, 0
    v_mov_b32 v29, 0
    v_mov_b32 v30, 0
    v_mov_b32 v31, 0
    v_mov_b32 v32, 0
    v_mov_b32 v33, 0
    v_mov_b32 v34, 0
    v_mov_b32 v35, 0
    v_mov_b32 v36, 0
    v_mov_b32 v37, 0
    v_mov_b32 v38, 0
    v_mov_b32 v39, 0
    v_mov_b32 v40, 0
    v_mov_b32 v41, 0
    v_mov_b32 v42, 0
    v_mov_b32 v43, 0
    v_mov_b32 v44, 0
    v_mov_b32 v45, 0
    v_mov_b32 v46, 0
    v_mov_b32 v47, 0
    v_mov_b32 v48, 0
    v_mov_b32 v49, 0
    v_mov_b32 v50, 0
    v_mov_b32 v51, 0
    v_mov_b32 v52, 0
    v_mov_b32 v53, 0
    v_mov_b32 v54, 0
    v_mov_b32 v55, 0
    v_mov_b32 v56, 0
    v_mov_b32 v57, 0
    v_mov_b32 v58, 0
    v_mov_b32 v59, 0
    v_mov_b32 v60, 0
    v_mov_b32 v61, 0
    v_mov_b32 v62, 0
    v_mov_b32 v63, 0
    v_mov_b32 v64, 0
    v_mov_b32 v65, 0
    v_mov_b32 v66, 0
    v_mov_b32 v67, 0
    v_mov_b32 v68, 0
    v_mov_b32 v69, 0
    v_mov_b32 v70, 0
    v_mov_b32 v71, 0
    v_mov_b32 v72, 0
    v_mov_b32 v73, 0
    v_mov_b32 v74, 0
    v_mov_b32 v75, 0
    v_mov_b32 v76, 0
    v_mov_b32 v77, 0
    v_mov_b32 v78, 0
    v_mov_b32 v79, 0
mg_sloop:
    buffer_load_dwordx4 v[192:195], v1, s[32:35], s52 offen offset:0 sc1
    buffer_load_dwordx4 v[196:199], v1, s[32:35], s52 offen offset:1024 sc1
    buffer_load_dwordx4 v[200:203], v1, s[32:35], s52 offen offset:2048 sc1
    buffer_load_dwordx4 v[204:207], v1, s[32:35], s52 offen offset:3072 sc1
    buffer_load_dwordx4 v[208:211], v2, s[32:35], s52 offen offset:0 sc1
    buffer_load_dwordx4 v[212:215], v2, s[32:35], s52 offen offset:1024 sc1
    buffer_load_dwordx4 v[216:219], v2, s[32:35], s52 offen offset:2048 sc1
    buffer_load_dwordx4 v[220:223], v2, s[32:35], s52 offen offset:3072 sc1
    buffer_load_dwordx4 v[224:227], v3, s[32:35], s52 offen offset:0 sc1
    buffer_load_dwordx4 v[228:231], v3, s[32:35], s52 offen offset:1024 sc1
    buffer_load_dwordx4 v[232:235], v3, s[32:35], s52 offen offset:2048 sc1
    buffer_load_dwordx4 v[236:239], v3, s[32:35], s52 offen offset:3072 sc1
    buffer_load_dwordx4 v[240:243], v178, s[32:35], s52 offen offset:0 sc1
    buffer_load_dwordx4 v[244:247], v178, s[32:35], s52 offen offset:1024 sc1
    buffer_load_dwordx4 v[248:251], v178, s[32:35], s52 offen offset:2048 sc1
    buffer_load_dwordx4 v[252:255], v178, s[32:35], s52 offen offset:3072 sc1
    s_waitcnt vmcnt(0)
    v_mfma_f32_16x16x32_bf16 v[80:83], v[192:195], v[144:147], 0
    v_mfma_f32_16x16x32_bf16 v[88:91], v[192:195], v[148:151], 0
    v_mfma_f32_16x16x32_bf16 v[80:83], v[196:199], v[152:155], v[80:83]
    v_mfma_f32_16x16x32_bf16 v[88:91], v[196:199], v[156:159], v[88:91]
    v_mfma_f32_16x16x32_bf16 v[80:83], v[200:203], v[160:163], v[80:83]
    v_mfma_f32_16x16x32_bf16 v[88:91], v[200:203], v[164:167], v[88:91]
    v_mfma_f32_16x16x32_bf16 v[80:83], v[204:207], v[168:171], v[80:83]
    v_mfma_f32_16x16x32_bf16 v[88:91], v[204:207], v[172:175], v[88:91]
    v_mfma_f32_16x16x32_bf16 v[84:87], v[208:211], v[144:147], 0
    v_mfma_f32_16x16x32_bf16 v[92:95], v[208:211], v[148:151], 0
    v_mfma_f32_16x16x32_bf16 v[84:87], v[212:215], v[152:155], v[84:87]
    v_mfma_f32_16x16x32_bf16 v[92:95], v[212:215], v[156:159], v[92:95]
    v_mfma_f32_16x16x32_bf16 v[84:87], v[216:219], v[160:163], v[84:87]
    v_mfma_f32_16x16x32_bf16 v[92:95], v[216:219], v[164:167], v[92:95]
    v_mfma_f32_16x16x32_bf16 v[84:87], v[220:223], v[168:171], v[84:87]
    v_mfma_f32_16x16x32_bf16 v[92:95], v[220:223], v[172:175], v[92:95]
    v_mfma_f32_16x16x32_bf16 v[96:99], v[224:227], v[144:147], 0
    v_mfma_f32_16x16x32_bf16 v[104:107], v[224:227], v[148:151], 0
    v_mfma_f32_16x16x32_bf16 v[96:99], v[228:231], v[152:155], v[96:99]
    v_mfma_f32_16x16x32_bf16 v[104:107], v[228:231], v[156:159], v[104:107]
    v_mfma_f32_16x16x32_bf16 v[96:99], v[232:235], v[160:163], v[96:99]
    v_mfma_f32_16x16x32_bf16 v[104:107], v[232:235], v[164:167], v[104:107]
    v_mfma_f32_16x16x32_bf16 v[96:99], v[236:239], v[168:171], v[96:99]
    v_mfma_f32_16x16x32_bf16 v[104:107], v[236:239], v[172:175], v[104:107]
    v_mfma_f32_16x16x32_bf16 v[100:103], v[240:243], v[144:147], 0
    v_mfma_f32_16x16x32_bf16 v[108:111], v[240:243], v[148:151], 0
    v_mfma_f32_16x16x32_bf16 v[100:103], v[244:247], v[152:155], v[100:103]
    v_mfma_f32_16x16x32_bf16 v[108:111], v[244:247], v[156:159], v[108:111]
    v_mfma_f32_16x16x32_bf16 v[100:103], v[248:251], v[160:163], v[100:103]
    v_mfma_f32_16x16x32_bf16 v[108:111], v[248:251], v[164:167], v[108:111]
    v_mfma_f32_16x16x32_bf16 v[100:103], v[252:255], v[168:171], v[100:103]
    v_mfma_f32_16x16x32_bf16 v[108:111], v[252:255], v[172:175], v[108:111]
    s_nop 7
    buffer_load_dwordx4 v[192:195], v1, s[36:39], s52 offen offset:0 sc1
    buffer_load_dwordx4 v[196:199], v1, s[36:39], s52 offen offset:1024 sc1
    buffer_load_dwordx4 v[200:203], v1, s[36:39], s52 offen offset:2048 sc1
    buffer_load_dwordx4 v[204:207], v1, s[36:39], s52 offen offset:3072 sc1
    buffer_load_dwordx4 v[208:211], v2, s[36:39], s52 offen offset:0 sc1
    buffer_load_dwordx4 v[212:215], v2, s[36:39], s52 offen offset:1024 sc1
    buffer_load_dwordx4 v[216:219], v2, s[36:39], s52 offen offset:2048 sc1
    buffer_load_dwordx4 v[220:223], v2, s[36:39], s52 offen offset:3072 sc1
    buffer_load_dwordx4 v[224:227], v3, s[36:39], s52 offen offset:0 sc1
    buffer_load_dwordx4 v[228:231], v3, s[36:39], s52 offen offset:1024 sc1
    buffer_load_dwordx4 v[232:235], v3, s[36:39], s52 offen offset:2048 sc1
    buffer_load_dwordx4 v[236:239], v3, s[36:39], s52 offen offset:3072 sc1
    buffer_load_dwordx4 v[240:243], v178, s[36:39], s52 offen offset:0 sc1
    buffer_load_dwordx4 v[244:247], v178, s[36:39], s52 offen offset:1024 sc1
    buffer_load_dwordx4 v[248:251], v178, s[36:39], s52 offen offset:2048 sc1
    buffer_load_dwordx4 v[252:255], v178, s[36:39], s52 offen offset:3072 sc1
    s_cmp_eq_u32 s59, s46
    s_cbranch_scc0 mg_snomask
    s_cmp_eq_u32 s60, 0
    s_cbranch_scc1 mg_mkse
    v_cndmask_b32_e64 v96, v10, v96, s[70:71]
    v_cndmask_b32_e64 v97, v10, v97, s[72:73]
    v_cndmask_b32_e64 v98, v10, v98, s[74:75]
    v_cndmask_b32_e64 v99, v10, v99, s[76:77]
    v_mov_b32 v100, v10
    v_mov_b32 v101, v10
    v_mov_b32 v102, v10
    v_mov_b32 v103, v10
    v_cndmask_b32_e64 v108, v10, v108, s[70:71]
    v_cndmask_b32_e64 v109, v10, v109, s[72:73]
    v_cndmask_b32_e64 v110, v10, v110, s[74:75]
    v_cndmask_b32_e64 v111, v10, v111, s[76:77]
    s_branch mg_mksd
mg_mkse:
    v_cndmask_b32_e64 v80, v10, v80, s[70:71]
    v_cndmask_b32_e64 v81, v10, v81, s[72:73]
    v_cndmask_b32_e64 v82, v10, v82, s[74:75]
    v_cndmask_b32_e64 v83, v10, v83, s[76:77]
    v_mov_b32 v84, v10
    v_mov_b32 v85, v10
    v_mov_b32 v86, v10
    v_mov_b32 v87, v10
    v_cndmask_b32_e64 v92, v10, v92, s[70:71]
    v_cndmask_b32_e64 v93, v10, v93, s[72:73]
    v_cndmask_b32_e64 v94, v10, v94, s[74:75]
    v_cndmask_b32_e64 v95, v10, v95, s[76:77]
    v_mov_b32 v96, v10
    v_mov_b32 v97, v10
    v_mov_b32 v98, v10
    v_mov_b32 v99, v10
    v_mov_b32 v104, v10
    v_mov_b32 v105, v10
    v_mov_b32 v106, v10
    v_mov_b32 v107, v10
    v_mov_b32 v100, v10
    v_mov_b32 v101, v10
    v_mov_b32 v102, v10
    v_mov_b32 v103, v10
    v_mov_b32 v108, v10
    v_mov_b32 v109, v10
    v_mov_b32 v110, v10
    v_mov_b32 v111, v10
mg_mksd:
mg_snomask:
    v_max3_f32 v11, v80, v81, v8
    v_max3_f32 v11, v11, v82, v83
    v_max3_f32 v11, v11, v84, v85
    v_max3_f32 v11, v11, v86, v87
    v_max3_f32 v11, v11, v96, v97
    v_max3_f32 v11, v11, v98, v99
    v_max3_f32 v11, v11, v100, v101
    v_max3_f32 v11, v11, v102, v103
    v_max3_f32 v12, v88, v89, v9
    v_max3_f32 v12, v12, v90, v91
    v_max3_f32 v12, v12, v92, v93
    v_max3_f32 v12, v12, v94, v95
    v_max3_f32 v12, v12, v104, v105
    v_max3_f32 v12, v12, v106, v107
    v_max3_f32 v12, v12, v108, v109
    v_max3_f32 v12, v12, v110, v111
    v_mov_b32 v13, v11
    v_mov_b32 v14, v12
    s_nop 0
    v_permlane32_swap_b32 v11, v13
    v_permlane32_swap_b32 v12, v14
    s_nop 0
    v_max_f32 v11, v11, v13
    v_max_f32 v12, v12, v14
    v_mov_b32 v13, v11
    v_mov_b32 v14, v12
    s_nop 0
    v_permlane16_swap_b32 v11, v13
    v_permlane16_swap_b32 v12, v14
    s_nop 0
    v_max_f32 v11, v11, v13
    v_max_f32 v12, v12, v14
    v_sub_f32 v13, v8, v11
    v_sub_f32 v14, v9, v12
    v_exp_f32 v13, v13
    v_exp_f32 v14, v14
    v_mov_b32 v8, v11
    v_mov_b32 v9, v12
    v_mul_f32 v184, v184, v13
    v_mul_f32 v188, v188, v14
    v_mul_f32 v16, v16, v13
    v_mul_f32 v17, v17, v13
    v_mul_f32 v18, v18, v13
    v_mul_f32 v19, v19, v13
    v_mul_f32 v20, v20, v13
    v_mul_f32 v21, v21, v13
    v_mul_f32 v22, v22, v13
    v_mul_f32 v23, v23, v13
    v_mul_f32 v24, v24, v14
    v_mul_f32 v25, v25, v14
    v_mul_f32 v26, v26, v14
    v_mul_f32 v27, v27, v14
    v_mul_f32 v28, v28, v14
    v_mul_f32 v29, v29, v14
    v_mul_f32 v30, v30, v14
    v_mul_f32 v31, v31, v14
    v_mul_f32 v32, v32, v13
    v_mul_f32 v33, v33, v13
    v_mul_f32 v34, v34, v13
    v_mul_f32 v35, v35, v13
    v_mul_f32 v36, v36, v13
    v_mul_f32 v37, v37, v13
    v_mul_f32 v38, v38, v13
    v_mul_f32 v39, v39, v13
    v_mul_f32 v40, v40, v14
    v_mul_f32 v41, v41, v14
    v_mul_f32 v42, v42, v14
    v_mul_f32 v43, v43, v14
    v_mul_f32 v44, v44, v14
    v_mul_f32 v45, v45, v14
    v_mul_f32 v46, v46, v14
    v_mul_f32 v47, v47, v14
    v_mul_f32 v48, v48, v13
    v_mul_f32 v49, v49, v13
    v_mul_f32 v50, v50, v13
    v_mul_f32 v51, v51, v13
    v_mul_f32 v52, v52, v13
    v_mul_f32 v53, v53, v13
    v_mul_f32 v54, v54, v13
    v_mul_f32 v55, v55, v13
    v_mul_f32 v56, v56, v14
    v_mul_f32 v57, v57, v14
    v_mul_f32 v58, v58, v14
    v_mul_f32 v59, v59, v14
    v_mul_f32 v60, v60, v14
    v_mul_f32 v61, v61, v14
    v_mul_f32 v62, v62, v14
    v_mul_f32 v63, v63, v14
    v_mul_f32 v64, v64, v13
    v_mul_f32 v65, v65, v13
    v_mul_f32 v66, v66, v13
    v_mul_f32 v67, v67, v13
    v_mul_f32 v68, v68, v13
    v_mul_f32 v69, v69, v13
    v_mul_f32 v70, v70, v13
    v_mul_f32 v71, v71, v13
    v_mul_f32 v72, v72, v14
    v_mul_f32 v73, v73, v14
    v_mul_f32 v74, v74, v14
    v_mul_f32 v75, v75, v14
    v_mul_f32 v76, v76, v14
    v_mul_f32 v77, v77, v14
    v_mul_f32 v78, v78, v14
    v_mul_f32 v79, v79, v14
    v_sub_f32 v80, v80, v8
    v_sub_f32 v81, v81, v8
    v_sub_f32 v82, v82, v8
    v_sub_f32 v83, v83, v8
    v_sub_f32 v84, v84, v8
    v_sub_f32 v85, v85, v8
    v_sub_f32 v86, v86, v8
    v_sub_f32 v87, v87, v8
    v_sub_f32 v88, v88, v9
    v_sub_f32 v89, v89, v9
    v_sub_f32 v90, v90, v9
    v_sub_f32 v91, v91, v9
    v_sub_f32 v92, v92, v9
    v_sub_f32 v93, v93, v9
    v_sub_f32 v94, v94, v9
    v_sub_f32 v95, v95, v9
    v_sub_f32 v96, v96, v8
    v_sub_f32 v97, v97, v8
    v_sub_f32 v98, v98, v8
    v_sub_f32 v99, v99, v8
    v_sub_f32 v100, v100, v8
    v_sub_f32 v101, v101, v8
    v_sub_f32 v102, v102, v8
    v_sub_f32 v103, v103, v8
    v_sub_f32 v104, v104, v9
    v_sub_f32 v105, v105, v9
    v_sub_f32 v106, v106, v9
    v_sub_f32 v107, v107, v9
    v_sub_f32 v108, v108, v9
    v_sub_f32 v109, v109, v9
    v_sub_f32 v110, v110, v9
    v_sub_f32 v111, v111, v9
    v_exp_f32 v80, v80
    v_exp_f32 v81, v81
    v_exp_f32 v82, v82
    v_exp_f32 v83, v83
    v_exp_f32 v84, v84
    v_exp_f32 v85, v85
    v_exp_f32 v86, v86
    v_exp_f32 v87, v87
    v_exp_f32 v88, v88
    v_exp_f32 v89, v89
    v_exp_f32 v90, v90
    v_exp_f32 v91, v91
    v_exp_f32 v92, v92
    v_exp_f32 v93, v93
    v_exp_f32 v94, v94
    v_exp_f32 v95, v95
    v_exp_f32 v96, v96
    v_exp_f32 v97, v97
    v_exp_f32 v98, v98
    v_exp_f32 v99, v99
    v_exp_f32 v100, v100
    v_exp_f32 v101, v101
    v_exp_f32 v102, v102
    v_exp_f32 v103, v103
    v_exp_f32 v104, v104
    v_exp_f32 v105, v105
    v_exp_f32 v106, v106
    v_exp_f32 v107, v107
    v_exp_f32 v108, v108
    v_exp_f32 v109, v109
    v_exp_f32 v110, v110
    v_exp_f32 v111, v111
    v_cvt_pk_bf16_f32 v80, v80, v81
    v_cvt_pk_bf16_f32 v81, v82, v83
    v_cvt_pk_bf16_f32 v82, v84, v85
    v_cvt_pk_bf16_f32 v83, v86, v87
    v_cvt_pk_bf16_f32 v88, v88, v89
    v_cvt_pk_bf16_f32 v89, v90, v91
    v_cvt_pk_bf16_f32 v90, v92, v93
    v_cvt_pk_bf16_f32 v91, v94, v95
    v_cvt_pk_bf16_f32 v96, v96, v97
    v_cvt_pk_bf16_f32 v97, v98, v99
    v_cvt_pk_bf16_f32 v98, v100, v101
    v_cvt_pk_bf16_f32 v99, v102, v103
    v_cvt_pk_bf16_f32 v104, v104, v105
    v_cvt_pk_bf16_f32 v105, v106, v107
    v_cvt_pk_bf16_f32 v106, v108, v109
    v_cvt_pk_bf16_f32 v107, v110, v111
    s_waitcnt vmcnt(0)
    v_mfma_f32_16x16x32_bf16 v[184:187], v[4:7], v[80:83], v[184:187]
    v_mfma_f32_16x16x32_bf16 v[188:191], v[4:7], v[88:91], v[188:191]
    v_mfma_f32_16x16x32_bf16 v[184:187], v[4:7], v[96:99], v[184:187]
    v_mfma_f32_16x16x32_bf16 v[188:191], v[4:7], v[104:107], v[188:191]
    v_mfma_f32_16x16x32_bf16 v[16:19], v[192:195], v[80:83], v[16:19]
    v_mfma_f32_16x16x32_bf16 v[24:27], v[192:195], v[88:91], v[24:27]
    v_mfma_f32_16x16x32_bf16 v[20:23], v[196:199], v[80:83], v[20:23]
    v_mfma_f32_16x16x32_bf16 v[28:31], v[196:199], v[88:91], v[28:31]
    v_mfma_f32_16x16x32_bf16 v[32:35], v[200:203], v[80:83], v[32:35]
    v_mfma_f32_16x16x32_bf16 v[40:43], v[200:203], v[88:91], v[40:43]
    v_mfma_f32_16x16x32_bf16 v[36:39], v[204:207], v[80:83], v[36:39]
    v_mfma_f32_16x16x32_bf16 v[44:47], v[204:207], v[88:91], v[44:47]
    v_mfma_f32_16x16x32_bf16 v[48:51], v[208:211], v[80:83], v[48:51]
    v_mfma_f32_16x16x32_bf16 v[56:59], v[208:211], v[88:91], v[56:59]
    v_mfma_f32_16x16x32_bf16 v[52:55], v[212:215], v[80:83], v[52:55]
    v_mfma_f32_16x16x32_bf16 v[60:63], v[212:215], v[88:91], v[60:63]
    v_mfma_f32_16x16x32_bf16 v[64:67], v[216:219], v[80:83], v[64:67]
    v_mfma_f32_16x16x32_bf16 v[72:75], v[216:219], v[88:91], v[72:75]
    v_mfma_f32_16x16x32_bf16 v[68:71], v[220:223], v[80:83], v[68:71]
    v_mfma_f32_16x16x32_bf16 v[76:79], v[220:223], v[88:91], v[76:79]
    v_mfma_f32_16x16x32_bf16 v[16:19], v[224:227], v[96:99], v[16:19]
    v_mfma_f32_16x16x32_bf16 v[24:27], v[224:227], v[104:107], v[24:27]
    v_mfma_f32_16x16x32_bf16 v[20:23], v[228:231], v[96:99], v[20:23]
    v_mfma_f32_16x16x32_bf16 v[28:31], v[228:231], v[104:107], v[28:31]
    v_mfma_f32_16x16x32_bf16 v[32:35], v[232:235], v[96:99], v[32:35]
    v_mfma_f32_16x16x32_bf16 v[40:43], v[232:235], v[104:107], v[40:43]
    v_mfma_f32_16x16x32_bf16 v[36:39], v[236:239], v[96:99], v[36:39]
    v_mfma_f32_16x16x32_bf16 v[44:47], v[236:239], v[104:107], v[44:47]
    v_mfma_f32_16x16x32_bf16 v[48:51], v[240:243], v[96:99], v[48:51]
    v_mfma_f32_16x16x32_bf16 v[56:59], v[240:243], v[104:107], v[56:59]
    v_mfma_f32_16x16x32_bf16 v[52:55], v[244:247], v[96:99], v[52:55]
    v_mfma_f32_16x16x32_bf16 v[60:63], v[244:247], v[104:107], v[60:63]
    v_mfma_f32_16x16x32_bf16 v[64:67], v[248:251], v[96:99], v[64:67]
    v_mfma_f32_16x16x32_bf16 v[72:75], v[248:251], v[104:107], v[72:75]
    v_mfma_f32_16x16x32_bf16 v[68:71], v[252:255], v[96:99], v[68:71]
    v_mfma_f32_16x16x32_bf16 v[76:79], v[252:255], v[104:107], v[76:79]
    s_add_u32 s52, s52, 16384
    s_add_u32 s59, s59, 1
    s_cmp_le_u32 s59, s46
    s_nop 7
    s_cbranch_scc1 mg_sloop
    v_rcp_f32 v12, v184
    v_rcp_f32 v13, v184
    v_rcp_f32 v8, v188
    v_rcp_f32 v9, v188
    s_nop 7
    s_branch mg_store
mg_kpw_r1:
    s_mov_b32 s14, 0
mg_kpl_r1:
    s_sub_u32 s70, s70, 65536
    buffer_load_dwordx4 v[16:19], v8, s[16:19], s70 offen sc1
    s_add_u32 s70, s70, 8192
    buffer_load_dwordx4 v[20:23], v8, s[16:19], s70 offen sc1
    s_add_u32 s70, s70, 8192
    buffer_load_dwordx4 v[24:27], v8, s[16:19], s70 offen sc1
    s_add_u32 s70, s70, 8192
    buffer_load_dwordx4 v[28:31], v8, s[16:19], s70 offen sc1
    s_add_u32 s70, s70, 8192
    buffer_load_dwordx4 v[32:35], v8, s[16:19], s70 offen sc1
    s_add_u32 s70, s70, 8192
    buffer_load_dwordx4 v[36:39], v8, s[16:19], s70 offen sc1
    s_add_u32 s70, s70, 8192
    buffer_load_dwordx4 v[40:43], v8, s[16:19], s70 offen sc1
    s_add_u32 s70, s70, 8192
    buffer_load_dwordx4 v[44:47], v8, s[16:19], s70 offen sc1
    s_add_u32 s70, s70, 8192
    s_add_u32 s14, s14, 1
    s_waitcnt vmcnt(0)
    v_max_u32 v144, v16, v17
    v_max3_u32 v144, v144, v18, v19
    v_max3_u32 v144, v144, v20, v21
    v_max3_u32 v144, v144, v22, v23
    v_max3_u32 v144, v144, v24, v25
    v_max3_u32 v144, v144, v26, v27
    v_max3_u32 v144, v144, v28, v29
    v_max3_u32 v144, v144, v30, v31
    v_max3_u32 v144, v144, v32, v33
    v_max3_u32 v144, v144, v34, v35
    v_max3_u32 v144, v144, v36, v37
    v_max3_u32 v144, v144, v38, v39
    v_max3_u32 v144, v144, v40, v41
    v_max3_u32 v144, v144, v42, v43
    v_max3_u32 v144, v144, v44, v45
    v_max3_u32 v144, v144, v46, v47
    v_cmp_eq_u32 vcc, -1, v144
    s_cmp_ge_u32 s14, 0x40000
    s_cbranch_scc1 mg_kpd_r1
    s_cbranch_vccnz mg_kpl_r1
mg_kpd_r1:
    v_mfma_f32_16x16x32_bf16 v[144:147], v[148:151], v[16:19], 0
    v_mfma_f32_16x16x32_bf16 v[144:147], v[148:151], v[20:23], v[144:147]
    v_mfma_f32_16x16x32_bf16 v[144:147], v[148:151], v[24:27], v[144:147]
    v_mfma_f32_16x16x32_bf16 v[144:147], v[148:151], v[28:31], v[144:147]
    v_mfma_f32_16x16x32_bf16 v[144:147], v[148:151], v[32:35], v[144:147]
    v_mfma_f32_16x16x32_bf16 v[144:147], v[148:151], v[36:39], v[144:147]
    v_mfma_f32_16x16x32_bf16 v[144:147], v[148:151], v[40:43], v[144:147]
    v_mfma_f32_16x16x32_bf16 v[144:147], v[148:151], v[44:47], v[144:147]
    s_nop 7
    s_nop 3
    s_branch mg_kpr_r1
mg_pwrpk_r0:
    buffer_load_dword v5, off, s[20:23], s67 sc1
    s_add_u32 s14, s14, 1
    s_cmp_ge_u32 s14, 0x100000
    s_waitcnt vmcnt(0)
    v_readfirstlane_b32 s13, v5
    s_cbranch_scc1 mg_w3rpk_r0
    s_cmp_lt_u32 s13, 0x100000
    s_cbranch_scc1 mg_pwrpk_r0
    s_branch mg_w3rpk_r0
mg_pwrpv_r0:
    buffer_load_dword v5, off, s[20:23], s67 sc1
    s_add_u32 s14, s14, 1
    s_cmp_ge_u32 s14, 0x100000
    s_waitcnt vmcnt(0)
    v_readfirstlane_b32 s13, v5
    s_cbranch_scc1 mg_w3rpv_r0
    s_cmp_lt_u32 s13, 0x100000
    s_cbranch_scc1 mg_pwrpv_r0
    s_branch mg_w3rpv_r0
mg_pwb_r0:
    buffer_load_dword v5, off, s[20:23], s72 offset:128 sc1
    s_add_u32 s14, s14, 1
    s_cmp_ge_u32 s14, 0x100000
    s_waitcnt vmcnt(0)
    v_readfirstlane_b32 s13, v5
    s_cbranch_scc1 mg_w3qb_r0
    s_cmp_eq_u32 s13, 0
    s_cbranch_scc1 mg_pwb_r0
    s_branch mg_w3qb_r0
mg_kpw_r0:
    s_mov_b32 s14, 0
mg_kpl_r0:
    s_sub_u32 s70, s70, 65536
    buffer_load_dwordx4 v[16:19], v8, s[16:19], s70 offen sc1
    s_add_u32 s70, s70, 8192
    buffer_load_dwordx4 v[20:23], v8, s[16:19], s70 offen sc1
    s_add_u32 s70, s70, 8192
    buffer_load_dwordx4 v[24:27], v8, s[16:19], s70 offen sc1
    s_add_u32 s70, s70, 8192
    buffer_load_dwordx4 v[28:31], v8, s[16:19], s70 offen sc1
    s_add_u32 s70, s70, 8192
    buffer_load_dwordx4 v[32:35], v8, s[16:19], s70 offen sc1
    s_add_u32 s70, s70, 8192
    buffer_load_dwordx4 v[36:39], v8, s[16:19], s70 offen sc1
    s_add_u32 s70, s70, 8192
    buffer_load_dwordx4 v[40:43], v8, s[16:19], s70 offen sc1
    s_add_u32 s70, s70, 8192
    buffer_load_dwordx4 v[44:47], v8, s[16:19], s70 offen sc1
    s_add_u32 s70, s70, 8192
    s_add_u32 s14, s14, 1
    s_waitcnt vmcnt(0)
    v_max_u32 v144, v16, v17
    v_max3_u32 v144, v144, v18, v19
    v_max3_u32 v144, v144, v20, v21
    v_max3_u32 v144, v144, v22, v23
    v_max3_u32 v144, v144, v24, v25
    v_max3_u32 v144, v144, v26, v27
    v_max3_u32 v144, v144, v28, v29
    v_max3_u32 v144, v144, v30, v31
    v_max3_u32 v144, v144, v32, v33
    v_max3_u32 v144, v144, v34, v35
    v_max3_u32 v144, v144, v36, v37
    v_max3_u32 v144, v144, v38, v39
    v_max3_u32 v144, v144, v40, v41
    v_max3_u32 v144, v144, v42, v43
    v_max3_u32 v144, v144, v44, v45
    v_max3_u32 v144, v144, v46, v47
    v_cmp_eq_u32 vcc, -1, v144
    s_cmp_ge_u32 s14, 0x40000
    s_cbranch_scc1 mg_kpd_r0
    s_cbranch_vccnz mg_kpl_r0
mg_kpd_r0:
    v_mfma_f32_16x16x32_bf16 v[144:147], v[148:151], v[16:19], 0
    v_mfma_f32_16x16x32_bf16 v[144:147], v[148:151], v[20:23], v[144:147]
    v_mfma_f32_16x16x32_bf16 v[144:147], v[148:151], v[24:27], v[144:147]
    v_mfma_f32_16x16x32_bf16 v[144:147], v[148:151], v[28:31], v[144:147]
    v_mfma_f32_16x16x32_bf16 v[144:147], v[148:151], v[32:35], v[144:147]
    v_mfma_f32_16x16x32_bf16 v[144:147], v[148:151], v[36:39], v[144:147]
    v_mfma_f32_16x16x32_bf16 v[144:147], v[148:151], v[40:43], v[144:147]
    v_mfma_f32_16x16x32_bf16 v[144:147], v[148:151], v[44:47], v[144:147]
    s_nop 7
    s_nop 3
    s_branch mg_kpr_r0
mg_c2sub:
    s_bitset0_b32 s11, s3
    s_cmp_eq_u32 s3, 7
    s_cbranch_scc1 mg_c2s
    s_cmp_eq_u32 s11, 0
    s_cbranch_scc1 mg_c2chk
    buffer_load_dword v15, off, s[20:23], 0 offset:64 sc1
    s_setpc_b64 s[4:5]
mg_c2chk:
    s_mov_b32 s6, 25
    s_waitcnt vmcnt(8)
mg_c2q:
    s_mov_b32 s8, 0
mg_c2l:
    v_readfirstlane_b32 s3, v15
    s_add_u32 s8, s8, 1
    s_bitcmp1_b32 s3, s6
    s_cbranch_scc1 mg_c2ok
    s_sleep 16
    buffer_load_dword v15, off, s[20:23], 0 offset:64 sc1
    s_cmp_ge_u32 s8, 0x40000
    s_waitcnt vmcnt(0)
    s_cbranch_scc0 mg_c2l
mg_c2ok:
    s_setpc_b64 s[4:5]
mg_c2s:
    v_mov_b32 v15, 0x10000
    s_mov_b64 exec, 1
    buffer_atomic_add v15, off, s[20:23], 0 offset:64 sc1
    s_mov_b64 exec, -1
    s_setpc_b64 s[4:5]
mg_decN:
    s_mov_b32 s13, 0x44800000
    v_cmp_nge_f32 vcc, 0x44800000, v184
    v_cmp_nge_f32_e64 s[4:5], s13, v188
    s_nop 1
    s_or_b64 vcc, vcc, s[4:5]
    v_frexp_exp_i32_f32 v11, v184
    v_add_u32 v11, 96, v11
    v_max_i32 v11, 0, v11
    v_cvt_f32_i32 v13, v11
    v_sub_u32 v8, 0, v11
    v_frexp_exp_i32_f32 v12, v188
    v_add_u32 v12, 96, v12
    v_max_i32 v12, 0, v12
    v_cvt_f32_i32 v14, v12
    v_sub_u32 v9, 0, v12
    s_cbranch_scc1 mg_poiN
    v_sub_f32 v176, v176, v13
    v_sub_f32 v177, v177, v13
    v_sub_f32 v178, v178, v13
    v_sub_f32 v179, v179, v13
    v_sub_f32 v180, v180, v14
    v_sub_f32 v181, v181, v14
    v_sub_f32 v182, v182, v14
    v_sub_f32 v183, v183, v14
    s_mov_b64 vcc, -1
    s_branch mg_P1N
mg_poiN:
    s_mov_b32 s54, 1
    s_mov_b32 s55, 0x7fc00000
    s_mov_b64 vcc, 0
    s_branch mg_P1N
mg_ck_9:
    s_call_b64 s[4:5], mg_c2sub
    s_branch mg_ck_9r
mg_ck_10:
    s_call_b64 s[4:5], mg_c2sub
    s_branch mg_ck_10r
mg_decL:
    s_mov_b32 s13, 0x44800000
    v_cmp_nge_f32 vcc, 0x44800000, v184
    v_cmp_nge_f32_e64 s[4:5], s13, v188
    s_nop 1
    s_or_b64 vcc, vcc, s[4:5]
    v_frexp_exp_i32_f32 v11, v184
    v_add_u32 v11, 96, v11
    v_max_i32 v11, 0, v11
    v_cvt_f32_i32 v13, v11
    v_sub_u32 v8, 0, v11
    v_frexp_exp_i32_f32 v12, v188
    v_add_u32 v12, 96, v12
    v_max_i32 v12, 0, v12
    v_cvt_f32_i32 v14, v12
    v_sub_u32 v9, 0, v12
    s_cbranch_scc1 mg_poiL
    v_sub_f32 v176, v176, v13
    v_sub_f32 v177, v177, v13
    v_sub_f32 v178, v178, v13
    v_sub_f32 v179, v179, v13
    v_sub_f32 v180, v180, v14
    v_sub_f32 v181, v181, v14
    v_sub_f32 v182, v182, v14
    v_sub_f32 v183, v183, v14
    s_mov_b64 vcc, -1
    s_branch mg_P1L
mg_poiL:
    s_mov_b32 s54, 1
    s_mov_b32 s55, 0x7fc00000
    s_mov_b64 vcc, 0
    s_branch mg_P1L
mg_ck_11:
    s_call_b64 s[4:5], mg_c2sub
    s_branch mg_ck_11r
mg_ck_12:
    s_call_b64 s[4:5], mg_c2sub
    s_branch mg_ck_12r
mg_ck_13:
    s_call_b64 s[4:5], mg_c2sub
    s_branch mg_ck_13r
mg_ck_14:
    s_call_b64 s[4:5], mg_c2sub
    s_branch mg_ck_14r
mg_store3:
    s_mov_b32 s31, 3
    s_mov_b32 s30, 1
    s_branch mg_store2
mg_store1:
    s_cmp_eq_u32 s31, 0
    s_cbranch_scc1 mg_store2
    s_waitcnt vmcnt(16)
    v_cmp_ne_u32 vcc, 1, v176
    s_nop 1
    s_and_b32 s13, vcc_lo, 3
    s_cbranch_scc1 mg_store2
    s_mov_b32 s31, 2
    s_branch mg_storeq
mg_ck_15:
    s_call_b64 s[4:5], mg_c2sub
    s_branch mg_ck_15r
mg_iter:
    s_waitcnt vmcnt(16)
mg_itn:
    s_barrier
    s_bfe_u32 s3, s52, 0x5000e
    s_bitcmp1_b32 s11, s3
    s_cbranch_scc1 mg_ck_15
mg_ck_15r:
    s_mov_b32 m0, s50
    s_add_u32 s50, s50, 16384
    buffer_load_dwordx4 v1, s[16:19], s52 offen offset:0 sc1 lds
    buffer_load_dwordx4 v1, s[16:19], s52 offen offset:1024 sc1 lds
    buffer_load_dwordx4 v1, s[16:19], s52 offen offset:2048 sc1 lds
    buffer_load_dwordx4 v1, s[16:19], s52 offen offset:3072 sc1 lds
    s_and_b32 s50, s50, 65535
    s_add_u32 s52, s52, 16384
    s_cmp_eq_u32 s52, s65
    s_cselect_b32 s52, s63, s52
    s_mov_b32 m0, s51
    s_add_u32 s51, s51, 16384
    buffer_load_dwordx4 v1, s[16:19], s53 offen offset:0 sc1 lds
    buffer_load_dwordx4 v1, s[16:19], s53 offen offset:1024 sc1 lds
    buffer_load_dwordx4 v1, s[16:19], s53 offen offset:2048 sc1 lds
    buffer_load_dwordx4 v1, s[16:19], s53 offen offset:3072 sc1 lds
    s_sub_u32 s14, s51, 81920
    s_cmp_ge_u32 s51, 147456
    s_cselect_b32 s51, s14, s51
    s_add_u32 s53, s53, 16384
    s_cmp_eq_u32 s53, s66
    s_cselect_b32 s53, s64, s53
    s_add_u32 s47, s47, 1
    s_setpc_b64 s[28:29]
mg_fwa:
    s_mov_b32 s14, 0
mg_fla:
    s_mov_b64 exec, 3
    buffer_load_dword v176, v1, s[16:19], s68 offen sc1
    s_mov_b64 exec, -1
    s_add_u32 s14, s14, 1
    s_cmp_ge_u32 s14, 0x100000
    s_waitcnt vmcnt(0)
    s_cbranch_scc1 mg_fra
    v_cmp_ne_u32 vcc, 1, v176
    s_nop 1
    s_and_b32 s13, vcc_lo, 3
    s_cbranch_scc1 mg_fla
    s_branch mg_fra
mg_cx:
    s_cmp_eq_u32 s15, 0
    s_cbranch_scc1 mg_lw
    s_cmp_lg_u32 s7, 0
    s_cbranch_scc1 mg_ch
    s_and_b32 s13, s12, 3
    s_lshl_b32 s13, s13, 12
    s_add_u32 m0, s13, 147456
    s_add_u32 s13, s64, 49152
    buffer_load_dwordx4 v1, s[16:19], s13 offen offset:0 sc1 lds
    buffer_load_dwordx4 v1, s[16:19], s13 offen offset:1024 sc1 lds
    buffer_load_dwordx4 v1, s[16:19], s13 offen offset:2048 sc1 lds
    buffer_load_dwordx4 v1, s[16:19], s13 offen offset:3072 sc1 lds
    buffer_load_dwordx4 v[192:195], v1, s[16:19], s62 offen offset:0 sc1
    buffer_load_dwordx4 v[196:199], v1, s[16:19], s62 offen offset:1024 sc1
    buffer_load_dwordx4 v[200:203], v1, s[16:19], s62 offen offset:2048 sc1
    buffer_load_dwordx4 v[204:207], v1, s[16:19], s62 offen offset:3072 sc1
    s_add_u32 s62, s62, 16384
    buffer_load_dwordx4 v[208:211], v1, s[16:19], s62 offen offset:0 sc1
    buffer_load_dwordx4 v[212:215], v1, s[16:19], s62 offen offset:1024 sc1
    buffer_load_dwordx4 v[216:219], v1, s[16:19], s62 offen offset:2048 sc1
    buffer_load_dwordx4 v[220:223], v1, s[16:19], s62 offen offset:3072 sc1
    s_add_u32 s62, s62, 16384
    buffer_load_dwordx4 v[224:227], v1, s[16:19], s62 offen offset:0 sc1
    buffer_load_dwordx4 v[228:231], v1, s[16:19], s62 offen offset:1024 sc1
    buffer_load_dwordx4 v[232:235], v1, s[16:19], s62 offen offset:2048 sc1
    buffer_load_dwordx4 v[236:239], v1, s[16:19], s62 offen offset:3072 sc1
    s_add_u32 s62, s62, 16384
    buffer_load_dwordx4 v[240:243], v1, s[16:19], s62 offen offset:0 sc1
    buffer_load_dwordx4 v[244:247], v1, s[16:19], s62 offen offset:1024 sc1
    buffer_load_dwordx4 v[248:251], v1, s[16:19], s62 offen offset:2048 sc1
    buffer_load_dwordx4 v[252:255], v1, s[16:19], s62 offen offset:3072 sc1
    s_add_u32 s62, s62, 16384
    s_call_b64 s[28:29], mg_itn
    s_waitcnt vmcnt(28)
    v_mov_b32 v11, 1
    s_mov_b64 exec, 1
    buffer_store_dword v11, off, s[16:19], s9 sc1
    s_mov_b64 exec, -1
    buffer_load_dwordx4 v[16:19], v1, s[16:19], s62 offen offset:0 sc1
    buffer_load_dwordx4 v[20:23], v1, s[16:19], s62 offen offset:1024 sc1
    buffer_load_dwordx4 v[24:27], v1, s[16:19], s62 offen offset:2048 sc1
    buffer_load_dwordx4 v[28:31], v1, s[16:19], s62 offen offset:3072 sc1
    s_add_u32 s62, s62, 16384
    buffer_load_dwordx4 v[32:35], v1, s[16:19], s62 offen offset:0 sc1
    buffer_load_dwordx4 v[36:39], v1, s[16:19], s62 offen offset:1024 sc1
    buffer_load_dwordx4 v[40:43], v1, s[16:19], s62 offen offset:2048 sc1
    buffer_load_dwordx4 v[44:47], v1, s[16:19], s62 offen offset:3072 sc1
    s_add_u32 s62, s62, 16384
    buffer_load_dwordx4 v[48:51], v1, s[16:19], s62 offen offset:0 sc1
    buffer_load_dwordx4 v[52:55], v1, s[16:19], s62 offen offset:1024 sc1
    buffer_load_dwordx4 v[56:59], v1, s[16:19], s62 offen offset:2048 sc1
    buffer_load_dwordx4 v[60:63], v1, s[16:19], s62 offen offset:3072 sc1
    s_add_u32 s62, s62, 16384
    buffer_load_dwordx4 v[64:67], v1, s[16:19], s62 offen offset:0 sc1
    buffer_load_dwordx4 v[68:71], v1, s[16:19], s62 offen offset:1024 sc1
    buffer_load_dwordx4 v[72:75], v1, s[16:19], s62 offen offset:2048 sc1
    buffer_load_dwordx4 v[76:79], v1, s[16:19], s62 offen offset:3072 sc1
    s_add_u32 s62, s62, 16384
    s_cmp_ge_u32 s47, s45
    s_cbranch_scc1 mg_cy
    s_call_b64 s[28:29], mg_itn
mg_cy:
    s_cmp_eq_u32 s12, 4
    s_cselect_b64 exec, -1, 0
    buffer_load_dword v15, off, s[20:23], 0 offset:64 sc1
    s_mov_b64 exec, -1
    s_cmp_eq_u32 s31, 2
    s_cbranch_scc0 mg_eb
    s_waitcnt vmcnt(0)
    s_branch mg_p3
mg_lw:
    s_cmp_eq_u32 s31, 3
    s_cbranch_scc1 mg_lw3
    s_waitcnt vmcnt(0)
    v_mov_b32 v11, 1
    s_mov_b64 exec, 1
    buffer_store_dword v11, off, s[16:19], s9 sc1
    s_mov_b64 exec, -1
    s_branch mg_p3
mg_lw3:
    s_mov_b64 exec, 3
    buffer_load_dword v176, v1, s[16:19], s68 offen sc1
    s_mov_b64 exec, -1
    s_waitcnt vmcnt(1)
    v_mov_b32 v11, 1
    s_mov_b64 exec, 1
    buffer_store_dword v11, off, s[16:19], s9 sc1
    s_mov_b64 exec, -1
    s_waitcnt vmcnt(1)
    v_cmp_ne_u32 vcc, 1, v176
    s_nop 1
    s_and_b32 s13, vcc_lo, 3
    s_cbranch_scc1 mg_fwa
mg_fra:
    s_xor_b32 s69, s67, 131072
    buffer_load_dwordx4 v[144:147], v1, s[16:19], s69 offen offset:0 sc1
    buffer_load_dwordx4 v[148:151], v1, s[16:19], s69 offen offset:1024 sc1
    buffer_load_dwordx4 v[152:155], v1, s[16:19], s69 offen offset:2048 sc1
    buffer_load_dwordx4 v[156:159], v1, s[16:19], s69 offen offset:3072 sc1
    s_xor_b32 s69, s67, 135168
    buffer_load_dwordx4 v[160:163], v1, s[16:19], s69 offen offset:0 sc1
    buffer_load_dwordx4 v[164:167], v1, s[16:19], s69 offen offset:1024 sc1
    buffer_load_dwordx4 v[168:171], v1, s[16:19], s69 offen offset:2048 sc1
    buffer_load_dwordx4 v[172:175], v1, s[16:19], s69 offen offset:3072 sc1
    s_xor_b32 s69, s67, 0
    buffer_load_dwordx4 v[176:179], v1, s[16:19], s69 offen offset:0 sc1
    buffer_load_dwordx4 v[180:183], v1, s[16:19], s69 offen offset:1024 sc1
    buffer_load_dwordx4 v[184:187], v1, s[16:19], s69 offen offset:2048 sc1
    buffer_load_dwordx4 v[188:191], v1, s[16:19], s69 offen offset:3072 sc1
    s_waitcnt vmcnt(0)
    s_branch mg_p3
mg_ldP0:
    s_cmp_eq_u32 s7, 0
    s_cbranch_scc1 mg_ldP
mg_ch:
    s_call_b64 s[28:29], mg_iter
    s_and_b32 s10, s12, 3
    s_lshl_b32 s7, s2, 2
    s_add_u32 s7, s7, s10
    s_and_b32 s7, s7, 127
    s_lshl_b32 s10, s10, 12
    s_add_u32 s10, s10, 147456
    v_lshrrev_b32 v196, 4, v0
    v_lshlrev_b32 v196, 1, v196
    v_and_b32 v197, 7, v0
    v_xor_b32 v196, v196, v197
    v_lshrrev_b32 v197, 3, v0
    v_mul_u32_u24 v192, 1280, v197
    v_lshl_add_u32 v192, v196, 4, v192
    s_cmp_lt_u32 s2, 64
    s_cbranch_scc0 mg_cha
    v_add_u32 v193, 9216, v192
    v_add_u32 v194, 18432, v192
    v_add_u32 v195, 27648, v192
    s_cmp_lt_u32 s2, 32
    s_cselect_b32 s49, 0, 24
    s_cselect_b32 s59, 6, 4
    s_mul_i32 s48, s7, 40960
mg_chb:
    s_lshl_b32 s13, s49, 5
    s_add_u32 s48, s48, s13
    s_mov_b32 m0, s10
    s_sub_u32 s59, s59, 1
    buffer_load_dwordx4 v192, s[40:43], s48 offen offset:0 lds
    buffer_load_dwordx4 v193, s[40:43], s48 offen offset:1024 lds
    buffer_load_dwordx4 v194, s[40:43], s48 offen offset:2048 lds
    buffer_load_dwordx4 v195, s[40:43], s48 offen offset:3072 lds
    v_lshrrev_b32 v196, 2, v0
    v_lshlrev_b32 v196, 7, v196
    v_bfe_u32 v197, v0, 3, 2
    v_lshl_add_u32 v196, v197, 5, v196
    v_and_b32 v197, 3, v0
    v_lshl_add_u32 v196, v197, 3, v196
    v_add_u32 v196, s10, v196
    v_xor_b32 v197, 32, v196
    v_xor_b32 v198, 64, v196
    v_xor_b32 v199, 96, v196
    s_waitcnt vmcnt(20)
    s_call_b64 s[28:29], mg_itn
    v_mul_u32_u24 v206, 52, v0
    v_lshrrev_b32 v206, 8, v206
    s_cmp_lt_u32 s2, 64
    s_cbranch_scc0 mg_chc
    s_lshr_b32 s14, s7, 5
    s_mul_i32 s14, s14, 160
    s_bfe_u32 s13, s7, 0x20003
    s_lshl_b32 s13, s13, 2
    s_add_u32 s14, s14, s13
    s_add_u32 s14, s14, 49152
    s_and_b32 s13, s7, 7
    s_mul_i32 s13, s13, 5
    v_mul_u32_u24 v204, 5, v206
    v_sub_u32 v204, v0, v204
    v_add_u32 v204, s13, v204
    v_lshrrev_b32 v205, 2, v204
    v_mul_u32_u24 v205, 12, v205
    v_mul_u32_u24 v206, 640, v206
    v_add3_u32 v200, v204, v205, v206
    v_mov_b32 v201, 0x10000
mg_chd:
    v_add_lshl_u32 v200, v200, s14, 10
    v_mov_b32 v202, 1
    s_cmp_eq_u32 s54, 0
    s_cselect_b64 exec, 1, 0
    s_waitcnt vmcnt(8)
    buffer_store_dword v202, off, s[16:19], s9 sc1
    s_mov_b64 exec, -1
mg_chl:
    ds_read_b64_tr_b16 v[204:205], v196 offset:0
    ds_read_b64_tr_b16 v[206:207], v196 offset:2048
    ds_read_b64_tr_b16 v[208:209], v197 offset:0
    ds_read_b64_tr_b16 v[210:211], v197 offset:2048
    ds_read_b64_tr_b16 v[212:213], v198 offset:0
    ds_read_b64_tr_b16 v[214:215], v198 offset:2048
    ds_read_b64_tr_b16 v[216:217], v199 offset:0
    ds_read_b64_tr_b16 v[218:219], v199 offset:2048
    v_readlane_b32 s55, v200, s49
    s_add_u32 s49, s49, 1
    v_readlane_b32 s56, v200, s49
    s_add_u32 s49, s49, 1
    v_readlane_b32 s57, v200, s49
    s_add_u32 s49, s49, 1
    v_readlane_b32 s58, v200, s49
    s_add_u32 s49, s49, 1
    s_add_u32 s48, s48, 128
    s_cmp_eq_u32 s59, 0
    s_cselect_b32 s48, 2147418112, s48
    s_waitcnt lgkmcnt(0)
    s_mov_b32 m0, s10
    s_sub_u32 s59, s59, 1
    buffer_load_dwordx4 v192, s[40:43], s48 offen offset:0 lds
    buffer_load_dwordx4 v193, s[40:43], s48 offen offset:1024 lds
    buffer_load_dwordx4 v194, s[40:43], s48 offen offset:2048 lds
    buffer_load_dwordx4 v195, s[40:43], s48 offen offset:3072 lds
    buffer_store_dwordx4 v[204:207], v1, s[16:19], s55 offen sc1
    buffer_store_dwordx4 v[208:211], v1, s[16:19], s56 offen sc1
    buffer_store_dwordx4 v[212:215], v1, s[16:19], s57 offen sc1
    buffer_store_dwordx4 v[216:219], v1, s[16:19], s58 offen sc1
    s_call_b64 s[28:29], mg_itn
    s_cmp_lt_i32 s59, 0
    s_waitcnt vmcnt(12)
    s_cbranch_scc0 mg_chl
    s_call_b64 s[28:29], mg_itn
    s_waitcnt vmcnt(16)
    s_mov_b64 exec, 1
    buffer_atomic_add v201, off, s[20:23], 0 offset:64 sc1
    s_mov_b64 exec, -1
    s_mov_b32 s7, 0
    s_cmp_lg_u32 s54, 0
    s_cbranch_scc1 mg_ldP
    s_branch mg_cpl
mg_cha:
    v_lshrrev_b32 v197, 5, v0
    v_mul_u32_u24 v197, 5120, v197
    v_add_u32 v192, v192, v197
    v_add_u32 v193, 19456, v192
    v_add_u32 v194, 3072, v192
    v_add_u32 v195, 22528, v192
    s_mul_i32 s13, s7, 205
    s_lshr_b32 s13, s13, 10
    s_mul_i32 s48, s13, 40960
    s_mul_i32 s13, s13, 5
    s_sub_u32 s49, s7, s13
    s_lshl_b32 s49, s49, 3
    s_mov_b32 s59, 2
    s_cmp_lt_u32 s7, 100
    s_cselect_b32 s7, s13, 131072
    s_branch mg_chb
mg_chc:
    s_lshl_b32 s14, s7, 3
    s_add_u32 s14, s14, 55296
    v_mov_b32 v200, v0
    v_mov_b32 v201, 1
    s_branch mg_chd
mg_fwb:
    s_mov_b32 s14, 0
mg_flb:
    s_mov_b64 exec, 3
    buffer_load_dword v176, v1, s[16:19], s68 offen sc1
    s_mov_b64 exec, -1
    s_add_u32 s14, s14, 1
    s_cmp_ge_u32 s14, 0x100000
    s_waitcnt vmcnt(0)
    s_cbranch_scc1 mg_frb
    v_cmp_ne_u32 vcc, 1, v176
    s_nop 1
    s_and_b32 s13, vcc_lo, 3
    s_cbranch_scc1 mg_flb
    s_branch mg_frb
mg_ack:
    s_mov_b32 s6, 7
    s_call_b64 s[4:5], mg_c2q
    s_branch mg_acr
mg_fwc_16:
    s_mov_b32 s14, 0
mg_flc_16:
    s_mov_b64 exec, 3
    buffer_load_dword v0, v1, s[16:19], s68 offen sc1
    s_mov_b64 exec, -1
    s_add_u32 s14, s14, 1
    s_cmp_ge_u32 s14, 0x100000
    s_waitcnt vmcnt(0)
    s_cbranch_scc1 mg_frc_16
    v_cmp_ne_u32 vcc, 1, v0
    s_nop 1
    s_and_b32 s13, vcc_lo, 3
    s_cbranch_scc1 mg_flc_16
    s_branch mg_frc_16
mg_fwc_17:
    s_mov_b32 s14, 0
mg_flc_17:
    s_mov_b64 exec, 3
    buffer_load_dword v0, v1, s[16:19], s68 offen sc1
    s_mov_b64 exec, -1
    s_add_u32 s14, s14, 1
    s_cmp_ge_u32 s14, 0x100000
    s_waitcnt vmcnt(0)
    s_cbranch_scc1 mg_frc_17
    v_cmp_ne_u32 vcc, 1, v0
    s_nop 1
    s_and_b32 s13, vcc_lo, 3
    s_cbranch_scc1 mg_flc_17
    s_branch mg_frc_17
mg_fwc_18:
    s_mov_b32 s14, 0
mg_flc_18:
    s_mov_b64 exec, 3
    buffer_load_dword v0, v1, s[16:19], s68 offen sc1
    s_mov_b64 exec, -1
    s_add_u32 s14, s14, 1
    s_cmp_ge_u32 s14, 0x100000
    s_waitcnt vmcnt(0)
    s_cbranch_scc1 mg_frc_18
    v_cmp_ne_u32 vcc, 1, v0
    s_nop 1
    s_and_b32 s13, vcc_lo, 3
    s_cbranch_scc1 mg_flc_18
    s_branch mg_frc_18
mg_fwc_19:
    s_mov_b32 s14, 0
mg_flc_19:
    s_mov_b64 exec, 3
    buffer_load_dword v0, v1, s[16:19], s68 offen sc1
    s_mov_b64 exec, -1
    s_add_u32 s14, s14, 1
    s_cmp_ge_u32 s14, 0x100000
    s_waitcnt vmcnt(0)
    s_cbranch_scc1 mg_frc_19
    v_cmp_ne_u32 vcc, 1, v0
    s_nop 1
    s_and_b32 s13, vcc_lo, 3
    s_cbranch_scc1 mg_flc_19
    s_branch mg_frc_19
mg_xwx_20:
    s_mov_b32 s51, 0
mg_xlx_20:
    buffer_load_dwordx4 v[12:15], v5, s[16:19], s47 offen sc1
    s_add_u32 s51, s51, 1
    s_cmp_ge_u32 s51, 0x100000
    s_waitcnt vmcnt(0)
    v_max3_u32 v8, v12, v13, v14
    v_max_u32 v8, v8, v15
    v_cmp_eq_u32 vcc, -1, v8
    s_cbranch_scc1 mg_xrx_20
    s_cbranch_vccnz mg_xlx_20
    s_branch mg_xrx_20
mg_xwx_21:
    s_mov_b32 s51, 0
mg_xlx_21:
    buffer_load_dwordx4 v[12:15], v5, s[16:19], s47 offen sc1
    s_add_u32 s51, s51, 1
    s_cmp_ge_u32 s51, 0x100000
    s_waitcnt vmcnt(0)
    v_max3_u32 v8, v12, v13, v14
    v_max_u32 v8, v8, v15
    v_cmp_eq_u32 vcc, -1, v8
    s_cbranch_scc1 mg_xrx_21
    s_cbranch_vccnz mg_xlx_21
    s_branch mg_xrx_21
mg_xwx_22:
    s_mov_b32 s51, 0
mg_xlx_22:
    buffer_load_dwordx4 v[12:15], v5, s[16:19], s47 offen sc1
    s_add_u32 s51, s51, 1
    s_cmp_ge_u32 s51, 0x100000
    s_waitcnt vmcnt(0)
    v_max3_u32 v8, v12, v13, v14
    v_max_u32 v8, v8, v15
    v_cmp_eq_u32 vcc, -1, v8
    s_cbranch_scc1 mg_xrx_22
    s_cbranch_vccnz mg_xlx_22
    s_branch mg_xrx_22
mg_xwx_23:
    s_mov_b32 s51, 0
mg_xlx_23:
    buffer_load_dwordx4 v[252:255], v5, s[16:19], s64 offen sc1
    s_add_u32 s51, s51, 1
    s_cmp_ge_u32 s51, 0x100000
    s_waitcnt vmcnt(0)
    v_max3_u32 v8, v252, v253, v254
    v_max_u32 v8, v8, v255
    v_cmp_eq_u32 vcc, -1, v8
    s_cbranch_scc1 mg_xrx_23
    s_cbranch_vccnz mg_xlx_23
    s_branch mg_xrx_23
mg_one:
    s_nop 15
    v_mfma_f32_16x16x32_bf16 v[112:115], v[132:135], v[160:163], 0
    buffer_load_dwordx4 v[156:159], v1, s[16:19], s49 offen offset:3072 sc1
    s_add_u32 s49, s49, 4096
    ds_write_b128 v3, v[84:87] offset:41984
    ds_read_b128 v[204:207], v2 offset:6144
    ds_write_b128 v3, v[88:91] offset:43008
    s_waitcnt lgkmcnt(4)
    v_mfma_f32_16x16x32_bf16 v[112:115], v[192:195], v[164:167], v[112:115]
    ds_read_b128 v[132:135], v2 offset:9216
    ds_write_b128 v3, v[92:95] offset:44032
    s_waitcnt lgkmcnt(3)
    v_mfma_f32_16x16x32_bf16 v[112:115], v[204:207], v[168:171], v[112:115]
    ds_write_b128 v3, v[96:99] offset:45056
    ds_read_b128 v[192:195], v2 offset:12288
    s_waitcnt vmcnt(18) lgkmcnt(3)
    v_mfma_f32_16x16x32_bf16 v[112:115], v[132:135], v[172:175], v[112:115]
    ds_read_b128 v[204:207], v2 offset:15360
    s_waitcnt lgkmcnt(2)
    s_barrier
    s_waitcnt vmcnt(17) lgkmcnt(1)
    v_mfma_f32_16x16x32_bf16 v[112:115], v[192:195], v[176:179], v[112:115]
    ds_read_b128 v[100:103], v4 offset:40960
    ds_read_b128 v[132:135], v2 offset:18432
    ds_read_b128 v[104:107], v4 offset:46080
    ds_read_b128 v[108:111], v4 offset:51200
    s_waitcnt vmcnt(16) lgkmcnt(4)
    v_mfma_f32_16x16x32_bf16 v[112:115], v[204:207], v[180:183], v[112:115]
    ds_read_b128 v[8:11], v4 offset:56320
    ds_read_b128 v[192:195], v2 offset:21504
    s_waitcnt vmcnt(15) lgkmcnt(4)
    v_mfma_f32_16x16x32_bf16 v[112:115], v[132:135], v[184:187], v[112:115]
    ds_read_b128 v[204:207], v2 offset:24576
    s_waitcnt lgkmcnt(4)
    v_add_f32 v100, v100, v104
    v_add_f32 v101, v101, v105
    v_add_f32 v102, v102, v106
    v_add_f32 v103, v103, v107
    ds_read_b128 v[104:107], v4 offset:61440
    s_waitcnt vmcnt(14) lgkmcnt(2)
    v_mfma_f32_16x16x32_bf16 v[112:115], v[192:195], v[188:191], v[112:115]
    v_add_f32 v100, v100, v108
    v_add_f32 v101, v101, v109
    ds_read_b128 v[132:135], v2 offset:27648
    v_add_f32 v102, v102, v110
    v_add_f32 v103, v103, v111
    ds_read_b128 v[108:111], v7 offset:25600
    v_add_f32 v100, v100, v8
    v_add_f32 v101, v101, v9
    s_waitcnt vmcnt(12) lgkmcnt(3)
    v_mfma_f32_16x16x32_bf16 v[112:115], v[204:207], v[220:223], v[112:115]
    v_add_f32 v102, v102, v10
    v_add_f32 v103, v103, v11
    ds_read_b128 v[8:11], v7 offset:30720
    ds_read_b128 v[192:195], v2 offset:30720
    s_waitcnt lgkmcnt(4)
    v_add_f32 v100, v100, v104
    v_add_f32 v101, v101, v105
    v_add_f32 v102, v102, v106
    v_add_f32 v103, v103, v107
    ds_read_b128 v[104:107], v7 offset:35840
    s_waitcnt vmcnt(11) lgkmcnt(4)
    v_mfma_f32_16x16x32_bf16 v[112:115], v[132:135], v[224:227], v[112:115]
    s_waitcnt lgkmcnt(3)
    v_add_f32 v100, v100, v108
    v_add_f32 v101, v101, v109
    ds_read_b128 v[204:207], v2 offset:33792
    v_add_f32 v102, v102, v110
    v_add_f32 v103, v103, v111
    s_waitcnt lgkmcnt(3)
    v_add_f32 v100, v100, v8
    v_add_f32 v101, v101, v9
    s_waitcnt vmcnt(10) lgkmcnt(2)
    v_mfma_f32_16x16x32_bf16 v[112:115], v[192:195], v[228:231], v[112:115]
    v_add_f32 v102, v102, v10
    v_add_f32 v103, v103, v11
    ds_read_b128 v[132:135], v2 offset:36864
    s_waitcnt lgkmcnt(2)
    v_add_f32 v100, v100, v104
    v_add_f32 v101, v101, v105
    s_waitcnt vmcnt(9) lgkmcnt(1)
    v_mfma_f32_16x16x32_bf16 v[112:115], v[204:207], v[232:235], v[112:115]
    v_add_f32 v102, v102, v106
    v_add_f32 v103, v103, v107
    ds_read_b128 v[192:195], v2 offset:39936
    v_max3_u32 v8, v252, v253, v254
    v_max_u32 v8, v8, v255
    v_cmp_eq_u32 vcc, -1, v8
    s_add_u32 s13, s48, 3933440
    s_waitcnt vmcnt(8) lgkmcnt(1)
    v_mfma_f32_16x16x32_bf16 v[112:115], v[132:135], v[236:239], v[112:115]
    s_cbranch_vccnz mg_xwx_23
mg_xrx_23:
    v_add_f32 v100, v100, v252
    v_add_f32 v101, v101, v253
    ds_read_b128 v[204:207], v2 offset:43008
    v_add_f32 v102, v102, v254
    v_add_f32 v103, v103, v255
    v_cvt_pk_bf16_f32 v100, v100, v101
    v_cvt_pk_bf16_f32 v101, v102, v103
    s_waitcnt vmcnt(7) lgkmcnt(1)
    v_mfma_f32_16x16x32_bf16 v[112:115], v[192:195], v[240:243], v[112:115]
    buffer_store_dwordx2 v[100:101], v6, s[24:27], s13 offen
    ds_read_b128 v[132:135], v2 offset:46080
    s_waitcnt vmcnt(7) lgkmcnt(1)
    v_mfma_f32_16x16x32_bf16 v[112:115], v[204:207], v[244:247], v[112:115]
    ds_read_b128 v[192:195], v2 offset:49152
    s_waitcnt vmcnt(6) lgkmcnt(1)
    v_mfma_f32_16x16x32_bf16 v[112:115], v[132:135], v[248:251], v[112:115]
    ds_read_b128 v[204:207], v2 offset:52224
    s_waitcnt vmcnt(5) lgkmcnt(1)
    v_mfma_f32_16x16x32_bf16 v[112:115], v[192:195], v[144:147], v[112:115]
    ds_read_b128 v[132:135], v2 offset:55296
    s_waitcnt vmcnt(4) lgkmcnt(1)
    v_mfma_f32_16x16x32_bf16 v[112:115], v[204:207], v[148:151], v[112:115]
    ds_read_b128 v[192:195], v2 offset:58368
    s_waitcnt vmcnt(3) lgkmcnt(1)
    v_mfma_f32_16x16x32_bf16 v[112:115], v[132:135], v[152:155], v[112:115]
    s_waitcnt vmcnt(1) lgkmcnt(0)
    v_mfma_f32_16x16x32_bf16 v[112:115], v[192:195], v[156:159], v[112:115]
    v_bfe_u32 v8, v1, 4, 4
    v_mul_u32_u24 v8, 2560, v8
    v_lshrrev_b32 v9, 8, v1
    v_lshl_add_u32 v8, v9, 3, v8
    s_add_u32 s13, s50, 40960
    s_bitcmp1_b32 s2, 0
    s_nop 1
    v_cvt_pk_bf16_f32 v112, v112, v113
    v_cvt_pk_bf16_f32 v113, v114, v115
    buffer_store_dwordx2 v[112:113], v8, s[24:27], s50 offen offset:0
    s_branch mg_fin
mg_xwx_24:
    s_mov_b32 s51, 0
mg_xlx_24:
    buffer_load_dwordx4 v[252:255], v5, s[16:19], s64 offen sc1
    s_add_u32 s51, s51, 1
    s_cmp_ge_u32 s51, 0x100000
    s_waitcnt vmcnt(0)
    v_max3_u32 v8, v252, v253, v254
    v_max_u32 v8, v8, v255
    v_cmp_eq_u32 vcc, -1, v8
    s_cbranch_scc1 mg_xrx_24
    s_cbranch_vccnz mg_xlx_24
    s_branch mg_xrx_24
mg_end:
    s_endpgm
mg_codeend:
.section .rodata,"a"
.p2align 6
.amdhsa_kernel mega_kernel
  .amdhsa_next_free_vgpr 256
  .amdhsa_next_free_sgpr 78
  .amdhsa_accum_offset 256
  .amdhsa_group_segment_fixed_size 0
  .amdhsa_kernarg_size 104
  .amdhsa_user_sgpr_count 2
  .amdhsa_user_sgpr_kernarg_segment_ptr 1
  .amdhsa_system_sgpr_workgroup_id_x 1
.end_amdhsa_kernel
```
